```python
import torch

def _softmax(x, axis=-1):
    return torch.softmax(x, dim=axis)
def _gelu(x):
    return torch.nn.functional.gelu(x, approximate="tanh")
def _silu(x):
    return torch.nn.functional.silu(x)
def _sigmoid(x):
    return torch.sigmoid(x)
def _layernorm(x, axis=-1, eps=1e-5):
    m = x.mean(dim=axis, keepdim=True)
    v = x.var(dim=axis, keepdim=True, unbiased=False)
    return (x - m) / torch.sqrt(v + eps)
def _scatter_add(tgt, idx, src, axis=0):
    return tgt.clone().index_add_(axis, idx, src)
def _segment_sum(src, seg, n):
    out = torch.zeros((n,) + src.shape[1:], dtype=src.dtype)
    return out.index_add_(0, seg, src)
def _pad(x, pw):
    flat = tuple(v for pair in reversed(pw) for v in pair)
    return torch.nn.functional.pad(x, flat)

kernel_name = 'sequential_preLN__ssm_conv_h3__glu_gated_swiglu__prompt'

def setup_inputs():

    _w = (lambda a: (lambda t: t.to(torch.bfloat16) if t.is_floating_point() else t)(torch.as_tensor(a)))
    def _A_setup():
        B, S, D = 1, 2048, 576
        ks = 4
        return {
            "q": _w((lambda *s: torch.randn(*s, dtype=torch.bfloat16) * 0.05)(B, S, D)),
            "k": _w((lambda *s: torch.randn(*s, dtype=torch.bfloat16) * 0.2)(B, S, D)),
            "v": _w((lambda *s: torch.randn(*s, dtype=torch.bfloat16) * 0.2)(B, S, D)),
            "shift_k": _w((lambda *s: torch.randn(*s, dtype=torch.bfloat16) * 0.2)(D, ks) * 0.5),
            "ssm_k": _w((lambda *s: torch.randn(*s, dtype=torch.bfloat16) * 0.4)(D, S) * (1.0 / S ** 0.5)),
            "ssm_D": _w((lambda *s: torch.randn(*s, dtype=torch.bfloat16) * 0.2)(D)),
        }
    _A_in = _A_setup()

    def _B_setup():
        B, S, D, F = 1, 2048, 576, 4608
        return {
            "x": _w((lambda *s: torch.randn(*s, dtype=torch.bfloat16) * 0.05)(B, S, D)),
            "w1": _w((lambda *s: torch.randn(*s, dtype=torch.bfloat16) * 0.2)(D, F) * (2.0 / D) ** 0.5),
            "w3": _w((lambda *s: torch.randn(*s, dtype=torch.bfloat16) * 0.2)(D, F) * (2.0 / D) ** 0.5),
            "w2": _w((lambda *s: torch.randn(*s, dtype=torch.bfloat16) * 0.2)(F, D) * (2.0 / F) ** 0.5),
        }
    _B_in = _B_setup()

    return {
        "A_q": _A_in["q"],
        "A_k": _A_in["k"],
        "A_v": _A_in["v"],
        "A_shift_k": _A_in["shift_k"],
        "A_ssm_k": _A_in["ssm_k"],
        "A_ssm_D": _A_in["ssm_D"],
        "B_x": _B_in["x"],
        "B_w1": _B_in["w1"],
        "B_w3": _B_in["w3"],
        "B_w2": _B_in["w2"],
    }

def reference(A_q, A_k, A_v, A_shift_k, A_ssm_k, A_ssm_D, B_x, B_w1, B_w3, B_w2):
    def _A_ref(q, k, v, shift_k, ssm_k, ssm_D):
        B, S, D = q.shape
        ks = shift_k.shape[-1]
        k_pad = _pad(k, ((0, 0), (ks - 1, 0), (0, 0)))
        k_shift = torch.zeros_like(k)
        for t in range(ks):
            k_shift = k_shift + k_pad[:, t:t + S, :] * shift_k[:, ks - 1 - t][None, None, :]
        kv = k_shift * v
        L = 2 * S
        kv_pad = _pad(kv, ((0, 0), (0, S), (0, 0)))
        kf_pad = _pad(ssm_k, ((0, 0), (0, S)))
        kv_f = (lambda x, axes=(-2,-1): torch.fft.rfft2(x.float(), dim=axes))(kv_pad[:, None, :, :], axes=(1, 2))
        kf_f = (lambda x, axes=(-2,-1): torch.fft.rfft2(x.float(), dim=axes))(kf_pad[:, None, :], axes=(1, 2))
        kf_f = (lambda x, *d: x.permute(*d))(kf_f, 1, 2, 0)
        y_f = kv_f * kf_f[None, :, :, :]
        y = (lambda x, s, axes=(-2,-1): torch.fft.irfft2(x, s=s, dim=axes).to(torch.bfloat16))(y_f, (1, L), axes=(1, 2))[:, 0, :S, :]
        y = y + kv * ssm_D[None, None, :]
        return q * y

    def _B_ref(x, w1, w3, w2):
        gate = torch.einsum("bsd,df->bsf", x, w1)
        up = torch.einsum("bsd,df->bsf", x, w3)
        h = _silu(gate) * up
        out = torch.einsum("bsf,fd->bsd", h, w2)
        return out

    x = A_q
    h = x + _A_ref(_layernorm(x, axis=-1), A_k, A_v, A_shift_k, A_ssm_k, A_ssm_D)
    h2 = h + _B_ref(_layernorm(h, axis=-1), B_w1, B_w3, B_w2)
    return h2
```

```asm
; @launch grid=(256,1,1) block=(256,1,1) lds=163840
.amdgcn_target "amdgcn-amd-amdhsa--gfx950"
.text
.globl sequential_preLN__ssm_conv_h3__glu_gated_swiglu__prompt_kernel
.p2align 8
.type sequential_preLN__ssm_conv_h3__glu_gated_swiglu__prompt_kernel,@function
sequential_preLN__ssm_conv_h3__glu_gated_swiglu__prompt_kernel:
s_cmp_ge_u32 s2, 256
s_cbranch_scc1 L3_end
s_load_dwordx4 s[4:7], s[0:1], 0
s_load_dwordx4 s[8:11], s[0:1], 16
s_load_dwordx2 s[12:13], s[0:1], 96
s_load_dwordx2 s[60:61], s[0:1], 32
s_load_dwordx4 s[68:71], s[0:1], 56
s_getpc_b64 s[98:99]
LU_pc0:
s_lshr_b32 s3, s2, 3
s_cmp_ge_u32 s3, 7
s_cbranch_scc1 LU_nopf
s_lshl_b32 s3, s3, 12
v_lshl_add_u32 v1, v0, 4, s3
v_min_u32 v1, L3_codeend-LU_pc0-16, v1
global_load_dwordx4 v[244:247], v1, s[98:99]
LU_nopf:
s_add_u32 s98, s98, LU_arith-LU_pc0
s_addc_u32 s99, s99, 0
s_and_b32 s3, s2, 31
s_lshr_b32 s14, s2, 5
s_mul_i32 s15, s3, 73728
s_lshl_b32 s16, s14, 7
s_add_u32 s15, s15, s16
v_and_b32 v1, 31, v0
v_lshrrev_b32 v2, 5, v0
v_mul_u32_u24 v3, 9216, v2
v_lshl_add_u32 v3, v1, 2, v3
v_add_u32 v3, s15, v3
v_subrev_u32 v4, 3456, v3
v_add_u32 v5, 4608, v3
s_lshl_b32 s17, s14, 9
v_lshl_add_u32 v6, v1, 4, s17
s_waitcnt lgkmcnt(0)
  s_mov_b32 s20, s6
  s_mov_b32 s21, s7
  s_mov_b32 s22, 2359296
  s_mov_b32 s23, 0x20000
  s_mov_b32 s24, s8
  s_mov_b32 s25, s9
  s_mov_b32 s26, 2359296
  s_mov_b32 s27, 0x20000
  s_mov_b32 s28, s4
  s_mov_b32 s29, s5
  s_mov_b32 s30, 2359296
  s_mov_b32 s31, 0x20000
  s_mov_b32 s32, s10
  s_mov_b32 s33, s11
  s_mov_b32 s34, 4608
  s_mov_b32 s35, 0x20000
  buffer_load_dword v16, v4, s[20:23], 0 offen offset:0
  buffer_load_dword v17, v4, s[20:23], 0 offen offset:1152
  buffer_load_dword v18, v4, s[20:23], 0 offen offset:2304
  buffer_load_dword v19, v3, s[20:23], 0 offen offset:0
  buffer_load_dword v20, v3, s[20:23], 0 offen offset:1152
  buffer_load_dword v21, v3, s[20:23], 0 offen offset:2304
  buffer_load_dword v22, v3, s[20:23], 0 offen offset:3456
  buffer_load_dword v23, v5, s[20:23], 0 offen offset:0
  buffer_load_dword v24, v5, s[20:23], 0 offen offset:1152
  buffer_load_dword v25, v5, s[20:23], 0 offen offset:2304
  buffer_load_dword v26, v5, s[20:23], 0 offen offset:3456
  buffer_load_dwordx4 v[44:47], v6, s[32:35], 0 offen
  buffer_load_dword v27, v3, s[24:27], 0 offen offset:0
  buffer_load_dword v28, v3, s[24:27], 0 offen offset:1152
  buffer_load_dword v29, v3, s[24:27], 0 offen offset:2304
  buffer_load_dword v30, v3, s[24:27], 0 offen offset:3456
  buffer_load_dword v31, v5, s[24:27], 0 offen offset:0
  buffer_load_dword v32, v5, s[24:27], 0 offen offset:1152
  buffer_load_dword v33, v5, s[24:27], 0 offen offset:2304
  buffer_load_dword v34, v5, s[24:27], 0 offen offset:3456
  s_lshl_b32 s50, s14, 4
  s_add_u32 s56, s12, 7340032
  s_addc_u32 s57, s13, 0
  s_mov_b32 s58, 294912
  s_mov_b32 s59, 0x20000
  v_cmp_gt_u32 vcc, 16, v0
  v_add_u32 v110, s50, v0
  v_lshlrev_b32 v110, 11, v110
  v_cndmask_b32 v110, 2.0, v110, vcc
  buffer_load_dword v108, v110, s[56:59], 0 offen offset:1024 sc1
  s_add_u32 s52, s12, 7667712
  s_addc_u32 s53, s13, 0
  s_mov_b32 s54, 65536
  s_mov_b32 s55, 0x20000
  s_lshr_b32 s51, s2, 4
  s_mul_i32 s51, s51, 4096
  buffer_load_dword v254, off, s[52:55], s51 offset:3584 sc1
s_cmp_lt_u32 s2, 32
s_cbranch_scc1 LU_double
s_cmp_lt_u32 s2, 96
s_cbranch_scc1 LU_stats
s_cmp_lt_u32 s2, 240
s_cbranch_scc1 LU_conv
  buffer_load_dword v35, v3, s[28:31], 0 offen offset:0
  buffer_load_dword v36, v3, s[28:31], 0 offen offset:1152
  buffer_load_dword v37, v3, s[28:31], 0 offen offset:2304
  buffer_load_dword v38, v3, s[28:31], 0 offen offset:3456
  buffer_load_dword v39, v5, s[28:31], 0 offen offset:0
  buffer_load_dword v40, v5, s[28:31], 0 offen offset:1152
  buffer_load_dword v41, v5, s[28:31], 0 offen offset:2304
  buffer_load_dword v42, v5, s[28:31], 0 offen offset:3456
  s_mov_b32 s36, s12
  s_mov_b32 s37, s13
  s_mov_b32 s38, 2359296
  s_mov_b32 s39, 0x20000
  s_add_u32 s40, s12, 2359296
  s_addc_u32 s41, s13, 0
  s_mov_b32 s42, 2359296
  s_mov_b32 s43, 0x20000
  s_lshl_b32 s18, s14, 18
  s_lshl_b32 s19, s3, 7
  v_and_b32 v13, 7, v1
  v_xor_b32 v14, v13, v2
  v_lshlrev_b32 v11, 8, v1
  v_lshl_add_u32 v11, v14, 4, v11
  v_xor_b32 v10, 0x70, v11
  v_lshrrev_b32 v13, 3, v0
  v_and_b32 v14, 7, v0
  v_bfe_u32 v15, v0, 4, 3
  v_xor_b32 v15, v15, v14
  v_lshlrev_b32 v12, 7, v13
  v_lshl_add_u32 v12, v15, 4, v12
  v_lshlrev_b32 v7, 12, v13
  v_lshl_add_u32 v7, v14, 4, v7
  v_add_u32 v7, s18, v7
  v_add_u32 v9, s19, v7
  s_sub_u32 s19, 3968, s19
  v_add_u32 v8, s19, v7
  s_mov_b32 s44, 131072
  s_mov_b32 s45, 0x05040100
  s_mov_b32 s46, 0x07060302
  s_lshl_b32 s47, s3, 3
  s_mov_b32 s48, 0x200000
  s_mov_b32 s49, 0x220000
  s_waitcnt vmcnt(10)
  s_swappc_b64 s[100:101], s[98:99]
  ds_write_b128 v10, v[112:115] offset:0
  ds_write_b128 v10, v[116:119] offset:128
  s_waitcnt lgkmcnt(0)
  s_barrier
  ds_read_b128 v[96:99], v12 offset:0
  ds_read_b128 v[100:103], v12 offset:4096
  s_waitcnt lgkmcnt(1)
  buffer_store_dwordx4 v[96:99], v8, s[36:39], 0 offen sc1
  s_waitcnt lgkmcnt(0)
  buffer_store_dwordx4 v[100:103], v8, s[36:39], s44 offen sc1
  s_waitcnt vmcnt(8)
  v_perm_b32 v120, v36, v35, s45
  s_waitcnt vmcnt(6)
  v_perm_b32 v121, v38, v37, s45
  s_waitcnt vmcnt(4)
  v_perm_b32 v122, v40, v39, s45
  s_waitcnt vmcnt(2)
  v_perm_b32 v123, v42, v41, s45
  v_perm_b32 v124, v36, v35, s46
  v_perm_b32 v125, v38, v37, s46
  v_perm_b32 v126, v40, v39, s46
  v_perm_b32 v127, v42, v41, s46
  ds_write_b128 v11, v[120:123] offset:8192
  ds_write_b128 v11, v[124:127] offset:8320
  v_add_u32 v108, 1, v108
  v_not_b32 v109, v108
  s_waitcnt vmcnt(0) lgkmcnt(0)
  s_barrier
  buffer_store_dwordx2 v[108:109], v110, s[56:59], s47 offen offset:0 sc1
  ds_read_b128 v[96:99], v12 offset:8192
  ds_read_b128 v[100:103], v12 offset:12288
  s_waitcnt lgkmcnt(1)
  buffer_store_dwordx4 v[96:99], v9, s[40:43], 0 offen sc1
  s_waitcnt lgkmcnt(0)
  buffer_store_dwordx4 v[100:103], v9, s[40:43], s44 offen sc1
  v_mov_b32 v248, v108
  v_mov_b32 v249, v109
  v_mov_b32 v253, v110
  s_mov_b32 s83, s47
  s_waitcnt vmcnt(0) lgkmcnt(0)
  s_barrier
  buffer_store_dwordx2 v[248:249], v253, s[56:59], s83 offen offset:768 sc1
s_sub_u32 s3, s2, 176
s_branch LU_cs
LU_arith:
  v_lshlrev_b32 v48, 16, v44
  v_and_b32 v49, 0xffff0000, v44
  v_lshlrev_b32 v50, 16, v45
  v_and_b32 v51, 0xffff0000, v45
  v_lshlrev_b32 v52, 16, v46
  v_and_b32 v53, 0xffff0000, v46
  v_lshlrev_b32 v54, 16, v47
  v_and_b32 v55, 0xffff0000, v47
  v_lshlrev_b32 v56, 16, v16
  v_and_b32 v67, 0xffff0000, v16
  v_lshlrev_b32 v57, 16, v17
  v_and_b32 v68, 0xffff0000, v17
  v_lshlrev_b32 v58, 16, v18
  v_and_b32 v69, 0xffff0000, v18
  v_lshlrev_b32 v59, 16, v19
  v_and_b32 v70, 0xffff0000, v19
  v_lshlrev_b32 v60, 16, v20
  v_and_b32 v71, 0xffff0000, v20
  v_lshlrev_b32 v61, 16, v21
  v_and_b32 v72, 0xffff0000, v21
  v_lshlrev_b32 v62, 16, v22
  v_and_b32 v73, 0xffff0000, v22
  v_lshlrev_b32 v63, 16, v23
  v_and_b32 v74, 0xffff0000, v23
  v_lshlrev_b32 v64, 16, v24
  v_and_b32 v75, 0xffff0000, v24
  v_lshlrev_b32 v65, 16, v25
  v_and_b32 v76, 0xffff0000, v25
  v_lshlrev_b32 v66, 16, v26
  v_and_b32 v77, 0xffff0000, v26
  v_mul_f32 v80, v51, v56
  v_mul_f32 v81, v51, v57
  v_mul_f32 v82, v51, v58
  v_mul_f32 v83, v51, v59
  v_mul_f32 v84, v51, v60
  v_mul_f32 v85, v51, v61
  v_mul_f32 v86, v51, v62
  v_mul_f32 v87, v51, v63
  v_fmac_f32 v80, v50, v57
  v_fmac_f32 v81, v50, v58
  v_fmac_f32 v82, v50, v59
  v_fmac_f32 v83, v50, v60
  v_fmac_f32 v84, v50, v61
  v_fmac_f32 v85, v50, v62
  v_fmac_f32 v86, v50, v63
  v_fmac_f32 v87, v50, v64
  v_fmac_f32 v80, v49, v58
  v_fmac_f32 v81, v49, v59
  v_fmac_f32 v82, v49, v60
  v_fmac_f32 v83, v49, v61
  v_fmac_f32 v84, v49, v62
  v_fmac_f32 v85, v49, v63
  v_fmac_f32 v86, v49, v64
  v_fmac_f32 v87, v49, v65
  v_fmac_f32 v80, v48, v59
  v_fmac_f32 v81, v48, v60
  v_fmac_f32 v82, v48, v61
  v_fmac_f32 v83, v48, v62
  v_fmac_f32 v84, v48, v63
  v_fmac_f32 v85, v48, v64
  v_fmac_f32 v86, v48, v65
  v_fmac_f32 v87, v48, v66
  v_mul_f32 v88, v55, v67
  v_mul_f32 v89, v55, v68
  v_mul_f32 v90, v55, v69
  v_mul_f32 v91, v55, v70
  v_mul_f32 v92, v55, v71
  v_mul_f32 v93, v55, v72
  v_mul_f32 v94, v55, v73
  v_mul_f32 v95, v55, v74
  v_fmac_f32 v88, v54, v68
  v_fmac_f32 v89, v54, v69
  v_fmac_f32 v90, v54, v70
  v_fmac_f32 v91, v54, v71
  v_fmac_f32 v92, v54, v72
  v_fmac_f32 v93, v54, v73
  v_fmac_f32 v94, v54, v74
  v_fmac_f32 v95, v54, v75
  v_fmac_f32 v88, v53, v69
  v_fmac_f32 v89, v53, v70
  v_fmac_f32 v90, v53, v71
  v_fmac_f32 v91, v53, v72
  v_fmac_f32 v92, v53, v73
  v_fmac_f32 v93, v53, v74
  v_fmac_f32 v94, v53, v75
  v_fmac_f32 v95, v53, v76
  v_fmac_f32 v88, v52, v70
  v_fmac_f32 v89, v52, v71
  v_fmac_f32 v90, v52, v72
  v_fmac_f32 v91, v52, v73
  v_fmac_f32 v92, v52, v74
  v_fmac_f32 v93, v52, v75
  v_fmac_f32 v94, v52, v76
  v_fmac_f32 v95, v52, v77
  v_lshlrev_b32 v56, 16, v27
  v_and_b32 v67, 0xffff0000, v27
  v_lshlrev_b32 v57, 16, v28
  v_and_b32 v68, 0xffff0000, v28
  v_lshlrev_b32 v58, 16, v29
  v_and_b32 v69, 0xffff0000, v29
  v_lshlrev_b32 v59, 16, v30
  v_and_b32 v70, 0xffff0000, v30
  v_lshlrev_b32 v60, 16, v31
  v_and_b32 v71, 0xffff0000, v31
  v_lshlrev_b32 v61, 16, v32
  v_and_b32 v72, 0xffff0000, v32
  v_lshlrev_b32 v62, 16, v33
  v_and_b32 v73, 0xffff0000, v33
  v_lshlrev_b32 v63, 16, v34
  v_and_b32 v74, 0xffff0000, v34
  v_mul_f32 v80, v80, v56
  v_mul_f32 v88, v88, v67
  v_mul_f32 v81, v81, v57
  v_mul_f32 v89, v89, v68
  v_mul_f32 v82, v82, v58
  v_mul_f32 v90, v90, v69
  v_mul_f32 v83, v83, v59
  v_mul_f32 v91, v91, v70
  v_mul_f32 v84, v84, v60
  v_mul_f32 v92, v92, v71
  v_mul_f32 v85, v85, v61
  v_mul_f32 v93, v93, v72
  v_mul_f32 v86, v86, v62
  v_mul_f32 v94, v94, v73
  v_mul_f32 v87, v87, v63
  v_mul_f32 v95, v95, v74
  v_cvt_pk_bf16_f32 v112, v87, v86
  v_cvt_pk_bf16_f32 v113, v85, v84
  v_cvt_pk_bf16_f32 v114, v83, v82
  v_cvt_pk_bf16_f32 v115, v81, v80
  v_cvt_pk_bf16_f32 v116, v95, v94
  v_cvt_pk_bf16_f32 v117, v93, v92
  v_cvt_pk_bf16_f32 v118, v91, v90
  v_cvt_pk_bf16_f32 v119, v89, v88
s_setpc_b64 s[100:101]
LU_double:
  v_add_u32 v163, 1024, v3
  v_add_u32 v164, 1024, v4
  v_add_u32 v165, 1024, v5
  v_add_u32 v166, 4096, v6
  v_cmp_gt_i32 vcc, 0, v4
  s_nop 1
  v_cndmask_b32 v164, v164, v4, vcc
  buffer_load_dword v128, v164, s[20:23], 0 offen offset:0
  buffer_load_dword v129, v164, s[20:23], 0 offen offset:1152
  buffer_load_dword v130, v164, s[20:23], 0 offen offset:2304
  buffer_load_dword v131, v163, s[20:23], 0 offen offset:0
  buffer_load_dword v132, v163, s[20:23], 0 offen offset:1152
  buffer_load_dword v133, v163, s[20:23], 0 offen offset:2304
  buffer_load_dword v134, v163, s[20:23], 0 offen offset:3456
  buffer_load_dword v135, v165, s[20:23], 0 offen offset:0
  buffer_load_dword v136, v165, s[20:23], 0 offen offset:1152
  buffer_load_dword v137, v165, s[20:23], 0 offen offset:2304
  buffer_load_dword v138, v165, s[20:23], 0 offen offset:3456
  buffer_load_dwordx4 v[156:159], v166, s[32:35], 0 offen
  buffer_load_dword v139, v163, s[24:27], 0 offen offset:0
  buffer_load_dword v140, v163, s[24:27], 0 offen offset:1152
  buffer_load_dword v141, v163, s[24:27], 0 offen offset:2304
  buffer_load_dword v142, v163, s[24:27], 0 offen offset:3456
  buffer_load_dword v143, v165, s[24:27], 0 offen offset:0
  buffer_load_dword v144, v165, s[24:27], 0 offen offset:1152
  buffer_load_dword v145, v165, s[24:27], 0 offen offset:2304
  buffer_load_dword v146, v165, s[24:27], 0 offen offset:3456
  s_movk_i32 s50, 128
  v_cmp_gt_u32 vcc, 16, v0
  v_add_u32 v170, s50, v0
  v_lshlrev_b32 v170, 11, v170
  v_cndmask_b32 v170, 2.0, v170, vcc
  buffer_load_dword v168, v170, s[56:59], 0 offen offset:1024 sc1
  buffer_load_dword v35, v3, s[28:31], 0 offen offset:0
  buffer_load_dword v36, v3, s[28:31], 0 offen offset:1152
  buffer_load_dword v37, v3, s[28:31], 0 offen offset:2304
  buffer_load_dword v38, v3, s[28:31], 0 offen offset:3456
  buffer_load_dword v39, v5, s[28:31], 0 offen offset:0
  buffer_load_dword v40, v5, s[28:31], 0 offen offset:1152
  buffer_load_dword v41, v5, s[28:31], 0 offen offset:2304
  buffer_load_dword v42, v5, s[28:31], 0 offen offset:3456
  buffer_load_dword v147, v163, s[28:31], 0 offen offset:0
  buffer_load_dword v148, v163, s[28:31], 0 offen offset:1152
  buffer_load_dword v149, v163, s[28:31], 0 offen offset:2304
  buffer_load_dword v150, v163, s[28:31], 0 offen offset:3456
  buffer_load_dword v151, v165, s[28:31], 0 offen offset:0
  buffer_load_dword v152, v165, s[28:31], 0 offen offset:1152
  buffer_load_dword v153, v165, s[28:31], 0 offen offset:2304
  buffer_load_dword v154, v165, s[28:31], 0 offen offset:3456
  s_mov_b32 s36, s12
  s_mov_b32 s37, s13
  s_mov_b32 s38, 2359296
  s_mov_b32 s39, 0x20000
  s_add_u32 s40, s12, 2359296
  s_addc_u32 s41, s13, 0
  s_mov_b32 s42, 2359296
  s_mov_b32 s43, 0x20000
  s_lshl_b32 s18, s14, 18
  s_lshl_b32 s19, s3, 7
  v_and_b32 v13, 7, v1
  v_xor_b32 v14, v13, v2
  v_lshlrev_b32 v11, 8, v1
  v_lshl_add_u32 v11, v14, 4, v11
  v_xor_b32 v10, 0x70, v11
  v_lshrrev_b32 v13, 3, v0
  v_and_b32 v14, 7, v0
  v_bfe_u32 v15, v0, 4, 3
  v_xor_b32 v15, v15, v14
  v_lshlrev_b32 v12, 7, v13
  v_lshl_add_u32 v12, v15, 4, v12
  v_lshlrev_b32 v7, 12, v13
  v_lshl_add_u32 v7, v14, 4, v7
  v_add_u32 v7, s18, v7
  v_add_u32 v9, s19, v7
  s_sub_u32 s19, 3968, s19
  v_add_u32 v8, s19, v7
  s_mov_b32 s44, 131072
  s_mov_b32 s45, 0x05040100
  s_mov_b32 s46, 0x07060302
  s_lshl_b32 s47, s3, 3
  s_mov_b32 s48, 0x200000
  s_mov_b32 s49, 0x220000
  s_waitcnt vmcnt(39)
  s_swappc_b64 s[100:101], s[98:99]
  ds_write_b128 v10, v[112:115] offset:0
  ds_write_b128 v10, v[116:119] offset:128
  s_waitcnt lgkmcnt(0)
  s_barrier
  ds_read_b128 v[96:99], v12 offset:0
  ds_read_b128 v[100:103], v12 offset:4096
  s_waitcnt lgkmcnt(1)
  buffer_store_dwordx4 v[96:99], v8, s[36:39], 0 offen sc1
  s_waitcnt lgkmcnt(0)
  buffer_store_dwordx4 v[100:103], v8, s[36:39], s44 offen sc1
  s_waitcnt vmcnt(38)
  v_mov_b32 v16, v128
  s_waitcnt vmcnt(37)
  v_mov_b32 v17, v129
  s_waitcnt vmcnt(36)
  v_mov_b32 v18, v130
  s_waitcnt vmcnt(35)
  v_mov_b32 v19, v131
  s_waitcnt vmcnt(34)
  v_mov_b32 v20, v132
  s_waitcnt vmcnt(33)
  v_mov_b32 v21, v133
  s_waitcnt vmcnt(32)
  v_mov_b32 v22, v134
  s_waitcnt vmcnt(31)
  v_mov_b32 v23, v135
  s_waitcnt vmcnt(30)
  v_mov_b32 v24, v136
  s_waitcnt vmcnt(29)
  v_mov_b32 v25, v137
  s_waitcnt vmcnt(28)
  v_mov_b32 v26, v138
  s_waitcnt vmcnt(26)
  v_mov_b32 v27, v139
  s_waitcnt vmcnt(25)
  v_mov_b32 v28, v140
  s_waitcnt vmcnt(24)
  v_mov_b32 v29, v141
  s_waitcnt vmcnt(23)
  v_mov_b32 v30, v142
  s_waitcnt vmcnt(22)
  v_mov_b32 v31, v143
  s_waitcnt vmcnt(21)
  v_mov_b32 v32, v144
  s_waitcnt vmcnt(20)
  v_mov_b32 v33, v145
  s_waitcnt vmcnt(19)
  v_mov_b32 v34, v146
  v_mov_b32 v44, v156
  v_mov_b32 v45, v157
  v_mov_b32 v46, v158
  v_mov_b32 v47, v159
  s_swappc_b64 s[100:101], s[98:99]
  ds_write_b128 v10, v[112:115] offset:16384
  ds_write_b128 v10, v[116:119] offset:16512
  s_waitcnt lgkmcnt(0)
  s_barrier
  ds_read_b128 v[172:175], v12 offset:16384
  ds_read_b128 v[176:179], v12 offset:20480
  s_waitcnt lgkmcnt(1)
  buffer_store_dwordx4 v[172:175], v8, s[36:39], s48 offen sc1
  s_waitcnt lgkmcnt(0)
  buffer_store_dwordx4 v[176:179], v8, s[36:39], s49 offen sc1
  s_waitcnt vmcnt(18)
  v_perm_b32 v120, v36, v35, s45
  s_waitcnt vmcnt(16)
  v_perm_b32 v121, v38, v37, s45
  s_waitcnt vmcnt(14)
  v_perm_b32 v122, v40, v39, s45
  s_waitcnt vmcnt(12)
  v_perm_b32 v123, v42, v41, s45
  v_perm_b32 v124, v36, v35, s46
  v_perm_b32 v125, v38, v37, s46
  v_perm_b32 v126, v40, v39, s46
  v_perm_b32 v127, v42, v41, s46
  ds_write_b128 v11, v[120:123] offset:8192
  ds_write_b128 v11, v[124:127] offset:8320
  s_waitcnt vmcnt(10)
  v_perm_b32 v120, v148, v147, s45
  s_waitcnt vmcnt(8)
  v_perm_b32 v121, v150, v149, s45
  s_waitcnt vmcnt(6)
  v_perm_b32 v122, v152, v151, s45
  s_waitcnt vmcnt(4)
  v_perm_b32 v123, v154, v153, s45
  v_perm_b32 v124, v148, v147, s46
  v_perm_b32 v125, v150, v149, s46
  v_perm_b32 v126, v152, v151, s46
  v_perm_b32 v127, v154, v153, s46
  ds_write_b128 v11, v[120:123] offset:24576
  ds_write_b128 v11, v[124:127] offset:24704
  v_add_u32 v108, 1, v108
  v_not_b32 v109, v108
  v_add_u32 v168, 1, v168
  v_not_b32 v169, v168
  s_waitcnt vmcnt(0) lgkmcnt(0)
  s_barrier
  buffer_store_dwordx2 v[108:109], v110, s[56:59], s47 offen offset:0 sc1
  buffer_store_dwordx2 v[168:169], v170, s[56:59], s47 offen offset:0 sc1
  ds_read_b128 v[96:99], v12 offset:8192
  ds_read_b128 v[100:103], v12 offset:12288
  s_waitcnt lgkmcnt(1)
  buffer_store_dwordx4 v[96:99], v9, s[40:43], 0 offen sc1
  s_waitcnt lgkmcnt(0)
  buffer_store_dwordx4 v[100:103], v9, s[40:43], s44 offen sc1
  ds_read_b128 v[172:175], v12 offset:24576
  ds_read_b128 v[176:179], v12 offset:28672
  s_waitcnt lgkmcnt(1)
  buffer_store_dwordx4 v[172:175], v9, s[40:43], s48 offen sc1
  s_waitcnt lgkmcnt(0)
  buffer_store_dwordx4 v[176:179], v9, s[40:43], s49 offen sc1
  s_waitcnt vmcnt(0) lgkmcnt(0)
  s_barrier
  buffer_store_dwordx2 v[108:109], v110, s[56:59], s47 offen offset:768 sc1
  buffer_store_dwordx2 v[168:169], v170, s[56:59], s47 offen offset:768 sc1
s_add_u32 s3, s2, 32
s_branch LU_cs
LU_stats:
  buffer_load_dword v35, v3, s[28:31], 0 offen offset:0
  buffer_load_dword v36, v3, s[28:31], 0 offen offset:1152
  buffer_load_dword v37, v3, s[28:31], 0 offen offset:2304
  buffer_load_dword v38, v3, s[28:31], 0 offen offset:3456
  buffer_load_dword v39, v5, s[28:31], 0 offen offset:0
  buffer_load_dword v40, v5, s[28:31], 0 offen offset:1152
  buffer_load_dword v41, v5, s[28:31], 0 offen offset:2304
  buffer_load_dword v42, v5, s[28:31], 0 offen offset:3456
  s_mov_b32 s36, s12
  s_mov_b32 s37, s13
  s_mov_b32 s38, 2359296
  s_mov_b32 s39, 0x20000
  s_add_u32 s40, s12, 2359296
  s_addc_u32 s41, s13, 0
  s_mov_b32 s42, 2359296
  s_mov_b32 s43, 0x20000
  s_lshl_b32 s18, s14, 18
  s_lshl_b32 s19, s3, 7
  v_and_b32 v13, 7, v1
  v_xor_b32 v14, v13, v2
  v_lshlrev_b32 v11, 8, v1
  v_lshl_add_u32 v11, v14, 4, v11
  v_xor_b32 v10, 0x70, v11
  v_lshrrev_b32 v13, 3, v0
  v_and_b32 v14, 7, v0
  v_bfe_u32 v15, v0, 4, 3
  v_xor_b32 v15, v15, v14
  v_lshlrev_b32 v12, 7, v13
  v_lshl_add_u32 v12, v15, 4, v12
  v_lshlrev_b32 v7, 12, v13
  v_lshl_add_u32 v7, v14, 4, v7
  v_add_u32 v7, s18, v7
  v_add_u32 v9, s19, v7
  s_sub_u32 s19, 3968, s19
  v_add_u32 v8, s19, v7
  s_mov_b32 s44, 131072
  s_mov_b32 s45, 0x05040100
  s_mov_b32 s46, 0x07060302
  s_lshl_b32 s47, s3, 3
  s_mov_b32 s48, 0x200000
  s_mov_b32 s49, 0x220000
  s_waitcnt vmcnt(10)
  s_swappc_b64 s[100:101], s[98:99]
  ds_write_b128 v10, v[112:115] offset:0
  ds_write_b128 v10, v[116:119] offset:128
  s_waitcnt lgkmcnt(0)
  s_barrier
  ds_read_b128 v[96:99], v12 offset:0
  ds_read_b128 v[100:103], v12 offset:4096
  s_waitcnt lgkmcnt(1)
  buffer_store_dwordx4 v[96:99], v8, s[36:39], 0 offen sc1
  s_waitcnt lgkmcnt(0)
  buffer_store_dwordx4 v[100:103], v8, s[36:39], s44 offen sc1
  s_sub_u32 s16, s2, 32
  s_and_b32 s17, s16, 7
  s_lshr_b32 s18, s16, 4
  s_lshl_b32 s18, s18, 3
  s_add_u32 s52, s17, s18
  s_lshl_b32 s52, s52, 1
  s_bfe_u32 s18, s16, 0x10003
  s_add_u32 s52, s52, s18
  s_lshl_b32 s52, s52, 5
  v_lshrrev_b32 v164, 3, v0
  v_add_u32 v164, s52, v164
  v_and_b32 v165, 7, v0
  v_mul_u32_u24 v166, 1152, v164
  v_lshl_add_u32 v166, v165, 4, v166
  buffer_load_dwordx4 v[128:131], v166, s[28:31], 0 offen offset:0
  buffer_load_dwordx4 v[132:135], v166, s[28:31], 0 offen offset:128
  buffer_load_dwordx4 v[136:139], v166, s[28:31], 0 offen offset:256
  buffer_load_dwordx4 v[140:143], v166, s[28:31], 0 offen offset:384
  buffer_load_dwordx4 v[144:147], v166, s[28:31], 0 offen offset:512
  buffer_load_dwordx4 v[148:151], v166, s[28:31], 0 offen offset:640
  buffer_load_dwordx4 v[152:155], v166, s[28:31], 0 offen offset:768
  buffer_load_dwordx4 v[156:159], v166, s[28:31], 0 offen offset:896
  buffer_load_dwordx4 v[160:163], v166, s[28:31], 0 offen offset:1024
  s_movk_i32 s52, 144
  v_cmp_gt_u32 vcc, s52, v0
  v_add_u32 v170, 0, v0
  v_lshlrev_b32 v170, 11, v170
  v_cndmask_b32 v170, 2.0, v170, vcc
  buffer_load_dword v168, v170, s[56:59], 0 offen offset:1024 sc1
  s_waitcnt vmcnt(18)
  v_perm_b32 v120, v36, v35, s45
  s_waitcnt vmcnt(16)
  v_perm_b32 v121, v38, v37, s45
  s_waitcnt vmcnt(14)
  v_perm_b32 v122, v40, v39, s45
  s_waitcnt vmcnt(12)
  v_perm_b32 v123, v42, v41, s45
  v_perm_b32 v124, v36, v35, s46
  v_perm_b32 v125, v38, v37, s46
  v_perm_b32 v126, v40, v39, s46
  v_perm_b32 v127, v42, v41, s46
  ds_write_b128 v11, v[120:123] offset:8192
  ds_write_b128 v11, v[124:127] offset:8320
  v_add_u32 v108, 1, v108
  v_not_b32 v109, v108
  s_waitcnt vmcnt(10) lgkmcnt(0)
  s_barrier
  buffer_store_dwordx2 v[108:109], v110, s[56:59], s47 offen offset:0 sc1
  ds_read_b128 v[96:99], v12 offset:8192
  ds_read_b128 v[100:103], v12 offset:12288
  s_waitcnt lgkmcnt(1)
  buffer_store_dwordx4 v[96:99], v9, s[40:43], 0 offen sc1
  s_waitcnt lgkmcnt(0)
  buffer_store_dwordx4 v[100:103], v9, s[40:43], s44 offen sc1
  v_mov_b32 v248, v108
  v_mov_b32 v249, v109
  v_mov_b32 v253, v110
  s_mov_b32 s83, s47
  s_add_u32 s24, s12, 7077888
  s_addc_u32 s25, s13, 0
  s_mov_b32 s26, 16384
  s_mov_b32 s27, 0x20000
  s_lshl_b32 s47, s16, 3
  s_mov_b32 s14, 0x3f803f80
  v_mov_b32 v4, 0
  v_mov_b32 v5, 0
  v_mov_b32 v6, 0
  v_mov_b32 v7, 0
  v_lshlrev_b32 v1, 2, v164
  s_movk_i32 s15, 8192
  s_waitcnt vmcnt(12)
  v_dot2_f32_bf16 v4, v128, s14, v4
  v_dot2_f32_bf16 v6, v128, v128, v6
  v_dot2_f32_bf16 v5, v129, s14, v5
  v_dot2_f32_bf16 v7, v129, v129, v7
  v_dot2_f32_bf16 v4, v130, s14, v4
  v_dot2_f32_bf16 v6, v130, v130, v6
  v_dot2_f32_bf16 v5, v131, s14, v5
  v_dot2_f32_bf16 v7, v131, v131, v7
  s_waitcnt vmcnt(11)
  v_dot2_f32_bf16 v4, v132, s14, v4
  v_dot2_f32_bf16 v6, v132, v132, v6
  v_dot2_f32_bf16 v5, v133, s14, v5
  v_dot2_f32_bf16 v7, v133, v133, v7
  v_dot2_f32_bf16 v4, v134, s14, v4
  v_dot2_f32_bf16 v6, v134, v134, v6
  v_dot2_f32_bf16 v5, v135, s14, v5
  v_dot2_f32_bf16 v7, v135, v135, v7
  s_waitcnt vmcnt(10)
  v_dot2_f32_bf16 v4, v136, s14, v4
  v_dot2_f32_bf16 v6, v136, v136, v6
  v_dot2_f32_bf16 v5, v137, s14, v5
  v_dot2_f32_bf16 v7, v137, v137, v7
  v_dot2_f32_bf16 v4, v138, s14, v4
  v_dot2_f32_bf16 v6, v138, v138, v6
  v_dot2_f32_bf16 v5, v139, s14, v5
  v_dot2_f32_bf16 v7, v139, v139, v7
  s_waitcnt vmcnt(9)
  v_dot2_f32_bf16 v4, v140, s14, v4
  v_dot2_f32_bf16 v6, v140, v140, v6
  v_dot2_f32_bf16 v5, v141, s14, v5
  v_dot2_f32_bf16 v7, v141, v141, v7
  v_dot2_f32_bf16 v4, v142, s14, v4
  v_dot2_f32_bf16 v6, v142, v142, v6
  v_dot2_f32_bf16 v5, v143, s14, v5
  v_dot2_f32_bf16 v7, v143, v143, v7
  s_waitcnt vmcnt(8)
  v_dot2_f32_bf16 v4, v144, s14, v4
  v_dot2_f32_bf16 v6, v144, v144, v6
  v_dot2_f32_bf16 v5, v145, s14, v5
  v_dot2_f32_bf16 v7, v145, v145, v7
  v_dot2_f32_bf16 v4, v146, s14, v4
  v_dot2_f32_bf16 v6, v146, v146, v6
  v_dot2_f32_bf16 v5, v147, s14, v5
  v_dot2_f32_bf16 v7, v147, v147, v7
  s_waitcnt vmcnt(7)
  v_dot2_f32_bf16 v4, v148, s14, v4
  v_dot2_f32_bf16 v6, v148, v148, v6
  v_dot2_f32_bf16 v5, v149, s14, v5
  v_dot2_f32_bf16 v7, v149, v149, v7
  v_dot2_f32_bf16 v4, v150, s14, v4
  v_dot2_f32_bf16 v6, v150, v150, v6
  v_dot2_f32_bf16 v5, v151, s14, v5
  v_dot2_f32_bf16 v7, v151, v151, v7
  s_waitcnt vmcnt(6)
  v_dot2_f32_bf16 v4, v152, s14, v4
  v_dot2_f32_bf16 v6, v152, v152, v6
  v_dot2_f32_bf16 v5, v153, s14, v5
  v_dot2_f32_bf16 v7, v153, v153, v7
  v_dot2_f32_bf16 v4, v154, s14, v4
  v_dot2_f32_bf16 v6, v154, v154, v6
  v_dot2_f32_bf16 v5, v155, s14, v5
  v_dot2_f32_bf16 v7, v155, v155, v7
  s_waitcnt vmcnt(5)
  v_dot2_f32_bf16 v4, v156, s14, v4
  v_dot2_f32_bf16 v6, v156, v156, v6
  v_dot2_f32_bf16 v5, v157, s14, v5
  v_dot2_f32_bf16 v7, v157, v157, v7
  v_dot2_f32_bf16 v4, v158, s14, v4
  v_dot2_f32_bf16 v6, v158, v158, v6
  v_dot2_f32_bf16 v5, v159, s14, v5
  v_dot2_f32_bf16 v7, v159, v159, v7
  s_waitcnt vmcnt(4)
  v_dot2_f32_bf16 v4, v160, s14, v4
  v_dot2_f32_bf16 v6, v160, v160, v6
  v_dot2_f32_bf16 v5, v161, s14, v5
  v_dot2_f32_bf16 v7, v161, v161, v7
  v_dot2_f32_bf16 v4, v162, s14, v4
  v_dot2_f32_bf16 v6, v162, v162, v6
  v_dot2_f32_bf16 v5, v163, s14, v5
  v_dot2_f32_bf16 v7, v163, v163, v7
  s_nop 2
  v_add_f32 v4, v4, v5
  v_add_f32 v6, v6, v7
  s_nop 0
  v_add_f32_dpp v4, v4, v4 quad_perm:[1,0,3,2] row_mask:0xf bank_mask:0xf
  v_add_f32_dpp v6, v6, v6 quad_perm:[1,0,3,2] row_mask:0xf bank_mask:0xf
  s_nop 0
  v_add_f32_dpp v4, v4, v4 quad_perm:[2,3,0,1] row_mask:0xf bank_mask:0xf
  v_add_f32_dpp v6, v6, v6 quad_perm:[2,3,0,1] row_mask:0xf bank_mask:0xf
  s_nop 0
  v_add_f32_dpp v4, v4, v4 row_half_mirror row_mask:0xf bank_mask:0xf
  v_add_f32_dpp v6, v6, v6 row_half_mirror row_mask:0xf bank_mask:0xf
  v_mul_f32 v4, 0x3ae38e39, v4
  v_mul_f32 v6, 0x3ae38e39, v6
  v_fma_f32 v6, -v4, v4, v6
  v_max_f32 v6, 0, v6
  v_add_f32 v6, 0x3727c5ac, v6
  v_rsq_f32 v6, v6
  v_cmp_eq_u32 vcc, 0, v165
  v_mul_f32 v4, v4, v6
  v_sub_f32 v4, 0, v4
  v_cndmask_b32 v1, 2.0, v1, vcc
  buffer_store_dword v6, v1, s[24:27], 0 offen sc1
  buffer_store_dword v4, v1, s[24:27], s15 offen sc1
  s_waitcnt vmcnt(5)
  v_add_u32 v168, 1, v168
  v_not_b32 v169, v168
  s_waitcnt vmcnt(0) lgkmcnt(0)
  s_barrier
  buffer_store_dwordx2 v[248:249], v253, s[56:59], s83 offen offset:768 sc1
  buffer_store_dwordx2 v[168:169], v170, s[56:59], s47 offen offset:256 sc1
s_sub_u32 s3, s2, 64
LU_cs:
s_getpc_b64 s[66:67]
LU_pc2:
s_add_u32 s66, s66, L3_entry-LU_pc2
s_addc_u32 s67, s67, 0
s_add_u32 s56, s12, 7667712
s_addc_u32 s57, s13, 0
s_mov_b32 s58, 65536
s_mov_b32 s59, 0x20000
  v_cmp_gt_u32 vcc, 16, v0
  v_add_u32 v110, 0, v0
  v_mul_u32_u24 v110, 4096, v110
  v_cndmask_b32 v110, 2.0, v110, vcc
  buffer_load_dword v108, v110, s[56:59], 0 offen offset:3584 sc1
s_and_b32 s12, s2, 7
s_cmp_lt_i32 s3, 0
s_cbranch_scc1 LU_dual
s_lshr_b32 s68, s3, 3
s_cmp_ge_u32 s68, 5
s_cselect_b32 s69, 32, 0
s_add_u32 s3, s3, s69
s_mul_i32 s68, s68, 8192
v_lshl_add_u32 v5, v0, 4, s68
v_min_u32 v28, L3_codeend-L3_entry-16, v5
global_load_dwordx4 v[104:107], v28, s[66:67]
v_add_u32 v5, 4096, v5
v_min_u32 v28, L3_codeend-L3_entry-16, v5
global_load_dwordx4 v[104:107], v28, s[66:67]
v_add_u32 v5, 4096, v5
s_load_dwordx4 s[4:7], s[0:1], 56
s_load_dwordx2 s[10:11], s[0:1], 96
s_and_b32 s12, s3, 7
s_lshr_b32 s15, s3, 3
s_cmp_ge_u32 s15, 9
s_cselect_b32 s14, 36864, 0
s_cselect_b32 s13, 9, 0
s_sub_u32 s15, s15, s13
s_mul_i32 s16, s12, 576
s_lshl_b32 s17, s15, 6
s_add_u32 s16, s16, s17
s_lshl_b32 s17, s16, 1
v_lshrrev_b32 v1, 3, v0
v_and_b32 v2, 7, v0
v_mul_u32_u24 v3, 9216, v1
v_lshl_add_u32 v3, v2, 4, v3
v_add_u32 v3, s17, v3
s_waitcnt lgkmcnt(0)
  s_cmp_eq_u32 s14, 0
  s_cselect_b32 s20, s4, s6
  s_cselect_b32 s21, s5, s7
  s_mov_b32 s22, 5308416
  s_mov_b32 s23, 0x20000
  s_mov_b32 s18, 0
  buffer_load_dwordx4 v[32:35], v3, s[20:23], s18 offen
  s_add_u32 s18, s18, 294912
  buffer_load_dwordx4 v[36:39], v3, s[20:23], s18 offen
  s_add_u32 s18, s18, 294912
  buffer_load_dwordx4 v[40:43], v3, s[20:23], s18 offen
  s_add_u32 s18, s18, 294912
  buffer_load_dwordx4 v[44:47], v3, s[20:23], s18 offen
  s_add_u32 s18, s18, 294912
  buffer_load_dwordx4 v[48:51], v3, s[20:23], s18 offen
  s_add_u32 s18, s18, 294912
  buffer_load_dwordx4 v[52:55], v3, s[20:23], s18 offen
  s_add_u32 s18, s18, 294912
  buffer_load_dwordx4 v[56:59], v3, s[20:23], s18 offen
  s_add_u32 s18, s18, 294912
  buffer_load_dwordx4 v[60:63], v3, s[20:23], s18 offen
  s_add_u32 s18, s18, 294912
  buffer_load_dwordx4 v[64:67], v3, s[20:23], s18 offen
  s_add_u32 s18, s18, 294912
  buffer_load_dwordx4 v[68:71], v3, s[20:23], s18 offen
  s_add_u32 s18, s18, 294912
  buffer_load_dwordx4 v[72:75], v3, s[20:23], s18 offen
  s_add_u32 s18, s18, 294912
  buffer_load_dwordx4 v[76:79], v3, s[20:23], s18 offen
  s_add_u32 s18, s18, 294912
  buffer_load_dwordx4 v[80:83], v3, s[20:23], s18 offen
  s_add_u32 s18, s18, 294912
  buffer_load_dwordx4 v[84:87], v3, s[20:23], s18 offen
  s_add_u32 s18, s18, 294912
  buffer_load_dwordx4 v[88:91], v3, s[20:23], s18 offen
  s_add_u32 s18, s18, 294912
  buffer_load_dwordx4 v[92:95], v3, s[20:23], s18 offen
  s_add_u32 s18, s18, 294912
  buffer_load_dwordx4 v[96:99], v3, s[20:23], s18 offen
  s_add_u32 s18, s18, 294912
  buffer_load_dwordx4 v[100:103], v3, s[20:23], s18 offen
  s_add_u32 s28, s10, 7094272
  s_addc_u32 s29, s11, 0
  s_mov_b32 s30, 73728
  s_mov_b32 s31, 0x20000
  s_mov_b32 s34, 0xffff0000
  s_mov_b32 s32, 0x00003f80
  s_mov_b32 s33, 0x3f800000
  v_mov_b32 v8, 0
  v_mov_b32 v9, 0
  v_mov_b32 v10, 0
  v_mov_b32 v11, 0
  v_mov_b32 v12, 0
  v_mov_b32 v13, 0
  v_mov_b32 v14, 0
  v_mov_b32 v15, 0
  v_and_b32 v6, 8, v0
  v_cmp_eq_u32 vcc, 0, v6
  v_and_b32 v7, 63, v0
  v_lshrrev_b32 v26, 3, v7
  v_lshl_add_u32 v26, v2, 3, v26
  v_lshrrev_b32 v27, 6, v0
  v_lshl_add_u32 v27, v27, 6, v26
  v_lshlrev_b32 v27, 2, v27
  s_waitcnt vmcnt(17)
  v_dot2_f32_bf16 v8, v32, s32, v8
  v_dot2_f32_bf16 v9, v32, s33, v9
  v_dot2_f32_bf16 v10, v33, s32, v10
  v_dot2_f32_bf16 v11, v33, s33, v11
  v_dot2_f32_bf16 v12, v34, s32, v12
  v_dot2_f32_bf16 v13, v34, s33, v13
  v_dot2_f32_bf16 v14, v35, s32, v14
  v_dot2_f32_bf16 v15, v35, s33, v15
  s_waitcnt vmcnt(16)
  v_dot2_f32_bf16 v8, v36, s32, v8
  v_dot2_f32_bf16 v9, v36, s33, v9
  v_dot2_f32_bf16 v10, v37, s32, v10
  v_dot2_f32_bf16 v11, v37, s33, v11
  v_dot2_f32_bf16 v12, v38, s32, v12
  v_dot2_f32_bf16 v13, v38, s33, v13
  v_dot2_f32_bf16 v14, v39, s32, v14
  v_dot2_f32_bf16 v15, v39, s33, v15
  s_waitcnt vmcnt(15)
  v_dot2_f32_bf16 v8, v40, s32, v8
  v_dot2_f32_bf16 v9, v40, s33, v9
  v_dot2_f32_bf16 v10, v41, s32, v10
  v_dot2_f32_bf16 v11, v41, s33, v11
  v_dot2_f32_bf16 v12, v42, s32, v12
  v_dot2_f32_bf16 v13, v42, s33, v13
  v_dot2_f32_bf16 v14, v43, s32, v14
  v_dot2_f32_bf16 v15, v43, s33, v15
  s_waitcnt vmcnt(14)
  v_dot2_f32_bf16 v8, v44, s32, v8
  v_dot2_f32_bf16 v9, v44, s33, v9
  v_dot2_f32_bf16 v10, v45, s32, v10
  v_dot2_f32_bf16 v11, v45, s33, v11
  v_dot2_f32_bf16 v12, v46, s32, v12
  v_dot2_f32_bf16 v13, v46, s33, v13
  v_dot2_f32_bf16 v14, v47, s32, v14
  v_dot2_f32_bf16 v15, v47, s33, v15
  s_waitcnt vmcnt(13)
  v_dot2_f32_bf16 v8, v48, s32, v8
  v_dot2_f32_bf16 v9, v48, s33, v9
  v_dot2_f32_bf16 v10, v49, s32, v10
  v_dot2_f32_bf16 v11, v49, s33, v11
  v_dot2_f32_bf16 v12, v50, s32, v12
  v_dot2_f32_bf16 v13, v50, s33, v13
  v_dot2_f32_bf16 v14, v51, s32, v14
  v_dot2_f32_bf16 v15, v51, s33, v15
  s_waitcnt vmcnt(12)
  v_dot2_f32_bf16 v8, v52, s32, v8
  v_dot2_f32_bf16 v9, v52, s33, v9
  v_dot2_f32_bf16 v10, v53, s32, v10
  v_dot2_f32_bf16 v11, v53, s33, v11
  v_dot2_f32_bf16 v12, v54, s32, v12
  v_dot2_f32_bf16 v13, v54, s33, v13
  v_dot2_f32_bf16 v14, v55, s32, v14
  v_dot2_f32_bf16 v15, v55, s33, v15
  s_waitcnt vmcnt(11)
  v_dot2_f32_bf16 v8, v56, s32, v8
  v_dot2_f32_bf16 v9, v56, s33, v9
  v_dot2_f32_bf16 v10, v57, s32, v10
  v_dot2_f32_bf16 v11, v57, s33, v11
  v_dot2_f32_bf16 v12, v58, s32, v12
  v_dot2_f32_bf16 v13, v58, s33, v13
  v_dot2_f32_bf16 v14, v59, s32, v14
  v_dot2_f32_bf16 v15, v59, s33, v15
  s_waitcnt vmcnt(10)
  v_dot2_f32_bf16 v8, v60, s32, v8
  v_dot2_f32_bf16 v9, v60, s33, v9
  v_dot2_f32_bf16 v10, v61, s32, v10
  v_dot2_f32_bf16 v11, v61, s33, v11
  v_dot2_f32_bf16 v12, v62, s32, v12
  v_dot2_f32_bf16 v13, v62, s33, v13
  v_dot2_f32_bf16 v14, v63, s32, v14
  v_dot2_f32_bf16 v15, v63, s33, v15
  s_waitcnt vmcnt(9)
  v_dot2_f32_bf16 v8, v64, s32, v8
  v_dot2_f32_bf16 v9, v64, s33, v9
  v_dot2_f32_bf16 v10, v65, s32, v10
  v_dot2_f32_bf16 v11, v65, s33, v11
  v_dot2_f32_bf16 v12, v66, s32, v12
  v_dot2_f32_bf16 v13, v66, s33, v13
  v_dot2_f32_bf16 v14, v67, s32, v14
  v_dot2_f32_bf16 v15, v67, s33, v15
  s_waitcnt vmcnt(8)
  v_dot2_f32_bf16 v8, v68, s32, v8
  v_dot2_f32_bf16 v9, v68, s33, v9
  v_dot2_f32_bf16 v10, v69, s32, v10
  v_dot2_f32_bf16 v11, v69, s33, v11
  v_dot2_f32_bf16 v12, v70, s32, v12
  v_dot2_f32_bf16 v13, v70, s33, v13
  v_dot2_f32_bf16 v14, v71, s32, v14
  v_dot2_f32_bf16 v15, v71, s33, v15
  s_waitcnt vmcnt(7)
  v_dot2_f32_bf16 v8, v72, s32, v8
  v_dot2_f32_bf16 v9, v72, s33, v9
  v_dot2_f32_bf16 v10, v73, s32, v10
  v_dot2_f32_bf16 v11, v73, s33, v11
  v_dot2_f32_bf16 v12, v74, s32, v12
  v_dot2_f32_bf16 v13, v74, s33, v13
  v_dot2_f32_bf16 v14, v75, s32, v14
  v_dot2_f32_bf16 v15, v75, s33, v15
  s_waitcnt vmcnt(6)
  v_dot2_f32_bf16 v8, v76, s32, v8
  v_dot2_f32_bf16 v9, v76, s33, v9
  v_dot2_f32_bf16 v10, v77, s32, v10
  v_dot2_f32_bf16 v11, v77, s33, v11
  v_dot2_f32_bf16 v12, v78, s32, v12
  v_dot2_f32_bf16 v13, v78, s33, v13
  v_dot2_f32_bf16 v14, v79, s32, v14
  v_dot2_f32_bf16 v15, v79, s33, v15
  s_waitcnt vmcnt(5)
  v_dot2_f32_bf16 v8, v80, s32, v8
  v_dot2_f32_bf16 v9, v80, s33, v9
  v_dot2_f32_bf16 v10, v81, s32, v10
  v_dot2_f32_bf16 v11, v81, s33, v11
  v_dot2_f32_bf16 v12, v82, s32, v12
  v_dot2_f32_bf16 v13, v82, s33, v13
  v_dot2_f32_bf16 v14, v83, s32, v14
  v_dot2_f32_bf16 v15, v83, s33, v15
  s_waitcnt vmcnt(4)
  v_dot2_f32_bf16 v8, v84, s32, v8
  v_dot2_f32_bf16 v9, v84, s33, v9
  v_dot2_f32_bf16 v10, v85, s32, v10
  v_dot2_f32_bf16 v11, v85, s33, v11
  v_dot2_f32_bf16 v12, v86, s32, v12
  v_dot2_f32_bf16 v13, v86, s33, v13
  v_dot2_f32_bf16 v14, v87, s32, v14
  v_dot2_f32_bf16 v15, v87, s33, v15
  s_waitcnt vmcnt(3)
  v_dot2_f32_bf16 v8, v88, s32, v8
  v_dot2_f32_bf16 v9, v88, s33, v9
  v_dot2_f32_bf16 v10, v89, s32, v10
  v_dot2_f32_bf16 v11, v89, s33, v11
  v_dot2_f32_bf16 v12, v90, s32, v12
  v_dot2_f32_bf16 v13, v90, s33, v13
  v_dot2_f32_bf16 v14, v91, s32, v14
  v_dot2_f32_bf16 v15, v91, s33, v15
  s_waitcnt vmcnt(2)
  v_dot2_f32_bf16 v8, v92, s32, v8
  v_dot2_f32_bf16 v9, v92, s33, v9
  v_dot2_f32_bf16 v10, v93, s32, v10
  v_dot2_f32_bf16 v11, v93, s33, v11
  v_dot2_f32_bf16 v12, v94, s32, v12
  v_dot2_f32_bf16 v13, v94, s33, v13
  v_dot2_f32_bf16 v14, v95, s32, v14
  v_dot2_f32_bf16 v15, v95, s33, v15
  s_waitcnt vmcnt(1)
  v_dot2_f32_bf16 v8, v96, s32, v8
  v_dot2_f32_bf16 v9, v96, s33, v9
  v_dot2_f32_bf16 v10, v97, s32, v10
  v_dot2_f32_bf16 v11, v97, s33, v11
  v_dot2_f32_bf16 v12, v98, s32, v12
  v_dot2_f32_bf16 v13, v98, s33, v13
  v_dot2_f32_bf16 v14, v99, s32, v14
  v_dot2_f32_bf16 v15, v99, s33, v15
  s_waitcnt vmcnt(0)
  v_dot2_f32_bf16 v8, v100, s32, v8
  v_dot2_f32_bf16 v9, v100, s33, v9
  v_dot2_f32_bf16 v10, v101, s32, v10
  v_dot2_f32_bf16 v11, v101, s33, v11
  v_dot2_f32_bf16 v12, v102, s32, v12
  v_dot2_f32_bf16 v13, v102, s33, v13
  v_dot2_f32_bf16 v14, v103, s32, v14
  v_dot2_f32_bf16 v15, v103, s33, v15
  s_nop 2
  v_permlane32_swap_b32 v8, v12
  v_permlane32_swap_b32 v9, v13
  v_permlane32_swap_b32 v10, v14
  v_permlane32_swap_b32 v11, v15
  v_add_f32 v8, v8, v12
  v_add_f32 v9, v9, v13
  v_add_f32 v10, v10, v14
  v_add_f32 v11, v11, v15
  s_nop 0
  v_permlane16_swap_b32 v8, v10
  v_permlane16_swap_b32 v9, v11
  v_add_f32 v8, v8, v10
  v_add_f32 v9, v9, v11
  s_nop 0
  v_add_f32_dpp v8, v8, v8 row_ror:8 row_mask:0xf bank_mask:0xf
  v_add_f32_dpp v9, v9, v9 row_ror:8 row_mask:0xf bank_mask:0xf
  v_cndmask_b32 v8, v9, v8, vcc
  ds_write_b32 v27, v8
  s_waitcnt lgkmcnt(0)
  s_barrier
  v_lshlrev_b32 v11, 2, v7
  ds_read2st64_b32 v[12:13], v11 offset0:0 offset1:1
  ds_read2st64_b32 v[14:15], v11 offset0:2 offset1:3
  s_lshl_b32 s18, s16, 3
  s_add_u32 s18, s18, s14
  v_cmp_gt_u32 vcc, 64, v0
  v_lshlrev_b32 v11, 3, v7
  s_nop 0
  v_cndmask_b32 v11, 2.0, v11, vcc
  s_waitcnt lgkmcnt(1)
  v_add_f32 v12, v12, v13
  s_waitcnt lgkmcnt(0)
  v_add_f32 v14, v14, v15
  v_add_f32 v12, v12, v14
  v_cvt_pk_bf16_f32 v13, v12, v12
  v_and_b32 v15, 0xffff, v13
  v_and_b32 v13, 0xffff0000, v13
  v_sub_f32 v12, v12, v13
  v_cvt_pk_bf16_f32 v12, v12, v12
  v_and_or_b32 v14, v12, s34, v15
  buffer_store_dwordx2 v[14:15], v11, s[28:31], s18 offen sc1
v_add_u32 v108, 1, v108
v_not_b32 v109, v108
s_mul_i32 s68, s12, 18
s_lshr_b32 s69, s3, 3
s_add_u32 s68, s68, s69
s_lshl_b32 s68, s68, 3
s_waitcnt vmcnt(0) lgkmcnt(0)
s_barrier
buffer_store_dwordx2 v[108:109], v110, s[56:59], s68 offen offset:1152 sc1
s_branch LU_csdone
LU_dual:
s_sub_u32 s15, s2, 32
s_lshr_b32 s15, s15, 3
s_add_u32 s15, s15, 5
s_load_dwordx4 s[4:7], s[0:1], 56
s_load_dwordx2 s[10:11], s[0:1], 96
s_mul_i32 s16, s12, 576
s_lshl_b32 s17, s15, 6
s_add_u32 s16, s16, s17
s_lshl_b32 s17, s16, 1
v_lshrrev_b32 v1, 3, v0
v_and_b32 v2, 7, v0
v_mul_u32_u24 v3, 9216, v1
v_lshl_add_u32 v3, v2, 4, v3
v_add_u32 v3, s17, v3
s_waitcnt lgkmcnt(0)
  s_mov_b32 s20, s4
  s_mov_b32 s21, s5
  s_mov_b32 s22, 5308416
  s_mov_b32 s23, 0x20000
  s_mov_b32 s24, s6
  s_mov_b32 s25, s7
  s_mov_b32 s26, 5308416
  s_mov_b32 s27, 0x20000
  s_mov_b32 s18, 0
  buffer_load_dwordx4 v[32:35], v3, s[20:23], s18 offen
  buffer_load_dwordx4 v[128:131], v3, s[24:27], s18 offen
  s_add_u32 s18, s18, 294912
  buffer_load_dwordx4 v[36:39], v3, s[20:23], s18 offen
  buffer_load_dwordx4 v[132:135], v3, s[24:27], s18 offen
  s_add_u32 s18, s18, 294912
  buffer_load_dwordx4 v[40:43], v3, s[20:23], s18 offen
  buffer_load_dwordx4 v[136:139], v3, s[24:27], s18 offen
  s_add_u32 s18, s18, 294912
  buffer_load_dwordx4 v[44:47], v3, s[20:23], s18 offen
  buffer_load_dwordx4 v[140:143], v3, s[24:27], s18 offen
  s_add_u32 s18, s18, 294912
  buffer_load_dwordx4 v[48:51], v3, s[20:23], s18 offen
  buffer_load_dwordx4 v[144:147], v3, s[24:27], s18 offen
  s_add_u32 s18, s18, 294912
  buffer_load_dwordx4 v[52:55], v3, s[20:23], s18 offen
  buffer_load_dwordx4 v[148:151], v3, s[24:27], s18 offen
  s_add_u32 s18, s18, 294912
  buffer_load_dwordx4 v[56:59], v3, s[20:23], s18 offen
  buffer_load_dwordx4 v[152:155], v3, s[24:27], s18 offen
  s_add_u32 s18, s18, 294912
  buffer_load_dwordx4 v[60:63], v3, s[20:23], s18 offen
  buffer_load_dwordx4 v[156:159], v3, s[24:27], s18 offen
  s_add_u32 s18, s18, 294912
  buffer_load_dwordx4 v[64:67], v3, s[20:23], s18 offen
  buffer_load_dwordx4 v[160:163], v3, s[24:27], s18 offen
  s_add_u32 s18, s18, 294912
  buffer_load_dwordx4 v[68:71], v3, s[20:23], s18 offen
  buffer_load_dwordx4 v[164:167], v3, s[24:27], s18 offen
  s_add_u32 s18, s18, 294912
  buffer_load_dwordx4 v[72:75], v3, s[20:23], s18 offen
  buffer_load_dwordx4 v[168:171], v3, s[24:27], s18 offen
  s_add_u32 s18, s18, 294912
  buffer_load_dwordx4 v[76:79], v3, s[20:23], s18 offen
  buffer_load_dwordx4 v[172:175], v3, s[24:27], s18 offen
  s_add_u32 s18, s18, 294912
  buffer_load_dwordx4 v[80:83], v3, s[20:23], s18 offen
  buffer_load_dwordx4 v[176:179], v3, s[24:27], s18 offen
  s_add_u32 s18, s18, 294912
  buffer_load_dwordx4 v[84:87], v3, s[20:23], s18 offen
  buffer_load_dwordx4 v[180:183], v3, s[24:27], s18 offen
  s_add_u32 s18, s18, 294912
  buffer_load_dwordx4 v[88:91], v3, s[20:23], s18 offen
  buffer_load_dwordx4 v[184:187], v3, s[24:27], s18 offen
  s_add_u32 s18, s18, 294912
  buffer_load_dwordx4 v[92:95], v3, s[20:23], s18 offen
  buffer_load_dwordx4 v[188:191], v3, s[24:27], s18 offen
  s_add_u32 s18, s18, 294912
  buffer_load_dwordx4 v[96:99], v3, s[20:23], s18 offen
  buffer_load_dwordx4 v[192:195], v3, s[24:27], s18 offen
  s_add_u32 s18, s18, 294912
  buffer_load_dwordx4 v[100:103], v3, s[20:23], s18 offen
  buffer_load_dwordx4 v[196:199], v3, s[24:27], s18 offen
  s_add_u32 s28, s10, 7094272
  s_addc_u32 s29, s11, 0
  s_mov_b32 s30, 73728
  s_mov_b32 s31, 0x20000
  s_mov_b32 s34, 0xffff0000
  s_mov_b32 s32, 0x00003f80
  s_mov_b32 s33, 0x3f800000
  v_mov_b32 v8, 0
  v_mov_b32 v9, 0
  v_mov_b32 v10, 0
  v_mov_b32 v11, 0
  v_mov_b32 v12, 0
  v_mov_b32 v13, 0
  v_mov_b32 v14, 0
  v_mov_b32 v15, 0
  v_mov_b32 v16, 0
  v_mov_b32 v17, 0
  v_mov_b32 v18, 0
  v_mov_b32 v19, 0
  v_mov_b32 v20, 0
  v_mov_b32 v21, 0
  v_mov_b32 v22, 0
  v_mov_b32 v23, 0
  v_and_b32 v6, 8, v0
  v_cmp_eq_u32 vcc, 0, v6
  v_and_b32 v7, 63, v0
  v_lshrrev_b32 v26, 3, v7
  v_lshl_add_u32 v26, v2, 3, v26
  v_lshrrev_b32 v27, 6, v0
  v_lshl_add_u32 v27, v27, 6, v26
  v_lshlrev_b32 v27, 2, v27
  s_waitcnt vmcnt(35)
  v_dot2_f32_bf16 v8, v32, s32, v8
  v_dot2_f32_bf16 v9, v32, s33, v9
  v_dot2_f32_bf16 v10, v33, s32, v10
  v_dot2_f32_bf16 v11, v33, s33, v11
  v_dot2_f32_bf16 v12, v34, s32, v12
  v_dot2_f32_bf16 v13, v34, s33, v13
  v_dot2_f32_bf16 v14, v35, s32, v14
  v_dot2_f32_bf16 v15, v35, s33, v15
  s_waitcnt vmcnt(34)
  v_dot2_f32_bf16 v16, v128, s32, v16
  v_dot2_f32_bf16 v17, v128, s33, v17
  v_dot2_f32_bf16 v18, v129, s32, v18
  v_dot2_f32_bf16 v19, v129, s33, v19
  v_dot2_f32_bf16 v20, v130, s32, v20
  v_dot2_f32_bf16 v21, v130, s33, v21
  v_dot2_f32_bf16 v22, v131, s32, v22
  v_dot2_f32_bf16 v23, v131, s33, v23
  s_waitcnt vmcnt(33)
  v_dot2_f32_bf16 v8, v36, s32, v8
  v_dot2_f32_bf16 v9, v36, s33, v9
  v_dot2_f32_bf16 v10, v37, s32, v10
  v_dot2_f32_bf16 v11, v37, s33, v11
  v_dot2_f32_bf16 v12, v38, s32, v12
  v_dot2_f32_bf16 v13, v38, s33, v13
  v_dot2_f32_bf16 v14, v39, s32, v14
  v_dot2_f32_bf16 v15, v39, s33, v15
  s_waitcnt vmcnt(32)
  v_dot2_f32_bf16 v16, v132, s32, v16
  v_dot2_f32_bf16 v17, v132, s33, v17
  v_dot2_f32_bf16 v18, v133, s32, v18
  v_dot2_f32_bf16 v19, v133, s33, v19
  v_dot2_f32_bf16 v20, v134, s32, v20
  v_dot2_f32_bf16 v21, v134, s33, v21
  v_dot2_f32_bf16 v22, v135, s32, v22
  v_dot2_f32_bf16 v23, v135, s33, v23
  s_waitcnt vmcnt(31)
  v_dot2_f32_bf16 v8, v40, s32, v8
  v_dot2_f32_bf16 v9, v40, s33, v9
  v_dot2_f32_bf16 v10, v41, s32, v10
  v_dot2_f32_bf16 v11, v41, s33, v11
  v_dot2_f32_bf16 v12, v42, s32, v12
  v_dot2_f32_bf16 v13, v42, s33, v13
  v_dot2_f32_bf16 v14, v43, s32, v14
  v_dot2_f32_bf16 v15, v43, s33, v15
  s_waitcnt vmcnt(30)
  v_dot2_f32_bf16 v16, v136, s32, v16
  v_dot2_f32_bf16 v17, v136, s33, v17
  v_dot2_f32_bf16 v18, v137, s32, v18
  v_dot2_f32_bf16 v19, v137, s33, v19
  v_dot2_f32_bf16 v20, v138, s32, v20
  v_dot2_f32_bf16 v21, v138, s33, v21
  v_dot2_f32_bf16 v22, v139, s32, v22
  v_dot2_f32_bf16 v23, v139, s33, v23
  s_waitcnt vmcnt(29)
  v_dot2_f32_bf16 v8, v44, s32, v8
  v_dot2_f32_bf16 v9, v44, s33, v9
  v_dot2_f32_bf16 v10, v45, s32, v10
  v_dot2_f32_bf16 v11, v45, s33, v11
  v_dot2_f32_bf16 v12, v46, s32, v12
  v_dot2_f32_bf16 v13, v46, s33, v13
  v_dot2_f32_bf16 v14, v47, s32, v14
  v_dot2_f32_bf16 v15, v47, s33, v15
  s_waitcnt vmcnt(28)
  v_dot2_f32_bf16 v16, v140, s32, v16
  v_dot2_f32_bf16 v17, v140, s33, v17
  v_dot2_f32_bf16 v18, v141, s32, v18
  v_dot2_f32_bf16 v19, v141, s33, v19
  v_dot2_f32_bf16 v20, v142, s32, v20
  v_dot2_f32_bf16 v21, v142, s33, v21
  v_dot2_f32_bf16 v22, v143, s32, v22
  v_dot2_f32_bf16 v23, v143, s33, v23
  s_waitcnt vmcnt(27)
  v_dot2_f32_bf16 v8, v48, s32, v8
  v_dot2_f32_bf16 v9, v48, s33, v9
  v_dot2_f32_bf16 v10, v49, s32, v10
  v_dot2_f32_bf16 v11, v49, s33, v11
  v_dot2_f32_bf16 v12, v50, s32, v12
  v_dot2_f32_bf16 v13, v50, s33, v13
  v_dot2_f32_bf16 v14, v51, s32, v14
  v_dot2_f32_bf16 v15, v51, s33, v15
  s_waitcnt vmcnt(26)
  v_dot2_f32_bf16 v16, v144, s32, v16
  v_dot2_f32_bf16 v17, v144, s33, v17
  v_dot2_f32_bf16 v18, v145, s32, v18
  v_dot2_f32_bf16 v19, v145, s33, v19
  v_dot2_f32_bf16 v20, v146, s32, v20
  v_dot2_f32_bf16 v21, v146, s33, v21
  v_dot2_f32_bf16 v22, v147, s32, v22
  v_dot2_f32_bf16 v23, v147, s33, v23
  s_waitcnt vmcnt(25)
  v_dot2_f32_bf16 v8, v52, s32, v8
  v_dot2_f32_bf16 v9, v52, s33, v9
  v_dot2_f32_bf16 v10, v53, s32, v10
  v_dot2_f32_bf16 v11, v53, s33, v11
  v_dot2_f32_bf16 v12, v54, s32, v12
  v_dot2_f32_bf16 v13, v54, s33, v13
  v_dot2_f32_bf16 v14, v55, s32, v14
  v_dot2_f32_bf16 v15, v55, s33, v15
  s_waitcnt vmcnt(24)
  v_dot2_f32_bf16 v16, v148, s32, v16
  v_dot2_f32_bf16 v17, v148, s33, v17
  v_dot2_f32_bf16 v18, v149, s32, v18
  v_dot2_f32_bf16 v19, v149, s33, v19
  v_dot2_f32_bf16 v20, v150, s32, v20
  v_dot2_f32_bf16 v21, v150, s33, v21
  v_dot2_f32_bf16 v22, v151, s32, v22
  v_dot2_f32_bf16 v23, v151, s33, v23
  s_waitcnt vmcnt(23)
  v_dot2_f32_bf16 v8, v56, s32, v8
  v_dot2_f32_bf16 v9, v56, s33, v9
  v_dot2_f32_bf16 v10, v57, s32, v10
  v_dot2_f32_bf16 v11, v57, s33, v11
  v_dot2_f32_bf16 v12, v58, s32, v12
  v_dot2_f32_bf16 v13, v58, s33, v13
  v_dot2_f32_bf16 v14, v59, s32, v14
  v_dot2_f32_bf16 v15, v59, s33, v15
  s_waitcnt vmcnt(22)
  v_dot2_f32_bf16 v16, v152, s32, v16
  v_dot2_f32_bf16 v17, v152, s33, v17
  v_dot2_f32_bf16 v18, v153, s32, v18
  v_dot2_f32_bf16 v19, v153, s33, v19
  v_dot2_f32_bf16 v20, v154, s32, v20
  v_dot2_f32_bf16 v21, v154, s33, v21
  v_dot2_f32_bf16 v22, v155, s32, v22
  v_dot2_f32_bf16 v23, v155, s33, v23
  s_waitcnt vmcnt(21)
  v_dot2_f32_bf16 v8, v60, s32, v8
  v_dot2_f32_bf16 v9, v60, s33, v9
  v_dot2_f32_bf16 v10, v61, s32, v10
  v_dot2_f32_bf16 v11, v61, s33, v11
  v_dot2_f32_bf16 v12, v62, s32, v12
  v_dot2_f32_bf16 v13, v62, s33, v13
  v_dot2_f32_bf16 v14, v63, s32, v14
  v_dot2_f32_bf16 v15, v63, s33, v15
  s_waitcnt vmcnt(20)
  v_dot2_f32_bf16 v16, v156, s32, v16
  v_dot2_f32_bf16 v17, v156, s33, v17
  v_dot2_f32_bf16 v18, v157, s32, v18
  v_dot2_f32_bf16 v19, v157, s33, v19
  v_dot2_f32_bf16 v20, v158, s32, v20
  v_dot2_f32_bf16 v21, v158, s33, v21
  v_dot2_f32_bf16 v22, v159, s32, v22
  v_dot2_f32_bf16 v23, v159, s33, v23
  s_waitcnt vmcnt(19)
  v_dot2_f32_bf16 v8, v64, s32, v8
  v_dot2_f32_bf16 v9, v64, s33, v9
  v_dot2_f32_bf16 v10, v65, s32, v10
  v_dot2_f32_bf16 v11, v65, s33, v11
  v_dot2_f32_bf16 v12, v66, s32, v12
  v_dot2_f32_bf16 v13, v66, s33, v13
  v_dot2_f32_bf16 v14, v67, s32, v14
  v_dot2_f32_bf16 v15, v67, s33, v15
  s_waitcnt vmcnt(18)
  v_dot2_f32_bf16 v16, v160, s32, v16
  v_dot2_f32_bf16 v17, v160, s33, v17
  v_dot2_f32_bf16 v18, v161, s32, v18
  v_dot2_f32_bf16 v19, v161, s33, v19
  v_dot2_f32_bf16 v20, v162, s32, v20
  v_dot2_f32_bf16 v21, v162, s33, v21
  v_dot2_f32_bf16 v22, v163, s32, v22
  v_dot2_f32_bf16 v23, v163, s33, v23
  s_waitcnt vmcnt(17)
  v_dot2_f32_bf16 v8, v68, s32, v8
  v_dot2_f32_bf16 v9, v68, s33, v9
  v_dot2_f32_bf16 v10, v69, s32, v10
  v_dot2_f32_bf16 v11, v69, s33, v11
  v_dot2_f32_bf16 v12, v70, s32, v12
  v_dot2_f32_bf16 v13, v70, s33, v13
  v_dot2_f32_bf16 v14, v71, s32, v14
  v_dot2_f32_bf16 v15, v71, s33, v15
  s_waitcnt vmcnt(16)
  v_dot2_f32_bf16 v16, v164, s32, v16
  v_dot2_f32_bf16 v17, v164, s33, v17
  v_dot2_f32_bf16 v18, v165, s32, v18
  v_dot2_f32_bf16 v19, v165, s33, v19
  v_dot2_f32_bf16 v20, v166, s32, v20
  v_dot2_f32_bf16 v21, v166, s33, v21
  v_dot2_f32_bf16 v22, v167, s32, v22
  v_dot2_f32_bf16 v23, v167, s33, v23
  s_waitcnt vmcnt(15)
  v_dot2_f32_bf16 v8, v72, s32, v8
  v_dot2_f32_bf16 v9, v72, s33, v9
  v_dot2_f32_bf16 v10, v73, s32, v10
  v_dot2_f32_bf16 v11, v73, s33, v11
  v_dot2_f32_bf16 v12, v74, s32, v12
  v_dot2_f32_bf16 v13, v74, s33, v13
  v_dot2_f32_bf16 v14, v75, s32, v14
  v_dot2_f32_bf16 v15, v75, s33, v15
  s_waitcnt vmcnt(14)
  v_dot2_f32_bf16 v16, v168, s32, v16
  v_dot2_f32_bf16 v17, v168, s33, v17
  v_dot2_f32_bf16 v18, v169, s32, v18
  v_dot2_f32_bf16 v19, v169, s33, v19
  v_dot2_f32_bf16 v20, v170, s32, v20
  v_dot2_f32_bf16 v21, v170, s33, v21
  v_dot2_f32_bf16 v22, v171, s32, v22
  v_dot2_f32_bf16 v23, v171, s33, v23
  s_waitcnt vmcnt(13)
  v_dot2_f32_bf16 v8, v76, s32, v8
  v_dot2_f32_bf16 v9, v76, s33, v9
  v_dot2_f32_bf16 v10, v77, s32, v10
  v_dot2_f32_bf16 v11, v77, s33, v11
  v_dot2_f32_bf16 v12, v78, s32, v12
  v_dot2_f32_bf16 v13, v78, s33, v13
  v_dot2_f32_bf16 v14, v79, s32, v14
  v_dot2_f32_bf16 v15, v79, s33, v15
  s_waitcnt vmcnt(12)
  v_dot2_f32_bf16 v16, v172, s32, v16
  v_dot2_f32_bf16 v17, v172, s33, v17
  v_dot2_f32_bf16 v18, v173, s32, v18
  v_dot2_f32_bf16 v19, v173, s33, v19
  v_dot2_f32_bf16 v20, v174, s32, v20
  v_dot2_f32_bf16 v21, v174, s33, v21
  v_dot2_f32_bf16 v22, v175, s32, v22
  v_dot2_f32_bf16 v23, v175, s33, v23
  s_waitcnt vmcnt(11)
  v_dot2_f32_bf16 v8, v80, s32, v8
  v_dot2_f32_bf16 v9, v80, s33, v9
  v_dot2_f32_bf16 v10, v81, s32, v10
  v_dot2_f32_bf16 v11, v81, s33, v11
  v_dot2_f32_bf16 v12, v82, s32, v12
  v_dot2_f32_bf16 v13, v82, s33, v13
  v_dot2_f32_bf16 v14, v83, s32, v14
  v_dot2_f32_bf16 v15, v83, s33, v15
  s_waitcnt vmcnt(10)
  v_dot2_f32_bf16 v16, v176, s32, v16
  v_dot2_f32_bf16 v17, v176, s33, v17
  v_dot2_f32_bf16 v18, v177, s32, v18
  v_dot2_f32_bf16 v19, v177, s33, v19
  v_dot2_f32_bf16 v20, v178, s32, v20
  v_dot2_f32_bf16 v21, v178, s33, v21
  v_dot2_f32_bf16 v22, v179, s32, v22
  v_dot2_f32_bf16 v23, v179, s33, v23
  s_waitcnt vmcnt(9)
  v_dot2_f32_bf16 v8, v84, s32, v8
  v_dot2_f32_bf16 v9, v84, s33, v9
  v_dot2_f32_bf16 v10, v85, s32, v10
  v_dot2_f32_bf16 v11, v85, s33, v11
  v_dot2_f32_bf16 v12, v86, s32, v12
  v_dot2_f32_bf16 v13, v86, s33, v13
  v_dot2_f32_bf16 v14, v87, s32, v14
  v_dot2_f32_bf16 v15, v87, s33, v15
  s_waitcnt vmcnt(8)
  v_dot2_f32_bf16 v16, v180, s32, v16
  v_dot2_f32_bf16 v17, v180, s33, v17
  v_dot2_f32_bf16 v18, v181, s32, v18
  v_dot2_f32_bf16 v19, v181, s33, v19
  v_dot2_f32_bf16 v20, v182, s32, v20
  v_dot2_f32_bf16 v21, v182, s33, v21
  v_dot2_f32_bf16 v22, v183, s32, v22
  v_dot2_f32_bf16 v23, v183, s33, v23
  s_waitcnt vmcnt(7)
  v_dot2_f32_bf16 v8, v88, s32, v8
  v_dot2_f32_bf16 v9, v88, s33, v9
  v_dot2_f32_bf16 v10, v89, s32, v10
  v_dot2_f32_bf16 v11, v89, s33, v11
  v_dot2_f32_bf16 v12, v90, s32, v12
  v_dot2_f32_bf16 v13, v90, s33, v13
  v_dot2_f32_bf16 v14, v91, s32, v14
  v_dot2_f32_bf16 v15, v91, s33, v15
  s_waitcnt vmcnt(6)
  v_dot2_f32_bf16 v16, v184, s32, v16
  v_dot2_f32_bf16 v17, v184, s33, v17
  v_dot2_f32_bf16 v18, v185, s32, v18
  v_dot2_f32_bf16 v19, v185, s33, v19
  v_dot2_f32_bf16 v20, v186, s32, v20
  v_dot2_f32_bf16 v21, v186, s33, v21
  v_dot2_f32_bf16 v22, v187, s32, v22
  v_dot2_f32_bf16 v23, v187, s33, v23
  s_waitcnt vmcnt(5)
  v_dot2_f32_bf16 v8, v92, s32, v8
  v_dot2_f32_bf16 v9, v92, s33, v9
  v_dot2_f32_bf16 v10, v93, s32, v10
  v_dot2_f32_bf16 v11, v93, s33, v11
  v_dot2_f32_bf16 v12, v94, s32, v12
  v_dot2_f32_bf16 v13, v94, s33, v13
  v_dot2_f32_bf16 v14, v95, s32, v14
  v_dot2_f32_bf16 v15, v95, s33, v15
  s_waitcnt vmcnt(4)
  v_dot2_f32_bf16 v16, v188, s32, v16
  v_dot2_f32_bf16 v17, v188, s33, v17
  v_dot2_f32_bf16 v18, v189, s32, v18
  v_dot2_f32_bf16 v19, v189, s33, v19
  v_dot2_f32_bf16 v20, v190, s32, v20
  v_dot2_f32_bf16 v21, v190, s33, v21
  v_dot2_f32_bf16 v22, v191, s32, v22
  v_dot2_f32_bf16 v23, v191, s33, v23
  s_waitcnt vmcnt(3)
  v_dot2_f32_bf16 v8, v96, s32, v8
  v_dot2_f32_bf16 v9, v96, s33, v9
  v_dot2_f32_bf16 v10, v97, s32, v10
  v_dot2_f32_bf16 v11, v97, s33, v11
  v_dot2_f32_bf16 v12, v98, s32, v12
  v_dot2_f32_bf16 v13, v98, s33, v13
  v_dot2_f32_bf16 v14, v99, s32, v14
  v_dot2_f32_bf16 v15, v99, s33, v15
  s_waitcnt vmcnt(2)
  v_dot2_f32_bf16 v16, v192, s32, v16
  v_dot2_f32_bf16 v17, v192, s33, v17
  v_dot2_f32_bf16 v18, v193, s32, v18
  v_dot2_f32_bf16 v19, v193, s33, v19
  v_dot2_f32_bf16 v20, v194, s32, v20
  v_dot2_f32_bf16 v21, v194, s33, v21
  v_dot2_f32_bf16 v22, v195, s32, v22
  v_dot2_f32_bf16 v23, v195, s33, v23
  s_waitcnt vmcnt(1)
  v_dot2_f32_bf16 v8, v100, s32, v8
  v_dot2_f32_bf16 v9, v100, s33, v9
  v_dot2_f32_bf16 v10, v101, s32, v10
  v_dot2_f32_bf16 v11, v101, s33, v11
  v_dot2_f32_bf16 v12, v102, s32, v12
  v_dot2_f32_bf16 v13, v102, s33, v13
  v_dot2_f32_bf16 v14, v103, s32, v14
  v_dot2_f32_bf16 v15, v103, s33, v15
  s_waitcnt vmcnt(0)
  v_dot2_f32_bf16 v16, v196, s32, v16
  v_dot2_f32_bf16 v17, v196, s33, v17
  v_dot2_f32_bf16 v18, v197, s32, v18
  v_dot2_f32_bf16 v19, v197, s33, v19
  v_dot2_f32_bf16 v20, v198, s32, v20
  v_dot2_f32_bf16 v21, v198, s33, v21
  v_dot2_f32_bf16 v22, v199, s32, v22
  v_dot2_f32_bf16 v23, v199, s33, v23
  s_nop 2
  v_permlane32_swap_b32 v8, v12
  v_permlane32_swap_b32 v9, v13
  v_permlane32_swap_b32 v10, v14
  v_permlane32_swap_b32 v11, v15
  v_add_f32 v8, v8, v12
  v_add_f32 v9, v9, v13
  v_add_f32 v10, v10, v14
  v_add_f32 v11, v11, v15
  s_nop 0
  v_permlane16_swap_b32 v8, v10
  v_permlane16_swap_b32 v9, v11
  v_add_f32 v8, v8, v10
  v_add_f32 v9, v9, v11
  s_nop 0
  v_add_f32_dpp v8, v8, v8 row_ror:8 row_mask:0xf bank_mask:0xf
  v_add_f32_dpp v9, v9, v9 row_ror:8 row_mask:0xf bank_mask:0xf
  v_cndmask_b32 v8, v9, v8, vcc
  ds_write_b32 v27, v8 offset:0
  v_permlane32_swap_b32 v16, v20
  v_permlane32_swap_b32 v17, v21
  v_permlane32_swap_b32 v18, v22
  v_permlane32_swap_b32 v19, v23
  v_add_f32 v16, v16, v20
  v_add_f32 v17, v17, v21
  v_add_f32 v18, v18, v22
  v_add_f32 v19, v19, v23
  s_nop 0
  v_permlane16_swap_b32 v16, v18
  v_permlane16_swap_b32 v17, v19
  v_add_f32 v16, v16, v18
  v_add_f32 v17, v17, v19
  s_nop 0
  v_add_f32_dpp v16, v16, v16 row_ror:8 row_mask:0xf bank_mask:0xf
  v_add_f32_dpp v17, v17, v17 row_ror:8 row_mask:0xf bank_mask:0xf
  v_cndmask_b32 v16, v17, v16, vcc
  ds_write_b32 v27, v16 offset:1024
  s_waitcnt lgkmcnt(0)
  s_barrier
  v_bfe_u32 v10, v0, 6, 1
  v_lshlrev_b32 v11, 2, v7
  v_lshl_add_u32 v11, v10, 10, v11
  ds_read2st64_b32 v[12:13], v11 offset0:0 offset1:1
  ds_read2st64_b32 v[14:15], v11 offset0:2 offset1:3
  s_lshl_b32 s18, s16, 3
  v_mul_u32_u24 v10, 36864, v10
  v_cmp_gt_u32 vcc, 128, v0
  v_lshl_add_u32 v11, v7, 3, v10
  s_nop 0
  v_cndmask_b32 v11, 2.0, v11, vcc
  s_waitcnt lgkmcnt(1)
  v_add_f32 v12, v12, v13
  s_waitcnt lgkmcnt(0)
  v_add_f32 v14, v14, v15
  v_add_f32 v12, v12, v14
  v_cvt_pk_bf16_f32 v13, v12, v12
  v_and_b32 v15, 0xffff, v13
  v_and_b32 v13, 0xffff0000, v13
  v_sub_f32 v12, v12, v13
  v_cvt_pk_bf16_f32 v12, v12, v12
  v_and_or_b32 v14, v12, s34, v15
  buffer_store_dwordx2 v[14:15], v11, s[28:31], s18 offen sc1
v_add_u32 v108, 1, v108
v_not_b32 v109, v108
s_mul_i32 s68, s12, 18
s_add_u32 s68, s68, s15
s_lshl_b32 s68, s68, 3
s_waitcnt vmcnt(0) lgkmcnt(0)
s_barrier
buffer_store_dwordx2 v[108:109], v110, s[56:59], s68 offen offset:1152 sc1
buffer_store_dwordx2 v[108:109], v110, s[56:59], s68 offen offset:1224 sc1
LU_csdone:
v_mov_b32 v252, 2.0
s_load_dwordx2 s[4:5], s[0:1], 72
s_lshr_b32 s68, s2, 3
s_sub_u32 s69, s68, 18
s_cmp_ge_u32 s2, 240
s_cselect_b32 s68, s69, s68
s_mul_i32 s68, s68, 49152
s_add_u32 s68, s68, 0
s_mul_i32 s69, s12, 663552
v_lshlrev_b32 v4, 4, v0
s_waitcnt lgkmcnt(0)
s_add_u32 s20, s4, s69
s_addc_u32 s21, s5, 0
s_mov_b32 s22, 663552
s_mov_b32 s23, 0x20000
buffer_load_dwordx4 v[104:107], v4, s[20:23], s68 offen
s_add_u32 s68, s68, 4096
buffer_load_dwordx4 v[104:107], v4, s[20:23], s68 offen
s_add_u32 s68, s68, 4096
buffer_load_dwordx4 v[104:107], v4, s[20:23], s68 offen
s_add_u32 s68, s68, 4096
buffer_load_dwordx4 v[104:107], v4, s[20:23], s68 offen
s_add_u32 s68, s68, 4096
buffer_load_dwordx4 v[104:107], v4, s[20:23], s68 offen
s_add_u32 s68, s68, 4096
buffer_load_dwordx4 v[104:107], v4, s[20:23], s68 offen
s_add_u32 s68, s68, 4096
buffer_load_dwordx4 v[104:107], v4, s[20:23], s68 offen
s_add_u32 s68, s68, 4096
buffer_load_dwordx4 v[104:107], v4, s[20:23], s68 offen
s_add_u32 s68, s68, 4096
buffer_load_dwordx4 v[104:107], v4, s[20:23], s68 offen
s_add_u32 s68, s68, 4096
buffer_load_dwordx4 v[104:107], v4, s[20:23], s68 offen
s_add_u32 s68, s68, 4096
buffer_load_dwordx4 v[104:107], v4, s[20:23], s68 offen
s_add_u32 s68, s68, 4096
buffer_load_dwordx4 v[104:107], v4, s[20:23], s68 offen
s_add_u32 s68, s68, 4096
s_branch L3_entry
LU_conv:
  buffer_load_dword v35, v3, s[28:31], 0 offen offset:0
  buffer_load_dword v36, v3, s[28:31], 0 offen offset:1152
  buffer_load_dword v37, v3, s[28:31], 0 offen offset:2304
  buffer_load_dword v38, v3, s[28:31], 0 offen offset:3456
  buffer_load_dword v39, v5, s[28:31], 0 offen offset:0
  buffer_load_dword v40, v5, s[28:31], 0 offen offset:1152
  buffer_load_dword v41, v5, s[28:31], 0 offen offset:2304
  buffer_load_dword v42, v5, s[28:31], 0 offen offset:3456
  v_lshrrev_b32 v148, 6, v0
  v_and_b32 v149, 63, v0
  v_readfirstlane_b32 s62, v148
  v_lshlrev_b32 v149, 4, v149
  s_sub_u32 s63, s2, 96
  s_lshl_b32 s64, s63, 2
  s_nop 0
  s_add_u32 s64, s64, s62
  s_lshl_b32 s64, s64, 12
  s_mov_b32 s62, 2359296
  s_lshl_b32 s65, s63, 11
  s_mov_b32 s63, 0x20000
  buffer_load_dwordx4 v[128:131], v149, s[60:63], s64 offen offset:0
  buffer_load_dword v144, v149, s[60:63], s64 offen offset:16
  buffer_load_dwordx4 v[132:135], v149, s[60:63], s64 offen offset:1024
  buffer_load_dword v145, v149, s[60:63], s64 offen offset:1040
  buffer_load_dwordx4 v[136:139], v149, s[60:63], s64 offen offset:2048
  buffer_load_dword v146, v149, s[60:63], s64 offen offset:2064
  buffer_load_dwordx4 v[140:143], v149, s[60:63], s64 offen offset:3072
  buffer_load_dword v147, v149, s[60:63], s64 offen offset:3088
  buffer_load_dword v242, off, s[56:59], s65 offset:1024 sc1
  v_cmp_gt_u32 vcc, 16, v0
  v_add_u32 v252, 0, v0
  v_mul_u32_u24 v252, 4096, v252
  v_cndmask_b32 v252, 2.0, v252, vcc
  buffer_load_dword v250, v252, s[52:55], 0 offen offset:3584 sc1
  s_mov_b32 s36, s12
  s_mov_b32 s37, s13
  s_mov_b32 s38, 2359296
  s_mov_b32 s39, 0x20000
  s_add_u32 s40, s12, 2359296
  s_addc_u32 s41, s13, 0
  s_mov_b32 s42, 2359296
  s_mov_b32 s43, 0x20000
  s_lshl_b32 s18, s14, 18
  s_lshl_b32 s19, s3, 7
  v_and_b32 v13, 7, v1
  v_xor_b32 v14, v13, v2
  v_lshlrev_b32 v11, 8, v1
  v_lshl_add_u32 v11, v14, 4, v11
  v_xor_b32 v10, 0x70, v11
  v_lshrrev_b32 v13, 3, v0
  v_and_b32 v14, 7, v0
  v_bfe_u32 v15, v0, 4, 3
  v_xor_b32 v15, v15, v14
  v_lshlrev_b32 v12, 7, v13
  v_lshl_add_u32 v12, v15, 4, v12
  v_lshlrev_b32 v7, 12, v13
  v_lshl_add_u32 v7, v14, 4, v7
  v_add_u32 v7, s18, v7
  v_add_u32 v9, s19, v7
  s_sub_u32 s19, 3968, s19
  v_add_u32 v8, s19, v7
  s_mov_b32 s44, 131072
  s_mov_b32 s45, 0x05040100
  s_mov_b32 s46, 0x07060302
  s_lshl_b32 s47, s3, 3
  s_mov_b32 s48, 0x200000
  s_mov_b32 s49, 0x220000
  s_waitcnt vmcnt(20)
  s_swappc_b64 s[100:101], s[98:99]
  ds_write_b128 v10, v[112:115] offset:0
  ds_write_b128 v10, v[116:119] offset:128
  s_waitcnt lgkmcnt(0)
  s_barrier
  ds_read_b128 v[96:99], v12 offset:0
  ds_read_b128 v[100:103], v12 offset:4096
  s_waitcnt lgkmcnt(1)
  buffer_store_dwordx4 v[96:99], v8, s[36:39], 0 offen sc1
  s_waitcnt lgkmcnt(0)
  buffer_store_dwordx4 v[100:103], v8, s[36:39], s44 offen sc1
  s_sub_u32 s64, s2, 96
  s_lshr_b32 s65, s64, 3
  s_mul_i32 s65, s65, 294912
  s_and_b32 s64, s64, 7
  s_mul_i32 s64, s64, 1152
  s_add_u32 s65, s65, s64
  s_add_u32 s65, s65, 640
  v_lshrrev_b32 v148, 5, v0
  v_mul_u32_u24 v148, 9216, v148
  v_and_b32 v149, 31, v0
  v_lshl_add_u32 v148, v149, 4, v148
  s_mov_b32 s60, s68
  s_mov_b32 s61, s69
  s_mov_b32 s62, 5308416
  s_mov_b32 s63, 0x20000
  s_mov_b32 s72, s70
  s_mov_b32 s73, s71
  s_mov_b32 s74, 5308416
  s_mov_b32 s75, 0x20000
  buffer_load_dwordx4 v[244:247], v148, s[60:63], s65 offen
  buffer_load_dwordx4 v[244:247], v148, s[72:75], s65 offen
  s_add_u32 s65, s65, 73728
  buffer_load_dwordx4 v[244:247], v148, s[60:63], s65 offen
  buffer_load_dwordx4 v[244:247], v148, s[72:75], s65 offen
  s_add_u32 s65, s65, 73728
  buffer_load_dwordx4 v[244:247], v148, s[60:63], s65 offen
  buffer_load_dwordx4 v[244:247], v148, s[72:75], s65 offen
  s_add_u32 s65, s65, 73728
  buffer_load_dwordx4 v[244:247], v148, s[60:63], s65 offen
  buffer_load_dwordx4 v[244:247], v148, s[72:75], s65 offen
  s_add_u32 s65, s65, 73728
  s_waitcnt vmcnt(26)
  v_perm_b32 v120, v36, v35, s45
  s_waitcnt vmcnt(24)
  v_perm_b32 v121, v38, v37, s45
  s_waitcnt vmcnt(22)
  v_perm_b32 v122, v40, v39, s45
  s_waitcnt vmcnt(20)
  v_perm_b32 v123, v42, v41, s45
  v_perm_b32 v124, v36, v35, s46
  v_perm_b32 v125, v38, v37, s46
  v_perm_b32 v126, v40, v39, s46
  v_perm_b32 v127, v42, v41, s46
  ds_write_b128 v11, v[120:123] offset:8192
  ds_write_b128 v11, v[124:127] offset:8320
  v_add_u32 v108, 1, v108
  v_not_b32 v109, v108
  s_waitcnt vmcnt(8) lgkmcnt(0)
  s_barrier
  buffer_store_dwordx2 v[108:109], v110, s[56:59], s47 offen offset:0 sc1
  ds_read_b128 v[96:99], v12 offset:8192
  ds_read_b128 v[100:103], v12 offset:12288
  s_waitcnt lgkmcnt(1)
  buffer_store_dwordx4 v[96:99], v9, s[40:43], 0 offen sc1
  s_waitcnt lgkmcnt(0)
  buffer_store_dwordx4 v[100:103], v9, s[40:43], s44 offen sc1
  v_mov_b32 v248, v108
  v_mov_b32 v249, v109
  v_mov_b32 v253, v110
  s_mov_b32 s83, s47
  s_sub_u32 s46, s2, 96
  s_load_dwordx4 s[60:63], s[0:1], 56
  s_load_dwordx2 s[48:49], s[0:1], 72
  s_getpc_b64 s[50:51]
LU_pc:
  s_add_u32 s50, s50, L3_entry-LU_pc
  s_addc_u32 s51, s51, 0
  s_load_dwordx2 s[6:7], s[0:1], 40
  s_mov_b64 s[8:9], s[12:13]
  v_lshrrev_b32 v1, 6, v0
  v_and_b32 v2, 63, v0
  v_readfirstlane_b32 s3, v1
  v_lshlrev_b32 v3, 4, v2
  v_and_b32 v4, 15, v2
  v_lshrrev_b32 v5, 4, v2
  s_lshl_b32 s10, s46, 2
  s_add_u32 s10, s10, s3
  s_mul_i32 s11, s3, 12928
  s_add_u32 s11, s11, 32768
  s_lshl_b32 s12, s10, 12
  s_lshr_b32 s13, s10, 1
  s_lshl_b32 s13, s13, 2
  s_waitcnt lgkmcnt(0)
  s_load_dword s14, s[6:7], s13
  s_mov_b32 s20, s8
  s_mov_b32 s21, s9
  s_mov_b32 s22, 2359296
  s_mov_b32 s23, 0x20000
  s_add_u32 m0, s11, 8320
  s_add_u32 s76, s8, 7340032
  s_addc_u32 s77, s9, 0
  s_mov_b32 s78, 294912
  s_mov_b32 s79, 0x20000
  s_lshl_b32 s80, s46, 11
  s_mov_b32 s52, s48
  s_mov_b32 s53, s49
  s_mov_b32 s54, 5308416
  s_mov_b32 s55, 0x20000
  s_and_b32 s72, s46, 7
  s_mul_i32 s72, s72, 663552
  s_lshr_b32 s73, s46, 3
  s_mul_i32 s73, s73, 0
  s_add_u32 s75, s72, s73
  s_add_u32 s24, s8, 2359296
  s_addc_u32 s25, s9, 0
  s_mov_b32 s26, 2359296
  s_mov_b32 s27, 0x20000
  s_add_u32 s28, s8, 7077888
  s_addc_u32 s29, s9, 0
  s_mov_b32 s30, 16384
  s_mov_b32 s31, 0x20000
  s_add_u32 s32, s8, 4718592
  s_addc_u32 s33, s9, 0
  s_mov_b32 s34, 2359296
  s_mov_b32 s35, 0x20000
  v_lshlrev_b32 v224, 5, v4
  v_lshl_add_u32 v224, v5, 3, v224
  v_lshlrev_b32 v225, 1, v224
  s_movk_i32 s36, 4096
  s_movk_i32 s37, 8192
  s_movk_i32 s38, 12288
  s_and_b32 s84, s46, 7
  s_mul_i32 s84, s84, 663552
  s_lshr_b32 s85, s46, 3
  s_mul_i32 s86, s85, 36864
  s_add_u32 s84, s84, s86
  s_lshl_b32 s85, s85, 12
  v_lshlrev_b32 v6, 4, v0
  v_add_u32 v7, s85, v6
  v_min_u32 v234, L3_codeend-L3_entry-16, v7
  v_mov_b32 v233, v6
  s_and_b32 s88, s3, 1
  s_cmp_eq_u32 s88, 0
  s_cselect_b32 s64, s60, s62
  s_cselect_b32 s65, s61, s63
  s_mov_b32 s66, 5308416
  s_mov_b32 s67, 0x20000
  s_lshr_b32 s88, s46, 3
  s_lshl_b32 s88, s88, 1
  s_lshr_b32 s87, s3, 1
  s_add_u32 s88, s88, s87
  s_mul_i32 s88, s88, 147456
  s_and_b32 s87, s46, 7
  s_mul_i32 s87, s87, 1152
  s_add_u32 s88, s88, s87
  v_mul_u32_u24 v6, 43, v2
  v_lshrrev_b32 v6, 7, v6
  v_mul_u32_u24 v7, 3, v6
  v_sub_u32 v7, v2, v7
  v_mul_u32_u24 v6, 9216, v6
  v_lshl_add_u32 v6, v7, 7, v6
  v_cmp_gt_u32 vcc, 48, v2
  s_nop 1
  v_cndmask_b32 v235, 2.0, v6, vcc
  v_add_u32 v232, s11, v3
  v_mov_b32 v28, 0
  v_mov_b32 v29, 0
  v_lshlrev_b32 v6, 3, v2
  v_add_u32 v6, s11, v6
  s_waitcnt lgkmcnt(0)
  s_and_b32 s15, s10, 1
  s_lshl_b32 s15, s15, 4
  s_lshr_b32 s14, s14, s15
  s_lshl_b32 s14, s14, 16
  ds_write_b64 v6, v[28:29] offset:12416
  v_and_b32 v7, 1, v4
  v_add_u32 v30, 1, v4
  v_and_b32 v30, 30, v30
  v_lshlrev_b32 v30, 1, v30
  v_mul_u32_u24 v7, 4160, v7
  v_sub_u32 v30, v30, v7
  v_lshl_add_u32 v30, v5, 4, v30
  v_add_u32 v30, 4160, v30
  v_add_u32 v226, s11, v30
  v_add_u32 v227, 1024, v226
  v_add_u32 v228, 2048, v226
  v_add_u32 v229, 3072, v226
  v_lshlrev_b32 v30, 5, v4
  v_sub_u32 v30, 8800, v30
  v_lshl_add_u32 v230, v5, 4, v30
  v_add_u32 v230, s11, v230
  v_sub_u32 v231, 8824, v224
  v_add_u32 v231, s11, v231
  v_lshlrev_b32 v6, 2, v2
  v_add_u32 v6, s11, v6
  v_cmp_eq_u32 s[40:41], 7, v2
  v_cmp_gt_u32 s[42:43], 8, v2
  ds_write_b128 v232, v[128:131] offset:32
  v_readfirstlane_b32 s39, v128
  v_alignbit_b32 v148, v129, v128, 16
  v_alignbit_b32 v149, v130, v129, 16
  v_alignbit_b32 v150, v131, v130, 16
  v_alignbit_b32 v151, v144, v131, 16
  ds_write_b128 v232, v[148:151] offset:4192
  s_lshl_b32 s39, s39, 16
  v_mov_b32 v31, s39
  v_cndmask_b32 v31, 0, v31, s[40:41]
  s_mov_b64 s[44:45], exec
  s_mov_b64 exec, s[42:43]
  ds_write_b32 v6, v28 offset:0
  ds_write_b32 v6, v31 offset:4160
  s_mov_b64 exec, s[44:45]
  ds_write_b128 v232, v[132:135] offset:1056
  v_alignbit_b32 v152, v133, v132, 16
  v_alignbit_b32 v153, v134, v133, 16
  v_alignbit_b32 v154, v135, v134, 16
  v_alignbit_b32 v155, v145, v135, 16
  ds_write_b128 v232, v[152:155] offset:5216
  ds_write_b128 v232, v[136:139] offset:2080
  v_alignbit_b32 v148, v137, v136, 16
  v_alignbit_b32 v149, v138, v137, 16
  v_alignbit_b32 v150, v139, v138, 16
  v_alignbit_b32 v151, v146, v139, 16
  ds_write_b128 v232, v[148:151] offset:6240
  ds_write_b128 v232, v[140:143] offset:3104
  v_alignbit_b32 v152, v141, v140, 16
  v_alignbit_b32 v153, v142, v141, 16
  v_alignbit_b32 v154, v143, v142, 16
  v_alignbit_b32 v155, v147, v143, 16
  ds_write_b128 v232, v[152:155] offset:7264
  v_and_b32 v6, 31, v2
  v_lshlrev_b32 v6, 3, v6
  v_lshlrev_b32 v7, 3, v2
  v_add_u32 v30, 1, v242
  v_not_b32 v31, v30
  ds_read2_b32 v[64:65], v226 offset0:0 offset1:1
  ds_read2_b32 v[66:67], v226 offset0:2 offset1:3
  ds_read2_b32 v[68:69], v226 offset0:128 offset1:129
  ds_read2_b32 v[70:71], v226 offset0:130 offset1:131
  ds_read2_b32 v[72:73], v227 offset0:0 offset1:1
  ds_read2_b32 v[74:75], v227 offset0:2 offset1:3
  ds_read2_b32 v[76:77], v227 offset0:128 offset1:129
  ds_read2_b32 v[78:79], v227 offset0:130 offset1:131
  ds_read2_b32 v[80:81], v228 offset0:0 offset1:1
  ds_read2_b32 v[82:83], v228 offset0:2 offset1:3
  ds_read2_b32 v[84:85], v228 offset0:128 offset1:129
  ds_read2_b32 v[86:87], v228 offset0:130 offset1:131
  ds_read2_b32 v[88:89], v229 offset0:0 offset1:1
  ds_read2_b32 v[90:91], v229 offset0:2 offset1:3
  ds_read2_b32 v[92:93], v229 offset0:128 offset1:129
  ds_read2_b32 v[94:95], v229 offset0:130 offset1:131
  s_lshl_b32 s72, s46, 3
  v_add_u32 v252, s72, v252
  v_add_u32 v250, 1, v250
  v_not_b32 v251, v250
  s_waitcnt vmcnt(0) lgkmcnt(0)
  s_barrier
  buffer_store_dwordx2 v[248:249], v253, s[56:59], s83 offen offset:768 sc1
s_mov_b32 s68, s62
s_mov_b32 s69, s63
s_mov_b32 s70, 5308416
s_mov_b32 s71, 0x20000

v_lshrrev_b32 v8, 5, v2
v_mul_u32_u24 v8, 9216, v8
v_and_b32 v9, 31, v0
v_lshl_add_u32 v9, v9, 4, v8
s_lshr_b32 s72, s46, 3
s_lshl_b32 s72, s72, 5
s_mul_i32 s73, s3, 12
s_add_u32 s72, s72, s73
s_sub_u32 s72, s72, 12
s_mul_i32 s72, s72, 9216
s_and_b32 s73, s46, 7
s_mul_i32 s73, s73, 1152
s_add_u32 s72, s72, s73
s_add_u32 s81, s72, 640
s_cmp_eq_u32 s3, 0
s_cbranch_scc1 LU_nomid
LU_nomid:
s_mov_b32 s82, 1
s_branch LU_pad0
LU_slow:
s_add_u32 s74, s74, 1
s_cmp_ge_u32 s74, 0x40000
s_cbranch_scc1 LU_ok
s_sleep 1
buffer_load_dwordx2 v[10:11], v6, s[76:79], s80 offen offset:768 sc1
buffer_load_dwordx2 v[12:13], v7, s[76:79], s80 offen offset:256 sc1
s_waitcnt vmcnt(0)
v_cmp_ne_u64 vcc, v[10:11], v[30:31]
v_cmp_ne_u64 s[72:73], v[12:13], v[30:31]
s_nop 3
s_or_b64 vcc, vcc, s[72:73]
s_cbranch_scc1 LU_slow
s_branch LU_ok
.p2align 12
LU_main:
  s_mov_b32 s82, 0
  s_mov_b32 s74, 0
  s_cmp_lg_u32 s3, 0
  s_cbranch_scc1 LU_sync
LU_poll:
  s_add_u32 s74, s74, 1
  s_cmp_ge_u32 s74, 0x40000
  s_cbranch_scc1 LU_sync
  s_sleep 1
  buffer_load_dwordx2 v[10:11], v6, s[76:79], s80 offen sc1
  s_waitcnt vmcnt(0)
  v_cmp_ne_u64 vcc, v[10:11], v[30:31]
  s_nop 3
  s_cbranch_vccnz LU_poll
LU_sync:
  s_barrier
  buffer_load_dwordx4 v3, s[20:23], s12 offen offset:0 sc1 lds
  buffer_load_dwordx4 v3, s[20:23], s12 offen offset:1024 sc1 lds
  buffer_load_dwordx4 v3, s[20:23], s12 offen offset:2048 sc1 lds
  buffer_load_dwordx4 v3, s[20:23], s12 offen offset:3072 sc1 lds
  s_waitcnt vmcnt(3)
  ds_read_b128 v[124:127], v230 offset:0
  s_waitcnt vmcnt(2)
  ds_read_b128 v[120:123], v230 offset:512
  ds_read_b128 v[116:119], v230 offset:1024
  s_waitcnt vmcnt(1)
  ds_read_b128 v[112:115], v230 offset:1536
  ds_read_b128 v[108:111], v230 offset:2048
  s_waitcnt vmcnt(0)
  ds_read_b128 v[104:107], v230 offset:2560
  ds_read_b128 v[100:103], v230 offset:3072
  ds_read_b128 v[96:99], v230 offset:3584
  s_waitcnt lgkmcnt(7)
  v_mfma_f32_16x16x32_bf16 v[60:63], v[64:67], v[124:127], 0
  s_waitcnt lgkmcnt(6)
  ds_read_b128 v[124:127], v230 offset:64
  v_mfma_f32_16x16x32_bf16 v[56:59], v[64:67], v[120:123], 0
  s_waitcnt lgkmcnt(6)
  buffer_load_dwordx2 v[10:11], v6, s[76:79], s80 offen offset:768 sc1
  v_mfma_f32_16x16x32_bf16 v[52:55], v[64:67], v[116:119], 0
  s_waitcnt lgkmcnt(5)
  v_mfma_f32_16x16x32_bf16 v[48:51], v[64:67], v[112:115], 0
  s_waitcnt lgkmcnt(4)
  buffer_load_dwordx2 v[12:13], v7, s[76:79], s80 offen offset:256 sc1
  v_mfma_f32_16x16x32_bf16 v[44:47], v[64:67], v[108:111], 0
  s_waitcnt lgkmcnt(3)
  v_mfma_f32_16x16x32_bf16 v[40:43], v[64:67], v[104:107], 0
  s_waitcnt lgkmcnt(2)
  v_mfma_f32_16x16x32_bf16 v[36:39], v[64:67], v[100:103], 0
  s_waitcnt lgkmcnt(1)
  v_mfma_f32_16x16x32_bf16 v[32:35], v[64:67], v[96:99], 0
  ds_read2_b32 v[64:65], v226 offset0:16 offset1:17
  v_mfma_f32_16x16x32_bf16 v[60:63], v[68:71], v[120:123], v[60:63]
  ds_read2_b32 v[66:67], v226 offset0:18 offset1:19
  v_mfma_f32_16x16x32_bf16 v[56:59], v[68:71], v[116:119], v[56:59]
  ds_read_b128 v[120:123], v230 offset:576
  v_mfma_f32_16x16x32_bf16 v[52:55], v[68:71], v[112:115], v[52:55]
  v_mfma_f32_16x16x32_bf16 v[48:51], v[68:71], v[108:111], v[48:51]
  v_mfma_f32_16x16x32_bf16 v[44:47], v[68:71], v[104:107], v[44:47]
  v_mfma_f32_16x16x32_bf16 v[40:43], v[68:71], v[100:103], v[40:43]
  v_mfma_f32_16x16x32_bf16 v[36:39], v[68:71], v[96:99], v[36:39]
  ds_read2_b32 v[68:69], v226 offset0:144 offset1:145
  v_mfma_f32_16x16x32_bf16 v[60:63], v[72:75], v[116:119], v[60:63]
  ds_read_b128 v[116:119], v230 offset:1088
  v_mfma_f32_16x16x32_bf16 v[56:59], v[72:75], v[112:115], v[56:59]
  ds_read2_b32 v[70:71], v226 offset0:146 offset1:147
  v_mfma_f32_16x16x32_bf16 v[52:55], v[72:75], v[108:111], v[52:55]
  v_mfma_f32_16x16x32_bf16 v[48:51], v[72:75], v[104:107], v[48:51]
  v_mfma_f32_16x16x32_bf16 v[44:47], v[72:75], v[100:103], v[44:47]
  v_mfma_f32_16x16x32_bf16 v[40:43], v[72:75], v[96:99], v[40:43]
  ds_read2_b32 v[72:73], v227 offset0:16 offset1:17
  v_mfma_f32_16x16x32_bf16 v[60:63], v[76:79], v[112:115], v[60:63]
  ds_read_b128 v[112:115], v230 offset:1600
  v_mfma_f32_16x16x32_bf16 v[56:59], v[76:79], v[108:111], v[56:59]
  ds_read2_b32 v[74:75], v227 offset0:18 offset1:19
  v_mfma_f32_16x16x32_bf16 v[52:55], v[76:79], v[104:107], v[52:55]
  v_mfma_f32_16x16x32_bf16 v[48:51], v[76:79], v[100:103], v[48:51]
  s_waitcnt vmcnt(0)
  v_cmp_ne_u64 vcc, v[10:11], v[30:31]
  v_cmp_ne_u64 s[72:73], v[12:13], v[30:31]
  s_nop 3
  s_or_b64 vcc, vcc, s[72:73]
  s_cbranch_scc1 LU_slow
LU_ok:
  v_mfma_f32_16x16x32_bf16 v[44:47], v[76:79], v[96:99], v[44:47]
  buffer_load_dwordx2 v[128:129], v224, s[24:27], s12 offen offset:0 sc1
  v_mfma_f32_16x16x32_bf16 v[60:63], v[80:83], v[108:111], v[60:63]
  ds_read_b128 v[108:111], v230 offset:2112
  v_mfma_f32_16x16x32_bf16 v[56:59], v[80:83], v[104:107], v[56:59]
  ds_read2_b32 v[76:77], v227 offset0:144 offset1:145
  v_mfma_f32_16x16x32_bf16 v[52:55], v[80:83], v[100:103], v[52:55]
  ds_read2_b32 v[78:79], v227 offset0:146 offset1:147
  v_cmp_eq_u32 vcc, 0, v0
  v_mfma_f32_16x16x32_bf16 v[48:51], v[80:83], v[96:99], v[48:51]
  buffer_load_dwordx4 v[144:147], v225, s[28:31], 0 offen offset:0 sc1
  v_mfma_f32_16x16x32_bf16 v[60:63], v[84:87], v[104:107], v[60:63]
  ds_read_b128 v[104:107], v230 offset:2624
  v_cndmask_b32 v8, 2.0, 0, vcc
  v_mfma_f32_16x16x32_bf16 v[56:59], v[84:87], v[100:103], v[56:59]
  ds_read2_b32 v[80:81], v228 offset0:16 offset1:17
  v_mfma_f32_16x16x32_bf16 v[52:55], v[84:87], v[96:99], v[52:55]
  ds_read2_b32 v[82:83], v228 offset0:18 offset1:19
  v_mfma_f32_16x16x32_bf16 v[60:63], v[88:91], v[100:103], v[60:63]
  buffer_load_dwordx4 v[176:179], v225, s[28:31], s37 offen offset:0 sc1
  v_mfma_f32_16x16x32_bf16 v[56:59], v[88:91], v[96:99], v[56:59]
  ds_read_b128 v[100:103], v230 offset:3136
  v_mfma_f32_16x16x32_bf16 v[60:63], v[92:95], v[96:99], v[60:63]
  s_waitcnt lgkmcnt(14)
  ds_read_b128 v[96:99], v230 offset:3648
  v_mfma_f32_16x16x32_bf16 v[60:63], v[64:67], v[124:127], v[60:63]
  s_waitcnt lgkmcnt(14)
  ds_read2_b32 v[84:85], v228 offset0:144 offset1:145
  v_mfma_f32_16x16x32_bf16 v[56:59], v[64:67], v[120:123], v[56:59]
  s_waitcnt lgkmcnt(13)
  buffer_load_dwordx2 v[130:131], v224, s[24:27], s12 offen offset:512 sc1
  v_mfma_f32_16x16x32_bf16 v[52:55], v[64:67], v[116:119], v[52:55]
  s_waitcnt lgkmcnt(10)
  ds_read2_b32 v[86:87], v228 offset0:146 offset1:147
  v_mfma_f32_16x16x32_bf16 v[48:51], v[64:67], v[112:115], v[48:51]
  s_waitcnt lgkmcnt(9)
  ds_read2_b32 v[88:89], v229 offset0:16 offset1:17
  v_mfma_f32_16x16x32_bf16 v[44:47], v[64:67], v[108:111], v[44:47]
  s_waitcnt lgkmcnt(7)
  ds_read2_b32 v[90:91], v229 offset0:18 offset1:19
  v_mfma_f32_16x16x32_bf16 v[40:43], v[64:67], v[104:107], v[40:43]
  s_waitcnt lgkmcnt(5)
  buffer_load_dwordx4 v[148:151], v225, s[28:31], 0 offen offset:1024 sc1
  v_mfma_f32_16x16x32_bf16 v[36:39], v[64:67], v[100:103], v[36:39]
  s_waitcnt lgkmcnt(4)
  ds_read2_b32 v[92:93], v229 offset0:144 offset1:145
  v_mfma_f32_16x16x32_bf16 v[32:35], v[64:67], v[96:99], v[32:35]
  ds_read2_b32 v[94:95], v229 offset0:146 offset1:147
  v_mfma_f32_16x16x32_bf16 v[60:63], v[68:71], v[120:123], v[60:63]
  ds_read2_b32 v[64:65], v226 offset0:32 offset1:33
  v_mfma_f32_16x16x32_bf16 v[56:59], v[68:71], v[116:119], v[56:59]
  buffer_load_dwordx4 v[180:183], v225, s[28:31], s37 offen offset:1024 sc1
  v_mfma_f32_16x16x32_bf16 v[52:55], v[68:71], v[112:115], v[52:55]
  ds_read2_b32 v[66:67], v226 offset0:34 offset1:35
  v_mfma_f32_16x16x32_bf16 v[48:51], v[68:71], v[108:111], v[48:51]
  ds_read_b128 v[124:127], v230 offset:128
  v_mfma_f32_16x16x32_bf16 v[44:47], v[68:71], v[104:107], v[44:47]
  ds_read_b128 v[120:123], v230 offset:640
  v_mfma_f32_16x16x32_bf16 v[40:43], v[68:71], v[100:103], v[40:43]
  buffer_load_dwordx2 v[132:133], v224, s[24:27], s12 offen offset:1024 sc1
  v_mfma_f32_16x16x32_bf16 v[36:39], v[68:71], v[96:99], v[36:39]
  ds_read2_b32 v[68:69], v226 offset0:160 offset1:161
  v_mfma_f32_16x16x32_bf16 v[60:63], v[72:75], v[116:119], v[60:63]
  ds_read_b128 v[116:119], v230 offset:1152
  v_mfma_f32_16x16x32_bf16 v[56:59], v[72:75], v[112:115], v[56:59]
  ds_read2_b32 v[70:71], v226 offset0:162 offset1:163
  v_mfma_f32_16x16x32_bf16 v[52:55], v[72:75], v[108:111], v[52:55]
  buffer_load_dwordx4 v[152:155], v225, s[28:31], 0 offen offset:2048 sc1
  v_mfma_f32_16x16x32_bf16 v[48:51], v[72:75], v[104:107], v[48:51]
  ds_read_b64 v[208:209], v231 offset:3584
  v_mfma_f32_16x16x32_bf16 v[44:47], v[72:75], v[100:103], v[44:47]
  ds_read_b64 v[210:211], v231 offset:3072
  v_mfma_f32_16x16x32_bf16 v[40:43], v[72:75], v[96:99], v[40:43]
  ds_read2_b32 v[72:73], v227 offset0:32 offset1:33
  v_mfma_f32_16x16x32_bf16 v[60:63], v[76:79], v[112:115], v[60:63]
  buffer_load_dwordx4 v[184:187], v225, s[28:31], s37 offen offset:2048 sc1
  v_mfma_f32_16x16x32_bf16 v[56:59], v[76:79], v[108:111], v[56:59]
  ds_read_b128 v[112:115], v230 offset:1664
  v_mfma_f32_16x16x32_bf16 v[52:55], v[76:79], v[104:107], v[52:55]
  ds_read2_b32 v[74:75], v227 offset0:34 offset1:35
  v_mfma_f32_16x16x32_bf16 v[48:51], v[76:79], v[100:103], v[48:51]
  ds_read_b64 v[212:213], v231 offset:2560
  v_mfma_f32_16x16x32_bf16 v[44:47], v[76:79], v[96:99], v[44:47]
  buffer_load_dwordx2 v[134:135], v224, s[24:27], s12 offen offset:1536 sc1
  v_mfma_f32_16x16x32_bf16 v[60:63], v[80:83], v[108:111], v[60:63]
  ds_read_b128 v[108:111], v230 offset:2176
  v_mfma_f32_16x16x32_bf16 v[56:59], v[80:83], v[104:107], v[56:59]
  s_waitcnt vmcnt(9)
  ds_read2_b32 v[76:77], v227 offset0:160 offset1:161
  v_lshlrev_b32 v236, 16, v128
  v_mfma_f32_16x16x32_bf16 v[52:55], v[80:83], v[100:103], v[52:55]
  s_waitcnt lgkmcnt(7)
  ds_read2_b32 v[78:79], v227 offset0:162 offset1:163
  v_and_b32 v237, 0xffff0000, v209
  v_mfma_f32_16x16x32_bf16 v[48:51], v[80:83], v[96:99], v[48:51]
  buffer_load_dwordx4 v[156:159], v225, s[28:31], 0 offen offset:3072 sc1
  v_mfma_f32_16x16x32_bf16 v[60:63], v[84:87], v[104:107], v[60:63]
  s_waitcnt vmcnt(8)
  ds_read_b128 v[104:107], v230 offset:2688
  v_fma_f32 v144, v144, v236, v176
  v_mfma_f32_16x16x32_bf16 v[56:59], v[84:87], v[100:103], v[56:59]
  ds_read2_b32 v[80:81], v228 offset0:32 offset1:33
  v_mul_f32 v237, s14, v237
  v_mfma_f32_16x16x32_bf16 v[52:55], v[84:87], v[96:99], v[52:55]
  ds_read2_b32 v[82:83], v228 offset0:34 offset1:35
  v_fma_f32 v176, v144, v237, v236
  v_mfma_f32_16x16x32_bf16 v[60:63], v[88:91], v[100:103], v[60:63]
  buffer_load_dwordx4 v[188:191], v225, s[28:31], s37 offen offset:3072 sc1
  v_mfma_f32_16x16x32_bf16 v[56:59], v[88:91], v[96:99], v[56:59]
  ds_read_b128 v[100:103], v230 offset:3200
  v_and_b32 v238, 0xffff0000, v128
  v_mfma_f32_16x16x32_bf16 v[60:63], v[92:95], v[96:99], v[60:63]
  ds_read_b128 v[96:99], v230 offset:3712
  v_lshlrev_b32 v239, 16, v209
  v_mfma_f32_16x16x32_bf16 v[60:63], v[64:67], v[124:127], v[60:63]
  ds_read2_b32 v[84:85], v228 offset0:160 offset1:161
  v_fma_f32 v145, v145, v238, v177
  v_mfma_f32_16x16x32_bf16 v[56:59], v[64:67], v[120:123], v[56:59]
  buffer_load_dwordx2 v[136:137], v224, s[24:27], s12 offen offset:2048 sc1
  v_mfma_f32_16x16x32_bf16 v[52:55], v[64:67], v[116:119], v[52:55]
  s_waitcnt lgkmcnt(11)
  ds_read2_b32 v[86:87], v228 offset0:162 offset1:163
  v_mul_f32 v239, s14, v239
  v_mfma_f32_16x16x32_bf16 v[48:51], v[64:67], v[112:115], v[48:51]
  s_waitcnt lgkmcnt(9)
  ds_read2_b32 v[88:89], v229 offset0:32 offset1:33
  v_fma_f32 v177, v145, v239, v238
  v_mfma_f32_16x16x32_bf16 v[44:47], v[64:67], v[108:111], v[44:47]
  s_waitcnt lgkmcnt(7)
  ds_read2_b32 v[90:91], v229 offset0:34 offset1:35
  v_lshlrev_b32 v236, 16, v129
  v_mfma_f32_16x16x32_bf16 v[40:43], v[64:67], v[104:107], v[40:43]
  s_waitcnt lgkmcnt(5)
  buffer_load_dwordx4 v[160:163], v225, s[28:31], s36 offen offset:0 sc1
  v_mfma_f32_16x16x32_bf16 v[36:39], v[64:67], v[100:103], v[36:39]
  s_waitcnt lgkmcnt(4)
  ds_read2_b32 v[92:93], v229 offset0:160 offset1:161
  v_and_b32 v237, 0xffff0000, v208
  v_mfma_f32_16x16x32_bf16 v[32:35], v[64:67], v[96:99], v[32:35]
  ds_read2_b32 v[94:95], v229 offset0:162 offset1:163
  v_fma_f32 v146, v146, v236, v178
  v_mfma_f32_16x16x32_bf16 v[60:63], v[68:71], v[120:123], v[60:63]
  ds_read2_b32 v[64:65], v226 offset0:48 offset1:49
  v_mul_f32 v237, s14, v237
  v_mfma_f32_16x16x32_bf16 v[56:59], v[68:71], v[116:119], v[56:59]
  buffer_load_dwordx4 v[192:195], v225, s[28:31], s38 offen offset:0 sc1
  v_mfma_f32_16x16x32_bf16 v[52:55], v[68:71], v[112:115], v[52:55]
  ds_read2_b32 v[66:67], v226 offset0:50 offset1:51
  v_fma_f32 v178, v146, v237, v236
  v_mfma_f32_16x16x32_bf16 v[48:51], v[68:71], v[108:111], v[48:51]
  ds_read_b128 v[124:127], v230 offset:192
  v_and_b32 v238, 0xffff0000, v129
  v_mfma_f32_16x16x32_bf16 v[44:47], v[68:71], v[104:107], v[44:47]
  ds_read_b128 v[120:123], v230 offset:704
  v_lshlrev_b32 v239, 16, v208
  v_mfma_f32_16x16x32_bf16 v[40:43], v[68:71], v[100:103], v[40:43]
  buffer_load_dwordx2 v[138:139], v224, s[24:27], s12 offen offset:2560 sc1
  v_mfma_f32_16x16x32_bf16 v[36:39], v[68:71], v[96:99], v[36:39]
  ds_read2_b32 v[68:69], v226 offset0:176 offset1:177
  v_fma_f32 v147, v147, v238, v179
  v_mfma_f32_16x16x32_bf16 v[60:63], v[72:75], v[116:119], v[60:63]
  ds_read_b128 v[116:119], v230 offset:1216
  v_mul_f32 v239, s14, v239
  v_mfma_f32_16x16x32_bf16 v[56:59], v[72:75], v[112:115], v[56:59]
  ds_read2_b32 v[70:71], v226 offset0:178 offset1:179
  v_fma_f32 v179, v147, v239, v238
  v_mfma_f32_16x16x32_bf16 v[52:55], v[72:75], v[108:111], v[52:55]
  buffer_load_dwordx4 v[164:167], v225, s[28:31], s36 offen offset:1024 sc1
  v_mfma_f32_16x16x32_bf16 v[48:51], v[72:75], v[104:107], v[48:51]
  s_waitcnt vmcnt(13)
  ds_read_b64 v[214:215], v231 offset:2048
  v_lshlrev_b32 v236, 16, v130
  v_mfma_f32_16x16x32_bf16 v[44:47], v[72:75], v[100:103], v[44:47]
  ds_read_b64 v[216:217], v231 offset:1536
  v_and_b32 v237, 0xffff0000, v211
  v_mfma_f32_16x16x32_bf16 v[40:43], v[72:75], v[96:99], v[40:43]
  s_waitcnt vmcnt(11)
  ds_read2_b32 v[72:73], v227 offset0:48 offset1:49
  v_fma_f32 v148, v148, v236, v180
  v_mfma_f32_16x16x32_bf16 v[60:63], v[76:79], v[112:115], v[60:63]
  buffer_load_dwordx4 v[196:199], v225, s[28:31], s38 offen offset:1024 sc1
  v_mfma_f32_16x16x32_bf16 v[56:59], v[76:79], v[108:111], v[56:59]
  ds_read_b128 v[112:115], v230 offset:1728
  v_mul_f32 v237, s14, v237
  v_mfma_f32_16x16x32_bf16 v[52:55], v[76:79], v[104:107], v[52:55]
  ds_read2_b32 v[74:75], v227 offset0:50 offset1:51
  v_fma_f32 v180, v148, v237, v236
  v_mfma_f32_16x16x32_bf16 v[48:51], v[76:79], v[100:103], v[48:51]
  ds_read_b64 v[218:219], v231 offset:1024
  v_and_b32 v238, 0xffff0000, v130
  v_mfma_f32_16x16x32_bf16 v[44:47], v[76:79], v[96:99], v[44:47]
  buffer_load_dwordx2 v[140:141], v224, s[24:27], s12 offen offset:3072 sc1
  v_mfma_f32_16x16x32_bf16 v[60:63], v[80:83], v[108:111], v[60:63]
  ds_read_b128 v[108:111], v230 offset:2240
  v_lshlrev_b32 v239, 16, v211
  v_mfma_f32_16x16x32_bf16 v[56:59], v[80:83], v[104:107], v[56:59]
  ds_read2_b32 v[76:77], v227 offset0:176 offset1:177
  v_fma_f32 v149, v149, v238, v181
  v_mfma_f32_16x16x32_bf16 v[52:55], v[80:83], v[100:103], v[52:55]
  ds_read2_b32 v[78:79], v227 offset0:178 offset1:179
  v_mul_f32 v239, s14, v239
  v_mfma_f32_16x16x32_bf16 v[48:51], v[80:83], v[96:99], v[48:51]
  s_waitcnt lgkmcnt(15)
  buffer_load_dwordx4 v[168:171], v225, s[28:31], s36 offen offset:2048 sc1
  v_mfma_f32_16x16x32_bf16 v[60:63], v[84:87], v[104:107], v[60:63]
  ds_read_b128 v[104:107], v230 offset:2752
  v_fma_f32 v181, v149, v239, v238
  v_mfma_f32_16x16x32_bf16 v[56:59], v[84:87], v[100:103], v[56:59]
  ds_read2_b32 v[80:81], v228 offset0:48 offset1:49
  v_lshlrev_b32 v236, 16, v131
  v_mfma_f32_16x16x32_bf16 v[52:55], v[84:87], v[96:99], v[52:55]
  ds_read2_b32 v[82:83], v228 offset0:50 offset1:51
  v_and_b32 v237, 0xffff0000, v210
  v_mfma_f32_16x16x32_bf16 v[60:63], v[88:91], v[100:103], v[60:63]
  buffer_load_dwordx4 v[200:203], v225, s[28:31], s38 offen offset:2048 sc1
  v_mfma_f32_16x16x32_bf16 v[56:59], v[88:91], v[96:99], v[56:59]
  ds_read_b128 v[100:103], v230 offset:3264
  v_fma_f32 v150, v150, v236, v182
  v_mfma_f32_16x16x32_bf16 v[60:63], v[92:95], v[96:99], v[60:63]
  s_waitcnt lgkmcnt(15)
  ds_read_b128 v[96:99], v230 offset:3776
  v_mul_f32 v237, s14, v237
  v_mfma_f32_16x16x32_bf16 v[60:63], v[64:67], v[124:127], v[60:63]
  ds_read2_b32 v[84:85], v228 offset0:176 offset1:177
  v_fma_f32 v182, v150, v237, v236
  v_mfma_f32_16x16x32_bf16 v[56:59], v[64:67], v[120:123], v[56:59]
  s_waitcnt lgkmcnt(15)
  buffer_load_dwordx2 v[142:143], v224, s[24:27], s12 offen offset:3584 sc1
  v_mfma_f32_16x16x32_bf16 v[52:55], v[64:67], v[116:119], v[52:55]
  s_waitcnt lgkmcnt(11)
  ds_read2_b32 v[86:87], v228 offset0:178 offset1:179
  v_and_b32 v238, 0xffff0000, v131
  v_mfma_f32_16x16x32_bf16 v[48:51], v[64:67], v[112:115], v[48:51]
  s_waitcnt lgkmcnt(9)
  ds_read2_b32 v[88:89], v229 offset0:48 offset1:49
  v_lshlrev_b32 v239, 16, v210
  v_mfma_f32_16x16x32_bf16 v[44:47], v[64:67], v[108:111], v[44:47]
  s_waitcnt lgkmcnt(7)
  ds_read2_b32 v[90:91], v229 offset0:50 offset1:51
  v_fma_f32 v151, v151, v238, v183
  v_mfma_f32_16x16x32_bf16 v[40:43], v[64:67], v[104:107], v[40:43]
  s_waitcnt lgkmcnt(5)
  buffer_load_dwordx4 v[172:175], v225, s[28:31], s36 offen offset:3072 sc1
  v_mfma_f32_16x16x32_bf16 v[36:39], v[64:67], v[100:103], v[36:39]
  s_waitcnt lgkmcnt(4)
  ds_read2_b32 v[92:93], v229 offset0:176 offset1:177
  v_mul_f32 v239, s14, v239
  v_mfma_f32_16x16x32_bf16 v[32:35], v[64:67], v[96:99], v[32:35]
  ds_read2_b32 v[94:95], v229 offset0:178 offset1:179
  v_fma_f32 v183, v151, v239, v238
  v_mfma_f32_16x16x32_bf16 v[60:63], v[68:71], v[120:123], v[60:63]
  s_waitcnt vmcnt(16)
  ds_read2_b32 v[64:65], v226 offset0:64 offset1:65
  v_lshlrev_b32 v236, 16, v132
  v_mfma_f32_16x16x32_bf16 v[56:59], v[68:71], v[116:119], v[56:59]
  buffer_load_dwordx4 v[204:207], v225, s[28:31], s38 offen offset:3072 sc1
  v_mfma_f32_16x16x32_bf16 v[52:55], v[68:71], v[112:115], v[52:55]
  ds_read2_b32 v[66:67], v226 offset0:66 offset1:67
  v_and_b32 v237, 0xffff0000, v213
  v_mfma_f32_16x16x32_bf16 v[48:51], v[68:71], v[108:111], v[48:51]
  s_waitcnt vmcnt(15)
  ds_read_b128 v[124:127], v230 offset:256
  v_fma_f32 v152, v152, v236, v184
  v_mfma_f32_16x16x32_bf16 v[44:47], v[68:71], v[104:107], v[44:47]
  ds_read_b128 v[120:123], v230 offset:768
  v_mul_f32 v237, s14, v237
  v_mfma_f32_16x16x32_bf16 v[40:43], v[68:71], v[100:103], v[40:43]
  ds_read_b64 v[220:221], v231 offset:512
  v_fma_f32 v184, v152, v237, v236
  v_mfma_f32_16x16x32_bf16 v[36:39], v[68:71], v[96:99], v[36:39]
  ds_read2_b32 v[68:69], v226 offset0:192 offset1:193
  v_and_b32 v238, 0xffff0000, v132
  v_mfma_f32_16x16x32_bf16 v[60:63], v[72:75], v[116:119], v[60:63]
  ds_read_b128 v[116:119], v230 offset:1280
  v_lshlrev_b32 v239, 16, v213
  v_mfma_f32_16x16x32_bf16 v[56:59], v[72:75], v[112:115], v[56:59]
  ds_read2_b32 v[70:71], v226 offset0:194 offset1:195
  v_fma_f32 v153, v153, v238, v185
  v_mfma_f32_16x16x32_bf16 v[52:55], v[72:75], v[108:111], v[52:55]
  ds_read_b64 v[222:223], v231 offset:0
  v_mul_f32 v239, s14, v239
  v_mfma_f32_16x16x32_bf16 v[48:51], v[72:75], v[104:107], v[48:51]
  v_fma_f32 v185, v153, v239, v238
  v_lshlrev_b32 v236, 16, v133
  v_mfma_f32_16x16x32_bf16 v[44:47], v[72:75], v[100:103], v[44:47]
  v_and_b32 v237, 0xffff0000, v212
  v_fma_f32 v154, v154, v236, v186
  v_mfma_f32_16x16x32_bf16 v[40:43], v[72:75], v[96:99], v[40:43]
  ds_read2_b32 v[72:73], v227 offset0:64 offset1:65
  v_mul_f32 v237, s14, v237
  v_mfma_f32_16x16x32_bf16 v[60:63], v[76:79], v[112:115], v[60:63]
  ds_read_b128 v[112:115], v230 offset:1792
  v_fma_f32 v186, v154, v237, v236
  v_mfma_f32_16x16x32_bf16 v[56:59], v[76:79], v[108:111], v[56:59]
  ds_read2_b32 v[74:75], v227 offset0:66 offset1:67
  v_and_b32 v238, 0xffff0000, v133
  v_mfma_f32_16x16x32_bf16 v[52:55], v[76:79], v[104:107], v[52:55]
  v_lshlrev_b32 v239, 16, v212
  v_fma_f32 v155, v155, v238, v187
  v_mfma_f32_16x16x32_bf16 v[48:51], v[76:79], v[100:103], v[48:51]
  v_mul_f32 v239, s14, v239
  v_fma_f32 v187, v155, v239, v238
  v_mfma_f32_16x16x32_bf16 v[44:47], v[76:79], v[96:99], v[44:47]
  s_waitcnt vmcnt(14)
  ds_read2_b32 v[76:77], v227 offset0:192 offset1:193
  v_lshlrev_b32 v236, 16, v134
  v_mfma_f32_16x16x32_bf16 v[60:63], v[80:83], v[108:111], v[60:63]
  ds_read_b128 v[108:111], v230 offset:2304
  v_and_b32 v237, 0xffff0000, v215
  v_mfma_f32_16x16x32_bf16 v[56:59], v[80:83], v[104:107], v[56:59]
  s_waitcnt vmcnt(12)
  ds_read2_b32 v[78:79], v227 offset0:194 offset1:195
  v_fma_f32 v156, v156, v236, v188
  v_mfma_f32_16x16x32_bf16 v[52:55], v[80:83], v[100:103], v[52:55]
  v_mul_f32 v237, s14, v237
  v_fma_f32 v188, v156, v237, v236
  v_mfma_f32_16x16x32_bf16 v[48:51], v[80:83], v[96:99], v[48:51]
  s_waitcnt lgkmcnt(15)
  ds_read2_b32 v[80:81], v228 offset0:64 offset1:65
  v_and_b32 v238, 0xffff0000, v134
  v_mfma_f32_16x16x32_bf16 v[60:63], v[84:87], v[104:107], v[60:63]
  ds_read_b128 v[104:107], v230 offset:2816
  v_lshlrev_b32 v239, 16, v215
  v_mfma_f32_16x16x32_bf16 v[56:59], v[84:87], v[100:103], v[56:59]
  ds_read2_b32 v[82:83], v228 offset0:66 offset1:67
  v_fma_f32 v157, v157, v238, v189
  v_mfma_f32_16x16x32_bf16 v[52:55], v[84:87], v[96:99], v[52:55]
  ds_read2_b32 v[84:85], v228 offset0:192 offset1:193
  v_mul_f32 v239, s14, v239
  v_mfma_f32_16x16x32_bf16 v[60:63], v[88:91], v[100:103], v[60:63]
  ds_read_b128 v[100:103], v230 offset:3328
  v_fma_f32 v189, v157, v239, v238
  v_mfma_f32_16x16x32_bf16 v[56:59], v[88:91], v[96:99], v[56:59]
  ds_read2_b32 v[86:87], v228 offset0:194 offset1:195
  v_lshlrev_b32 v236, 16, v135
  v_mfma_f32_16x16x32_bf16 v[60:63], v[92:95], v[96:99], v[60:63]
  s_waitcnt lgkmcnt(15)
  ds_read_b128 v[96:99], v230 offset:3840
  v_and_b32 v237, 0xffff0000, v214
  v_mfma_f32_16x16x32_bf16 v[60:63], v[64:67], v[124:127], v[60:63]
  ds_read2_b32 v[88:89], v229 offset0:64 offset1:65
  v_fma_f32 v158, v158, v236, v190
  v_mfma_f32_16x16x32_bf16 v[56:59], v[64:67], v[120:123], v[56:59]
  s_waitcnt lgkmcnt(15)
  ds_read2_b32 v[90:91], v229 offset0:66 offset1:67
  v_mul_f32 v237, s14, v237
  v_mfma_f32_16x16x32_bf16 v[52:55], v[64:67], v[116:119], v[52:55]
  s_waitcnt lgkmcnt(13)
  ds_read2_b32 v[92:93], v229 offset0:192 offset1:193
  v_fma_f32 v190, v158, v237, v236
  v_mfma_f32_16x16x32_bf16 v[48:51], v[64:67], v[112:115], v[48:51]
  s_waitcnt lgkmcnt(11)
  ds_read2_b32 v[94:95], v229 offset0:194 offset1:195
  v_and_b32 v238, 0xffff0000, v135
  v_mfma_f32_16x16x32_bf16 v[44:47], v[64:67], v[108:111], v[44:47]
  s_waitcnt lgkmcnt(9)
  ds_read_b128 v[124:127], v230 offset:320
  v_lshlrev_b32 v239, 16, v214
  v_mfma_f32_16x16x32_bf16 v[40:43], v[64:67], v[104:107], v[40:43]
  s_waitcnt lgkmcnt(7)
  v_fma_f32 v159, v159, v238, v191
  v_mul_f32 v239, s14, v239
  v_mfma_f32_16x16x32_bf16 v[36:39], v[64:67], v[100:103], v[36:39]
  s_waitcnt vmcnt(11) lgkmcnt(5)
  v_fma_f32 v191, v159, v239, v238
  v_lshlrev_b32 v236, 16, v136
  v_mfma_f32_16x16x32_bf16 v[32:35], v[64:67], v[96:99], v[32:35]
  ds_read2_b32 v[64:65], v226 offset0:80 offset1:81
  v_and_b32 v237, 0xffff0000, v217
  v_mfma_f32_16x16x32_bf16 v[60:63], v[68:71], v[120:123], v[60:63]
  s_waitcnt vmcnt(9)
  ds_read2_b32 v[66:67], v226 offset0:82 offset1:83
  v_fma_f32 v160, v160, v236, v192
  v_mfma_f32_16x16x32_bf16 v[56:59], v[68:71], v[116:119], v[56:59]
  ds_read_b128 v[120:123], v230 offset:832
  v_mul_f32 v237, s14, v237
  v_mfma_f32_16x16x32_bf16 v[52:55], v[68:71], v[112:115], v[52:55]
  v_fma_f32 v192, v160, v237, v236
  v_and_b32 v238, 0xffff0000, v136
  v_mfma_f32_16x16x32_bf16 v[48:51], v[68:71], v[108:111], v[48:51]
  v_lshlrev_b32 v239, 16, v217
  v_fma_f32 v161, v161, v238, v193
  v_mfma_f32_16x16x32_bf16 v[44:47], v[68:71], v[104:107], v[44:47]
  v_mul_f32 v239, s14, v239
  v_fma_f32 v193, v161, v239, v238
  v_mfma_f32_16x16x32_bf16 v[40:43], v[68:71], v[100:103], v[40:43]
  v_lshlrev_b32 v236, 16, v137
  v_and_b32 v237, 0xffff0000, v216
  v_mfma_f32_16x16x32_bf16 v[36:39], v[68:71], v[96:99], v[36:39]
  ds_read2_b32 v[68:69], v226 offset0:208 offset1:209
  v_fma_f32 v162, v162, v236, v194
  v_mfma_f32_16x16x32_bf16 v[60:63], v[72:75], v[116:119], v[60:63]
  ds_read_b128 v[116:119], v230 offset:1344
  v_mul_f32 v237, s14, v237
  v_mfma_f32_16x16x32_bf16 v[56:59], v[72:75], v[112:115], v[56:59]
  ds_read2_b32 v[70:71], v226 offset0:210 offset1:211
  v_fma_f32 v194, v162, v237, v236
  v_mfma_f32_16x16x32_bf16 v[52:55], v[72:75], v[108:111], v[52:55]
  v_and_b32 v238, 0xffff0000, v137
  v_lshlrev_b32 v239, 16, v216
  v_mfma_f32_16x16x32_bf16 v[48:51], v[72:75], v[104:107], v[48:51]
  v_fma_f32 v163, v163, v238, v195
  v_mul_f32 v239, s14, v239
  v_mfma_f32_16x16x32_bf16 v[44:47], v[72:75], v[100:103], v[44:47]
  s_waitcnt vmcnt(8)
  v_fma_f32 v195, v163, v239, v238
  v_lshlrev_b32 v236, 16, v138
  v_mfma_f32_16x16x32_bf16 v[40:43], v[72:75], v[96:99], v[40:43]
  ds_read2_b32 v[72:73], v227 offset0:80 offset1:81
  v_and_b32 v237, 0xffff0000, v219
  v_mfma_f32_16x16x32_bf16 v[60:63], v[76:79], v[112:115], v[60:63]
  s_waitcnt vmcnt(6)
  ds_read_b128 v[112:115], v230 offset:1856
  v_fma_f32 v164, v164, v236, v196
  v_mfma_f32_16x16x32_bf16 v[56:59], v[76:79], v[108:111], v[56:59]
  ds_read2_b32 v[74:75], v227 offset0:82 offset1:83
  v_mul_f32 v237, s14, v237
  v_mfma_f32_16x16x32_bf16 v[52:55], v[76:79], v[104:107], v[52:55]
  v_fma_f32 v196, v164, v237, v236
  v_and_b32 v238, 0xffff0000, v138
  v_mfma_f32_16x16x32_bf16 v[48:51], v[76:79], v[100:103], v[48:51]
  v_lshlrev_b32 v239, 16, v219
  v_fma_f32 v165, v165, v238, v197
  v_mfma_f32_16x16x32_bf16 v[44:47], v[76:79], v[96:99], v[44:47]
  ds_read2_b32 v[76:77], v227 offset0:208 offset1:209
  v_mul_f32 v239, s14, v239
  v_mfma_f32_16x16x32_bf16 v[60:63], v[80:83], v[108:111], v[60:63]
  ds_read_b128 v[108:111], v230 offset:2368
  v_fma_f32 v197, v165, v239, v238
  v_mfma_f32_16x16x32_bf16 v[56:59], v[80:83], v[104:107], v[56:59]
  ds_read2_b32 v[78:79], v227 offset0:210 offset1:211
  v_lshlrev_b32 v236, 16, v139
  v_mfma_f32_16x16x32_bf16 v[52:55], v[80:83], v[100:103], v[52:55]
  v_and_b32 v237, 0xffff0000, v218
  v_fma_f32 v166, v166, v236, v198
  v_mfma_f32_16x16x32_bf16 v[48:51], v[80:83], v[96:99], v[48:51]
  ds_read2_b32 v[80:81], v228 offset0:80 offset1:81
  v_mul_f32 v237, s14, v237
  v_mfma_f32_16x16x32_bf16 v[60:63], v[84:87], v[104:107], v[60:63]
  ds_read_b128 v[104:107], v230 offset:2880
  v_fma_f32 v198, v166, v237, v236
  v_mfma_f32_16x16x32_bf16 v[56:59], v[84:87], v[100:103], v[56:59]
  ds_read2_b32 v[82:83], v228 offset0:82 offset1:83
  v_and_b32 v238, 0xffff0000, v139
  v_mfma_f32_16x16x32_bf16 v[52:55], v[84:87], v[96:99], v[52:55]
  s_waitcnt lgkmcnt(15)
  ds_read2_b32 v[84:85], v228 offset0:208 offset1:209
  v_lshlrev_b32 v239, 16, v218
  v_mfma_f32_16x16x32_bf16 v[60:63], v[88:91], v[100:103], v[60:63]
  ds_read_b128 v[100:103], v230 offset:3392
  v_fma_f32 v167, v167, v238, v199
  v_mfma_f32_16x16x32_bf16 v[56:59], v[88:91], v[96:99], v[56:59]
  ds_read2_b32 v[86:87], v228 offset0:210 offset1:211
  v_mul_f32 v239, s14, v239
  v_mfma_f32_16x16x32_bf16 v[60:63], v[92:95], v[96:99], v[60:63]
  s_waitcnt lgkmcnt(15)
  ds_read_b128 v[96:99], v230 offset:3904
  v_fma_f32 v199, v167, v239, v238
  v_mfma_f32_16x16x32_bf16 v[60:63], v[64:67], v[124:127], v[60:63]
  s_waitcnt vmcnt(5)
  ds_read2_b32 v[88:89], v229 offset0:80 offset1:81
  v_lshlrev_b32 v236, 16, v140
  v_mfma_f32_16x16x32_bf16 v[56:59], v[64:67], v[120:123], v[56:59]
  s_waitcnt lgkmcnt(15)
  ds_read2_b32 v[90:91], v229 offset0:82 offset1:83
  v_and_b32 v237, 0xffff0000, v221
  v_mfma_f32_16x16x32_bf16 v[52:55], v[64:67], v[116:119], v[52:55]
  s_waitcnt vmcnt(3) lgkmcnt(13)
  ds_read2_b32 v[92:93], v229 offset0:208 offset1:209
  v_fma_f32 v168, v168, v236, v200
  v_mfma_f32_16x16x32_bf16 v[48:51], v[64:67], v[112:115], v[48:51]
  s_waitcnt lgkmcnt(11)
  ds_read2_b32 v[94:95], v229 offset0:210 offset1:211
  v_mul_f32 v237, s14, v237
  v_mfma_f32_16x16x32_bf16 v[44:47], v[64:67], v[108:111], v[44:47]
  s_waitcnt lgkmcnt(9)
  ds_read_b128 v[124:127], v230 offset:384
  v_fma_f32 v200, v168, v237, v236
  v_mfma_f32_16x16x32_bf16 v[40:43], v[64:67], v[104:107], v[40:43]
  s_waitcnt lgkmcnt(7)
  v_and_b32 v238, 0xffff0000, v140
  v_lshlrev_b32 v239, 16, v221
  v_mfma_f32_16x16x32_bf16 v[36:39], v[64:67], v[100:103], v[36:39]
  s_waitcnt lgkmcnt(5)
  v_fma_f32 v169, v169, v238, v201
  v_mul_f32 v239, s14, v239
  v_mfma_f32_16x16x32_bf16 v[32:35], v[64:67], v[96:99], v[32:35]
  ds_read2_b32 v[64:65], v226 offset0:96 offset1:97
  v_fma_f32 v201, v169, v239, v238
  v_mfma_f32_16x16x32_bf16 v[60:63], v[68:71], v[120:123], v[60:63]
  ds_read2_b32 v[66:67], v226 offset0:98 offset1:99
  v_lshlrev_b32 v236, 16, v141
  v_mfma_f32_16x16x32_bf16 v[56:59], v[68:71], v[116:119], v[56:59]
  ds_read_b128 v[120:123], v230 offset:896
  v_and_b32 v237, 0xffff0000, v220
  v_mfma_f32_16x16x32_bf16 v[52:55], v[68:71], v[112:115], v[52:55]
  v_fma_f32 v170, v170, v236, v202
  v_mul_f32 v237, s14, v237
  v_mfma_f32_16x16x32_bf16 v[48:51], v[68:71], v[108:111], v[48:51]
LU_pad0:
  s_cmp_lg_u32 s82, 0
  s_cbranch_scc1 LU_main
  v_fma_f32 v202, v170, v237, v236
  v_and_b32 v238, 0xffff0000, v141
  v_mfma_f32_16x16x32_bf16 v[44:47], v[68:71], v[104:107], v[44:47]
  v_lshlrev_b32 v239, 16, v220
  v_fma_f32 v171, v171, v238, v203
  v_mfma_f32_16x16x32_bf16 v[40:43], v[68:71], v[100:103], v[40:43]
  v_mul_f32 v239, s14, v239
  v_fma_f32 v203, v171, v239, v238
  v_mfma_f32_16x16x32_bf16 v[36:39], v[68:71], v[96:99], v[36:39]
  s_waitcnt vmcnt(2)
  ds_read2_b32 v[68:69], v226 offset0:224 offset1:225
  v_lshlrev_b32 v236, 16, v142
  v_mfma_f32_16x16x32_bf16 v[60:63], v[72:75], v[116:119], v[60:63]
  ds_read_b128 v[116:119], v230 offset:1408
  v_and_b32 v237, 0xffff0000, v223
  v_mfma_f32_16x16x32_bf16 v[56:59], v[72:75], v[112:115], v[56:59]
  s_waitcnt vmcnt(0)
  ds_read2_b32 v[70:71], v226 offset0:226 offset1:227
  v_fma_f32 v172, v172, v236, v204
  v_mfma_f32_16x16x32_bf16 v[52:55], v[72:75], v[108:111], v[52:55]
  v_mul_f32 v237, s14, v237
  v_fma_f32 v204, v172, v237, v236
  v_mfma_f32_16x16x32_bf16 v[48:51], v[72:75], v[104:107], v[48:51]
  v_and_b32 v238, 0xffff0000, v142
  v_lshlrev_b32 v239, 16, v223
  v_mfma_f32_16x16x32_bf16 v[44:47], v[72:75], v[100:103], v[44:47]
  v_fma_f32 v173, v173, v238, v205
  v_mul_f32 v239, s14, v239
  v_mfma_f32_16x16x32_bf16 v[40:43], v[72:75], v[96:99], v[40:43]
  ds_read2_b32 v[72:73], v227 offset0:96 offset1:97
  v_fma_f32 v205, v173, v239, v238
  v_mfma_f32_16x16x32_bf16 v[60:63], v[76:79], v[112:115], v[60:63]
  ds_read_b128 v[112:115], v230 offset:1920
  v_lshlrev_b32 v236, 16, v143
  v_mfma_f32_16x16x32_bf16 v[56:59], v[76:79], v[108:111], v[56:59]
  ds_read2_b32 v[74:75], v227 offset0:98 offset1:99
  v_and_b32 v237, 0xffff0000, v222
  v_mfma_f32_16x16x32_bf16 v[52:55], v[76:79], v[104:107], v[52:55]
  buffer_store_dword v30, v8, s[76:79], s80 offen offset:1024 sc1
  v_mfma_f32_16x16x32_bf16 v[48:51], v[76:79], v[100:103], v[48:51]
  v_fma_f32 v174, v174, v236, v206
  v_mul_f32 v237, s14, v237
  v_mfma_f32_16x16x32_bf16 v[44:47], v[76:79], v[96:99], v[44:47]
  ds_read2_b32 v[76:77], v227 offset0:224 offset1:225
  v_fma_f32 v206, v174, v237, v236
  v_mfma_f32_16x16x32_bf16 v[60:63], v[80:83], v[108:111], v[60:63]
  ds_read_b128 v[108:111], v230 offset:2432
  v_and_b32 v238, 0xffff0000, v143
  v_mfma_f32_16x16x32_bf16 v[56:59], v[80:83], v[104:107], v[56:59]
  ds_read2_b32 v[78:79], v227 offset0:226 offset1:227
  v_lshlrev_b32 v239, 16, v222
  v_mfma_f32_16x16x32_bf16 v[52:55], v[80:83], v[100:103], v[52:55]
  v_fma_f32 v175, v175, v238, v207
  v_mul_f32 v239, s14, v239
  v_mfma_f32_16x16x32_bf16 v[48:51], v[80:83], v[96:99], v[48:51]
  ds_read2_b32 v[80:81], v228 offset0:96 offset1:97
  v_fma_f32 v207, v175, v239, v238
  v_mfma_f32_16x16x32_bf16 v[60:63], v[84:87], v[104:107], v[60:63]
  ds_read_b128 v[104:107], v230 offset:2944
  v_mfma_f32_16x16x32_bf16 v[56:59], v[84:87], v[100:103], v[56:59]
  ds_read2_b32 v[82:83], v228 offset0:98 offset1:99
  v_mfma_f32_16x16x32_bf16 v[52:55], v[84:87], v[96:99], v[52:55]
  s_waitcnt lgkmcnt(15)
  ds_read2_b32 v[84:85], v228 offset0:224 offset1:225
  v_mfma_f32_16x16x32_bf16 v[60:63], v[88:91], v[100:103], v[60:63]
  ds_read_b128 v[100:103], v230 offset:3456
  v_mfma_f32_16x16x32_bf16 v[56:59], v[88:91], v[96:99], v[56:59]
  ds_read2_b32 v[86:87], v228 offset0:226 offset1:227
  v_mfma_f32_16x16x32_bf16 v[60:63], v[92:95], v[96:99], v[60:63]
  s_waitcnt lgkmcnt(15)
  ds_read_b128 v[96:99], v230 offset:3968
  v_mfma_f32_16x16x32_bf16 v[60:63], v[64:67], v[124:127], v[60:63]
  ds_read2_b32 v[88:89], v229 offset0:96 offset1:97
  v_mfma_f32_16x16x32_bf16 v[56:59], v[64:67], v[120:123], v[56:59]
  s_waitcnt lgkmcnt(15)
  ds_read2_b32 v[90:91], v229 offset0:98 offset1:99
  v_mfma_f32_16x16x32_bf16 v[52:55], v[64:67], v[116:119], v[52:55]
  s_waitcnt lgkmcnt(13)
  ds_read2_b32 v[92:93], v229 offset0:224 offset1:225
  v_mfma_f32_16x16x32_bf16 v[48:51], v[64:67], v[112:115], v[48:51]
  s_waitcnt lgkmcnt(11)
  ds_read2_b32 v[94:95], v229 offset0:226 offset1:227
  v_mfma_f32_16x16x32_bf16 v[44:47], v[64:67], v[108:111], v[44:47]
  s_waitcnt lgkmcnt(9)
  ds_read_b128 v[124:127], v230 offset:448
  v_mfma_f32_16x16x32_bf16 v[40:43], v[64:67], v[104:107], v[40:43]
  s_waitcnt lgkmcnt(7)
  v_mfma_f32_16x16x32_bf16 v[36:39], v[64:67], v[100:103], v[36:39]
  s_waitcnt lgkmcnt(5)
  v_mfma_f32_16x16x32_bf16 v[32:35], v[64:67], v[96:99], v[32:35]
  ds_read2_b32 v[64:65], v226 offset0:112 offset1:113
  v_mfma_f32_16x16x32_bf16 v[60:63], v[68:71], v[120:123], v[60:63]
  ds_read2_b32 v[66:67], v226 offset0:114 offset1:115
  v_mfma_f32_16x16x32_bf16 v[56:59], v[68:71], v[116:119], v[56:59]
  ds_read_b128 v[120:123], v230 offset:960
  v_mfma_f32_16x16x32_bf16 v[52:55], v[68:71], v[112:115], v[52:55]
  v_mfma_f32_16x16x32_bf16 v[48:51], v[68:71], v[108:111], v[48:51]
  v_mfma_f32_16x16x32_bf16 v[44:47], v[68:71], v[104:107], v[44:47]
  v_mfma_f32_16x16x32_bf16 v[40:43], v[68:71], v[100:103], v[40:43]
  v_mfma_f32_16x16x32_bf16 v[36:39], v[68:71], v[96:99], v[36:39]
  ds_read2_b32 v[68:69], v226 offset0:240 offset1:241
  v_mfma_f32_16x16x32_bf16 v[60:63], v[72:75], v[116:119], v[60:63]
  ds_read_b128 v[116:119], v230 offset:1472
  v_mfma_f32_16x16x32_bf16 v[56:59], v[72:75], v[112:115], v[56:59]
  ds_read2_b32 v[70:71], v226 offset0:242 offset1:243
  v_mfma_f32_16x16x32_bf16 v[52:55], v[72:75], v[108:111], v[52:55]
  v_mfma_f32_16x16x32_bf16 v[48:51], v[72:75], v[104:107], v[48:51]
  v_mfma_f32_16x16x32_bf16 v[44:47], v[72:75], v[100:103], v[44:47]
  v_mfma_f32_16x16x32_bf16 v[40:43], v[72:75], v[96:99], v[40:43]
  ds_read2_b32 v[72:73], v227 offset0:112 offset1:113
  v_mfma_f32_16x16x32_bf16 v[60:63], v[76:79], v[112:115], v[60:63]
  ds_read_b128 v[112:115], v230 offset:1984
  v_mfma_f32_16x16x32_bf16 v[56:59], v[76:79], v[108:111], v[56:59]
  ds_read2_b32 v[74:75], v227 offset0:114 offset1:115
  v_mfma_f32_16x16x32_bf16 v[52:55], v[76:79], v[104:107], v[52:55]
  v_mfma_f32_16x16x32_bf16 v[48:51], v[76:79], v[100:103], v[48:51]
  v_mfma_f32_16x16x32_bf16 v[44:47], v[76:79], v[96:99], v[44:47]
  ds_read2_b32 v[76:77], v227 offset0:240 offset1:241
  v_mfma_f32_16x16x32_bf16 v[60:63], v[80:83], v[108:111], v[60:63]
  ds_read_b128 v[108:111], v230 offset:2496
  v_mfma_f32_16x16x32_bf16 v[56:59], v[80:83], v[104:107], v[56:59]
  ds_read2_b32 v[78:79], v227 offset0:242 offset1:243
  v_mfma_f32_16x16x32_bf16 v[52:55], v[80:83], v[100:103], v[52:55]
  v_mfma_f32_16x16x32_bf16 v[48:51], v[80:83], v[96:99], v[48:51]
  ds_read2_b32 v[80:81], v228 offset0:112 offset1:113
  v_mfma_f32_16x16x32_bf16 v[60:63], v[84:87], v[104:107], v[60:63]
  ds_read_b128 v[104:107], v230 offset:3008
  v_mfma_f32_16x16x32_bf16 v[56:59], v[84:87], v[100:103], v[56:59]
  ds_read2_b32 v[82:83], v228 offset0:114 offset1:115
  v_mfma_f32_16x16x32_bf16 v[52:55], v[84:87], v[96:99], v[52:55]
  s_waitcnt lgkmcnt(15)
  ds_read2_b32 v[84:85], v228 offset0:240 offset1:241
  v_mfma_f32_16x16x32_bf16 v[60:63], v[88:91], v[100:103], v[60:63]
  ds_read_b128 v[100:103], v230 offset:3520
  v_mfma_f32_16x16x32_bf16 v[56:59], v[88:91], v[96:99], v[56:59]
  ds_read2_b32 v[86:87], v228 offset0:242 offset1:243
  v_mfma_f32_16x16x32_bf16 v[60:63], v[92:95], v[96:99], v[60:63]
  s_waitcnt lgkmcnt(15)
  ds_read_b128 v[96:99], v230 offset:4032
  v_mfma_f32_16x16x32_bf16 v[60:63], v[64:67], v[124:127], v[60:63]
  ds_read2_b32 v[88:89], v229 offset0:112 offset1:113
  v_mfma_f32_16x16x32_bf16 v[56:59], v[64:67], v[120:123], v[56:59]
  s_waitcnt lgkmcnt(15)
  ds_read2_b32 v[90:91], v229 offset0:114 offset1:115
  v_mfma_f32_16x16x32_bf16 v[52:55], v[64:67], v[116:119], v[52:55]
  s_waitcnt lgkmcnt(13)
  ds_read2_b32 v[92:93], v229 offset0:240 offset1:241
  v_mfma_f32_16x16x32_bf16 v[48:51], v[64:67], v[112:115], v[48:51]
  s_waitcnt lgkmcnt(11)
  ds_read2_b32 v[94:95], v229 offset0:242 offset1:243
  v_mfma_f32_16x16x32_bf16 v[44:47], v[64:67], v[108:111], v[44:47]
  s_waitcnt lgkmcnt(9)
  v_mfma_f32_16x16x32_bf16 v[40:43], v[64:67], v[104:107], v[40:43]
  s_waitcnt lgkmcnt(6)
  v_mfma_f32_16x16x32_bf16 v[36:39], v[64:67], v[100:103], v[36:39]
  s_waitcnt lgkmcnt(4)
  v_mfma_f32_16x16x32_bf16 v[32:35], v[64:67], v[96:99], v[32:35]
  v_mfma_f32_16x16x32_bf16 v[60:63], v[68:71], v[120:123], v[60:63]
  v_mfma_f32_16x16x32_bf16 v[56:59], v[68:71], v[116:119], v[56:59]
  v_mfma_f32_16x16x32_bf16 v[52:55], v[68:71], v[112:115], v[52:55]
  v_mfma_f32_16x16x32_bf16 v[48:51], v[68:71], v[108:111], v[48:51]
  s_nop 3
  v_fma_f32 v176, v144, v32, v176
  v_fma_f32 v177, v145, v33, v177
  v_mfma_f32_16x16x32_bf16 v[44:47], v[68:71], v[104:107], v[44:47]
  v_fma_f32 v178, v146, v34, v178
  v_fma_f32 v179, v147, v35, v179
  v_mfma_f32_16x16x32_bf16 v[40:43], v[68:71], v[100:103], v[40:43]
  v_cvt_pk_bf16_f32 v128, v176, v177
  v_cvt_pk_bf16_f32 v129, v178, v179
  v_mfma_f32_16x16x32_bf16 v[36:39], v[68:71], v[96:99], v[36:39]
  buffer_store_dwordx2 v[128:129], v224, s[32:35], s12 offen offset:0 sc1
  v_mfma_f32_16x16x32_bf16 v[60:63], v[72:75], v[116:119], v[60:63]
  v_mfma_f32_16x16x32_bf16 v[56:59], v[72:75], v[112:115], v[56:59]
  v_mfma_f32_16x16x32_bf16 v[52:55], v[72:75], v[108:111], v[52:55]
  v_mfma_f32_16x16x32_bf16 v[48:51], v[72:75], v[104:107], v[48:51]
  s_nop 2
  v_fma_f32 v180, v148, v36, v180
  v_fma_f32 v181, v149, v37, v181
  v_mfma_f32_16x16x32_bf16 v[44:47], v[72:75], v[100:103], v[44:47]
  v_fma_f32 v182, v150, v38, v182
  v_fma_f32 v183, v151, v39, v183
  v_mfma_f32_16x16x32_bf16 v[40:43], v[72:75], v[96:99], v[40:43]
  v_cvt_pk_bf16_f32 v130, v180, v181
  v_cvt_pk_bf16_f32 v131, v182, v183
  v_mfma_f32_16x16x32_bf16 v[60:63], v[76:79], v[112:115], v[60:63]
  buffer_store_dwordx2 v[130:131], v224, s[32:35], s12 offen offset:512 sc1
  v_mfma_f32_16x16x32_bf16 v[56:59], v[76:79], v[108:111], v[56:59]
  v_mfma_f32_16x16x32_bf16 v[52:55], v[76:79], v[104:107], v[52:55]
  v_mfma_f32_16x16x32_bf16 v[48:51], v[76:79], v[100:103], v[48:51]
  s_nop 0
  v_fma_f32 v184, v152, v40, v184
  v_fma_f32 v185, v153, v41, v185
  v_mfma_f32_16x16x32_bf16 v[44:47], v[76:79], v[96:99], v[44:47]
  v_fma_f32 v186, v154, v42, v186
  v_fma_f32 v187, v155, v43, v187
  v_mfma_f32_16x16x32_bf16 v[60:63], v[80:83], v[108:111], v[60:63]
  v_cvt_pk_bf16_f32 v132, v184, v185
  v_cvt_pk_bf16_f32 v133, v186, v187
  v_mfma_f32_16x16x32_bf16 v[56:59], v[80:83], v[104:107], v[56:59]
  buffer_store_dwordx2 v[132:133], v224, s[32:35], s12 offen offset:1024 sc1
  v_mfma_f32_16x16x32_bf16 v[52:55], v[80:83], v[100:103], v[52:55]
  v_mfma_f32_16x16x32_bf16 v[48:51], v[80:83], v[96:99], v[48:51]
  v_fma_f32 v188, v156, v44, v188
  v_fma_f32 v189, v157, v45, v189
  v_mfma_f32_16x16x32_bf16 v[60:63], v[84:87], v[104:107], v[60:63]
  v_fma_f32 v190, v158, v46, v190
  v_fma_f32 v191, v159, v47, v191
  v_mfma_f32_16x16x32_bf16 v[56:59], v[84:87], v[100:103], v[56:59]
  v_cvt_pk_bf16_f32 v134, v188, v189
  v_cvt_pk_bf16_f32 v135, v190, v191
  v_mfma_f32_16x16x32_bf16 v[52:55], v[84:87], v[96:99], v[52:55]
  s_waitcnt lgkmcnt(2)
  buffer_store_dwordx2 v[134:135], v224, s[32:35], s12 offen offset:1536 sc1
  v_mfma_f32_16x16x32_bf16 v[60:63], v[88:91], v[100:103], v[60:63]
  v_fma_f32 v192, v160, v48, v192
  v_fma_f32 v193, v161, v49, v193
  v_mfma_f32_16x16x32_bf16 v[56:59], v[88:91], v[96:99], v[56:59]
  s_waitcnt lgkmcnt(0)
  v_fma_f32 v194, v162, v50, v194
  v_fma_f32 v195, v163, v51, v195
  v_mfma_f32_16x16x32_bf16 v[60:63], v[92:95], v[96:99], v[60:63]
  v_cvt_pk_bf16_f32 v136, v192, v193
  v_cvt_pk_bf16_f32 v137, v194, v195
  buffer_store_dwordx2 v[136:137], v224, s[32:35], s12 offen offset:2048 sc1
  v_fma_f32 v196, v164, v52, v196
  v_fma_f32 v197, v165, v53, v197
  v_fma_f32 v198, v166, v54, v198
  v_fma_f32 v199, v167, v55, v199
  v_cvt_pk_bf16_f32 v138, v196, v197
  v_cvt_pk_bf16_f32 v139, v198, v199
  buffer_store_dwordx2 v[138:139], v224, s[32:35], s12 offen offset:2560 sc1
  v_fma_f32 v200, v168, v56, v200
  v_fma_f32 v201, v169, v57, v201
  v_fma_f32 v202, v170, v58, v202
  v_fma_f32 v203, v171, v59, v203
  v_cvt_pk_bf16_f32 v140, v200, v201
  v_cvt_pk_bf16_f32 v141, v202, v203
  buffer_store_dwordx2 v[140:141], v224, s[32:35], s12 offen offset:3072 sc1
  v_fma_f32 v204, v172, v60, v204
  v_fma_f32 v205, v173, v61, v205
  v_fma_f32 v206, v174, v62, v206
  v_fma_f32 v207, v175, v63, v207
  v_cvt_pk_bf16_f32 v142, v204, v205
  v_cvt_pk_bf16_f32 v143, v206, v207
  buffer_store_dwordx2 v[142:143], v224, s[32:35], s12 offen offset:3584 sc1
s_add_u32 s56, s8, 7667712
s_addc_u32 s57, s9, 0
s_mov_b32 s58, 65536
s_mov_b32 s59, 0x20000
s_waitcnt vmcnt(0) lgkmcnt(0)
s_barrier
buffer_store_dwordx2 v[250:251], v252, s[56:59], 0 offen offset:0 sc1
L3_entry:
s_waitcnt lgkmcnt(0)
s_barrier
  s_load_dwordx4 s[68:71], s[0:1], 56
  s_load_dwordx2 s[60:61], s[0:1], 96
  s_load_dwordx4 s[56:59], s[0:1], 72
  v_lshrrev_b32 v90, 6, v0
  v_and_b32 v80, 63, v0
  v_readfirstlane_b32 s3, v90
  s_and_b32 s4, s2, 7
  s_bfe_u32 s6, s2, 0x10003
  s_lshr_b32 s5, s2, 4
  v_and_b32 v82, 7, v80
  v_bfe_u32 v83, v80, 4, 1
  s_lshl_b32 s42, s3, 11
  s_mul_i32 s7, s6, 2654208
  s_mul_i32 s83, s6, 1179648
  s_and_b32 s62, s3, 1
  s_lshl_b32 s63, s62, 1
  v_or_b32 v91, s63, v83
  v_lshlrev_b32 v91, 1, v91
  v_xor_b32 v91, v91, v82
  v_lshrrev_b32 v90, 3, v0
  v_mul_u32_u24 v11, 9216, v90
  v_lshl_add_u32 v11, v91, 4, v11
  v_lshlrev_b32 v231, 12, v90
  v_lshl_add_u32 v231, v91, 4, v231
  v_add_u32 v230, 1024, v231
  v_add_u32 v231, 128, v231
  s_mul_i32 s64, s4, 1152
  s_mul_i32 s65, s6, 640
  s_add_u32 s64, s64, s65
  s_sub_u32 s65, s64, 1024
  s_ashr_i32 s66, s65, 31
  s_sub_u32 s10, 5309440, s64
  s_mov_b32 s11, 0x20000
  s_add_u32 s54, s10, 1024
  s_mov_b32 s55, 0x20000
  v_add_u32 v11, 1024, v11
  s_lshl_b32 s72, s5, 8
  s_add_u32 s73, s72, 4717568
  s_sub_u32 s18, 2360320, s72
  s_mov_b32 s19, 0x20000
  s_lshl_b32 s67, s5, 12
  s_add_u32 s67, s67, 7667712
  s_mov_b32 s34, 4096
  s_mov_b32 s35, 0x20000
  s_waitcnt lgkmcnt(0)
  s_add_u32 s8, s68, s65
  s_addc_u32 s9, s69, s66
  s_add_u32 s52, s70, s65
  s_addc_u32 s53, s71, s66
  s_sub_u32 s52, s52, 1024
  s_subb_u32 s53, s53, 0
  s_add_u32 s16, s60, s73
  s_addc_u32 s17, s61, 0
  s_add_u32 s32, s60, s67
  s_addc_u32 s33, s61, 0
  s_add_u32 m0, s42, 0
  s_mov_b32 s40, 0
  buffer_load_dwordx4 v11, s[8:11], s40 offen offset:0 lds
  v_bfe_u32 v85, v80, 2, 2
  v_and_b32 v86, 3, v80
  v_lshrrev_b32 v87, 4, v80
  v_lshrrev_b32 v89, 1, v85
  v_lshl_or_b32 v93, v83, 1, v89
  v_lshlrev_b32 v90, 11, v87
  v_lshl_add_u32 v90, v85, 7, v90
  v_lshl_add_u32 v90, v86, 3, v90
  v_lshl_add_u32 v1, v93, 5, v90
  buffer_load_dwordx4 v11, s[52:55], s40 offen offset:1024 lds
  v_xor_b32 v2, 32, v1
  v_xor_b32 v3, 64, v1
  v_xor_b32 v4, 0x60, v1
  s_lshr_b32 s63, s3, 1
  s_lshl_b32 s64, s63, 10
  s_add_u32 s64, s64, 98304
  s_lshl_b32 s65, s62, 6
  v_xor_b32 v228, s65, v1
  v_add_u32 v228, s64, v228
  s_add_u32 m0, s42, 8192
  s_mov_b32 s40, 294912
  buffer_load_dwordx4 v11, s[8:11], s40 offen offset:0 lds
  v_xor_b32 v229, 32, v228
  v_mov_b32 v93, 0x3f803f80
  v_accvgpr_write_b32 a212, v93
  v_accvgpr_write_b32 a213, v93
  v_accvgpr_write_b32 a214, v93
  v_accvgpr_write_b32 a215, v93
  s_lshl_b32 s43, s3, 10
  s_mul_i32 s64, s4, 4608
  s_add_u32 s65, s64, 7094272
  buffer_load_dwordx4 v11, s[52:55], s40 offen offset:1024 lds
  s_add_u32 s20, s60, s65
  s_addc_u32 s21, s61, 0
  s_sub_u32 s22, 73728, s64
  s_mov_b32 s23, 0x20000
  s_mul_i32 s64, s4, 663552
  s_mul_i32 s65, s6, 640
  s_add_u32 s64, s64, s65
  s_add_u32 s12, s56, s64
  s_addc_u32 s13, s57, 0
  s_sub_u32 s12, s12, 1024
  s_subb_u32 s13, s13, 0
  s_sub_u32 s14, 5309440, s64
  s_add_u32 m0, s42, 16384
  s_mov_b32 s40, 589824
  buffer_load_dwordx4 v11, s[8:11], s40 offen offset:0 lds
  s_mov_b32 s15, 0x20000
  s_lshl_b32 s64, s5, 1
  s_add_u32 s64, s64, s6
  s_mul_i32 s64, s64, 589824
  s_add_u32 s64, s64, 7864320
  s_mul_i32 s65, s4, 73728
  s_add_u32 s65, s65, s64
  s_add_u32 s24, s60, s65
  s_addc_u32 s25, s61, 0
  s_mov_b32 s26, 73728
  buffer_load_dwordx4 v11, s[52:55], s40 offen offset:1024 lds
  s_mov_b32 s27, 0x20000
  s_mul_i32 s65, s4, 9216
  s_add_u32 s65, s65, s64
  s_add_u32 s28, s60, s65
  s_addc_u32 s29, s61, 0
  s_mov_b32 s30, 525312
  s_mov_b32 s31, 0x20000
  s_mul_i32 s64, s5, 147456
  s_add_u32 s36, s58, s64
  s_addc_u32 s37, s59, 0
  s_mov_b32 s38, 147456
  s_add_u32 m0, s42, 24576
  s_mov_b32 s40, 884736
  buffer_load_dwordx4 v11, s[8:11], s40 offen offset:0 lds
  s_mov_b32 s39, 0x20000
  s_lshl_b32 s64, s5, 3
  s_add_u32 s64, s64, s4
  s_lshl_b32 s64, s64, 3
  s_add_u32 s64, s64, s3
  s_lshl_b32 s65, s6, 2
  s_xor_b32 s66, s65, 4
  s_add_u32 s65, s65, s64
  s_add_u32 s66, s66, s64
  buffer_load_dwordx4 v11, s[52:55], s40 offen offset:1024 lds
  s_mul_i32 s65, s65, 18432
  s_mul_i32 s66, s66, 18432
  s_add_u32 s65, s65, 27262976
  s_add_u32 s66, s66, 27262976
  s_add_u32 s76, s60, s65
  s_addc_u32 s77, s61, 0
  s_mov_b32 s78, 18432
  s_mov_b32 s79, 0x20000
  s_add_u32 s84, s60, s66
  s_addc_u32 s85, s61, 0
  s_mov_b32 s86, 18432
  s_add_u32 m0, s42, 32768
  s_mov_b32 s40, 1179648
  buffer_load_dwordx4 v11, s[8:11], s40 offen offset:0 lds
  s_mov_b32 s87, 0x20000
  s_mul_i32 s56, s6, 576
  s_sub_u32 s56, 1536, s56
  s_mul_i32 s57, s6, 320
  s_lshl_b32 s58, s6, 5
  s_add_u32 s58, s58, 256
  s_lshl_b32 s59, s4, 1
  s_add_u32 s59, s59, s6
  s_lshl_b32 s59, s59, 2
  buffer_load_dwordx4 v11, s[52:55], s40 offen offset:1024 lds
  s_add_u32 s59, s59, s3
  s_lshl_b32 s59, s59, 3
  s_add_u32 s59, s59, 2304
  s_lshl_b32 s70, s6, 3
  s_add_u32 s70, s70, s4
  s_lshl_b32 s70, s70, 3
  s_add_u32 s70, s70, 2816
  s_and_b32 s71, s3, 1
  s_lshr_b32 s72, s3, 1
  s_add_u32 m0, s42, 40960
  s_mov_b32 s40, 1474560
  buffer_load_dwordx4 v11, s[8:11], s40 offen offset:0 lds
  s_lshl_b32 s73, s71, 1
  s_add_u32 s73, s73, s72
  s_lshl_b32 s73, s73, 3
  s_mul_i32 s62, s57, 1152
  s_sub_u32 s63, 368640, s62
  s_mul_i32 s64, s58, 1152
  s_sub_u32 s65, 626688, s64
  s_lshl_b32 s66, s57, 3
  s_lshl_b32 s67, s58, 3
  buffer_load_dwordx4 v11, s[52:55], s40 offen offset:1024 lds
  s_movk_i32 s80, 0xc0
  s_add_u32 s96, s52, 1024
  s_addc_u32 s97, s53, 0
  s_cmp_eq_u32 s72, 0
  s_cselect_b32 s96, s8, s96
  s_cselect_b32 s97, s9, s97
  s_mov_b32 s98, s10
  s_mov_b32 s99, 0x20000
  v_add_u32 v216, 1, v254
  v_not_b32 v217, v216
  v_lshlrev_b32 v218, 3, v80
  s_mul_i32 s81, s4, 144
  s_add_u32 s81, s81, 1024
  v_accvgpr_write_b32 a224, v216
  v_accvgpr_write_b32 a225, v217
  v_min_u32 v219, 264, v218
  v_cmp_gt_u32 s[74:75], 16, v80
  v_add_u32 v220, s81, v219
  v_add_u32 v219, 1024, v219
  v_cndmask_b32 v219, v220, v219, s[74:75]
  s_add_u32 m0, s42, 49152
  s_mov_b32 s40, 1769472
  buffer_load_dwordx4 v11, s[8:11], s40 offen offset:0 lds
  buffer_load_dwordx4 v11, s[52:55], s40 offen offset:1024 lds
  s_add_u32 m0, s42, 57344
  s_mov_b32 s40, 2064384
  buffer_load_dwordx4 v11, s[8:11], s40 offen offset:0 lds
  buffer_load_dwordx4 v11, s[52:55], s40 offen offset:1024 lds
  s_add_u32 m0, s42, 65536
  s_mov_b32 s40, 2359296
  buffer_load_dwordx4 v11, s[8:11], s40 offen offset:0 lds
  buffer_load_dwordx4 v11, s[52:55], s40 offen offset:1024 lds
  s_add_u32 m0, s42, 73728
  s_mov_b32 s40, 2654208
  buffer_load_dwordx4 v11, s[8:11], s40 offen offset:0 lds
  buffer_load_dwordx4 v11, s[52:55], s40 offen offset:1024 lds
s_mov_b32 s82, 1
s_cmp_eq_u32 s3, 0
s_cbranch_scc1 L3_pad0
s_cmp_eq_u32 s3, 1
s_cbranch_scc1 L3_pad1
s_cmp_eq_u32 s3, 2
s_cbranch_scc1 L3_pad2
s_branch L3_pad3
L3_hx0:
s_add_u32 s44, s44, 1
s_cmp_ge_u32 s44, 0x40000
s_cbranch_scc1 L3_hxok0
s_sleep 1
buffer_load_dwordx2 v[242:243], v248, s[32:35], 0 offen offset:0 sc1
s_waitcnt vmcnt(0)
  v_accvgpr_read_b32 v244, a224
  v_accvgpr_read_b32 v245, a225
  v_cmp_ne_u64 s[74:75], v[242:243], v[244:245]
  s_nop 3
  s_cmp_lg_u64 s[74:75], 0
s_cbranch_scc1 L3_hx0
s_branch L3_hxok0
L3_hx1:
s_add_u32 s44, s44, 1
s_cmp_ge_u32 s44, 0x40000
s_cbranch_scc1 L3_hxok1
s_sleep 1
buffer_load_dwordx2 v[242:243], v248, s[32:35], 0 offen offset:768 sc1
s_waitcnt vmcnt(0)
  v_accvgpr_read_b32 v244, a224
  v_accvgpr_read_b32 v245, a225
  v_cmp_ne_u64 s[74:75], v[242:243], v[244:245]
  s_nop 3
  s_cmp_lg_u64 s[74:75], 0
s_cbranch_scc1 L3_hx1
s_branch L3_hxok1
.p2align 12
L3_main:
  s_mov_b32 s82, 0
  s_mov_b32 s44, 0
  s_cmp_lg_u32 s3, 3
  s_cbranch_scc1 L3_in
L3_inp:
  s_add_u32 s44, s44, 1
  s_cmp_ge_u32 s44, 0x40000
  s_cbranch_scc1 L3_in
  s_sleep 2
  buffer_load_dwordx2 v[242:243], v218, s[32:35], 0 offen sc1
  buffer_load_dwordx2 v[244:245], v218, s[32:35], 0 offen offset:512 sc1
  buffer_load_dwordx2 v[246:247], v219, s[32:35], 0 offen sc1
  s_waitcnt vmcnt(0)
  v_cmp_ne_u64 s[74:75], v[242:243], v[216:217]
  v_cmp_ne_u64 s[48:49], v[244:245], v[216:217]
  v_cmp_ne_u64 s[50:51], v[246:247], v[216:217]
  s_nop 2
  s_or_b64 s[48:49], s[48:49], s[74:75]
  s_or_b64 s[48:49], s[48:49], s[50:51]
  s_cbranch_scc1 L3_inp
L3_in:
  s_barrier
  s_add_u32 m0, s42, 98304
  s_mov_b32 s41, 0
  buffer_load_dwordx4 v230, s[16:19], s41 offen offset:0 sc1 lds
  buffer_load_dwordx4 v231, s[16:19], s41 offen offset:1024 sc1 lds
  s_add_u32 m0, s42, 106496
  s_mov_b32 s41, 131072
  buffer_load_dwordx4 v230, s[16:19], s41 offen offset:0 sc1 lds
  buffer_load_dwordx4 v231, s[16:19], s41 offen offset:1024 sc1 lds
  s_add_u32 m0, s42, 114688
  s_mov_b32 s41, 262144
  buffer_load_dwordx4 v230, s[16:19], s41 offen offset:0 sc1 lds
  buffer_load_dwordx4 v231, s[16:19], s41 offen offset:1024 sc1 lds
  s_waitcnt vmcnt(4)
  s_barrier
  ds_read_b64_tr_b16 a[144:145], v1 offset:0
  ds_read_b64_tr_b16 a[146:147], v1 offset:512
  ds_read_b64_tr_b16 a[0:1], v228 offset:0
  ds_read_b64_tr_b16 a[2:3], v228 offset:512
  ds_read_b64_tr_b16 a[4:5], v229 offset:0
  ds_read_b64_tr_b16 a[6:7], v229 offset:512
  ds_read_b64_tr_b16 a[148:149], v2 offset:0
  ds_read_b64_tr_b16 a[150:151], v2 offset:512
  ds_read_b64_tr_b16 a[152:153], v3 offset:0
  ds_read_b64_tr_b16 a[154:155], v3 offset:512
  ds_read_b64_tr_b16 a[156:157], v4 offset:0
  ds_read_b64_tr_b16 a[158:159], v4 offset:512
  ds_read_b64_tr_b16 a[160:161], v1 offset:1024
  ds_read_b64_tr_b16 a[162:163], v1 offset:1536
  ds_read_b64_tr_b16 a[164:165], v2 offset:1024
  ds_read_b64_tr_b16 a[166:167], v2 offset:1536
  ds_read_b64_tr_b16 a[168:169], v3 offset:1024
  ds_read_b64_tr_b16 a[170:171], v3 offset:1536
  ds_read_b64_tr_b16 a[172:173], v4 offset:1024
  ds_read_b64_tr_b16 a[174:175], v4 offset:1536
  s_waitcnt vmcnt(2)
  s_barrier
  s_waitcnt lgkmcnt(15)
  v_mfma_f32_16x16x32_bf16 v[16:19], a[144:147], a[0:3], 0
  s_waitcnt lgkmcnt(14)
  s_add_u32 m0, s42, 81920
  s_mov_b32 s40, 2949120
  v_add_u32 v5, 0x10000, v1
  v_add_u32 v6, 0x10000, v2
  v_mfma_f32_16x16x32_bf16 v[20:23], a[144:147], a[4:7], 0
  s_waitcnt lgkmcnt(12)
  ds_read_b64_tr_b16 a[144:145], v1 offset:8192
  v_add_u32 v7, 0x10000, v3
  v_mfma_f32_16x16x32_bf16 v[24:27], a[148:151], a[0:3], 0
  buffer_load_dwordx4 v11, s[8:11], s40 offen offset:0 lds
  v_mfma_f32_16x16x32_bf16 v[28:31], a[148:151], a[4:7], 0
  s_add_u32 m0, s42, 122880
  s_mov_b32 s41, 393216
  ds_read_b64_tr_b16 a[146:147], v1 offset:8704
  v_add_u32 v8, 0x10000, v4
  v_mfma_f32_16x16x32_bf16 a[196:199], a[212:215], a[0:3], 0
  ds_read_b64_tr_b16 a[8:9], v228 offset:8192
  v_and_b32 v88, 15, v80
  v_mfma_f32_16x16x32_bf16 a[204:207], a[0:3], a[0:3], 0
  s_waitcnt lgkmcnt(3)
  ds_read_b64_tr_b16 a[10:11], v228 offset:8704
  v_cmp_eq_u32 s[88:89], 0, v87
  v_mfma_f32_16x16x32_bf16 v[32:35], a[152:155], a[0:3], 0
  buffer_load_dwordx4 v230, s[16:19], s41 offen offset:0 sc1 lds
  v_mfma_f32_16x16x32_bf16 v[36:39], a[152:155], a[4:7], 0
  s_add_u32 m0, s42, 81920
  ds_read_b64_tr_b16 a[12:13], v229 offset:8192
  v_lshlrev_b32 v91, 3, v88
  v_mfma_f32_16x16x32_bf16 v[40:43], a[156:159], a[0:3], 0
  ds_read_b64_tr_b16 a[14:15], v229 offset:8704
  v_lshlrev_b32 v233, 4, v80
  v_mfma_f32_16x16x32_bf16 v[44:47], a[156:159], a[4:7], 0
  ds_read_b64_tr_b16 a[148:149], v2 offset:8192
  v_cndmask_b32 v232, 2.0, v91, s[88:89]
  v_mfma_f32_16x16x32_bf16 v[48:51], a[160:163], a[0:3], 0
  buffer_load_dwordx4 v11, s[52:55], s40 offen offset:1024 lds
  v_mfma_f32_16x16x32_bf16 v[52:55], a[160:163], a[4:7], 0
  s_add_u32 m0, s42, 122880
  ds_read_b64_tr_b16 a[150:151], v2 offset:8704
  v_cmp_eq_u32 s[46:47], 1, v86
  v_mfma_f32_16x16x32_bf16 v[56:59], a[164:167], a[0:3], 0
  ds_read_b64_tr_b16 a[152:153], v3 offset:8192
  v_cmp_eq_u32 s[48:49], 2, v86
  v_mfma_f32_16x16x32_bf16 v[60:63], a[164:167], a[4:7], 0
  ds_read_b64_tr_b16 a[154:155], v3 offset:8704
  v_cmp_eq_u32 s[50:51], 3, v86
  v_mfma_f32_16x16x32_bf16 a[200:203], a[212:215], a[4:7], 0
  buffer_load_dwordx4 v231, s[16:19], s41 offen offset:1024 sc1 lds
  v_mfma_f32_16x16x32_bf16 a[208:211], a[4:7], a[4:7], 0
  s_add_u32 m0, s42, 90112
  s_mov_b32 s40, 3244032
  ds_read_b64_tr_b16 a[156:157], v4 offset:8192
  v_lshrrev_b32 v91, 2, v88
  v_mfma_f32_16x16x32_bf16 v[64:67], a[168:171], a[0:3], 0
  ds_read_b64_tr_b16 a[158:159], v4 offset:8704
  v_cmp_eq_u32 s[74:75], v91, v87
  v_mfma_f32_16x16x32_bf16 v[68:71], a[168:171], a[4:7], 0
  ds_read_b64_tr_b16 a[160:161], v1 offset:9216
  v_lshl_add_u32 v91, v91, 4, v88
  v_mfma_f32_16x16x32_bf16 v[72:75], a[172:175], a[0:3], 0
  s_waitcnt vmcnt(4) lgkmcnt(3)
  buffer_load_dwordx4 v11, s[8:11], s40 offen offset:0 lds
  v_mfma_f32_16x16x32_bf16 v[76:79], a[172:175], a[4:7], 0
  s_barrier
  v_mfma_f32_16x16x32_bf16 v[16:19], a[144:147], a[8:11], v[16:19]
  s_add_u32 m0, s42, 131072
  s_mov_b32 s41, 524288
  ds_read_b64_tr_b16 a[162:163], v1 offset:9728
  v_lshlrev_b32 v249, 2, v91
  v_mfma_f32_16x16x32_bf16 v[20:23], a[144:147], a[12:15], v[20:23]
  ds_read_b64_tr_b16 a[164:165], v2 offset:9216
  v_and_b32 v91, 1, v80
  v_mfma_f32_16x16x32_bf16 v[24:27], a[148:151], a[8:11], v[24:27]
  buffer_load_dwordx4 v230, s[16:19], s41 offen offset:0 sc1 lds
  v_mfma_f32_16x16x32_bf16 v[28:31], a[148:151], a[12:15], v[28:31]
  s_add_u32 m0, s42, 90112
  ds_read_b64_tr_b16 a[166:167], v2 offset:9728
  v_lshlrev_b32 v91, 4, v91
  v_mfma_f32_16x16x32_bf16 a[196:199], a[212:215], a[8:11], a[196:199]
  ds_read_b64_tr_b16 a[168:169], v3 offset:9216
  v_mov_b32 v92, 0x3f80
  v_mfma_f32_16x16x32_bf16 a[204:207], a[8:11], a[8:11], a[204:207]
  ds_read_b64_tr_b16 a[170:171], v3 offset:9728
  v_lshlrev_b32 v92, v91, v92
  v_mfma_f32_16x16x32_bf16 v[32:35], a[152:155], a[8:11], v[32:35]
  buffer_load_dwordx4 v11, s[52:55], s40 offen offset:1024 lds
  v_mfma_f32_16x16x32_bf16 v[36:39], a[152:155], a[12:15], v[36:39]
  s_waitcnt lgkmcnt(3)
  s_add_u32 m0, s42, 131072
  ds_read_b64_tr_b16 a[172:173], v4 offset:9216
  v_cndmask_b32 v92, 0, v92, s[74:75]
  v_mfma_f32_16x16x32_bf16 v[40:43], a[156:159], a[8:11], v[40:43]
  ds_read_b64_tr_b16 a[174:175], v4 offset:9728
  v_and_b32 v91, 2, v80
  v_mfma_f32_16x16x32_bf16 v[44:47], a[156:159], a[12:15], v[44:47]
  ds_read_b64_tr_b16 a[144:145], v1 offset:16384
  v_cmp_eq_u32 s[74:75], 0, v91
  v_mfma_f32_16x16x32_bf16 v[48:51], a[160:163], a[8:11], v[48:51]
  buffer_load_dwordx4 v231, s[16:19], s41 offen offset:1024 sc1 lds
  v_mfma_f32_16x16x32_bf16 v[52:55], a[160:163], a[12:15], v[52:55]
  s_waitcnt lgkmcnt(3)
  s_add_u32 m0, s42, 0
  s_mov_b32 s40, 3538944
  ds_read_b64_tr_b16 a[146:147], v1 offset:16896
  v_accvgpr_write_b32 a218, 0
  v_mfma_f32_16x16x32_bf16 v[56:59], a[164:167], a[8:11], v[56:59]
  ds_read_b64_tr_b16 a[16:17], v228 offset:16384
  ds_read_b64_tr_b16 a[18:19], v228 offset:16896
  v_mfma_f32_16x16x32_bf16 v[60:63], a[164:167], a[12:15], v[60:63]
  ds_read_b64_tr_b16 a[20:21], v229 offset:16384
  ds_read_b64_tr_b16 a[22:23], v229 offset:16896
  v_mfma_f32_16x16x32_bf16 a[200:203], a[212:215], a[12:15], a[200:203]
  buffer_load_dwordx4 v11, s[8:11], s40 offen offset:0 lds
  v_mfma_f32_16x16x32_bf16 a[208:211], a[12:15], a[12:15], a[208:211]
  s_add_u32 m0, s42, 139264
  ds_read_b64_tr_b16 a[148:149], v2 offset:16384
  ds_read_b64_tr_b16 a[150:151], v2 offset:16896
  v_mfma_f32_16x16x32_bf16 v[64:67], a[168:171], a[8:11], v[64:67]
  s_mov_b32 s41, 655360
  ds_read_b64_tr_b16 a[152:153], v3 offset:16384
  v_accvgpr_write_b32 a219, 0
  v_mfma_f32_16x16x32_bf16 v[68:71], a[168:171], a[12:15], v[68:71]
  s_waitcnt lgkmcnt(7)
  ds_read_b64_tr_b16 a[154:155], v3 offset:16896
  v_cndmask_b32 v90, 0, v92, s[74:75]
  v_mfma_f32_16x16x32_bf16 v[72:75], a[172:175], a[8:11], v[72:75]
  s_waitcnt vmcnt(5) lgkmcnt(4)
  buffer_load_dwordx4 v230, s[16:19], s41 offen offset:0 sc1 lds
  v_mfma_f32_16x16x32_bf16 v[76:79], a[172:175], a[12:15], v[76:79]
  s_barrier
  v_mfma_f32_16x16x32_bf16 v[16:19], a[144:147], a[16:19], v[16:19]
  s_add_u32 m0, s42, 0
  ds_read_b64_tr_b16 a[156:157], v4 offset:16384
  v_cndmask_b32 v91, v92, 0, s[74:75]
  v_mfma_f32_16x16x32_bf16 v[20:23], a[144:147], a[20:23], v[20:23]
  s_waitcnt lgkmcnt(3)
  ds_read_b64_tr_b16 a[158:159], v4 offset:16896
  v_accvgpr_write_b32 a220, 0
  v_mfma_f32_16x16x32_bf16 v[24:27], a[148:151], a[16:19], v[24:27]
  buffer_load_dwordx4 v11, s[52:55], s40 offen offset:1024 lds
  v_mfma_f32_16x16x32_bf16 v[28:31], a[148:151], a[20:23], v[28:31]
  s_add_u32 m0, s42, 139264
  ds_read_b64_tr_b16 a[160:161], v1 offset:17408
  ds_read_b64_tr_b16 a[162:163], v1 offset:17920
  v_mfma_f32_16x16x32_bf16 a[196:199], a[212:215], a[16:19], a[196:199]
  ds_read_b64_tr_b16 a[164:165], v2 offset:17408
  v_accvgpr_write_b32 a221, 0
  v_mfma_f32_16x16x32_bf16 a[204:207], a[16:19], a[16:19], a[204:207]
  s_waitcnt lgkmcnt(5)
  ds_read_b64_tr_b16 a[166:167], v2 offset:17920
  v_accvgpr_write_b32 a216, v90
  v_mfma_f32_16x16x32_bf16 v[32:35], a[152:155], a[16:19], v[32:35]
  buffer_load_dwordx4 v231, s[16:19], s41 offen offset:1024 sc1 lds
  v_mfma_f32_16x16x32_bf16 v[36:39], a[152:155], a[20:23], v[36:39]
  s_waitcnt lgkmcnt(4)
  s_add_u32 m0, s42, 8192
  s_mov_b32 s40, 3833856
  ds_read_b64_tr_b16 a[168:169], v3 offset:17408
  v_accvgpr_write_b32 a217, v91
  v_mfma_f32_16x16x32_bf16 v[40:43], a[156:159], a[16:19], v[40:43]
  ds_read_b64_tr_b16 a[170:171], v3 offset:17920
  v_accvgpr_write_b32 a222, v90
  v_mfma_f32_16x16x32_bf16 v[44:47], a[156:159], a[20:23], v[44:47]
  s_waitcnt lgkmcnt(4)
  ds_read_b64_tr_b16 a[172:173], v4 offset:17408
  ds_read_b64_tr_b16 a[174:175], v4 offset:17920
  v_mfma_f32_16x16x32_bf16 v[48:51], a[160:163], a[16:19], v[48:51]
  buffer_load_dwordx4 v11, s[8:11], s40 offen offset:0 lds
  v_mfma_f32_16x16x32_bf16 v[52:55], a[160:163], a[20:23], v[52:55]
  s_waitcnt lgkmcnt(4)
  s_add_u32 m0, s42, 147456
  ds_read_b64_tr_b16 a[144:145], v1 offset:24576
  ds_read_b64_tr_b16 a[146:147], v1 offset:25088
  v_mfma_f32_16x16x32_bf16 v[56:59], a[164:167], a[16:19], v[56:59]
  s_mov_b32 s41, 786432
  ds_read_b64_tr_b16 a[24:25], v228 offset:24576
  ds_read_b64_tr_b16 a[26:27], v228 offset:25088
  v_mfma_f32_16x16x32_bf16 v[60:63], a[164:167], a[20:23], v[60:63]
  ds_read_b64_tr_b16 a[28:29], v229 offset:24576
  ds_read_b64_tr_b16 a[30:31], v229 offset:25088
  v_mfma_f32_16x16x32_bf16 a[200:203], a[212:215], a[20:23], a[200:203]
  buffer_load_dwordx4 v230, s[16:19], s41 offen offset:0 sc1 lds
  v_mfma_f32_16x16x32_bf16 a[208:211], a[20:23], a[20:23], a[208:211]
  s_waitcnt lgkmcnt(6)
  s_add_u32 m0, s42, 8192
  ds_read_b64_tr_b16 a[148:149], v2 offset:24576
  ds_read_b64_tr_b16 a[150:151], v2 offset:25088
  v_mfma_f32_16x16x32_bf16 v[64:67], a[168:171], a[16:19], v[64:67]
  ds_read_b64_tr_b16 a[152:153], v3 offset:24576
  v_accvgpr_write_b32 a223, v91
  v_mfma_f32_16x16x32_bf16 v[68:71], a[168:171], a[20:23], v[68:71]
  ds_read_b64_tr_b16 a[154:155], v3 offset:25088
  v_lshrrev_b32 v90, 2, v80
  v_mfma_f32_16x16x32_bf16 v[72:75], a[172:175], a[16:19], v[72:75]
  s_waitcnt vmcnt(6) lgkmcnt(4)
  buffer_load_dwordx4 v11, s[52:55], s40 offen offset:1024 lds
  v_mfma_f32_16x16x32_bf16 v[76:79], a[172:175], a[20:23], v[76:79]
  s_barrier
  v_mfma_f32_16x16x32_bf16 v[16:19], a[144:147], a[24:27], v[16:19]
  s_add_u32 m0, s42, 147456
  ds_read_b64_tr_b16 a[156:157], v4 offset:24576
  v_lshl_add_u32 v90, s71, 4, v90
  v_mfma_f32_16x16x32_bf16 v[20:23], a[144:147], a[28:31], v[20:23]
  s_waitcnt lgkmcnt(3)
  ds_read_b64_tr_b16 a[158:159], v4 offset:25088
  v_lshrrev_b32 v84, 5, v80
  v_mfma_f32_16x16x32_bf16 v[24:27], a[148:151], a[24:27], v[24:27]
  buffer_load_dwordx4 v231, s[16:19], s41 offen offset:1024 sc1 lds
  v_mfma_f32_16x16x32_bf16 v[28:31], a[148:151], a[28:31], v[28:31]
  s_add_u32 m0, s42, 16384
  ds_read_b64_tr_b16 a[160:161], v1 offset:25600
  ds_read_b64_tr_b16 a[162:163], v1 offset:26112
  v_mfma_f32_16x16x32_bf16 a[196:199], a[212:215], a[24:27], a[196:199]
  s_mov_b32 s40, 4128768
  ds_read_b64_tr_b16 a[164:165], v2 offset:25600
  v_lshlrev_b32 v91, 1, v84
  v_mfma_f32_16x16x32_bf16 a[204:207], a[24:27], a[24:27], a[204:207]
  s_waitcnt lgkmcnt(5)
  ds_read_b64_tr_b16 a[166:167], v2 offset:26112
  v_xor_b32 v91, v91, v86
  v_mfma_f32_16x16x32_bf16 v[32:35], a[152:155], a[24:27], v[32:35]
  buffer_load_dwordx4 v11, s[8:11], s40 offen offset:0 lds
  v_mfma_f32_16x16x32_bf16 v[36:39], a[152:155], a[28:31], v[36:39]
  s_waitcnt lgkmcnt(4)
  s_add_u32 m0, s42, 155648
  s_mov_b32 s41, 917504
  ds_read_b64_tr_b16 a[168:169], v3 offset:25600
  v_mul_u32_u24 v12, 9216, v90
  v_mfma_f32_16x16x32_bf16 v[40:43], a[156:159], a[24:27], v[40:43]
  ds_read_b64_tr_b16 a[170:171], v3 offset:26112
  v_lshl_add_u32 v12, v91, 4, v12
  v_mfma_f32_16x16x32_bf16 v[44:47], a[156:159], a[28:31], v[44:47]
  s_waitcnt lgkmcnt(4)
  ds_read_b64_tr_b16 a[172:173], v4 offset:25600
  ds_read_b64_tr_b16 a[174:175], v4 offset:26112
  v_mfma_f32_16x16x32_bf16 v[48:51], a[160:163], a[24:27], v[48:51]
  buffer_load_dwordx4 v230, s[16:19], s41 offen offset:0 sc1 lds
  v_mfma_f32_16x16x32_bf16 v[52:55], a[160:163], a[28:31], v[52:55]
  s_waitcnt lgkmcnt(4)
  s_add_u32 m0, s42, 16384
  ds_read_b64_tr_b16 a[144:145], v1 offset:32768
  ds_read_b64_tr_b16 a[146:147], v1 offset:33280
  v_mfma_f32_16x16x32_bf16 v[56:59], a[164:167], a[24:27], v[56:59]
  ds_read_b64_tr_b16 a[32:33], v228 offset:32768
  ds_read_b64_tr_b16 a[34:35], v228 offset:33280
  v_mfma_f32_16x16x32_bf16 v[60:63], a[164:167], a[28:31], v[60:63]
  ds_read_b64_tr_b16 a[36:37], v229 offset:32768
  ds_read_b64_tr_b16 a[38:39], v229 offset:33280
  v_mfma_f32_16x16x32_bf16 a[200:203], a[212:215], a[28:31], a[200:203]
  buffer_load_dwordx4 v11, s[52:55], s40 offen offset:1024 lds
  v_mfma_f32_16x16x32_bf16 a[208:211], a[28:31], a[28:31], a[208:211]
  s_waitcnt lgkmcnt(6)
  s_add_u32 m0, s42, 155648
  ds_read_b64_tr_b16 a[148:149], v2 offset:32768
  ds_read_b64_tr_b16 a[150:151], v2 offset:33280
  v_mfma_f32_16x16x32_bf16 v[64:67], a[168:171], a[24:27], v[64:67]
  ds_read_b64_tr_b16 a[152:153], v3 offset:32768
  v_add_u32 v12, s56, v12
  v_mfma_f32_16x16x32_bf16 v[68:71], a[168:171], a[28:31], v[68:71]
  ds_read_b64_tr_b16 a[154:155], v3 offset:33280
  v_lshlrev_b32 v91, 1, v83
  v_mfma_f32_16x16x32_bf16 v[72:75], a[172:175], a[24:27], v[72:75]
  s_waitcnt vmcnt(7) lgkmcnt(4)
  buffer_load_dwordx4 v231, s[16:19], s41 offen offset:1024 sc1 lds
  v_mfma_f32_16x16x32_bf16 v[76:79], a[172:175], a[28:31], v[76:79]
  s_barrier
  v_mfma_f32_16x16x32_bf16 v[16:19], a[144:147], a[32:35], v[16:19]
  s_add_u32 m0, s42, 24576
  s_mov_b32 s40, 4423680
  ds_read_b64_tr_b16 a[156:157], v4 offset:32768
  v_xor_b32 v91, v91, v86
  v_mfma_f32_16x16x32_bf16 v[20:23], a[144:147], a[36:39], v[20:23]
  s_waitcnt lgkmcnt(3)
  ds_read_b64_tr_b16 a[158:159], v4 offset:33280
  v_mul_u32_u24 v92, 1152, v90
  v_mfma_f32_16x16x32_bf16 v[24:27], a[148:151], a[32:35], v[24:27]
  buffer_load_dwordx4 v11, s[8:11], s40 offen offset:0 lds
  v_mfma_f32_16x16x32_bf16 v[28:31], a[148:151], a[36:39], v[28:31]
  s_add_u32 m0, s42, 98304
  ds_read_b64_tr_b16 a[160:161], v1 offset:33792
  ds_read_b64_tr_b16 a[162:163], v1 offset:34304
  v_mfma_f32_16x16x32_bf16 a[196:199], a[212:215], a[32:35], a[196:199]
  s_mov_b32 s41, 1048576
  ds_read_b64_tr_b16 a[164:165], v2 offset:33792
  v_lshl_add_u32 v92, v91, 4, v92
  v_mfma_f32_16x16x32_bf16 a[204:207], a[32:35], a[32:35], a[204:207]
  s_waitcnt lgkmcnt(5)
  ds_read_b64_tr_b16 a[166:167], v2 offset:34304
  v_add_u32 v92, s56, v92
  v_mfma_f32_16x16x32_bf16 v[32:35], a[152:155], a[32:35], v[32:35]
  buffer_load_dwordx4 v230, s[16:19], s41 offen offset:0 sc1 lds
  v_mfma_f32_16x16x32_bf16 v[36:39], a[152:155], a[36:39], v[36:39]
  s_waitcnt lgkmcnt(4)
  s_add_u32 m0, s42, 24576
  ds_read_b64_tr_b16 a[168:169], v3 offset:33792
  v_mov_b32 v91, s72
  v_mfma_f32_16x16x32_bf16 v[40:43], a[156:159], a[32:35], v[40:43]
  ds_read_b64_tr_b16 a[170:171], v3 offset:34304
  v_mul_u32_u24 v91, 36864, v91
  v_mfma_f32_16x16x32_bf16 v[44:47], a[156:159], a[36:39], v[44:47]
  s_waitcnt lgkmcnt(4)
  ds_read_b64_tr_b16 a[172:173], v4 offset:33792
  ds_read_b64_tr_b16 a[174:175], v4 offset:34304
  v_mfma_f32_16x16x32_bf16 v[48:51], a[160:163], a[32:35], v[48:51]
  buffer_load_dwordx4 v11, s[52:55], s40 offen offset:1024 lds
  v_mfma_f32_16x16x32_bf16 v[52:55], a[160:163], a[36:39], v[52:55]
  s_waitcnt lgkmcnt(4)
  s_add_u32 m0, s42, 98304
  ds_read_b64_tr_b16 a[144:145], v1 offset:40960
  ds_read_b64_tr_b16 a[146:147], v1 offset:41472
  v_mfma_f32_16x16x32_bf16 v[56:59], a[164:167], a[32:35], v[56:59]
  ds_read_b64_tr_b16 a[40:41], v228 offset:40960
  ds_read_b64_tr_b16 a[42:43], v228 offset:41472
  v_mfma_f32_16x16x32_bf16 v[60:63], a[164:167], a[36:39], v[60:63]
  ds_read_b64_tr_b16 a[44:45], v229 offset:40960
  ds_read_b64_tr_b16 a[46:47], v229 offset:41472
  v_mfma_f32_16x16x32_bf16 a[200:203], a[212:215], a[36:39], a[200:203]
  buffer_load_dwordx4 v231, s[16:19], s41 offen offset:1024 sc1 lds
  v_mfma_f32_16x16x32_bf16 a[208:211], a[36:39], a[36:39], a[208:211]
  s_waitcnt lgkmcnt(6)
  s_add_u32 m0, s42, 106496
  ds_read_b64_tr_b16 a[148:149], v2 offset:40960
  ds_read_b64_tr_b16 a[150:151], v2 offset:41472
  v_mfma_f32_16x16x32_bf16 v[64:67], a[168:171], a[32:35], v[64:67]
  s_mov_b32 s41, 1179648
  ds_read_b64_tr_b16 a[152:153], v3 offset:40960
  v_add_u32 v238, v92, v91
  v_mfma_f32_16x16x32_bf16 v[68:71], a[168:171], a[36:39], v[68:71]
  ds_read_b64_tr_b16 a[154:155], v3 offset:41472
  v_mov_b32 v93, s6
  v_mfma_f32_16x16x32_bf16 v[72:75], a[172:175], a[32:35], v[72:75]
  s_waitcnt vmcnt(8) lgkmcnt(4)
  buffer_load_dwordx4 v230, s[16:19], s41 offen offset:0 sc1 lds
  v_mfma_f32_16x16x32_bf16 v[76:79], a[172:175], a[36:39], v[76:79]
  s_barrier
  v_mfma_f32_16x16x32_bf16 v[16:19], a[144:147], a[40:43], v[16:19]
  ds_read_b64_tr_b16 a[156:157], v4 offset:40960
  v_mul_u32_u24 v93, v93, v91
  v_mfma_f32_16x16x32_bf16 v[20:23], a[144:147], a[44:47], v[20:23]
  s_waitcnt lgkmcnt(3)
  ds_read_b64_tr_b16 a[158:159], v4 offset:41472
  v_lshlrev_b32 v93, 1, v93
  v_mfma_f32_16x16x32_bf16 v[24:27], a[148:151], a[40:43], v[24:27]
  buffer_load_dwordx4 v231, s[16:19], s41 offen offset:1024 sc1 lds
  v_mfma_f32_16x16x32_bf16 v[28:31], a[148:151], a[44:47], v[28:31]
  s_add_u32 m0, s42, 32768
  ds_read_b64_tr_b16 a[160:161], v1 offset:41984
  ds_read_b64_tr_b16 a[162:163], v1 offset:42496
  v_mfma_f32_16x16x32_bf16 a[196:199], a[212:215], a[40:43], a[196:199]
  s_mov_b32 s40, 4718592
  ds_read_b64_tr_b16 a[164:165], v2 offset:41984
  v_add_u32 v239, s64, v238
  v_mfma_f32_16x16x32_bf16 a[204:207], a[40:43], a[40:43], a[204:207]
  s_waitcnt lgkmcnt(5)
  ds_read_b64_tr_b16 a[166:167], v2 offset:42496
  v_sub_u32 v239, v239, v93
  v_mfma_f32_16x16x32_bf16 v[32:35], a[152:155], a[40:43], v[32:35]
  buffer_load_dwordx4 v11, s[8:11], s40 offen offset:0 lds
  v_mfma_f32_16x16x32_bf16 v[36:39], a[152:155], a[44:47], v[36:39]
  s_waitcnt lgkmcnt(4)
  s_add_u32 m0, s42, 114688
  s_mov_b32 s41, 1310720
  ds_read_b64_tr_b16 a[168:169], v3 offset:41984
  v_lshlrev_b32 v90, 9, v87
  v_mfma_f32_16x16x32_bf16 v[40:43], a[156:159], a[40:43], v[40:43]
  ds_read_b64_tr_b16 a[170:171], v3 offset:42496
  v_lshl_add_u32 v90, v85, 6, v90
  v_mfma_f32_16x16x32_bf16 v[44:47], a[156:159], a[44:47], v[44:47]
  s_waitcnt lgkmcnt(4)
  ds_read_b64_tr_b16 a[172:173], v4 offset:41984
  ds_read_b64_tr_b16 a[174:175], v4 offset:42496
  v_mfma_f32_16x16x32_bf16 v[48:51], a[160:163], a[40:43], v[48:51]
  buffer_load_dwordx4 v230, s[16:19], s41 offen offset:0 sc1 lds
  v_mfma_f32_16x16x32_bf16 v[52:55], a[160:163], a[44:47], v[52:55]
  s_waitcnt lgkmcnt(4)
  s_add_u32 m0, s42, 32768
  ds_read_b64_tr_b16 a[144:145], v1 offset:49152
  ds_read_b64_tr_b16 a[146:147], v1 offset:49664
  v_mfma_f32_16x16x32_bf16 v[56:59], a[164:167], a[40:43], v[56:59]
  ds_read_b64_tr_b16 a[48:49], v228 offset:49152
  ds_read_b64_tr_b16 a[50:51], v228 offset:49664
  v_mfma_f32_16x16x32_bf16 v[60:63], a[164:167], a[44:47], v[60:63]
  ds_read_b64_tr_b16 a[52:53], v229 offset:49152
  ds_read_b64_tr_b16 a[54:55], v229 offset:49664
  v_mfma_f32_16x16x32_bf16 a[200:203], a[212:215], a[44:47], a[200:203]
  buffer_load_dwordx4 v11, s[52:55], s40 offen offset:1024 lds
  v_mfma_f32_16x16x32_bf16 a[208:211], a[44:47], a[44:47], a[208:211]
  s_waitcnt lgkmcnt(6)
  s_add_u32 m0, s42, 114688
  ds_read_b64_tr_b16 a[148:149], v2 offset:49152
  ds_read_b64_tr_b16 a[150:151], v2 offset:49664
  v_mfma_f32_16x16x32_bf16 v[64:67], a[168:171], a[40:43], v[64:67]
  ds_read_b64_tr_b16 a[152:153], v3 offset:49152
  v_lshl_add_u32 v90, v86, 3, v90
  v_mfma_f32_16x16x32_bf16 v[68:71], a[168:171], a[44:47], v[68:71]
  ds_read_b64_tr_b16 a[154:155], v3 offset:49664
  v_lshl_add_u32 v9, v83, 5, v90
  v_mfma_f32_16x16x32_bf16 v[72:75], a[172:175], a[40:43], v[72:75]
  s_waitcnt vmcnt(9) lgkmcnt(4)
  buffer_load_dwordx4 v231, s[16:19], s41 offen offset:1024 sc1 lds
  v_mfma_f32_16x16x32_bf16 v[76:79], a[172:175], a[44:47], v[76:79]
  s_barrier
  v_mfma_f32_16x16x32_bf16 v[16:19], a[144:147], a[48:51], v[16:19]
  s_add_u32 m0, s42, 40960
  s_mov_b32 s40, 5013504
  ds_read_b64_tr_b16 a[156:157], v4 offset:49152
  v_xor_b32 v10, 32, v9
  v_mfma_f32_16x16x32_bf16 v[20:23], a[144:147], a[52:55], v[20:23]
  s_waitcnt lgkmcnt(3)
  ds_read_b64_tr_b16 a[158:159], v4 offset:49664
  v_add_u32 v252, 0x10000, v9
  v_mfma_f32_16x16x32_bf16 v[24:27], a[148:151], a[48:51], v[24:27]
  buffer_load_dwordx4 v11, s[8:11], s40 offen offset:0 lds
  v_mfma_f32_16x16x32_bf16 v[28:31], a[148:151], a[52:55], v[28:31]
  s_add_u32 m0, s42, 122880
  ds_read_b64_tr_b16 a[160:161], v1 offset:50176
  ds_read_b64_tr_b16 a[162:163], v1 offset:50688
  v_mfma_f32_16x16x32_bf16 a[196:199], a[212:215], a[48:51], a[196:199]
  s_mov_b32 s41, 1441792
  ds_read_b64_tr_b16 a[164:165], v2 offset:50176
  v_add_u32 v253, 0x10000, v10
  v_mfma_f32_16x16x32_bf16 a[204:207], a[48:51], a[48:51], a[204:207]
  s_waitcnt lgkmcnt(5)
  ds_read_b64_tr_b16 a[166:167], v2 offset:50688
  v_lshrrev_b32 v81, 3, v80
  v_mfma_f32_16x16x32_bf16 v[32:35], a[152:155], a[48:51], v[32:35]
  buffer_load_dwordx4 v230, s[16:19], s41 offen offset:0 sc1 lds
  v_mfma_f32_16x16x32_bf16 v[36:39], a[152:155], a[52:55], v[36:39]
  s_waitcnt lgkmcnt(4)
  s_add_u32 m0, s42, 40960
  ds_read_b64_tr_b16 a[168:169], v3 offset:50176
  v_lshrrev_b32 v91, 1, v81
  v_mfma_f32_16x16x32_bf16 v[40:43], a[156:159], a[48:51], v[40:43]
  ds_read_b64_tr_b16 a[170:171], v3 offset:50688
  v_and_b32 v91, 3, v91
  v_mfma_f32_16x16x32_bf16 v[44:47], a[156:159], a[52:55], v[44:47]
  s_waitcnt lgkmcnt(4)
  ds_read_b64_tr_b16 a[172:173], v4 offset:50176
  ds_read_b64_tr_b16 a[174:175], v4 offset:50688
  v_mfma_f32_16x16x32_bf16 v[48:51], a[160:163], a[48:51], v[48:51]
  buffer_load_dwordx4 v11, s[52:55], s40 offen offset:1024 lds
  v_mfma_f32_16x16x32_bf16 v[52:55], a[160:163], a[52:55], v[52:55]
  s_waitcnt lgkmcnt(4)
  s_add_u32 m0, s42, 122880
  ds_read_b64_tr_b16 a[144:145], v1 offset:57344
  ds_read_b64_tr_b16 a[146:147], v1 offset:57856
  v_mfma_f32_16x16x32_bf16 v[56:59], a[164:167], a[48:51], v[56:59]
  ds_read_b64_tr_b16 a[56:57], v228 offset:57344
  ds_read_b64_tr_b16 a[58:59], v228 offset:57856
  v_mfma_f32_16x16x32_bf16 v[60:63], a[164:167], a[52:55], v[60:63]
  ds_read_b64_tr_b16 a[60:61], v229 offset:57344
  ds_read_b64_tr_b16 a[62:63], v229 offset:57856
  v_mfma_f32_16x16x32_bf16 a[200:203], a[212:215], a[52:55], a[200:203]
  buffer_load_dwordx4 v231, s[16:19], s41 offen offset:1024 sc1 lds
  v_mfma_f32_16x16x32_bf16 a[208:211], a[52:55], a[52:55], a[208:211]
  s_waitcnt lgkmcnt(6)
  s_add_u32 m0, s42, 131072
  ds_read_b64_tr_b16 a[148:149], v2 offset:57344
  ds_read_b64_tr_b16 a[150:151], v2 offset:57856
  v_mfma_f32_16x16x32_bf16 v[64:67], a[168:171], a[48:51], v[64:67]
  s_mov_b32 s41, 1572864
  ds_read_b64_tr_b16 a[152:153], v3 offset:57344
  v_lshlrev_b32 v91, 1, v91
  v_mfma_f32_16x16x32_bf16 v[68:71], a[168:171], a[52:55], v[68:71]
  ds_read_b64_tr_b16 a[154:155], v3 offset:57856
  v_xor_b32 v91, v91, v82
  v_mfma_f32_16x16x32_bf16 v[72:75], a[172:175], a[48:51], v[72:75]
  s_waitcnt vmcnt(10) lgkmcnt(4)
  buffer_load_dwordx4 v230, s[16:19], s41 offen offset:0 sc1 lds
  v_mfma_f32_16x16x32_bf16 v[76:79], a[172:175], a[52:55], v[76:79]
  s_barrier
  v_mfma_f32_16x16x32_bf16 v[16:19], a[144:147], a[56:59], v[16:19]
  ds_read_b64_tr_b16 a[156:157], v4 offset:57344
  v_add_u32 v92, s73, v81
  v_mfma_f32_16x16x32_bf16 v[20:23], a[144:147], a[60:63], v[20:23]
  s_waitcnt lgkmcnt(3)
  ds_read_b64_tr_b16 a[158:159], v4 offset:57856
  v_mul_u32_u24 v92, 1152, v92
  v_mfma_f32_16x16x32_bf16 v[24:27], a[148:151], a[56:59], v[24:27]
  buffer_load_dwordx4 v231, s[16:19], s41 offen offset:1024 sc1 lds
  v_mfma_f32_16x16x32_bf16 v[28:31], a[148:151], a[60:63], v[28:31]
  s_add_u32 m0, s42, 49152
  ds_read_b64_tr_b16 a[160:161], v1 offset:58368
  ds_read_b64_tr_b16 a[162:163], v1 offset:58880
  v_mfma_f32_16x16x32_bf16 a[196:199], a[212:215], a[56:59], a[196:199]
  s_mov_b32 s40, 128
  ds_read_b64_tr_b16 a[164:165], v2 offset:58368
  v_lshl_add_u32 v92, v91, 4, v92
  v_mfma_f32_16x16x32_bf16 a[204:207], a[56:59], a[56:59], a[204:207]
  s_waitcnt lgkmcnt(5)
  ds_read_b64_tr_b16 a[166:167], v2 offset:58880
  v_add_u32 v13, 1024, v92
  v_mfma_f32_16x16x32_bf16 v[32:35], a[152:155], a[56:59], v[32:35]
  buffer_load_dwordx4 v11, s[8:11], s40 offen offset:0 lds
  v_mfma_f32_16x16x32_bf16 v[36:39], a[152:155], a[60:63], v[36:39]
  s_waitcnt lgkmcnt(4)
  s_add_u32 m0, s42, 139264
  s_mov_b32 s41, 1703936
  ds_read_b64_tr_b16 a[168:169], v3 offset:58368
  v_add_u32 v14, 128, v92
  v_mfma_f32_16x16x32_bf16 v[40:43], a[156:159], a[56:59], v[40:43]
  ds_read_b64_tr_b16 a[170:171], v3 offset:58880
  v_lshl_or_b32 v91, v83, 1, v84
  v_mfma_f32_16x16x32_bf16 v[44:47], a[156:159], a[60:63], v[44:47]
  s_waitcnt lgkmcnt(4)
  ds_read_b64_tr_b16 a[172:173], v4 offset:58368
  ds_read_b64_tr_b16 a[174:175], v4 offset:58880
  v_mfma_f32_16x16x32_bf16 v[48:51], a[160:163], a[56:59], v[48:51]
L3_pad0:
  s_cmp_lg_u32 s82, 0
  s_cbranch_scc1 L3_pad4
  buffer_load_dwordx4 v230, s[16:19], s41 offen offset:0 sc1 lds
  v_mfma_f32_16x16x32_bf16 v[52:55], a[160:163], a[60:63], v[52:55]
  s_waitcnt lgkmcnt(4)
  s_add_u32 m0, s42, 49152
  ds_read_b64_tr_b16 a[144:145], v5 offset:0
  ds_read_b64_tr_b16 a[146:147], v5 offset:512
  v_mfma_f32_16x16x32_bf16 v[56:59], a[164:167], a[56:59], v[56:59]
  ds_read_b64_tr_b16 a[64:65], v228 offset:0
  ds_read_b64_tr_b16 a[66:67], v228 offset:512
  v_mfma_f32_16x16x32_bf16 v[60:63], a[164:167], a[60:63], v[60:63]
  ds_read_b64_tr_b16 a[68:69], v229 offset:0
  ds_read_b64_tr_b16 a[70:71], v229 offset:512
  v_mfma_f32_16x16x32_bf16 a[200:203], a[212:215], a[60:63], a[200:203]
  buffer_load_dwordx4 v11, s[52:55], s40 offen offset:1024 lds
  v_mfma_f32_16x16x32_bf16 a[208:211], a[60:63], a[60:63], a[208:211]
  s_waitcnt lgkmcnt(6)
  s_add_u32 m0, s42, 139264
  ds_read_b64_tr_b16 a[148:149], v6 offset:0
  ds_read_b64_tr_b16 a[150:151], v6 offset:512
  v_mfma_f32_16x16x32_bf16 v[64:67], a[168:171], a[56:59], v[64:67]
  ds_read_b64_tr_b16 a[152:153], v7 offset:0
  v_lshlrev_b32 v91, 8, v91
  v_mfma_f32_16x16x32_bf16 v[68:71], a[168:171], a[60:63], v[68:71]
  ds_read_b64_tr_b16 a[154:155], v7 offset:512
  v_lshl_add_u32 v91, v88, 4, v91
  v_mfma_f32_16x16x32_bf16 v[72:75], a[172:175], a[56:59], v[72:75]
  s_waitcnt vmcnt(13) lgkmcnt(4)
  buffer_load_dwordx4 v231, s[16:19], s41 offen offset:1024 sc1 lds
  v_mfma_f32_16x16x32_bf16 v[76:79], a[172:175], a[60:63], v[76:79]
  s_barrier
  v_mfma_f32_16x16x32_bf16 v[16:19], a[144:147], a[64:67], v[16:19]
  s_add_u32 m0, s42, 57344
  s_mov_b32 s40, 295040
  ds_read_b64_tr_b16 a[156:157], v8 offset:0
  v_mov_b32 v92, s3
  v_mfma_f32_16x16x32_bf16 v[20:23], a[144:147], a[68:71], v[20:23]
  s_waitcnt lgkmcnt(3)
  ds_read_b64_tr_b16 a[158:159], v8 offset:512
  v_mul_u32_u24 v92, 18432, v92
  v_mfma_f32_16x16x32_bf16 v[24:27], a[148:151], a[64:67], v[24:27]
  buffer_load_dwordx4 v11, s[8:11], s40 offen offset:0 lds
  v_mfma_f32_16x16x32_bf16 v[28:31], a[148:151], a[68:71], v[28:31]
  s_add_u32 m0, s42, 147456
  ds_read_b64_tr_b16 a[160:161], v5 offset:1024
  ds_read_b64_tr_b16 a[162:163], v5 offset:1536
  v_mfma_f32_16x16x32_bf16 a[196:199], a[212:215], a[64:67], a[196:199]
  s_mov_b32 s41, 1835008
  ds_read_b64_tr_b16 a[164:165], v6 offset:1024
  v_add_u32 v234, v91, v92
  v_mfma_f32_16x16x32_bf16 a[204:207], a[64:67], a[64:67], a[204:207]
  s_waitcnt lgkmcnt(5)
  ds_read_b64_tr_b16 a[166:167], v6 offset:1536
  v_mov_b32 v92, s4
  v_mfma_f32_16x16x32_bf16 v[32:35], a[152:155], a[64:67], v[32:35]
  buffer_load_dwordx4 v230, s[16:19], s41 offen offset:0 sc1 lds
  v_mfma_f32_16x16x32_bf16 v[36:39], a[152:155], a[68:71], v[36:39]
  s_waitcnt lgkmcnt(4)
  s_add_u32 m0, s42, 57344
  ds_read_b64_tr_b16 a[168:169], v7 offset:1024
  v_lshl_add_u32 v91, v92, 4, v88
  v_mfma_f32_16x16x32_bf16 v[40:43], a[156:159], a[64:67], v[40:43]
  ds_read_b64_tr_b16 a[170:171], v7 offset:1536
  v_mul_u32_u24 v91, 1152, v91
  v_mfma_f32_16x16x32_bf16 v[44:47], a[156:159], a[68:71], v[44:47]
  s_waitcnt lgkmcnt(4)
  ds_read_b64_tr_b16 a[172:173], v8 offset:1024
  ds_read_b64_tr_b16 a[174:175], v8 offset:1536
  v_mfma_f32_16x16x32_bf16 v[48:51], a[160:163], a[64:67], v[48:51]
  buffer_load_dwordx4 v11, s[52:55], s40 offen offset:1024 lds
  v_mfma_f32_16x16x32_bf16 v[52:55], a[160:163], a[68:71], v[52:55]
  s_waitcnt lgkmcnt(4)
  s_add_u32 m0, s42, 147456
  ds_read_b64_tr_b16 a[144:145], v5 offset:8192
  ds_read_b64_tr_b16 a[146:147], v5 offset:8704
  v_mfma_f32_16x16x32_bf16 v[56:59], a[164:167], a[64:67], v[56:59]
  ds_read_b64_tr_b16 a[72:73], v228 offset:8192
  ds_read_b64_tr_b16 a[74:75], v228 offset:8704
  v_mfma_f32_16x16x32_bf16 v[60:63], a[164:167], a[68:71], v[60:63]
  ds_read_b64_tr_b16 a[76:77], v229 offset:8192
  ds_read_b64_tr_b16 a[78:79], v229 offset:8704
  v_mfma_f32_16x16x32_bf16 a[200:203], a[212:215], a[68:71], a[200:203]
  buffer_load_dwordx4 v231, s[16:19], s41 offen offset:1024 sc1 lds
  v_mfma_f32_16x16x32_bf16 a[208:211], a[68:71], a[68:71], a[208:211]
  s_waitcnt lgkmcnt(6)
  ds_read_b64_tr_b16 a[148:149], v6 offset:8192
  ds_read_b64_tr_b16 a[150:151], v6 offset:8704
  v_mfma_f32_16x16x32_bf16 v[64:67], a[168:171], a[64:67], v[64:67]
  ds_read_b64_tr_b16 a[152:153], v7 offset:8192
  v_lshl_add_u32 v15, v87, 4, v91
  v_mfma_f32_16x16x32_bf16 v[68:71], a[168:171], a[68:71], v[68:71]
  s_add_u32 m0, s42, 155648
  ds_read_b64_tr_b16 a[154:155], v7 offset:8704
  v_lshrrev_b32 v91, 1, v80
  v_mfma_f32_16x16x32_bf16 v[72:75], a[172:175], a[64:67], v[72:75]
  s_waitcnt vmcnt(14) lgkmcnt(4)
  ds_read_b64_tr_b16 a[156:157], v8 offset:8192
  v_lshlrev_b32 v91, 12, v91
  v_mfma_f32_16x16x32_bf16 v[76:79], a[172:175], a[68:71], v[76:79]
  s_barrier
  v_mfma_f32_16x16x32_bf16 v[16:19], a[144:147], a[72:75], v[16:19]
  s_mov_b32 s41, 1966080
  ds_read_b64_tr_b16 a[158:159], v8 offset:8704
  v_and_b32 v93, 1, v80
  v_mfma_f32_16x16x32_bf16 v[20:23], a[144:147], a[76:79], v[20:23]
  s_waitcnt lgkmcnt(4)
  ds_read_b64_tr_b16 a[160:161], v5 offset:9216
  v_lshl_add_u32 v91, v93, 4, v91
  v_mfma_f32_16x16x32_bf16 v[24:27], a[148:151], a[72:75], v[24:27]
  buffer_load_dwordx4 v230, s[16:19], s41 offen offset:0 sc1 lds
  v_mfma_f32_16x16x32_bf16 v[28:31], a[148:151], a[76:79], v[28:31]
  s_add_u32 m0, s42, 65536
  s_mov_b32 s40, 589952
  ds_read_b64_tr_b16 a[162:163], v5 offset:9728
  v_lshl_add_u32 v91, v92, 5, v91
  v_mfma_f32_16x16x32_bf16 a[196:199], a[212:215], a[72:75], a[196:199]
  ds_read_b64_tr_b16 a[164:165], v6 offset:9216
  v_add_u32 v235, 1024, v91
  v_mfma_f32_16x16x32_bf16 a[204:207], a[72:75], a[72:75], a[204:207]
  s_waitcnt lgkmcnt(4)
  ds_read_b64_tr_b16 a[166:167], v6 offset:9728
  v_lshl_add_u32 v91, v87, 3, v85
  v_mfma_f32_16x16x32_bf16 v[32:35], a[152:155], a[72:75], v[32:35]
  buffer_load_dwordx4 v11, s[8:11], s40 offen offset:0 lds
  v_mfma_f32_16x16x32_bf16 v[36:39], a[152:155], a[76:79], v[36:39]
  s_waitcnt lgkmcnt(3)
  s_add_u32 m0, s42, 155648
  ds_read_b64_tr_b16 a[168:169], v7 offset:9216
  v_lshlrev_b32 v91, 5, v91
  v_mfma_f32_16x16x32_bf16 v[40:43], a[156:159], a[72:75], v[40:43]
  ds_read_b64_tr_b16 a[170:171], v7 offset:9728
  v_lshl_add_u32 v91, v86, 3, v91
  v_mfma_f32_16x16x32_bf16 v[44:47], a[156:159], a[76:79], v[44:47]
  s_waitcnt lgkmcnt(4)
  ds_read_b64_tr_b16 a[172:173], v8 offset:9216
  ds_read_b64_tr_b16 a[174:175], v8 offset:9728
  v_mfma_f32_16x16x32_bf16 v[48:51], a[160:163], a[72:75], v[48:51]
  buffer_load_dwordx4 v231, s[16:19], s41 offen offset:1024 sc1 lds
  v_mfma_f32_16x16x32_bf16 v[52:55], a[160:163], a[76:79], v[52:55]
  s_waitcnt lgkmcnt(4)
  s_add_u32 m0, s42, 65536
  ds_read_b64_tr_b16 a[144:145], v5 offset:16384
  ds_read_b64_tr_b16 a[146:147], v5 offset:16896
  v_mfma_f32_16x16x32_bf16 v[56:59], a[164:167], a[72:75], v[56:59]
  ds_read_b64_tr_b16 a[80:81], v228 offset:16384
  ds_read_b64_tr_b16 a[82:83], v228 offset:16896
  v_mfma_f32_16x16x32_bf16 v[60:63], a[164:167], a[76:79], v[60:63]
  ds_read_b64_tr_b16 a[84:85], v229 offset:16384
  ds_read_b64_tr_b16 a[86:87], v229 offset:16896
  v_mfma_f32_16x16x32_bf16 a[200:203], a[212:215], a[76:79], a[200:203]
  s_add_u32 s68, s66, 0
  buffer_load_dwordx4 v11, s[52:55], s40 offen offset:1024 lds
  v_mfma_f32_16x16x32_bf16 a[208:211], a[76:79], a[76:79], a[208:211]
  s_waitcnt lgkmcnt(6)
  ds_read_b64_tr_b16 a[148:149], v6 offset:16384
  ds_read_b64_tr_b16 a[150:151], v6 offset:16896
  v_mfma_f32_16x16x32_bf16 v[64:67], a[168:171], a[72:75], v[64:67]
  ds_read_b64_tr_b16 a[152:153], v7 offset:16384
  v_mov_b32 v92, s3
  v_mfma_f32_16x16x32_bf16 v[68:71], a[168:171], a[76:79], v[68:71]
  s_add_u32 m0, s42, 73728
  ds_read_b64_tr_b16 a[154:155], v7 offset:16896
  v_mul_u32_u24 v92, 3072, v92
  v_mfma_f32_16x16x32_bf16 v[72:75], a[172:175], a[72:75], v[72:75]
  s_waitcnt vmcnt(14) lgkmcnt(4)
  buffer_load_dwordx2 a[176:177], v232, s[20:23], s68 offen offset:0 sc1
  v_mfma_f32_16x16x32_bf16 v[76:79], a[172:175], a[76:79], v[76:79]
  s_barrier
  v_mfma_f32_16x16x32_bf16 v[16:19], a[144:147], a[80:83], v[16:19]
  s_mov_b32 s40, 884864
  ds_read_b64_tr_b16 a[156:157], v8 offset:16384
  v_add_u32 v91, v91, v92
  v_mfma_f32_16x16x32_bf16 v[20:23], a[144:147], a[84:87], v[20:23]
  s_waitcnt lgkmcnt(3)
  ds_read_b64_tr_b16 a[158:159], v8 offset:16896
  v_add_u32 v236, 131072, v91
  v_mfma_f32_16x16x32_bf16 v[24:27], a[148:151], a[80:83], v[24:27]
  buffer_load_dwordx4 v11, s[8:11], s40 offen offset:0 lds
  v_mfma_f32_16x16x32_bf16 v[28:31], a[148:151], a[84:87], v[28:31]
  ds_read_b64_tr_b16 a[160:161], v5 offset:17408
  ds_read_b64_tr_b16 a[162:163], v5 offset:17920
  v_mfma_f32_16x16x32_bf16 a[196:199], a[212:215], a[80:83], a[196:199]
  ds_read_b64_tr_b16 a[164:165], v6 offset:17408
  v_cmp_eq_u32 s[74:75], s80, v0
  v_mfma_f32_16x16x32_bf16 a[204:207], a[80:83], a[80:83], a[204:207]
  s_waitcnt lgkmcnt(5)
  ds_read_b64_tr_b16 a[166:167], v6 offset:17920
  v_mov_b32 v91, s70
  v_mfma_f32_16x16x32_bf16 v[32:35], a[152:155], a[80:83], v[32:35]
  buffer_load_dwordx2 a[178:179], v232, s[20:23], s68 offen offset:128 sc1
  v_mfma_f32_16x16x32_bf16 v[36:39], a[152:155], a[84:87], v[36:39]
  s_waitcnt lgkmcnt(4)
  ds_read_b64_tr_b16 a[168:169], v7 offset:17408
  v_mov_b32 v92, s59
  v_mfma_f32_16x16x32_bf16 v[40:43], a[156:159], a[80:83], v[40:43]
  ds_read_b64_tr_b16 a[170:171], v7 offset:17920
  v_cndmask_b32 v237, 2.0, v91, s[74:75]
  v_mfma_f32_16x16x32_bf16 v[44:47], a[156:159], a[84:87], v[44:47]
  s_waitcnt lgkmcnt(4)
  ds_read_b64_tr_b16 a[172:173], v8 offset:17408
  ds_read_b64_tr_b16 a[174:175], v8 offset:17920
  v_mfma_f32_16x16x32_bf16 v[48:51], a[160:163], a[80:83], v[48:51]
  buffer_load_dwordx4 v11, s[52:55], s40 offen offset:1024 lds
  v_mfma_f32_16x16x32_bf16 v[52:55], a[160:163], a[84:87], v[52:55]
  s_waitcnt lgkmcnt(4)
  ds_read_b64_tr_b16 a[144:145], v5 offset:24576
  ds_read_b64_tr_b16 a[146:147], v5 offset:25088
  v_mfma_f32_16x16x32_bf16 v[56:59], a[164:167], a[80:83], v[56:59]
  ds_read_b64_tr_b16 a[88:89], v228 offset:24576
  ds_read_b64_tr_b16 a[90:91], v228 offset:25088
  v_mfma_f32_16x16x32_bf16 v[60:63], a[164:167], a[84:87], v[60:63]
  ds_read_b64_tr_b16 a[92:93], v229 offset:24576
  ds_read_b64_tr_b16 a[94:95], v229 offset:25088
  v_mfma_f32_16x16x32_bf16 a[200:203], a[212:215], a[84:87], a[200:203]
  buffer_load_dwordx2 a[180:181], v232, s[20:23], s68 offen offset:256 sc1
  v_mfma_f32_16x16x32_bf16 a[208:211], a[84:87], a[84:87], a[208:211]
  s_waitcnt lgkmcnt(6)
  ds_read_b64_tr_b16 a[148:149], v6 offset:24576
  ds_read_b64_tr_b16 a[150:151], v6 offset:25088
  v_mfma_f32_16x16x32_bf16 v[64:67], a[168:171], a[80:83], v[64:67]
  ds_read_b64_tr_b16 a[152:153], v7 offset:24576
  v_cmp_eq_u32 s[74:75], 0, v80
  v_mfma_f32_16x16x32_bf16 v[68:71], a[168:171], a[84:87], v[68:71]
  ds_read_b64_tr_b16 a[154:155], v7 offset:25088
  v_cndmask_b32 v240, 2.0, v92, s[74:75]
  v_mfma_f32_16x16x32_bf16 v[72:75], a[172:175], a[80:83], v[72:75]
  s_waitcnt vmcnt(17) lgkmcnt(4)
  buffer_load_dwordx2 a[182:183], v232, s[20:23], s68 offen offset:384 sc1
  v_mfma_f32_16x16x32_bf16 v[76:79], a[172:175], a[84:87], v[76:79]
  s_barrier
  v_mfma_f32_16x16x32_bf16 v[16:19], a[144:147], a[88:91], v[16:19]
  s_add_u32 s68, s66, 36864
  ds_read_b64_tr_b16 a[156:157], v8 offset:24576
  v_mfma_f32_16x16x32_bf16 v[20:23], a[144:147], a[92:95], v[20:23]
  s_waitcnt lgkmcnt(3)
  ds_read_b64_tr_b16 a[158:159], v8 offset:25088
  v_mfma_f32_16x16x32_bf16 v[24:27], a[148:151], a[88:91], v[24:27]
  buffer_load_dwordx2 a[184:185], v232, s[20:23], s68 offen offset:0 sc1
  v_mfma_f32_16x16x32_bf16 v[28:31], a[148:151], a[92:95], v[28:31]
  s_add_u32 m0, s42, 81920
  ds_read_b64_tr_b16 a[160:161], v5 offset:25600
  ds_read_b64_tr_b16 a[162:163], v5 offset:26112
  v_mfma_f32_16x16x32_bf16 a[196:199], a[212:215], a[88:91], a[196:199]
  s_mov_b32 s40, 1179776
  ds_read_b64_tr_b16 a[164:165], v6 offset:25600
  v_mfma_f32_16x16x32_bf16 a[204:207], a[88:91], a[88:91], a[204:207]
  s_waitcnt lgkmcnt(5)
  ds_read_b64_tr_b16 a[166:167], v6 offset:26112
  v_mfma_f32_16x16x32_bf16 v[32:35], a[152:155], a[88:91], v[32:35]
  buffer_load_dwordx4 v11, s[8:11], s40 offen offset:0 lds
  v_mfma_f32_16x16x32_bf16 v[36:39], a[152:155], a[92:95], v[36:39]
  s_waitcnt lgkmcnt(4)
  ds_read_b64_tr_b16 a[168:169], v7 offset:25600
  v_mfma_f32_16x16x32_bf16 v[40:43], a[156:159], a[88:91], v[40:43]
  ds_read_b64_tr_b16 a[170:171], v7 offset:26112
  v_mfma_f32_16x16x32_bf16 v[44:47], a[156:159], a[92:95], v[44:47]
  s_waitcnt lgkmcnt(4)
  ds_read_b64_tr_b16 a[172:173], v8 offset:25600
  ds_read_b64_tr_b16 a[174:175], v8 offset:26112
  v_mfma_f32_16x16x32_bf16 v[48:51], a[160:163], a[88:91], v[48:51]
  buffer_load_dwordx2 a[186:187], v232, s[20:23], s68 offen offset:128 sc1
  v_mfma_f32_16x16x32_bf16 v[52:55], a[160:163], a[92:95], v[52:55]
  s_waitcnt lgkmcnt(4)
  ds_read_b64_tr_b16 a[144:145], v1 offset:0
  ds_read_b64_tr_b16 a[146:147], v1 offset:512
  v_mfma_f32_16x16x32_bf16 v[56:59], a[164:167], a[88:91], v[56:59]
  ds_read_b64_tr_b16 a[96:97], v228 offset:32768
  ds_read_b64_tr_b16 a[98:99], v228 offset:33280
  v_mfma_f32_16x16x32_bf16 v[60:63], a[164:167], a[92:95], v[60:63]
  ds_read_b64_tr_b16 a[100:101], v229 offset:32768
  ds_read_b64_tr_b16 a[102:103], v229 offset:33280
  v_mfma_f32_16x16x32_bf16 a[200:203], a[212:215], a[92:95], a[200:203]
  buffer_load_dwordx4 v11, s[52:55], s40 offen offset:1024 lds
  v_mfma_f32_16x16x32_bf16 a[208:211], a[92:95], a[92:95], a[208:211]
  s_waitcnt lgkmcnt(6)
  ds_read_b64_tr_b16 a[148:149], v2 offset:0
  ds_read_b64_tr_b16 a[150:151], v2 offset:512
  v_mfma_f32_16x16x32_bf16 v[64:67], a[168:171], a[88:91], v[64:67]
  ds_read_b64_tr_b16 a[152:153], v3 offset:0
  v_mfma_f32_16x16x32_bf16 v[68:71], a[168:171], a[92:95], v[68:71]
  s_add_u32 m0, s42, 90112
  ds_read_b64_tr_b16 a[154:155], v3 offset:512
  v_mfma_f32_16x16x32_bf16 v[72:75], a[172:175], a[88:91], v[72:75]
  s_waitcnt vmcnt(18) lgkmcnt(4)
  buffer_load_dwordx2 a[188:189], v232, s[20:23], s68 offen offset:256 sc1
  v_mfma_f32_16x16x32_bf16 v[76:79], a[172:175], a[92:95], v[76:79]
  s_barrier
  v_mfma_f32_16x16x32_bf16 v[16:19], a[144:147], a[96:99], v[16:19]
  s_mov_b32 s40, 1474688
  ds_read_b64_tr_b16 a[156:157], v4 offset:0
  v_mfma_f32_16x16x32_bf16 v[20:23], a[144:147], a[100:103], v[20:23]
  s_waitcnt lgkmcnt(3)
  ds_read_b64_tr_b16 a[158:159], v4 offset:512
  v_mfma_f32_16x16x32_bf16 v[24:27], a[148:151], a[96:99], v[24:27]
  buffer_load_dwordx4 v11, s[8:11], s40 offen offset:0 lds
  v_mfma_f32_16x16x32_bf16 v[28:31], a[148:151], a[100:103], v[28:31]
  ds_read_b64_tr_b16 a[160:161], v1 offset:1024
  ds_read_b64_tr_b16 a[162:163], v1 offset:1536
  v_mfma_f32_16x16x32_bf16 a[196:199], a[212:215], a[96:99], a[196:199]
  ds_read_b64_tr_b16 a[164:165], v2 offset:1024
  v_mfma_f32_16x16x32_bf16 a[204:207], a[96:99], a[96:99], a[204:207]
  s_waitcnt lgkmcnt(5)
  ds_read_b64_tr_b16 a[166:167], v2 offset:1536
  v_mfma_f32_16x16x32_bf16 v[32:35], a[152:155], a[96:99], v[32:35]
  buffer_load_dwordx2 a[190:191], v232, s[20:23], s68 offen offset:384 sc1
  v_mfma_f32_16x16x32_bf16 v[36:39], a[152:155], a[100:103], v[36:39]
  s_waitcnt lgkmcnt(4)
  ds_read_b64_tr_b16 a[168:169], v3 offset:1024
  v_mfma_f32_16x16x32_bf16 v[40:43], a[156:159], a[96:99], v[40:43]
  ds_read_b64_tr_b16 a[170:171], v3 offset:1536
  v_mfma_f32_16x16x32_bf16 v[44:47], a[156:159], a[100:103], v[44:47]
  s_waitcnt lgkmcnt(4)
  ds_read_b64_tr_b16 a[172:173], v4 offset:1024
  ds_read_b64_tr_b16 a[174:175], v4 offset:1536
  v_mfma_f32_16x16x32_bf16 v[48:51], a[160:163], a[96:99], v[48:51]
  buffer_load_dwordx4 v11, s[52:55], s40 offen offset:1024 lds
  v_mfma_f32_16x16x32_bf16 v[52:55], a[160:163], a[100:103], v[52:55]
  s_waitcnt lgkmcnt(4)
  s_add_u32 m0, s42, 98304
  ds_read_b64_tr_b16 a[144:145], v1 offset:8192
  ds_read_b64_tr_b16 a[146:147], v1 offset:8704
  v_mfma_f32_16x16x32_bf16 v[56:59], a[164:167], a[96:99], v[56:59]
  s_mov_b32 s41, 2097152
  ds_read_b64_tr_b16 a[104:105], v228 offset:40960
  ds_read_b64_tr_b16 a[106:107], v228 offset:41472
  v_mfma_f32_16x16x32_bf16 v[60:63], a[164:167], a[100:103], v[60:63]
  ds_read_b64_tr_b16 a[108:109], v229 offset:40960
  ds_read_b64_tr_b16 a[110:111], v229 offset:41472
  v_mfma_f32_16x16x32_bf16 a[200:203], a[212:215], a[100:103], a[200:203]
  buffer_load_dwordx4 v230, s[16:19], s41 offen offset:0 sc1 lds
  v_mfma_f32_16x16x32_bf16 a[208:211], a[100:103], a[100:103], a[208:211]
  s_waitcnt lgkmcnt(6)
  ds_read_b64_tr_b16 a[148:149], v2 offset:8192
  ds_read_b64_tr_b16 a[150:151], v2 offset:8704
  v_mfma_f32_16x16x32_bf16 v[64:67], a[168:171], a[96:99], v[64:67]
  ds_read_b64_tr_b16 a[152:153], v3 offset:8192
  v_mfma_f32_16x16x32_bf16 v[68:71], a[168:171], a[100:103], v[68:71]
  ds_read_b64_tr_b16 a[154:155], v3 offset:8704
  v_mfma_f32_16x16x32_bf16 v[72:75], a[172:175], a[96:99], v[72:75]
  s_waitcnt vmcnt(19) lgkmcnt(4)
  buffer_load_dwordx4 v231, s[16:19], s41 offen offset:1024 sc1 lds
  v_mfma_f32_16x16x32_bf16 v[76:79], a[172:175], a[100:103], v[76:79]
  s_barrier
  v_mfma_f32_16x16x32_bf16 v[16:19], a[144:147], a[104:107], v[16:19]
  s_add_u32 m0, s42, 106496
  s_mov_b32 s41, 2228224
  ds_read_b64_tr_b16 a[156:157], v4 offset:8192
  v_mfma_f32_16x16x32_bf16 v[20:23], a[144:147], a[108:111], v[20:23]
  s_waitcnt lgkmcnt(3)
  ds_read_b64_tr_b16 a[158:159], v4 offset:8704
  v_mfma_f32_16x16x32_bf16 v[24:27], a[148:151], a[104:107], v[24:27]
  buffer_load_dwordx4 v230, s[16:19], s41 offen offset:0 sc1 lds
  v_mfma_f32_16x16x32_bf16 v[28:31], a[148:151], a[108:111], v[28:31]
  s_add_u32 m0, s42, 0
  ds_read_b64_tr_b16 a[160:161], v1 offset:9216
  ds_read_b64_tr_b16 a[162:163], v1 offset:9728
  v_mfma_f32_16x16x32_bf16 a[196:199], a[212:215], a[104:107], a[196:199]
  s_mov_b32 s40, 1769600
  ds_read_b64_tr_b16 a[164:165], v2 offset:9216
  v_mfma_f32_16x16x32_bf16 a[204:207], a[104:107], a[104:107], a[204:207]
  s_waitcnt lgkmcnt(5)
  ds_read_b64_tr_b16 a[166:167], v2 offset:9728
  v_mfma_f32_16x16x32_bf16 v[32:35], a[152:155], a[104:107], v[32:35]
  buffer_load_dwordx4 v11, s[8:11], s40 offen offset:0 lds
  v_mfma_f32_16x16x32_bf16 v[36:39], a[152:155], a[108:111], v[36:39]
  s_waitcnt lgkmcnt(4)
  s_add_u32 m0, s42, 106496
  ds_read_b64_tr_b16 a[168:169], v3 offset:9216
  v_mfma_f32_16x16x32_bf16 v[40:43], a[156:159], a[104:107], v[40:43]
  ds_read_b64_tr_b16 a[170:171], v3 offset:9728
  v_mfma_f32_16x16x32_bf16 v[44:47], a[156:159], a[108:111], v[44:47]
  s_waitcnt lgkmcnt(4)
  ds_read_b64_tr_b16 a[172:173], v4 offset:9216
  ds_read_b64_tr_b16 a[174:175], v4 offset:9728
  v_mfma_f32_16x16x32_bf16 v[48:51], a[160:163], a[104:107], v[48:51]
  buffer_load_dwordx4 v231, s[16:19], s41 offen offset:1024 sc1 lds
  v_mfma_f32_16x16x32_bf16 v[52:55], a[160:163], a[108:111], v[52:55]
  s_waitcnt lgkmcnt(4)
  s_add_u32 m0, s42, 0
  ds_read_b64_tr_b16 a[144:145], v1 offset:16384
  ds_read_b64_tr_b16 a[146:147], v1 offset:16896
  v_mfma_f32_16x16x32_bf16 v[56:59], a[164:167], a[104:107], v[56:59]
  ds_read_b64_tr_b16 a[112:113], v228 offset:49152
  ds_read_b64_tr_b16 a[114:115], v228 offset:49664
  v_mfma_f32_16x16x32_bf16 v[60:63], a[164:167], a[108:111], v[60:63]
  ds_read_b64_tr_b16 a[116:117], v229 offset:49152
  ds_read_b64_tr_b16 a[118:119], v229 offset:49664
  v_mfma_f32_16x16x32_bf16 a[200:203], a[212:215], a[108:111], a[200:203]
  buffer_load_dwordx4 v11, s[52:55], s40 offen offset:1024 lds
  v_mfma_f32_16x16x32_bf16 a[208:211], a[108:111], a[108:111], a[208:211]
  s_waitcnt lgkmcnt(6)
  ds_read_b64_tr_b16 a[148:149], v2 offset:16384
  ds_read_b64_tr_b16 a[150:151], v2 offset:16896
  v_mfma_f32_16x16x32_bf16 v[64:67], a[168:171], a[104:107], v[64:67]
  ds_read_b64_tr_b16 a[152:153], v3 offset:16384
  v_mfma_f32_16x16x32_bf16 v[68:71], a[168:171], a[108:111], v[68:71]
  s_add_u32 m0, s42, 8192
  ds_read_b64_tr_b16 a[154:155], v3 offset:16896
  v_mfma_f32_16x16x32_bf16 v[72:75], a[172:175], a[104:107], v[72:75]
  s_waitcnt vmcnt(21) lgkmcnt(4)
  ds_read_b64_tr_b16 a[156:157], v4 offset:16384
  v_mfma_f32_16x16x32_bf16 v[76:79], a[172:175], a[108:111], v[76:79]
  s_barrier
  v_mfma_f32_16x16x32_bf16 v[16:19], a[144:147], a[112:115], v[16:19]
  s_mov_b32 s40, 2064512
  ds_read_b64_tr_b16 a[158:159], v4 offset:16896
  v_mfma_f32_16x16x32_bf16 v[20:23], a[144:147], a[116:119], v[20:23]
  s_waitcnt lgkmcnt(4)
  ds_read_b64_tr_b16 a[160:161], v1 offset:17408
  v_mfma_f32_16x16x32_bf16 v[24:27], a[148:151], a[112:115], v[24:27]
  buffer_load_dwordx4 v11, s[8:11], s40 offen offset:0 lds
  v_mfma_f32_16x16x32_bf16 v[28:31], a[148:151], a[116:119], v[28:31]
  ds_read_b64_tr_b16 a[162:163], v1 offset:17920
  v_mfma_f32_16x16x32_bf16 a[196:199], a[212:215], a[112:115], a[196:199]
  ds_read_b64_tr_b16 a[164:165], v2 offset:17408
  v_mfma_f32_16x16x32_bf16 a[204:207], a[112:115], a[112:115], a[204:207]
  s_waitcnt lgkmcnt(4)
  ds_read_b64_tr_b16 a[166:167], v2 offset:17920
  v_mfma_f32_16x16x32_bf16 v[32:35], a[152:155], a[112:115], v[32:35]
  ds_read_b64_tr_b16 a[168:169], v3 offset:17408
  v_mfma_f32_16x16x32_bf16 v[36:39], a[152:155], a[116:119], v[36:39]
  s_waitcnt lgkmcnt(4)
  ds_read_b64_tr_b16 a[170:171], v3 offset:17920
  v_mfma_f32_16x16x32_bf16 v[40:43], a[156:159], a[112:115], v[40:43]
  ds_read_b64_tr_b16 a[172:173], v4 offset:17408
  v_mfma_f32_16x16x32_bf16 v[44:47], a[156:159], a[116:119], v[44:47]
  s_waitcnt lgkmcnt(5)
  ds_read_b64_tr_b16 a[174:175], v4 offset:17920
  v_mfma_f32_16x16x32_bf16 v[48:51], a[160:163], a[112:115], v[48:51]
  buffer_load_dwordx4 v11, s[52:55], s40 offen offset:1024 lds
  v_mfma_f32_16x16x32_bf16 v[52:55], a[160:163], a[116:119], v[52:55]
  s_waitcnt lgkmcnt(4)
  ds_read_b64_tr_b16 a[144:145], v1 offset:24576
  v_mfma_f32_16x16x32_bf16 v[56:59], a[164:167], a[112:115], v[56:59]
  ds_read_b64_tr_b16 a[146:147], v1 offset:25088
  v_mfma_f32_16x16x32_bf16 v[60:63], a[164:167], a[116:119], v[60:63]
  ds_read_b64_tr_b16 a[120:121], v228 offset:57344
  ds_read_b64_tr_b16 a[122:123], v228 offset:57856
  v_mfma_f32_16x16x32_bf16 a[200:203], a[212:215], a[116:119], a[200:203]
  ds_read_b64_tr_b16 a[124:125], v229 offset:57344
  ds_read_b64_tr_b16 a[126:127], v229 offset:57856
  v_mfma_f32_16x16x32_bf16 a[208:211], a[116:119], a[116:119], a[208:211]
  s_waitcnt lgkmcnt(6)
  ds_read_b64_tr_b16 a[148:149], v2 offset:24576
  ds_read_b64_tr_b16 a[150:151], v2 offset:25088
  v_mfma_f32_16x16x32_bf16 v[64:67], a[168:171], a[112:115], v[64:67]
  ds_read_b64_tr_b16 a[152:153], v3 offset:24576
  v_mfma_f32_16x16x32_bf16 v[68:71], a[168:171], a[116:119], v[68:71]
  ds_read_b64_tr_b16 a[154:155], v3 offset:25088
  v_mfma_f32_16x16x32_bf16 v[72:75], a[172:175], a[112:115], v[72:75]
  s_waitcnt vmcnt(6) lgkmcnt(6)
  ds_read_b64_tr_b16 a[156:157], v4 offset:24576
  v_mfma_f32_16x16x32_bf16 v[76:79], a[172:175], a[116:119], v[76:79]
  s_barrier
  v_mfma_f32_16x16x32_bf16 v[16:19], a[144:147], a[120:123], v[16:19]
  s_waitcnt lgkmcnt(5)
  ds_read_b64_tr_b16 a[158:159], v4 offset:25088
  v_mfma_f32_16x16x32_bf16 v[20:23], a[144:147], a[124:127], v[20:23]
  s_waitcnt lgkmcnt(4)
  ds_read_b64_tr_b16 a[160:161], v1 offset:25600
  v_mfma_f32_16x16x32_bf16 v[24:27], a[148:151], a[120:123], v[24:27]
  s_add_u32 m0, s42, 16384
  ds_read_b64_tr_b16 a[162:163], v1 offset:26112
  v_mfma_f32_16x16x32_bf16 v[28:31], a[148:151], a[124:127], v[28:31]
  s_mov_b32 s40, 2359424
  ds_read_b64_tr_b16 a[164:165], v2 offset:25600
  v_mfma_f32_16x16x32_bf16 a[196:199], a[212:215], a[120:123], a[196:199]
  ds_read_b64_tr_b16 a[166:167], v2 offset:26112
  v_mfma_f32_16x16x32_bf16 a[204:207], a[120:123], a[120:123], a[204:207]
  s_waitcnt lgkmcnt(5)
  ds_read_b64_tr_b16 a[168:169], v3 offset:25600
  v_mfma_f32_16x16x32_bf16 v[32:35], a[152:155], a[120:123], v[32:35]
  buffer_load_dwordx4 v11, s[8:11], s40 offen offset:0 lds
  v_mfma_f32_16x16x32_bf16 v[36:39], a[152:155], a[124:127], v[36:39]
  s_waitcnt lgkmcnt(4)
  ds_read_b64_tr_b16 a[170:171], v3 offset:26112
  v_mfma_f32_16x16x32_bf16 v[40:43], a[156:159], a[120:123], v[40:43]
  ds_read_b64_tr_b16 a[172:173], v4 offset:25600
  v_mfma_f32_16x16x32_bf16 v[44:47], a[156:159], a[124:127], v[44:47]
  s_waitcnt lgkmcnt(4)
  ds_read_b64_tr_b16 a[174:175], v4 offset:26112
  v_mfma_f32_16x16x32_bf16 v[48:51], a[160:163], a[120:123], v[48:51]
  ds_read_b64_tr_b16 a[144:145], v1 offset:32768
  v_mfma_f32_16x16x32_bf16 v[52:55], a[160:163], a[124:127], v[52:55]
  s_waitcnt lgkmcnt(4)
  ds_read_b64_tr_b16 a[146:147], v1 offset:33280
  v_mfma_f32_16x16x32_bf16 v[56:59], a[164:167], a[120:123], v[56:59]
  ds_read_b64_tr_b16 a[128:129], v228 offset:0
  ds_read_b64_tr_b16 a[130:131], v228 offset:512
  v_mfma_f32_16x16x32_bf16 v[60:63], a[164:167], a[124:127], v[60:63]
  ds_read_b64_tr_b16 a[132:133], v229 offset:0
  ds_read_b64_tr_b16 a[134:135], v229 offset:512
  v_mfma_f32_16x16x32_bf16 a[200:203], a[212:215], a[124:127], a[200:203]
  buffer_load_dwordx4 v11, s[52:55], s40 offen offset:1024 lds
  v_mfma_f32_16x16x32_bf16 a[208:211], a[124:127], a[124:127], a[208:211]
  s_waitcnt lgkmcnt(6)
  ds_read_b64_tr_b16 a[148:149], v2 offset:32768
  ds_read_b64_tr_b16 a[150:151], v2 offset:33280
  v_mfma_f32_16x16x32_bf16 v[64:67], a[168:171], a[120:123], v[64:67]
  ds_read_b64_tr_b16 a[152:153], v3 offset:32768
  v_mfma_f32_16x16x32_bf16 v[68:71], a[168:171], a[124:127], v[68:71]
  s_add_u32 m0, s42, 24576
  ds_read_b64_tr_b16 a[154:155], v3 offset:33280
  v_mfma_f32_16x16x32_bf16 v[72:75], a[172:175], a[120:123], v[72:75]
  s_waitcnt vmcnt(5) lgkmcnt(4)
  ds_read_b64_tr_b16 a[156:157], v4 offset:32768
  v_mfma_f32_16x16x32_bf16 v[76:79], a[172:175], a[124:127], v[76:79]
  s_barrier
  v_mfma_f32_16x16x32_bf16 v[16:19], a[144:147], a[128:131], v[16:19]
  s_mov_b32 s40, 2654336
  ds_read_b64_tr_b16 a[158:159], v4 offset:33280
  v_mfma_f32_16x16x32_bf16 v[20:23], a[144:147], a[132:135], v[20:23]
  s_waitcnt lgkmcnt(4)
  ds_read_b64_tr_b16 a[160:161], v1 offset:33792
  v_mfma_f32_16x16x32_bf16 v[24:27], a[148:151], a[128:131], v[24:27]
  buffer_load_dwordx4 v11, s[8:11], s40 offen offset:0 lds
  v_mfma_f32_16x16x32_bf16 v[28:31], a[148:151], a[132:135], v[28:31]
  ds_read_b64_tr_b16 a[162:163], v1 offset:34304
  v_mfma_f32_16x16x32_bf16 a[196:199], a[212:215], a[128:131], a[196:199]
  ds_read_b64_tr_b16 a[164:165], v2 offset:33792
  v_mfma_f32_16x16x32_bf16 a[204:207], a[128:131], a[128:131], a[204:207]
  s_waitcnt lgkmcnt(4)
  ds_read_b64_tr_b16 a[166:167], v2 offset:34304
  v_mfma_f32_16x16x32_bf16 v[32:35], a[152:155], a[128:131], v[32:35]
  ds_read_b64_tr_b16 a[168:169], v3 offset:33792
  v_mfma_f32_16x16x32_bf16 v[36:39], a[152:155], a[132:135], v[36:39]
  s_waitcnt lgkmcnt(4)
  ds_read_b64_tr_b16 a[170:171], v3 offset:34304
  v_mfma_f32_16x16x32_bf16 v[40:43], a[156:159], a[128:131], v[40:43]
  ds_read_b64_tr_b16 a[172:173], v4 offset:33792
  v_mfma_f32_16x16x32_bf16 v[44:47], a[156:159], a[132:135], v[44:47]
  s_waitcnt lgkmcnt(5)
  ds_read_b64_tr_b16 a[174:175], v4 offset:34304
  v_mfma_f32_16x16x32_bf16 v[48:51], a[160:163], a[128:131], v[48:51]
  buffer_load_dwordx4 v11, s[52:55], s40 offen offset:1024 lds
  v_mfma_f32_16x16x32_bf16 v[52:55], a[160:163], a[132:135], v[52:55]
  s_waitcnt lgkmcnt(4)
  ds_read_b64_tr_b16 a[144:145], v1 offset:40960
  v_mfma_f32_16x16x32_bf16 v[56:59], a[164:167], a[128:131], v[56:59]
  ds_read_b64_tr_b16 a[146:147], v1 offset:41472
  v_mfma_f32_16x16x32_bf16 v[60:63], a[164:167], a[132:135], v[60:63]
  ds_read_b64_tr_b16 a[136:137], v228 offset:8192
  ds_read_b64_tr_b16 a[138:139], v228 offset:8704
  v_mfma_f32_16x16x32_bf16 a[200:203], a[212:215], a[132:135], a[200:203]
  ds_read_b64_tr_b16 a[140:141], v229 offset:8192
  ds_read_b64_tr_b16 a[142:143], v229 offset:8704
  v_mfma_f32_16x16x32_bf16 a[208:211], a[132:135], a[132:135], a[208:211]
  s_waitcnt lgkmcnt(6)
  ds_read_b64_tr_b16 a[148:149], v2 offset:40960
  ds_read_b64_tr_b16 a[150:151], v2 offset:41472
  v_mfma_f32_16x16x32_bf16 v[64:67], a[168:171], a[128:131], v[64:67]
  ds_read_b64_tr_b16 a[152:153], v3 offset:40960
  v_mfma_f32_16x16x32_bf16 v[68:71], a[168:171], a[132:135], v[68:71]
  ds_read_b64_tr_b16 a[154:155], v3 offset:41472
  v_mfma_f32_16x16x32_bf16 v[72:75], a[172:175], a[128:131], v[72:75]
  s_waitcnt lgkmcnt(6)
  ds_read_b64_tr_b16 a[156:157], v4 offset:40960
  v_mfma_f32_16x16x32_bf16 v[76:79], a[172:175], a[132:135], v[76:79]
  s_barrier
  v_mfma_f32_16x16x32_bf16 v[16:19], a[144:147], a[136:139], v[16:19]
L3_pad1:
  s_cmp_lg_u32 s82, 0
  s_cbranch_scc1 L3_pad5
  s_waitcnt lgkmcnt(5)
  ds_read_b64_tr_b16 a[158:159], v4 offset:41472
  v_mfma_f32_16x16x32_bf16 v[20:23], a[144:147], a[140:143], v[20:23]
  s_waitcnt lgkmcnt(4)
  ds_read_b64_tr_b16 a[160:161], v1 offset:41984
  v_mfma_f32_16x16x32_bf16 v[24:27], a[148:151], a[136:139], v[24:27]
  s_add_u32 m0, s42, 32768
  ds_read_b64_tr_b16 a[162:163], v1 offset:42496
  v_mfma_f32_16x16x32_bf16 v[28:31], a[148:151], a[140:143], v[28:31]
  s_mov_b32 s40, 2949248
  ds_read_b64_tr_b16 a[164:165], v2 offset:41984
  v_mfma_f32_16x16x32_bf16 a[196:199], a[212:215], a[136:139], a[196:199]
  ds_read_b64_tr_b16 a[166:167], v2 offset:42496
  v_mfma_f32_16x16x32_bf16 a[204:207], a[136:139], a[136:139], a[204:207]
  s_waitcnt lgkmcnt(5)
  ds_read_b64_tr_b16 a[168:169], v3 offset:41984
  v_mfma_f32_16x16x32_bf16 v[32:35], a[152:155], a[136:139], v[32:35]
  buffer_load_dwordx4 v11, s[8:11], s40 offen offset:0 lds
  v_mfma_f32_16x16x32_bf16 v[36:39], a[152:155], a[140:143], v[36:39]
  s_waitcnt lgkmcnt(4)
  ds_read_b64_tr_b16 a[170:171], v3 offset:42496
  v_mfma_f32_16x16x32_bf16 v[40:43], a[156:159], a[136:139], v[40:43]
  ds_read_b64_tr_b16 a[172:173], v4 offset:41984
  v_mfma_f32_16x16x32_bf16 v[44:47], a[156:159], a[140:143], v[44:47]
  s_waitcnt lgkmcnt(4)
  ds_read_b64_tr_b16 a[174:175], v4 offset:42496
  v_mfma_f32_16x16x32_bf16 v[48:51], a[160:163], a[136:139], v[48:51]
  ds_read_b64_tr_b16 a[144:145], v1 offset:49152
  v_mfma_f32_16x16x32_bf16 v[52:55], a[160:163], a[140:143], v[52:55]
  s_waitcnt lgkmcnt(4)
  ds_read_b64_tr_b16 a[146:147], v1 offset:49664
  v_mfma_f32_16x16x32_bf16 v[56:59], a[164:167], a[136:139], v[56:59]
  ds_read_b64_tr_b16 a[148:149], v2 offset:49152
  v_mfma_f32_16x16x32_bf16 v[60:63], a[164:167], a[140:143], v[60:63]
  ds_read_b64_tr_b16 a[150:151], v2 offset:49664
  v_mfma_f32_16x16x32_bf16 a[200:203], a[212:215], a[140:143], a[200:203]
  buffer_load_dwordx4 v11, s[52:55], s40 offen offset:1024 lds
  v_mfma_f32_16x16x32_bf16 a[208:211], a[140:143], a[140:143], a[208:211]
  s_waitcnt lgkmcnt(4)
  ds_read_b64_tr_b16 a[152:153], v3 offset:49152
  v_mfma_f32_16x16x32_bf16 v[64:67], a[168:171], a[136:139], v[64:67]
  ds_read_b64_tr_b16 a[154:155], v3 offset:49664
  v_mfma_f32_16x16x32_bf16 v[68:71], a[168:171], a[140:143], v[68:71]
  s_add_u32 m0, s42, 40960
  ds_read_b64_tr_b16 a[156:157], v4 offset:49152
  v_mfma_f32_16x16x32_bf16 v[72:75], a[172:175], a[136:139], v[72:75]
  s_waitcnt lgkmcnt(3)
  ds_read_b64_tr_b16 a[158:159], v4 offset:49664
  v_mfma_f32_16x16x32_bf16 v[76:79], a[172:175], a[140:143], v[76:79]
  s_barrier
  v_mfma_f32_16x16x32_bf16 v[80:83], a[144:147], a[0:3], 0
  s_mov_b32 s40, 3244160
  ds_read_b64_tr_b16 a[160:161], v1 offset:50176
  v_accvgpr_read_b32 v243, a204
  v_mfma_f32_16x16x32_bf16 v[84:87], a[144:147], a[4:7], 0
  ds_read_b64_tr_b16 a[162:163], v1 offset:50688
  v_accvgpr_read_b32 v244, a205
  v_mfma_f32_16x16x32_bf16 v[88:91], a[148:151], a[0:3], 0
  buffer_load_dwordx4 v11, s[8:11], s40 offen offset:0 lds
  v_mfma_f32_16x16x32_bf16 v[92:95], a[148:151], a[4:7], 0
  s_waitcnt lgkmcnt(3)
  ds_read_b64_tr_b16 a[164:165], v2 offset:50176
  ds_read_b64_tr_b16 a[166:167], v2 offset:50688
  v_mfma_f32_16x16x32_bf16 v[96:99], a[152:155], a[0:3], 0
  ds_read_b64_tr_b16 a[168:169], v3 offset:50176
  v_accvgpr_read_b32 v245, a206
  v_mfma_f32_16x16x32_bf16 v[100:103], a[152:155], a[4:7], 0
  s_waitcnt lgkmcnt(5)
  ds_read_b64_tr_b16 a[170:171], v3 offset:50688
  v_accvgpr_read_b32 v246, a207
  v_mfma_f32_16x16x32_bf16 v[104:107], a[156:159], a[0:3], 0
  ds_read_b64_tr_b16 a[172:173], v4 offset:50176
  v_accvgpr_read_b32 v242, a196
  v_mfma_f32_16x16x32_bf16 v[108:111], a[156:159], a[4:7], 0
  s_waitcnt lgkmcnt(5)
  ds_read_b64_tr_b16 a[174:175], v4 offset:50688
  v_cndmask_b32 v243, v243, v244, s[46:47]
  v_mfma_f32_16x16x32_bf16 v[112:115], a[160:163], a[0:3], 0
  ds_read_b64_tr_b16 a[144:145], v1 offset:57344
  v_cndmask_b32 v243, v243, v245, s[48:49]
  v_mfma_f32_16x16x32_bf16 v[116:119], a[160:163], a[4:7], 0
  s_waitcnt lgkmcnt(5)
  ds_read_b64_tr_b16 a[146:147], v1 offset:57856
  v_cndmask_b32 v243, v243, v246, s[50:51]
  v_mfma_f32_16x16x32_bf16 v[120:123], a[164:167], a[0:3], 0
  buffer_load_dwordx4 v11, s[52:55], s40 offen offset:1024 lds
  v_mfma_f32_16x16x32_bf16 v[124:127], a[164:167], a[4:7], 0
  s_waitcnt lgkmcnt(4)
  ds_read_b64_tr_b16 a[148:149], v2 offset:57344
  ds_read_b64_tr_b16 a[150:151], v2 offset:57856
  v_mfma_f32_16x16x32_bf16 v[128:131], a[168:171], a[0:3], 0
  s_mov_b32 s40, 3539072
  ds_read_b64_tr_b16 a[152:153], v3 offset:57344
  v_mfma_f32_16x16x32_bf16 v[132:135], a[168:171], a[4:7], 0
  s_waitcnt lgkmcnt(5)
  ds_read_b64_tr_b16 a[154:155], v3 offset:57856
  v_mfma_f32_16x16x32_bf16 v[136:139], a[172:175], a[0:3], 0
  s_add_u32 m0, s42, 98304
  ds_read_b64_tr_b16 a[156:157], v4 offset:57344
  v_mfma_f32_16x16x32_bf16 v[140:143], a[172:175], a[4:7], 0
  s_waitcnt lgkmcnt(5)
  ds_read_b64_tr_b16 a[158:159], v4 offset:57856
  v_mfma_f32_16x16x32_bf16 v[80:83], a[144:147], a[8:11], v[80:83]
  ds_read_b64_tr_b16 a[160:161], v1 offset:58368
  v_mfma_f32_16x16x32_bf16 v[84:87], a[144:147], a[12:15], v[84:87]
  s_waitcnt lgkmcnt(5)
  ds_read_b64_tr_b16 a[162:163], v1 offset:58880
  v_mfma_f32_16x16x32_bf16 v[88:91], a[148:151], a[8:11], v[88:91]
  buffer_load_dwordx4 v11, s[8:11], s40 offen offset:0 lds
  v_mfma_f32_16x16x32_bf16 v[92:95], a[148:151], a[12:15], v[92:95]
  s_waitcnt lgkmcnt(4)
  ds_read_b64_tr_b16 a[164:165], v2 offset:58368
  ds_read_b64_tr_b16 a[166:167], v2 offset:58880
  v_mfma_f32_16x16x32_bf16 v[96:99], a[152:155], a[8:11], v[96:99]
  ds_read_b64_tr_b16 a[168:169], v3 offset:58368
  v_mfma_f32_16x16x32_bf16 v[100:103], a[152:155], a[12:15], v[100:103]
  s_waitcnt lgkmcnt(5)
  ds_read_b64_tr_b16 a[170:171], v3 offset:58880
  v_mfma_f32_16x16x32_bf16 v[104:107], a[156:159], a[8:11], v[104:107]
  ds_read_b64_tr_b16 a[172:173], v4 offset:58368
  v_mfma_f32_16x16x32_bf16 v[108:111], a[156:159], a[12:15], v[108:111]
  s_waitcnt lgkmcnt(5)
  ds_read_b64_tr_b16 a[174:175], v4 offset:58880
  v_mfma_f32_16x16x32_bf16 v[112:115], a[160:163], a[8:11], v[112:115]
  ds_read_b64_tr_b16 a[144:145], v5 offset:0
  v_mfma_f32_16x16x32_bf16 v[116:119], a[160:163], a[12:15], v[116:119]
  s_waitcnt lgkmcnt(5)
  ds_read_b64_tr_b16 a[146:147], v5 offset:512
  v_mfma_f32_16x16x32_bf16 v[120:123], a[164:167], a[8:11], v[120:123]
  buffer_load_dwordx4 v11, s[52:55], s40 offen offset:1024 lds
  v_mfma_f32_16x16x32_bf16 v[124:127], a[164:167], a[12:15], v[124:127]
  s_waitcnt lgkmcnt(4)
  ds_read_b64_tr_b16 a[148:149], v6 offset:0
  ds_read_b64_tr_b16 a[150:151], v6 offset:512
  v_mfma_f32_16x16x32_bf16 v[128:131], a[168:171], a[8:11], v[128:131]
  s_mov_b32 s40, 3833984
  ds_read_b64_tr_b16 a[152:153], v7 offset:0
  v_mfma_f32_16x16x32_bf16 v[132:135], a[168:171], a[12:15], v[132:135]
  s_waitcnt lgkmcnt(5)
  ds_read_b64_tr_b16 a[154:155], v7 offset:512
  v_mfma_f32_16x16x32_bf16 v[136:139], a[172:175], a[8:11], v[136:139]
  s_add_u32 m0, s42, 106496
  ds_read_b64_tr_b16 a[156:157], v8 offset:0
  v_mfma_f32_16x16x32_bf16 v[140:143], a[172:175], a[12:15], v[140:143]
  s_waitcnt lgkmcnt(5)
  ds_read_b64_tr_b16 a[158:159], v8 offset:512
  v_mfma_f32_16x16x32_bf16 v[80:83], a[144:147], a[16:19], v[80:83]
  ds_read_b64_tr_b16 a[160:161], v5 offset:1024
  v_mfma_f32_16x16x32_bf16 v[84:87], a[144:147], a[20:23], v[84:87]
  s_waitcnt lgkmcnt(5)
  ds_read_b64_tr_b16 a[162:163], v5 offset:1536
  v_mfma_f32_16x16x32_bf16 v[88:91], a[148:151], a[16:19], v[88:91]
  buffer_load_dwordx4 v11, s[8:11], s40 offen offset:0 lds
  v_mfma_f32_16x16x32_bf16 v[92:95], a[148:151], a[20:23], v[92:95]
  s_waitcnt lgkmcnt(4)
  ds_read_b64_tr_b16 a[164:165], v6 offset:1024
  ds_read_b64_tr_b16 a[166:167], v6 offset:1536
  v_mfma_f32_16x16x32_bf16 v[96:99], a[152:155], a[16:19], v[96:99]
  ds_read_b64_tr_b16 a[168:169], v7 offset:1024
  v_mfma_f32_16x16x32_bf16 v[100:103], a[152:155], a[20:23], v[100:103]
  s_waitcnt lgkmcnt(5)
  ds_read_b64_tr_b16 a[170:171], v7 offset:1536
  v_mfma_f32_16x16x32_bf16 v[104:107], a[156:159], a[16:19], v[104:107]
  ds_read_b64_tr_b16 a[172:173], v8 offset:1024
  v_mfma_f32_16x16x32_bf16 v[108:111], a[156:159], a[20:23], v[108:111]
  s_waitcnt lgkmcnt(5)
  ds_read_b64_tr_b16 a[174:175], v8 offset:1536
  v_mfma_f32_16x16x32_bf16 v[112:115], a[160:163], a[16:19], v[112:115]
  ds_bpermute_b32 v243, v249, v243
  v_mul_f32 v242, 0xbae38e39, v242
  v_mfma_f32_16x16x32_bf16 v[116:119], a[160:163], a[20:23], v[116:119]
  s_waitcnt lgkmcnt(5)
  ds_read_b64_tr_b16 a[144:145], v5 offset:8192
  v_cvt_pk_bf16_f32 v244, v242, v242
  v_mfma_f32_16x16x32_bf16 v[120:123], a[164:167], a[16:19], v[120:123]
  buffer_load_dwordx4 v11, s[52:55], s40 offen offset:1024 lds
  v_mfma_f32_16x16x32_bf16 v[124:127], a[164:167], a[20:23], v[124:127]
  s_waitcnt lgkmcnt(4)
  ds_read_b64_tr_b16 a[146:147], v5 offset:8704
  v_and_b32 v245, 0xffff0000, v244
  v_mfma_f32_16x16x32_bf16 v[128:131], a[168:171], a[16:19], v[128:131]
  s_waitcnt lgkmcnt(2)
  v_sub_f32 v245, v242, v245
  v_cvt_pk_bf16_f32 v245, v245, 0
  v_cndmask_b32 v244, 0, v244, s[88:89]
  v_cndmask_b32 v245, 0, v245, s[88:89]
  v_accvgpr_write_b32 a192, v244
  v_accvgpr_write_b32 a193, v245
  v_mul_f32 v243, 0x3ae38e39, v243
  v_fma_f32 v243, -v242, v242, v243
  v_max_f32 v243, 0, v243
  v_add_f32 v225, 0x3727c5ac, v243
  v_rsq_f32 v224, v225
  v_mov_b32 v246, 0
  v_mul_f32 v224, 0xbfb8aa3b, v224
  v_accvgpr_read_b32 v243, a208
  v_accvgpr_read_b32 v244, a209
  v_accvgpr_read_b32 v245, a210
  v_accvgpr_read_b32 v246, a211
  v_accvgpr_read_b32 v242, a200
  v_cndmask_b32 v243, v243, v244, s[46:47]
  v_cndmask_b32 v243, v243, v245, s[48:49]
  v_cndmask_b32 v243, v243, v246, s[50:51]
  v_mfma_f32_16x16x32_bf16 v[132:135], a[168:171], a[20:23], v[132:135]
  ds_bpermute_b32 v243, v249, v243
  v_mul_f32 v242, 0xbae38e39, v242
  v_cvt_pk_bf16_f32 v244, v242, v242
  v_and_b32 v245, 0xffff0000, v244
  v_sub_f32 v245, v242, v245
  v_cvt_pk_bf16_f32 v245, v245, 0
  v_cndmask_b32 v244, 0, v244, s[88:89]
  v_cndmask_b32 v245, 0, v245, s[88:89]
  v_accvgpr_write_b32 a194, v244
  v_accvgpr_write_b32 a195, v245
  s_waitcnt lgkmcnt(0)
  v_mul_f32 v243, 0x3ae38e39, v243
  v_fma_f32 v243, -v242, v242, v243
  v_max_f32 v243, 0, v243
  v_add_f32 v227, 0x3727c5ac, v243
  v_rsq_f32 v226, v227
  v_mov_b32 v246, 0
  v_mul_f32 v226, 0xbfb8aa3b, v226
  v_mfma_f32_16x16x32_bf16 v[136:139], a[172:175], a[16:19], v[136:139]
  s_waitcnt vmcnt(14)
  ds_read_b64_tr_b16 a[148:149], v6 offset:8192
  v_mfma_f32_16x16x32_bf16 v[140:143], a[172:175], a[20:23], v[140:143]
  s_barrier
  v_mfma_f32_16x16x16_bf16 v[16:19], a[176:177], a[192:193], v[16:19]
  s_add_u32 m0, s42, 114688
  s_mov_b32 s40, 4128896
  ds_read_b64_tr_b16 a[150:151], v6 offset:8704
  v_mfma_f32_16x16x16_bf16 v[48:51], a[184:185], a[192:193], v[48:51]
  ds_read_b64_tr_b16 a[152:153], v7 offset:8192
  v_mfma_f32_16x16x16_bf16 v[24:27], a[178:179], a[192:193], v[24:27]
  buffer_load_dwordx4 v11, s[8:11], s40 offen offset:0 lds
  v_mfma_f32_16x16x16_bf16 v[56:59], a[186:187], a[192:193], v[56:59]
  ds_read_b64_tr_b16 a[154:155], v7 offset:8704
  v_mfma_f32_16x16x16_bf16 v[32:35], a[180:181], a[192:193], v[32:35]
  ds_read_b64_tr_b16 a[156:157], v8 offset:8192
  v_mul_f32 v216, v224, v16
  v_mfma_f32_16x16x16_bf16 v[64:67], a[188:189], a[192:193], v[64:67]
  ds_read_b64_tr_b16 a[158:159], v8 offset:8704
  v_mul_f32 v217, v224, v17
  v_mfma_f32_16x16x16_bf16 v[40:43], a[182:183], a[192:193], v[40:43]
  ds_read_b64_tr_b16 a[160:161], v5 offset:9216
  v_mul_f32 v218, v224, v18
  v_mul_f32 v219, v224, v19
  v_mfma_f32_16x16x16_bf16 v[72:75], a[190:191], a[192:193], v[72:75]
  ds_read_b64_tr_b16 a[162:163], v5 offset:9728
  v_mfma_f32_16x16x16_bf16 v[20:23], a[176:177], a[194:195], v[20:23]
  ds_read_b64_tr_b16 a[164:165], v6 offset:9216
  v_exp_f32 v216, v216
  v_mfma_f32_16x16x16_bf16 v[52:55], a[184:185], a[194:195], v[52:55]
  ds_read_b64_tr_b16 a[166:167], v6 offset:9728
  v_mul_f32 v48, v16, v48
  v_mfma_f32_16x16x16_bf16 v[28:31], a[178:179], a[194:195], v[28:31]
  buffer_load_dwordx4 v11, s[52:55], s40 offen offset:1024 lds
  v_mfma_f32_16x16x16_bf16 v[60:63], a[186:187], a[194:195], v[60:63]
  ds_read_b64_tr_b16 a[168:169], v7 offset:9216
  v_exp_f32 v217, v217
  v_mfma_f32_16x16x16_bf16 v[36:39], a[180:181], a[194:195], v[36:39]
  ds_read_b64_tr_b16 a[170:171], v7 offset:9728
  v_mul_f32 v49, v17, v49
  v_mfma_f32_16x16x16_bf16 v[68:71], a[188:189], a[194:195], v[68:71]
  ds_read_b64_tr_b16 a[172:173], v8 offset:9216
  v_exp_f32 v218, v218
  v_mfma_f32_16x16x16_bf16 v[44:47], a[182:183], a[194:195], v[44:47]
  s_add_u32 m0, s42, 122880
  ds_read_b64_tr_b16 a[174:175], v8 offset:9728
  v_fma_f32 v216, v216, v225, v225
  v_fma_f32 v217, v217, v225, v225
  v_mfma_f32_16x16x16_bf16 v[76:79], a[190:191], a[194:195], v[76:79]
  s_mov_b32 s40, 4423808
  v_exp_f32 v219, v219
  v_mul_f32 v50, v18, v50
  v_mfma_f32_16x16x32_bf16 v[80:83], a[144:147], a[24:27], v[80:83]
  v_rcp_f32 v216, v216
  v_fma_f32 v218, v218, v225, v225
  v_mfma_f32_16x16x32_bf16 v[84:87], a[144:147], a[28:31], v[84:87]
  s_waitcnt lgkmcnt(3)
  ds_read_b64_tr_b16 a[144:145], v5 offset:16384
  v_rcp_f32 v217, v217
  v_mfma_f32_16x16x32_bf16 v[88:91], a[148:151], a[24:27], v[88:91]
  buffer_load_dwordx4 v11, s[8:11], s40 offen offset:0 lds
  v_mfma_f32_16x16x32_bf16 v[92:95], a[148:151], a[28:31], v[92:95]
  ds_read_b64_tr_b16 a[146:147], v5 offset:16896
  v_mul_f32 v51, v19, v51
  v_fma_f32 v219, v219, v225, v225
  v_mfma_f32_16x16x32_bf16 v[96:99], a[152:155], a[24:27], v[96:99]
  ds_read_b64_tr_b16 a[148:149], v6 offset:16384
  v_rcp_f32 v218, v218
  v_mfma_f32_16x16x32_bf16 v[100:103], a[152:155], a[28:31], v[100:103]
  ds_read_b64_tr_b16 a[150:151], v6 offset:16896
  v_mul_f32 v48, v48, v216
  v_mfma_f32_16x16x32_bf16 v[104:107], a[156:159], a[24:27], v[104:107]
  ds_read_b64_tr_b16 a[152:153], v7 offset:16384
  v_rcp_f32 v219, v219
  v_mfma_f32_16x16x32_bf16 v[108:111], a[156:159], a[28:31], v[108:111]
  ds_read_b64_tr_b16 a[154:155], v7 offset:16896
  v_mul_f32 v49, v49, v217
  v_mul_f32 v50, v50, v218
  v_mfma_f32_16x16x32_bf16 v[112:115], a[160:163], a[24:27], v[112:115]
  ds_read_b64_tr_b16 a[156:157], v8 offset:16384
  v_cvt_pk_bf16_f32 v144, v48, v49
  v_mul_f32 v51, v51, v219
  v_mfma_f32_16x16x32_bf16 v[116:119], a[160:163], a[28:31], v[116:119]
  ds_read_b64_tr_b16 a[158:159], v8 offset:16896
  v_cvt_pk_bf16_f32 v145, v50, v51
  v_mfma_f32_16x16x32_bf16 v[120:123], a[164:167], a[24:27], v[120:123]
  buffer_load_dwordx4 v11, s[52:55], s40 offen offset:1024 lds
  v_mfma_f32_16x16x32_bf16 v[124:127], a[164:167], a[28:31], v[124:127]
  s_waitcnt lgkmcnt(4)
  ds_read_b64_tr_b16 a[160:161], v5 offset:17408
  v_mul_f32 v220, v226, v20
  v_mul_f32 v221, v226, v21
  v_mfma_f32_16x16x32_bf16 v[128:131], a[168:171], a[24:27], v[128:131]
  ds_read_b64_tr_b16 a[162:163], v5 offset:17920
  v_mul_f32 v222, v226, v22
  v_mfma_f32_16x16x32_bf16 v[132:135], a[168:171], a[28:31], v[132:135]
  ds_read_b64_tr_b16 a[164:165], v6 offset:17408
  v_mul_f32 v223, v226, v23
  v_mfma_f32_16x16x32_bf16 v[136:139], a[172:175], a[24:27], v[136:139]
  s_add_u32 m0, s42, 49152
  ds_read_b64_tr_b16 a[166:167], v6 offset:17920
  v_exp_f32 v220, v220
  v_mfma_f32_16x16x32_bf16 v[140:143], a[172:175], a[28:31], v[140:143]
  s_mov_b32 s40, 4718720
  ds_read_b64_tr_b16 a[168:169], v7 offset:17408
  v_mul_f32 v52, v20, v52
  v_mfma_f32_16x16x32_bf16 v[80:83], a[144:147], a[32:35], v[80:83]
  ds_read_b64_tr_b16 a[170:171], v7 offset:17920
  v_exp_f32 v221, v221
  v_mfma_f32_16x16x32_bf16 v[84:87], a[144:147], a[36:39], v[84:87]
  ds_read_b64_tr_b16 a[172:173], v8 offset:17408
  v_mul_f32 v53, v21, v53
  v_mfma_f32_16x16x32_bf16 v[88:91], a[148:151], a[32:35], v[88:91]
  buffer_load_dwordx4 v11, s[8:11], s40 offen offset:0 lds
  v_mfma_f32_16x16x32_bf16 v[92:95], a[148:151], a[36:39], v[92:95]
  s_waitcnt lgkmcnt(4)
  ds_read_b64_tr_b16 a[174:175], v8 offset:17920
  v_exp_f32 v222, v222
  v_mfma_f32_16x16x32_bf16 v[96:99], a[152:155], a[32:35], v[96:99]
  ds_read_b64_tr_b16 a[144:145], v5 offset:24576
  v_fma_f32 v220, v220, v227, v227
  v_fma_f32 v221, v221, v227, v227
  v_mfma_f32_16x16x32_bf16 v[100:103], a[152:155], a[36:39], v[100:103]
  ds_read_b64_tr_b16 a[146:147], v5 offset:25088
  v_mfma_f32_16x16x32_bf16 v[104:107], a[156:159], a[32:35], v[104:107]
  ds_read_b64_tr_b16 a[148:149], v6 offset:24576
  v_exp_f32 v223, v223
  v_mfma_f32_16x16x32_bf16 v[108:111], a[156:159], a[36:39], v[108:111]
  ds_read_b64_tr_b16 a[150:151], v6 offset:25088
  v_mul_f32 v54, v22, v54
  v_mfma_f32_16x16x32_bf16 v[112:115], a[160:163], a[32:35], v[112:115]
  ds_read_b64_tr_b16 a[152:153], v7 offset:24576
  v_rcp_f32 v220, v220
  v_mfma_f32_16x16x32_bf16 v[116:119], a[160:163], a[36:39], v[116:119]
  s_waitcnt lgkmcnt(5)
  ds_read_b64_tr_b16 a[154:155], v7 offset:25088
  v_fma_f32 v222, v222, v227, v227
  v_mfma_f32_16x16x32_bf16 v[120:123], a[164:167], a[32:35], v[120:123]
  buffer_load_dwordx4 v11, s[52:55], s40 offen offset:1024 lds
  v_mfma_f32_16x16x32_bf16 v[124:127], a[164:167], a[36:39], v[124:127]
  s_add_u32 s68, s66, 512
  ds_read_b64_tr_b16 a[156:157], v8 offset:24576
  v_rcp_f32 v221, v221
  v_mfma_f32_16x16x32_bf16 v[128:131], a[168:171], a[32:35], v[128:131]
  ds_read_b64_tr_b16 a[158:159], v8 offset:25088
  v_mul_f32 v55, v23, v55
  v_fma_f32 v223, v223, v227, v227
  v_mfma_f32_16x16x32_bf16 v[132:135], a[168:171], a[36:39], v[132:135]
  s_mov_b32 s40, 5013632
  ds_read_b64_tr_b16 a[160:161], v5 offset:25600
  v_rcp_f32 v222, v222
  v_mfma_f32_16x16x32_bf16 v[136:139], a[172:175], a[32:35], v[136:139]
  s_add_u32 m0, s42, 57344
  buffer_load_dwordx2 a[176:177], v232, s[20:23], s68 offen offset:0 sc1
  v_mfma_f32_16x16x32_bf16 v[140:143], a[172:175], a[36:39], v[140:143]
  s_waitcnt lgkmcnt(3)
  ds_read_b64_tr_b16 a[162:163], v5 offset:26112
  v_mul_f32 v52, v52, v220
  v_mfma_f32_16x16x32_bf16 v[80:83], a[144:147], a[40:43], v[80:83]
  ds_read_b64_tr_b16 a[164:165], v6 offset:25600
  v_rcp_f32 v223, v223
  v_mfma_f32_16x16x32_bf16 v[84:87], a[144:147], a[44:47], v[84:87]
  ds_read_b64_tr_b16 a[166:167], v6 offset:26112
  v_mul_f32 v53, v53, v221
  v_mfma_f32_16x16x32_bf16 v[88:91], a[148:151], a[40:43], v[88:91]
  buffer_load_dwordx4 v11, s[8:11], s40 offen offset:0 lds
  v_mfma_f32_16x16x32_bf16 v[92:95], a[148:151], a[44:47], v[92:95]
  ds_read_b64_tr_b16 a[168:169], v7 offset:25600
  v_mul_f32 v54, v54, v222
  v_cvt_pk_bf16_f32 v148, v52, v53
  v_mfma_f32_16x16x32_bf16 v[96:99], a[152:155], a[40:43], v[96:99]
  ds_read_b64_tr_b16 a[170:171], v7 offset:26112
  v_mul_f32 v55, v55, v223
  v_mfma_f32_16x16x32_bf16 v[100:103], a[152:155], a[44:47], v[100:103]
  s_waitcnt lgkmcnt(4)
  ds_read_b64_tr_b16 a[172:173], v8 offset:25600
  v_cvt_pk_bf16_f32 v149, v54, v55
  v_mul_f32 v216, v224, v24
  v_mfma_f32_16x16x32_bf16 v[104:107], a[156:159], a[40:43], v[104:107]
  buffer_load_dwordx2 a[178:179], v232, s[20:23], s68 offen offset:128 sc1
  v_mfma_f32_16x16x32_bf16 v[108:111], a[156:159], a[44:47], v[108:111]
  ds_read_b64_tr_b16 a[174:175], v8 offset:26112
  v_mul_f32 v217, v224, v25
  v_mfma_f32_16x16x32_bf16 v[112:115], a[160:163], a[40:43], v[112:115]
  ds_read_b64_tr_b16 a[144:145], v1 offset:0
  v_mul_f32 v218, v224, v26
  v_mul_f32 v219, v224, v27
  v_mfma_f32_16x16x32_bf16 v[116:119], a[160:163], a[44:47], v[116:119]
  s_waitcnt lgkmcnt(4)
  ds_read_b64_tr_b16 a[146:147], v1 offset:512
  v_mfma_f32_16x16x32_bf16 v[120:123], a[164:167], a[40:43], v[120:123]
  buffer_load_dwordx4 v11, s[52:55], s40 offen offset:1024 lds
  v_mfma_f32_16x16x32_bf16 v[124:127], a[164:167], a[44:47], v[124:127]
  s_waitcnt lgkmcnt(3)
  ds_read_b64_tr_b16 a[148:149], v2 offset:0
  ds_read_b64_tr_b16 a[150:151], v2 offset:512
  v_mfma_f32_16x16x32_bf16 v[128:131], a[168:171], a[40:43], v[128:131]
  s_add_u32 m0, s42, 65536
  ds_read_b64_tr_b16 a[152:153], v3 offset:0
  ds_read_b64_tr_b16 a[154:155], v3 offset:512
  v_mfma_f32_16x16x32_bf16 v[132:135], a[168:171], a[44:47], v[132:135]
  s_waitcnt lgkmcnt(6)
  ds_read_b64_tr_b16 a[156:157], v4 offset:0
  ds_read_b64_tr_b16 a[158:159], v4 offset:512
  v_mfma_f32_16x16x32_bf16 v[136:139], a[172:175], a[40:43], v[136:139]
  s_waitcnt vmcnt(18) lgkmcnt(6)
  buffer_load_dwordx2 a[180:181], v232, s[20:23], s68 offen offset:256 sc1
  v_mfma_f32_16x16x32_bf16 v[140:143], a[172:175], a[44:47], v[140:143]
  s_barrier
  v_mfma_f32_16x16x32_bf16 v[80:83], a[144:147], a[48:51], v[80:83]
  s_mov_b32 s40, 256
  ds_read_b64_tr_b16 a[160:161], v1 offset:1024
  v_exp_f32 v216, v216
  v_mfma_f32_16x16x32_bf16 v[84:87], a[144:147], a[52:55], v[84:87]
  s_waitcnt lgkmcnt(5)
  ds_read_b64_tr_b16 a[162:163], v1 offset:1536
  v_mul_f32 v56, v24, v56
  v_mfma_f32_16x16x32_bf16 v[88:91], a[148:151], a[48:51], v[88:91]
  buffer_load_dwordx4 v11, s[8:11], s40 offen offset:0 lds
  v_mfma_f32_16x16x32_bf16 v[92:95], a[148:151], a[52:55], v[92:95]
  s_waitcnt lgkmcnt(2)
  ds_read_b64_tr_b16 a[164:165], v2 offset:1024
  ds_read_b64_tr_b16 a[166:167], v2 offset:1536
  v_mfma_f32_16x16x32_bf16 v[96:99], a[152:155], a[48:51], v[96:99]
  ds_read_b64_tr_b16 a[168:169], v3 offset:1024
  v_exp_f32 v217, v217
  v_mfma_f32_16x16x32_bf16 v[100:103], a[152:155], a[52:55], v[100:103]
  ds_read_b64_tr_b16 a[170:171], v3 offset:1536
  v_mul_f32 v57, v25, v57
  v_mfma_f32_16x16x32_bf16 v[104:107], a[156:159], a[48:51], v[104:107]
  buffer_load_dwordx2 a[182:183], v232, s[20:23], s68 offen offset:384 sc1
  v_mfma_f32_16x16x32_bf16 v[108:111], a[156:159], a[52:55], v[108:111]
  s_waitcnt lgkmcnt(4)
  ds_read_b64_tr_b16 a[172:173], v4 offset:1024
  ds_read_b64_tr_b16 a[174:175], v4 offset:1536
  v_mfma_f32_16x16x32_bf16 v[112:115], a[160:163], a[48:51], v[112:115]
  ds_read_b64_tr_b16 a[144:145], v1 offset:8192
  v_exp_f32 v218, v218
  v_mfma_f32_16x16x32_bf16 v[116:119], a[160:163], a[52:55], v[116:119]
  s_waitcnt lgkmcnt(5)
  ds_read_b64_tr_b16 a[146:147], v1 offset:8704
  v_fma_f32 v216, v216, v225, v225
  v_fma_f32 v217, v217, v225, v225
  v_mfma_f32_16x16x32_bf16 v[120:123], a[164:167], a[48:51], v[120:123]
  s_add_u32 s68, s66, 37376
  buffer_load_dwordx4 v11, s[52:55], s40 offen offset:1024 lds
  v_mfma_f32_16x16x32_bf16 v[124:127], a[164:167], a[52:55], v[124:127]
  s_waitcnt lgkmcnt(4)
  ds_read_b64_tr_b16 a[148:149], v2 offset:8192
  ds_read_b64_tr_b16 a[150:151], v2 offset:8704
  v_mfma_f32_16x16x32_bf16 v[128:131], a[168:171], a[48:51], v[128:131]
  ds_read_b64_tr_b16 a[152:153], v3 offset:8192
  v_exp_f32 v219, v219
  v_mfma_f32_16x16x32_bf16 v[132:135], a[168:171], a[52:55], v[132:135]
  s_waitcnt lgkmcnt(5)
  ds_read_b64_tr_b16 a[154:155], v3 offset:8704
  v_mul_f32 v58, v26, v58
  v_mfma_f32_16x16x32_bf16 v[136:139], a[172:175], a[48:51], v[136:139]
  s_add_u32 m0, s42, 73728
  buffer_load_dwordx2 a[184:185], v232, s[20:23], s68 offen offset:0 sc1
  v_mfma_f32_16x16x32_bf16 v[140:143], a[172:175], a[52:55], v[140:143]
  s_waitcnt lgkmcnt(4)
  ds_read_b64_tr_b16 a[156:157], v4 offset:8192
  ds_read_b64_tr_b16 a[158:159], v4 offset:8704
  v_mfma_f32_16x16x32_bf16 v[80:83], a[144:147], a[56:59], v[80:83]
  s_mov_b32 s40, 295168
  ds_read_b64_tr_b16 a[160:161], v1 offset:9216
  v_rcp_f32 v216, v216
  v_mfma_f32_16x16x32_bf16 v[84:87], a[144:147], a[60:63], v[84:87]
  s_waitcnt lgkmcnt(5)
  ds_read_b64_tr_b16 a[162:163], v1 offset:9728
  v_fma_f32 v218, v218, v225, v225
  v_mfma_f32_16x16x32_bf16 v[88:91], a[148:151], a[56:59], v[88:91]
  buffer_load_dwordx4 v11, s[8:11], s40 offen offset:0 lds
  v_mfma_f32_16x16x32_bf16 v[92:95], a[148:151], a[60:63], v[92:95]
  s_waitcnt lgkmcnt(4)
  ds_read_b64_tr_b16 a[164:165], v2 offset:9216
  ds_read_b64_tr_b16 a[166:167], v2 offset:9728
  v_mfma_f32_16x16x32_bf16 v[96:99], a[152:155], a[56:59], v[96:99]
  ds_read_b64_tr_b16 a[168:169], v3 offset:9216
  v_rcp_f32 v217, v217
  v_mfma_f32_16x16x32_bf16 v[100:103], a[152:155], a[60:63], v[100:103]
  s_waitcnt lgkmcnt(5)
  ds_read_b64_tr_b16 a[170:171], v3 offset:9728
  v_mul_f32 v59, v27, v59
  v_fma_f32 v219, v219, v225, v225
  v_mfma_f32_16x16x32_bf16 v[104:107], a[156:159], a[56:59], v[104:107]
  buffer_load_dwordx2 a[186:187], v232, s[20:23], s68 offen offset:128 sc1
  v_mfma_f32_16x16x32_bf16 v[108:111], a[156:159], a[60:63], v[108:111]
  s_waitcnt lgkmcnt(4)
  ds_read_b64_tr_b16 a[172:173], v4 offset:9216
  ds_read_b64_tr_b16 a[174:175], v4 offset:9728
  v_mfma_f32_16x16x32_bf16 v[112:115], a[160:163], a[56:59], v[112:115]
  ds_read_b64_tr_b16 a[144:145], v1 offset:16384
  v_rcp_f32 v218, v218
  v_mfma_f32_16x16x32_bf16 v[116:119], a[160:163], a[60:63], v[116:119]
  s_waitcnt lgkmcnt(5)
  ds_read_b64_tr_b16 a[146:147], v1 offset:16896
  v_mul_f32 v56, v56, v216
  v_mfma_f32_16x16x32_bf16 v[120:123], a[164:167], a[56:59], v[120:123]
  buffer_load_dwordx4 v11, s[52:55], s40 offen offset:1024 lds
  v_mfma_f32_16x16x32_bf16 v[124:127], a[164:167], a[60:63], v[124:127]
  s_waitcnt lgkmcnt(4)
  ds_read_b64_tr_b16 a[148:149], v2 offset:16384
  ds_read_b64_tr_b16 a[150:151], v2 offset:16896
  v_mfma_f32_16x16x32_bf16 v[128:131], a[168:171], a[56:59], v[128:131]
  ds_read_b64_tr_b16 a[152:153], v3 offset:16384
  v_rcp_f32 v219, v219
  v_mfma_f32_16x16x32_bf16 v[132:135], a[168:171], a[60:63], v[132:135]
  s_waitcnt lgkmcnt(5)
  ds_read_b64_tr_b16 a[154:155], v3 offset:16896
  v_mul_f32 v57, v57, v217
  v_mul_f32 v58, v58, v218
  v_mfma_f32_16x16x32_bf16 v[136:139], a[172:175], a[56:59], v[136:139]
  s_add_u32 m0, s42, 81920
  buffer_load_dwordx2 a[188:189], v232, s[20:23], s68 offen offset:256 sc1
  v_mfma_f32_16x16x32_bf16 v[140:143], a[172:175], a[60:63], v[140:143]
  s_waitcnt lgkmcnt(4)
  ds_read_b64_tr_b16 a[156:157], v4 offset:16384
  ds_read_b64_tr_b16 a[158:159], v4 offset:16896
  v_cvt_pk_bf16_f32 v146, v56, v57
  v_mfma_f32_16x16x32_bf16 v[80:83], a[144:147], a[64:67], v[80:83]
  s_mov_b32 s40, 590080
  ds_read_b64_tr_b16 a[160:161], v1 offset:17408
  v_mul_f32 v59, v59, v219
  v_cvt_pk_bf16_f32 v147, v58, v59
  v_mfma_f32_16x16x32_bf16 v[84:87], a[144:147], a[68:71], v[84:87]
  s_waitcnt lgkmcnt(5)
  ds_read_b64_tr_b16 a[162:163], v1 offset:17920
  v_mul_f32 v220, v226, v28
  v_mul_f32 v221, v226, v29
  v_mfma_f32_16x16x32_bf16 v[88:91], a[148:151], a[64:67], v[88:91]
  buffer_load_dwordx4 v11, s[8:11], s40 offen offset:0 lds
  v_mfma_f32_16x16x32_bf16 v[92:95], a[148:151], a[68:71], v[92:95]
  s_waitcnt lgkmcnt(4)
  ds_read_b64_tr_b16 a[164:165], v2 offset:17408
  ds_read_b64_tr_b16 a[166:167], v2 offset:17920
  v_mul_f32 v222, v226, v30
  v_mfma_f32_16x16x32_bf16 v[96:99], a[152:155], a[64:67], v[96:99]
  ds_read_b64_tr_b16 a[168:169], v3 offset:17408
  v_mul_f32 v223, v226, v31
  v_mfma_f32_16x16x32_bf16 v[100:103], a[152:155], a[68:71], v[100:103]
  s_waitcnt lgkmcnt(5)
  ds_read_b64_tr_b16 a[170:171], v3 offset:17920
  v_exp_f32 v220, v220
  v_mfma_f32_16x16x32_bf16 v[104:107], a[156:159], a[64:67], v[104:107]
  buffer_load_dwordx2 a[190:191], v232, s[20:23], s68 offen offset:384 sc1
  v_mfma_f32_16x16x32_bf16 v[108:111], a[156:159], a[68:71], v[108:111]
  s_waitcnt lgkmcnt(4)
  ds_read_b64_tr_b16 a[172:173], v4 offset:17408
  ds_read_b64_tr_b16 a[174:175], v4 offset:17920
  v_mul_f32 v60, v28, v60
  v_mfma_f32_16x16x32_bf16 v[112:115], a[160:163], a[64:67], v[112:115]
  ds_read_b64_tr_b16 a[144:145], v1 offset:24576
  v_exp_f32 v221, v221
  v_mfma_f32_16x16x32_bf16 v[116:119], a[160:163], a[68:71], v[116:119]
L3_pad2:
  s_cmp_lg_u32 s82, 0
  s_cbranch_scc1 L3_pad6
  s_waitcnt lgkmcnt(5)
  ds_read_b64_tr_b16 a[146:147], v1 offset:25088
  v_mul_f32 v61, v29, v61
  v_mfma_f32_16x16x32_bf16 v[120:123], a[164:167], a[64:67], v[120:123]
  buffer_load_dwordx4 v11, s[52:55], s40 offen offset:1024 lds
  v_mfma_f32_16x16x32_bf16 v[124:127], a[164:167], a[68:71], v[124:127]
  s_waitcnt lgkmcnt(4)
  ds_read_b64_tr_b16 a[148:149], v2 offset:24576
  ds_read_b64_tr_b16 a[150:151], v2 offset:25088
  v_mfma_f32_16x16x32_bf16 v[128:131], a[168:171], a[64:67], v[128:131]
  s_add_u32 m0, s42, 90112
  ds_read_b64_tr_b16 a[152:153], v3 offset:24576
  v_exp_f32 v222, v222
  v_mfma_f32_16x16x32_bf16 v[132:135], a[168:171], a[68:71], v[132:135]
  s_waitcnt lgkmcnt(5)
  ds_read_b64_tr_b16 a[154:155], v3 offset:25088
  v_fma_f32 v220, v220, v227, v227
  v_fma_f32 v221, v221, v227, v227
  v_mfma_f32_16x16x32_bf16 v[136:139], a[172:175], a[64:67], v[136:139]
  s_waitcnt vmcnt(24) lgkmcnt(4)
  ds_read_b64_tr_b16 a[156:157], v4 offset:24576
  ds_read_b64_tr_b16 a[158:159], v4 offset:25088
  v_mfma_f32_16x16x32_bf16 v[140:143], a[172:175], a[68:71], v[140:143]
  s_barrier
  v_mfma_f32_16x16x32_bf16 v[80:83], a[144:147], a[72:75], v[80:83]
  s_mov_b32 s40, 884992
  ds_read_b64_tr_b16 a[160:161], v1 offset:25600
  v_exp_f32 v223, v223
  v_mfma_f32_16x16x32_bf16 v[84:87], a[144:147], a[76:79], v[84:87]
  s_waitcnt lgkmcnt(5)
  ds_read_b64_tr_b16 a[162:163], v1 offset:26112
  v_mul_f32 v62, v30, v62
  v_mfma_f32_16x16x32_bf16 v[88:91], a[148:151], a[72:75], v[88:91]
  buffer_load_dwordx4 v11, s[8:11], s40 offen offset:0 lds
  v_mfma_f32_16x16x32_bf16 v[92:95], a[148:151], a[76:79], v[92:95]
  s_waitcnt lgkmcnt(4)
  ds_read_b64_tr_b16 a[164:165], v2 offset:25600
  ds_read_b64_tr_b16 a[166:167], v2 offset:26112
  v_mfma_f32_16x16x32_bf16 v[96:99], a[152:155], a[72:75], v[96:99]
  ds_read_b64_tr_b16 a[168:169], v3 offset:25600
  v_rcp_f32 v220, v220
  v_mfma_f32_16x16x32_bf16 v[100:103], a[152:155], a[76:79], v[100:103]
  s_waitcnt lgkmcnt(5)
  ds_read_b64_tr_b16 a[170:171], v3 offset:26112
  v_fma_f32 v222, v222, v227, v227
  v_mfma_f32_16x16x32_bf16 v[104:107], a[156:159], a[72:75], v[104:107]
  ds_read_b64_tr_b16 a[172:173], v4 offset:25600
  v_rcp_f32 v221, v221
  v_mfma_f32_16x16x32_bf16 v[108:111], a[156:159], a[76:79], v[108:111]
  s_waitcnt lgkmcnt(5)
  ds_read_b64_tr_b16 a[174:175], v4 offset:26112
  v_mul_f32 v63, v31, v63
  v_fma_f32 v223, v223, v227, v227
  v_mfma_f32_16x16x32_bf16 v[112:115], a[160:163], a[72:75], v[112:115]
  ds_read_b64_tr_b16 a[144:145], v1 offset:32768
  v_mfma_f32_16x16x32_bf16 v[116:119], a[160:163], a[76:79], v[116:119]
  s_waitcnt lgkmcnt(5)
  ds_read_b64_tr_b16 a[146:147], v1 offset:33280
  v_rcp_f32 v222, v222
  v_mfma_f32_16x16x32_bf16 v[120:123], a[164:167], a[72:75], v[120:123]
  buffer_load_dwordx4 v11, s[52:55], s40 offen offset:1024 lds
  v_mfma_f32_16x16x32_bf16 v[124:127], a[164:167], a[76:79], v[124:127]
  s_waitcnt lgkmcnt(4)
  ds_read_b64_tr_b16 a[148:149], v2 offset:32768
  ds_read_b64_tr_b16 a[150:151], v2 offset:33280
  v_mul_f32 v60, v60, v220
  v_mfma_f32_16x16x32_bf16 v[128:131], a[168:171], a[72:75], v[128:131]
  s_mov_b32 s40, 1179904
  ds_read_b64_tr_b16 a[152:153], v3 offset:32768
  v_rcp_f32 v223, v223
  v_mfma_f32_16x16x32_bf16 v[132:135], a[168:171], a[76:79], v[132:135]
  s_waitcnt lgkmcnt(5)
  ds_read_b64_tr_b16 a[154:155], v3 offset:33280
  v_mul_f32 v61, v61, v221
  v_mfma_f32_16x16x32_bf16 v[136:139], a[172:175], a[72:75], v[136:139]
  s_add_u32 m0, s42, 0
  ds_read_b64_tr_b16 a[156:157], v4 offset:32768
  v_mul_f32 v62, v62, v222
  v_cvt_pk_bf16_f32 v150, v60, v61
  v_mfma_f32_16x16x32_bf16 v[140:143], a[172:175], a[76:79], v[140:143]
  s_waitcnt lgkmcnt(5)
  ds_read_b64_tr_b16 a[158:159], v4 offset:33280
  v_mul_f32 v63, v63, v223
  v_mfma_f32_16x16x32_bf16 v[80:83], a[144:147], a[80:83], v[80:83]
  ds_read_b64_tr_b16 a[160:161], v1 offset:33792
  v_cvt_pk_bf16_f32 v151, v62, v63
  v_mul_f32 v216, v224, v32
  v_mfma_f32_16x16x32_bf16 v[84:87], a[144:147], a[84:87], v[84:87]
  s_waitcnt lgkmcnt(5)
  ds_read_b64_tr_b16 a[162:163], v1 offset:34304
  v_mul_f32 v217, v224, v33
  v_mfma_f32_16x16x32_bf16 v[88:91], a[148:151], a[80:83], v[88:91]
  buffer_load_dwordx4 v11, s[8:11], s40 offen offset:0 lds
  v_mfma_f32_16x16x32_bf16 v[92:95], a[148:151], a[84:87], v[92:95]
  s_waitcnt lgkmcnt(4)
  ds_read_b64_tr_b16 a[164:165], v2 offset:33792
  ds_read_b64_tr_b16 a[166:167], v2 offset:34304
  v_mul_f32 v218, v224, v34
  v_mfma_f32_16x16x32_bf16 v[96:99], a[152:155], a[80:83], v[96:99]
  ds_read_b64_tr_b16 a[168:169], v3 offset:33792
  v_mul_f32 v219, v224, v35
  v_mfma_f32_16x16x32_bf16 v[100:103], a[152:155], a[84:87], v[100:103]
  s_waitcnt lgkmcnt(5)
  ds_read_b64_tr_b16 a[170:171], v3 offset:34304
  v_exp_f32 v216, v216
  v_mfma_f32_16x16x32_bf16 v[104:107], a[156:159], a[80:83], v[104:107]
  ds_read_b64_tr_b16 a[172:173], v4 offset:33792
  v_mul_f32 v64, v32, v64
  v_mfma_f32_16x16x32_bf16 v[108:111], a[156:159], a[84:87], v[108:111]
  s_waitcnt lgkmcnt(5)
  ds_read_b64_tr_b16 a[174:175], v4 offset:34304
  v_exp_f32 v217, v217
  v_mfma_f32_16x16x32_bf16 v[112:115], a[160:163], a[80:83], v[112:115]
  ds_read_b64_tr_b16 a[144:145], v1 offset:40960
  v_mul_f32 v65, v33, v65
  v_mfma_f32_16x16x32_bf16 v[116:119], a[160:163], a[84:87], v[116:119]
  s_waitcnt lgkmcnt(5)
  ds_read_b64_tr_b16 a[146:147], v1 offset:41472
  v_exp_f32 v218, v218
  v_mfma_f32_16x16x32_bf16 v[120:123], a[164:167], a[80:83], v[120:123]
  buffer_load_dwordx4 v11, s[52:55], s40 offen offset:1024 lds
  v_mfma_f32_16x16x32_bf16 v[124:127], a[164:167], a[84:87], v[124:127]
  s_waitcnt lgkmcnt(4)
  ds_read_b64_tr_b16 a[148:149], v2 offset:40960
  ds_read_b64_tr_b16 a[150:151], v2 offset:41472
  v_mfma_f32_16x16x32_bf16 v[128:131], a[168:171], a[80:83], v[128:131]
  s_mov_b32 s40, 1474816
  ds_read_b64_tr_b16 a[152:153], v3 offset:40960
  v_fma_f32 v216, v216, v225, v225
  v_fma_f32 v217, v217, v225, v225
  v_mfma_f32_16x16x32_bf16 v[132:135], a[168:171], a[84:87], v[132:135]
  s_waitcnt lgkmcnt(5)
  ds_read_b64_tr_b16 a[154:155], v3 offset:41472
  v_mfma_f32_16x16x32_bf16 v[136:139], a[172:175], a[80:83], v[136:139]
  s_add_u32 m0, s42, 8192
  ds_read_b64_tr_b16 a[156:157], v4 offset:40960
  v_exp_f32 v219, v219
  v_mfma_f32_16x16x32_bf16 v[140:143], a[172:175], a[84:87], v[140:143]
  s_waitcnt lgkmcnt(5)
  ds_read_b64_tr_b16 a[158:159], v4 offset:41472
  v_mul_f32 v66, v34, v66
  v_mfma_f32_16x16x32_bf16 v[80:83], a[144:147], a[88:91], v[80:83]
  ds_read_b64_tr_b16 a[160:161], v1 offset:41984
  v_rcp_f32 v216, v216
  v_mfma_f32_16x16x32_bf16 v[84:87], a[144:147], a[92:95], v[84:87]
  s_waitcnt lgkmcnt(5)
  ds_read_b64_tr_b16 a[162:163], v1 offset:42496
  v_fma_f32 v218, v218, v225, v225
  v_mfma_f32_16x16x32_bf16 v[88:91], a[148:151], a[88:91], v[88:91]
  buffer_load_dwordx4 v11, s[8:11], s40 offen offset:0 lds
  v_mfma_f32_16x16x32_bf16 v[92:95], a[148:151], a[92:95], v[92:95]
  s_waitcnt lgkmcnt(4)
  ds_read_b64_tr_b16 a[164:165], v2 offset:41984
  ds_read_b64_tr_b16 a[166:167], v2 offset:42496
  v_mfma_f32_16x16x32_bf16 v[96:99], a[152:155], a[88:91], v[96:99]
  ds_read_b64_tr_b16 a[168:169], v3 offset:41984
  v_rcp_f32 v217, v217
  v_mfma_f32_16x16x32_bf16 v[100:103], a[152:155], a[92:95], v[100:103]
  s_waitcnt lgkmcnt(5)
  ds_read_b64_tr_b16 a[170:171], v3 offset:42496
  v_mul_f32 v67, v35, v67
  v_fma_f32 v219, v219, v225, v225
  v_mfma_f32_16x16x32_bf16 v[104:107], a[156:159], a[88:91], v[104:107]
  ds_read_b64_tr_b16 a[172:173], v4 offset:41984
  v_rcp_f32 v218, v218
  v_mfma_f32_16x16x32_bf16 v[108:111], a[156:159], a[92:95], v[108:111]
  s_waitcnt lgkmcnt(5)
  ds_read_b64_tr_b16 a[174:175], v4 offset:42496
  v_mul_f32 v64, v64, v216
  v_mfma_f32_16x16x32_bf16 v[112:115], a[160:163], a[88:91], v[112:115]
  ds_read_b64_tr_b16 a[144:145], v5 offset:32768
  v_rcp_f32 v219, v219
  v_mfma_f32_16x16x32_bf16 v[116:119], a[160:163], a[92:95], v[116:119]
  s_waitcnt lgkmcnt(5)
  ds_read_b64_tr_b16 a[146:147], v5 offset:33280
  v_mul_f32 v65, v65, v217
  v_mul_f32 v66, v66, v218
  v_mfma_f32_16x16x32_bf16 v[120:123], a[164:167], a[88:91], v[120:123]
  buffer_load_dwordx4 v11, s[52:55], s40 offen offset:1024 lds
  v_mfma_f32_16x16x32_bf16 v[124:127], a[164:167], a[92:95], v[124:127]
  s_waitcnt lgkmcnt(4)
  ds_read_b64_tr_b16 a[148:149], v6 offset:32768
  ds_read_b64_tr_b16 a[150:151], v6 offset:33280
  v_mfma_f32_16x16x32_bf16 v[128:131], a[168:171], a[88:91], v[128:131]
  s_add_u32 m0, s42, 16384
  ds_read_b64_tr_b16 a[152:153], v7 offset:32768
  v_cvt_pk_bf16_f32 v152, v64, v65
  v_mul_f32 v67, v67, v219
  v_mfma_f32_16x16x32_bf16 v[132:135], a[168:171], a[92:95], v[132:135]
  s_waitcnt lgkmcnt(5)
  ds_read_b64_tr_b16 a[154:155], v7 offset:33280
  v_cvt_pk_bf16_f32 v153, v66, v67
  v_mfma_f32_16x16x32_bf16 v[136:139], a[172:175], a[88:91], v[136:139]
  s_waitcnt vmcnt(24) lgkmcnt(4)
  ds_read_b64_tr_b16 a[156:157], v8 offset:32768
  ds_read_b64_tr_b16 a[158:159], v8 offset:33280
  v_mul_f32 v220, v226, v36
  v_mfma_f32_16x16x32_bf16 v[140:143], a[172:175], a[92:95], v[140:143]
  s_barrier
  v_mfma_f32_16x16x32_bf16 v[80:83], a[144:147], a[96:99], v[80:83]
  s_mov_b32 s40, 1769728
  ds_read_b64_tr_b16 a[160:161], v5 offset:33792
  v_mul_f32 v221, v226, v37
  v_mfma_f32_16x16x32_bf16 v[84:87], a[144:147], a[100:103], v[84:87]
  s_waitcnt lgkmcnt(5)
  ds_read_b64_tr_b16 a[162:163], v5 offset:34304
  v_mul_f32 v222, v226, v38
  v_mul_f32 v223, v226, v39
  v_mfma_f32_16x16x32_bf16 v[88:91], a[148:151], a[96:99], v[88:91]
  buffer_load_dwordx4 v11, s[8:11], s40 offen offset:0 lds
  v_mfma_f32_16x16x32_bf16 v[92:95], a[148:151], a[100:103], v[92:95]
  s_waitcnt lgkmcnt(4)
  ds_read_b64_tr_b16 a[164:165], v6 offset:33792
  ds_read_b64_tr_b16 a[166:167], v6 offset:34304
  v_mfma_f32_16x16x32_bf16 v[96:99], a[152:155], a[96:99], v[96:99]
  ds_read_b64_tr_b16 a[168:169], v7 offset:33792
  v_exp_f32 v220, v220
  v_mfma_f32_16x16x32_bf16 v[100:103], a[152:155], a[100:103], v[100:103]
  s_waitcnt lgkmcnt(5)
  ds_read_b64_tr_b16 a[170:171], v7 offset:34304
  v_mul_f32 v68, v36, v68
  v_mfma_f32_16x16x32_bf16 v[104:107], a[156:159], a[96:99], v[104:107]
  ds_read_b64_tr_b16 a[172:173], v8 offset:33792
  v_exp_f32 v221, v221
  v_mfma_f32_16x16x32_bf16 v[108:111], a[156:159], a[100:103], v[108:111]
  s_waitcnt lgkmcnt(5)
  ds_read_b64_tr_b16 a[174:175], v8 offset:34304
  v_mul_f32 v69, v37, v69
  v_mfma_f32_16x16x32_bf16 v[112:115], a[160:163], a[96:99], v[112:115]
  ds_read_b64_tr_b16 a[144:145], v5 offset:40960
  v_exp_f32 v222, v222
  v_mfma_f32_16x16x32_bf16 v[116:119], a[160:163], a[100:103], v[116:119]
  s_waitcnt lgkmcnt(5)
  ds_read_b64_tr_b16 a[146:147], v5 offset:41472
  v_fma_f32 v220, v220, v227, v227
  v_mfma_f32_16x16x32_bf16 v[120:123], a[164:167], a[96:99], v[120:123]
  s_mov_b32 s69, 0
  buffer_load_dwordx4 v11, s[52:55], s40 offen offset:1024 lds
  v_mfma_f32_16x16x32_bf16 v[124:127], a[164:167], a[100:103], v[124:127]
  s_waitcnt lgkmcnt(4)
  ds_read_b64_tr_b16 a[148:149], v6 offset:40960
  ds_read_b64_tr_b16 a[150:151], v6 offset:41472
  v_mfma_f32_16x16x32_bf16 v[128:131], a[168:171], a[96:99], v[128:131]
  ds_read_b64_tr_b16 a[152:153], v7 offset:40960
  v_fma_f32 v221, v221, v227, v227
  v_mfma_f32_16x16x32_bf16 v[132:135], a[168:171], a[100:103], v[132:135]
  s_waitcnt lgkmcnt(5)
  ds_read_b64_tr_b16 a[154:155], v7 offset:41472
  v_exp_f32 v223, v223
  v_mfma_f32_16x16x32_bf16 v[136:139], a[172:175], a[96:99], v[136:139]
  s_add_u32 m0, s42, 24576
  buffer_store_dwordx4 v[144:147], v233, s[76:79], s69 offen sc1
  v_mfma_f32_16x16x32_bf16 v[140:143], a[172:175], a[100:103], v[140:143]
  s_waitcnt lgkmcnt(4)
  ds_read_b64_tr_b16 a[156:157], v8 offset:40960
  ds_read_b64_tr_b16 a[158:159], v8 offset:41472
  v_mul_f32 v70, v38, v70
  v_mfma_f32_16x16x32_bf16 v[80:83], a[144:147], a[104:107], v[80:83]
  s_mov_b32 s40, 2064640
  ds_read_b64_tr_b16 a[160:161], v5 offset:41984
  v_mfma_f32_16x16x32_bf16 v[84:87], a[144:147], a[108:111], v[84:87]
  s_waitcnt lgkmcnt(5)
  ds_read_b64_tr_b16 a[162:163], v5 offset:42496
  v_rcp_f32 v220, v220
  v_mfma_f32_16x16x32_bf16 v[88:91], a[148:151], a[104:107], v[88:91]
  s_mov_b32 s69, 1024
  buffer_load_dwordx4 v11, s[8:11], s40 offen offset:0 lds
  v_mfma_f32_16x16x32_bf16 v[92:95], a[148:151], a[108:111], v[92:95]
  s_waitcnt lgkmcnt(4)
  ds_read_b64_tr_b16 a[164:165], v6 offset:41984
  ds_read_b64_tr_b16 a[166:167], v6 offset:42496
  v_fma_f32 v222, v222, v227, v227
  v_mfma_f32_16x16x32_bf16 v[96:99], a[152:155], a[104:107], v[96:99]
  ds_read_b64_tr_b16 a[168:169], v7 offset:41984
  v_rcp_f32 v221, v221
  v_mfma_f32_16x16x32_bf16 v[100:103], a[152:155], a[108:111], v[100:103]
  s_waitcnt lgkmcnt(5)
  ds_read_b64_tr_b16 a[170:171], v7 offset:42496
  v_mul_f32 v71, v39, v71
  v_mfma_f32_16x16x32_bf16 v[104:107], a[156:159], a[104:107], v[104:107]
  buffer_store_dwordx4 v[148:151], v233, s[76:79], s69 offen sc1
  v_mfma_f32_16x16x32_bf16 v[108:111], a[156:159], a[108:111], v[108:111]
  s_waitcnt lgkmcnt(4)
  ds_read_b64_tr_b16 a[172:173], v8 offset:41984
  ds_read_b64_tr_b16 a[174:175], v8 offset:42496
  v_fma_f32 v223, v223, v227, v227
  v_mfma_f32_16x16x32_bf16 v[112:115], a[160:163], a[104:107], v[112:115]
  ds_read_b64_tr_b16 a[144:145], v5 offset:49152
  v_mfma_f32_16x16x32_bf16 v[116:119], a[160:163], a[108:111], v[116:119]
  s_waitcnt lgkmcnt(5)
  ds_read_b64_tr_b16 a[146:147], v5 offset:49664
  v_rcp_f32 v222, v222
  v_mfma_f32_16x16x32_bf16 v[120:123], a[164:167], a[104:107], v[120:123]
  buffer_load_dwordx4 v11, s[52:55], s40 offen offset:1024 lds
  v_mfma_f32_16x16x32_bf16 v[124:127], a[164:167], a[108:111], v[124:127]
  s_waitcnt lgkmcnt(4)
  ds_read_b64_tr_b16 a[148:149], v6 offset:49152
  ds_read_b64_tr_b16 a[150:151], v6 offset:49664
  v_mul_f32 v68, v68, v220
  v_mfma_f32_16x16x32_bf16 v[128:131], a[168:171], a[104:107], v[128:131]
  s_mov_b32 s40, 2359552
  ds_read_b64_tr_b16 a[152:153], v7 offset:49152
  v_rcp_f32 v223, v223
  v_mfma_f32_16x16x32_bf16 v[132:135], a[168:171], a[108:111], v[132:135]
  s_waitcnt lgkmcnt(5)
  ds_read_b64_tr_b16 a[154:155], v7 offset:49664
  v_mul_f32 v69, v69, v221
  v_mfma_f32_16x16x32_bf16 v[136:139], a[172:175], a[104:107], v[136:139]
  s_add_u32 m0, s42, 32768
  ds_read_b64_tr_b16 a[156:157], v8 offset:49152
  v_mul_f32 v70, v70, v222
  v_cvt_pk_bf16_f32 v156, v68, v69
  v_mfma_f32_16x16x32_bf16 v[140:143], a[172:175], a[108:111], v[140:143]
  s_waitcnt lgkmcnt(5)
  ds_read_b64_tr_b16 a[158:159], v8 offset:49664
  v_mul_f32 v71, v71, v223
  v_mfma_f32_16x16x32_bf16 v[80:83], a[144:147], a[112:115], v[80:83]
  ds_read_b64_tr_b16 a[160:161], v5 offset:50176
  v_cvt_pk_bf16_f32 v157, v70, v71
  v_mul_f32 v216, v224, v40
  v_mfma_f32_16x16x32_bf16 v[84:87], a[144:147], a[116:119], v[84:87]
  s_waitcnt lgkmcnt(5)
  ds_read_b64_tr_b16 a[162:163], v5 offset:50688
  v_mul_f32 v217, v224, v41
  v_mfma_f32_16x16x32_bf16 v[88:91], a[148:151], a[112:115], v[88:91]
  buffer_load_dwordx4 v11, s[8:11], s40 offen offset:0 lds
  v_mfma_f32_16x16x32_bf16 v[92:95], a[148:151], a[116:119], v[92:95]
  s_waitcnt lgkmcnt(4)
  ds_read_b64_tr_b16 a[164:165], v6 offset:50176
  ds_read_b64_tr_b16 a[166:167], v6 offset:50688
  v_mul_f32 v218, v224, v42
  v_mfma_f32_16x16x32_bf16 v[96:99], a[152:155], a[112:115], v[96:99]
  ds_read_b64_tr_b16 a[168:169], v7 offset:50176
  v_mul_f32 v219, v224, v43
  v_mfma_f32_16x16x32_bf16 v[100:103], a[152:155], a[116:119], v[100:103]
  s_waitcnt lgkmcnt(5)
  ds_read_b64_tr_b16 a[170:171], v7 offset:50688
  v_exp_f32 v216, v216
  v_mfma_f32_16x16x32_bf16 v[104:107], a[156:159], a[112:115], v[104:107]
  ds_read_b64_tr_b16 a[172:173], v8 offset:50176
  v_mul_f32 v72, v40, v72
  v_mfma_f32_16x16x32_bf16 v[108:111], a[156:159], a[116:119], v[108:111]
  s_waitcnt lgkmcnt(5)
  ds_read_b64_tr_b16 a[174:175], v8 offset:50688
  v_exp_f32 v217, v217
  v_mfma_f32_16x16x32_bf16 v[112:115], a[160:163], a[112:115], v[112:115]
  ds_read_b64_tr_b16 a[144:145], v5 offset:57344
  v_mul_f32 v73, v41, v73
  v_mfma_f32_16x16x32_bf16 v[116:119], a[160:163], a[116:119], v[116:119]
  s_waitcnt lgkmcnt(5)
  ds_read_b64_tr_b16 a[146:147], v5 offset:57856
  v_exp_f32 v218, v218
  v_mfma_f32_16x16x32_bf16 v[120:123], a[164:167], a[112:115], v[120:123]
  buffer_load_dwordx4 v11, s[52:55], s40 offen offset:1024 lds
  v_mfma_f32_16x16x32_bf16 v[124:127], a[164:167], a[116:119], v[124:127]
  s_waitcnt lgkmcnt(4)
  ds_read_b64_tr_b16 a[148:149], v6 offset:57344
  ds_read_b64_tr_b16 a[150:151], v6 offset:57856
  v_mfma_f32_16x16x32_bf16 v[128:131], a[168:171], a[112:115], v[128:131]
  s_add_u32 m0, s42, 40960
  ds_read_b64_tr_b16 a[152:153], v7 offset:57344
  v_fma_f32 v216, v216, v225, v225
  v_fma_f32 v217, v217, v225, v225
  v_mfma_f32_16x16x32_bf16 v[132:135], a[168:171], a[116:119], v[132:135]
  s_waitcnt lgkmcnt(5)
  ds_read_b64_tr_b16 a[154:155], v7 offset:57856
  v_mfma_f32_16x16x32_bf16 v[136:139], a[172:175], a[112:115], v[136:139]
  s_waitcnt vmcnt(22) lgkmcnt(4)
  ds_read_b64_tr_b16 a[156:157], v8 offset:57344
  ds_read_b64_tr_b16 a[158:159], v8 offset:57856
  v_mfma_f32_16x16x32_bf16 v[140:143], a[172:175], a[116:119], v[140:143]
  s_barrier
  v_mfma_f32_16x16x32_bf16 v[80:83], a[144:147], a[120:123], v[80:83]
  s_mov_b32 s40, 2654464
  ds_read_b64_tr_b16 a[160:161], v5 offset:58368
  v_exp_f32 v219, v219
  v_mfma_f32_16x16x32_bf16 v[84:87], a[144:147], a[124:127], v[84:87]
  s_waitcnt lgkmcnt(5)
  ds_read_b64_tr_b16 a[162:163], v5 offset:58880
  v_mul_f32 v74, v42, v74
  v_mfma_f32_16x16x32_bf16 v[88:91], a[148:151], a[120:123], v[88:91]
  buffer_load_dwordx4 v11, s[8:11], s40 offen offset:0 lds
  v_mfma_f32_16x16x32_bf16 v[92:95], a[148:151], a[124:127], v[92:95]
  s_waitcnt lgkmcnt(4)
  ds_read_b64_tr_b16 a[164:165], v6 offset:58368
  ds_read_b64_tr_b16 a[166:167], v6 offset:58880
  v_mfma_f32_16x16x32_bf16 v[96:99], a[152:155], a[120:123], v[96:99]
  ds_read_b64_tr_b16 a[168:169], v7 offset:58368
  v_rcp_f32 v216, v216
  v_mfma_f32_16x16x32_bf16 v[100:103], a[152:155], a[124:127], v[100:103]
  s_waitcnt lgkmcnt(5)
  ds_read_b64_tr_b16 a[170:171], v7 offset:58880
  v_fma_f32 v218, v218, v225, v225
  v_mfma_f32_16x16x32_bf16 v[104:107], a[156:159], a[120:123], v[104:107]
  ds_read_b64_tr_b16 a[172:173], v8 offset:58368
  v_rcp_f32 v217, v217
  v_mfma_f32_16x16x32_bf16 v[108:111], a[156:159], a[124:127], v[108:111]
  s_waitcnt lgkmcnt(5)
  ds_read_b64_tr_b16 a[174:175], v8 offset:58880
  v_mul_f32 v75, v43, v75
  v_fma_f32 v219, v219, v225, v225
  v_mfma_f32_16x16x32_bf16 v[112:115], a[160:163], a[120:123], v[112:115]
  ds_read_b64_tr_b16 a[144:145], v1 offset:49152
  v_rcp_f32 v218, v218
  v_mfma_f32_16x16x32_bf16 v[116:119], a[160:163], a[124:127], v[116:119]
  s_waitcnt lgkmcnt(5)
  ds_read_b64_tr_b16 a[146:147], v1 offset:49664
  v_mul_f32 v72, v72, v216
  v_mfma_f32_16x16x32_bf16 v[120:123], a[164:167], a[120:123], v[120:123]
  buffer_load_dwordx4 v11, s[52:55], s40 offen offset:1024 lds
  v_mfma_f32_16x16x32_bf16 v[124:127], a[164:167], a[124:127], v[124:127]
  s_waitcnt lgkmcnt(4)
  ds_read_b64_tr_b16 a[148:149], v2 offset:49152
  ds_read_b64_tr_b16 a[150:151], v2 offset:49664
  v_mfma_f32_16x16x32_bf16 v[128:131], a[168:171], a[120:123], v[128:131]
  s_mov_b32 s40, 2949376
  ds_read_b64_tr_b16 a[152:153], v3 offset:49152
  v_rcp_f32 v219, v219
  v_mfma_f32_16x16x32_bf16 v[132:135], a[168:171], a[124:127], v[132:135]
  s_waitcnt lgkmcnt(5)
  ds_read_b64_tr_b16 a[154:155], v3 offset:49664
  v_mul_f32 v73, v73, v217
  v_mul_f32 v74, v74, v218
  v_mfma_f32_16x16x32_bf16 v[136:139], a[172:175], a[120:123], v[136:139]
  s_add_u32 m0, s42, 98304
  ds_read_b64_tr_b16 a[156:157], v4 offset:49152
  v_cvt_pk_bf16_f32 v154, v72, v73
  v_mul_f32 v75, v75, v219
  v_mfma_f32_16x16x32_bf16 v[140:143], a[172:175], a[124:127], v[140:143]
  s_waitcnt lgkmcnt(5)
  ds_read_b64_tr_b16 a[158:159], v4 offset:49664
  v_cvt_pk_bf16_f32 v155, v74, v75
  v_mul_f32 v220, v226, v44
  v_mfma_f32_16x16x32_bf16 v[80:83], a[144:147], a[128:131], v[80:83]
  ds_read_b64_tr_b16 a[160:161], v1 offset:50176
  v_mul_f32 v221, v226, v45
  v_mfma_f32_16x16x32_bf16 v[84:87], a[144:147], a[132:135], v[84:87]
  s_waitcnt lgkmcnt(5)
  ds_read_b64_tr_b16 a[162:163], v1 offset:50688
  v_mul_f32 v222, v226, v46
  v_mul_f32 v223, v226, v47
  v_mfma_f32_16x16x32_bf16 v[88:91], a[148:151], a[128:131], v[88:91]
  buffer_load_dwordx4 v11, s[8:11], s40 offen offset:0 lds
  v_mfma_f32_16x16x32_bf16 v[92:95], a[148:151], a[132:135], v[92:95]
  s_waitcnt lgkmcnt(4)
  ds_read_b64_tr_b16 a[164:165], v2 offset:50176
  ds_read_b64_tr_b16 a[166:167], v2 offset:50688
  v_mfma_f32_16x16x32_bf16 v[96:99], a[152:155], a[128:131], v[96:99]
  ds_read_b64_tr_b16 a[168:169], v3 offset:50176
  v_exp_f32 v220, v220
  v_mfma_f32_16x16x32_bf16 v[100:103], a[152:155], a[132:135], v[100:103]
  s_waitcnt lgkmcnt(5)
  ds_read_b64_tr_b16 a[170:171], v3 offset:50688
  v_mul_f32 v76, v44, v76
  v_mfma_f32_16x16x32_bf16 v[104:107], a[156:159], a[128:131], v[104:107]
  ds_read_b64_tr_b16 a[172:173], v4 offset:50176
  v_exp_f32 v221, v221
  v_mfma_f32_16x16x32_bf16 v[108:111], a[156:159], a[132:135], v[108:111]
  s_waitcnt lgkmcnt(5)
  ds_read_b64_tr_b16 a[174:175], v4 offset:50688
  v_mul_f32 v77, v45, v77
  v_mfma_f32_16x16x32_bf16 v[112:115], a[160:163], a[128:131], v[112:115]
  ds_read_b64_tr_b16 a[144:145], v1 offset:57344
  v_exp_f32 v222, v222
  v_mfma_f32_16x16x32_bf16 v[116:119], a[160:163], a[132:135], v[116:119]
  s_waitcnt lgkmcnt(5)
  ds_read_b64_tr_b16 a[146:147], v1 offset:57856
  v_fma_f32 v220, v220, v227, v227
  v_mfma_f32_16x16x32_bf16 v[120:123], a[164:167], a[128:131], v[120:123]
  buffer_load_dwordx4 v11, s[52:55], s40 offen offset:1024 lds
  v_mfma_f32_16x16x32_bf16 v[124:127], a[164:167], a[132:135], v[124:127]
  s_waitcnt lgkmcnt(4)
  ds_read_b64_tr_b16 a[148:149], v2 offset:57344
  ds_read_b64_tr_b16 a[150:151], v2 offset:57856
  v_fma_f32 v221, v221, v227, v227
  v_mfma_f32_16x16x32_bf16 v[128:131], a[168:171], a[128:131], v[128:131]
  s_mov_b32 s40, 3244288
  ds_read_b64_tr_b16 a[152:153], v3 offset:57344
  v_mfma_f32_16x16x32_bf16 v[132:135], a[168:171], a[132:135], v[132:135]
  s_waitcnt lgkmcnt(5)
  ds_read_b64_tr_b16 a[154:155], v3 offset:57856
  v_exp_f32 v223, v223
  v_mfma_f32_16x16x32_bf16 v[136:139], a[172:175], a[128:131], v[136:139]
  s_add_u32 m0, s42, 106496
  ds_read_b64_tr_b16 a[156:157], v4 offset:57344
  v_mul_f32 v78, v46, v78
  v_mfma_f32_16x16x32_bf16 v[140:143], a[172:175], a[132:135], v[140:143]
  s_waitcnt lgkmcnt(5)
  ds_read_b64_tr_b16 a[158:159], v4 offset:57856
  v_rcp_f32 v220, v220
  v_mfma_f32_16x16x32_bf16 v[80:83], a[144:147], a[136:139], v[80:83]
  ds_read_b64_tr_b16 a[160:161], v1 offset:58368
  v_fma_f32 v222, v222, v227, v227
  v_mfma_f32_16x16x32_bf16 v[84:87], a[144:147], a[140:143], v[84:87]
  s_waitcnt lgkmcnt(5)
  ds_read_b64_tr_b16 a[162:163], v1 offset:58880
  v_rcp_f32 v221, v221
  v_mfma_f32_16x16x32_bf16 v[88:91], a[148:151], a[136:139], v[88:91]
  buffer_load_dwordx4 v11, s[8:11], s40 offen offset:0 lds
  v_mfma_f32_16x16x32_bf16 v[92:95], a[148:151], a[140:143], v[92:95]
  s_waitcnt lgkmcnt(4)
  ds_read_b64_tr_b16 a[164:165], v2 offset:58368
  ds_read_b64_tr_b16 a[166:167], v2 offset:58880
  v_mul_f32 v79, v47, v79
  v_mfma_f32_16x16x32_bf16 v[96:99], a[152:155], a[136:139], v[96:99]
  ds_read_b64_tr_b16 a[168:169], v3 offset:58368
  v_fma_f32 v223, v223, v227, v227
  v_mfma_f32_16x16x32_bf16 v[100:103], a[152:155], a[140:143], v[100:103]
  s_waitcnt lgkmcnt(5)
  ds_read_b64_tr_b16 a[170:171], v3 offset:58880
  v_rcp_f32 v222, v222
  v_mfma_f32_16x16x32_bf16 v[104:107], a[156:159], a[136:139], v[104:107]
  ds_read_b64_tr_b16 a[172:173], v4 offset:58368
  v_mul_f32 v76, v76, v220
  v_mfma_f32_16x16x32_bf16 v[108:111], a[156:159], a[140:143], v[108:111]
  s_waitcnt lgkmcnt(5)
  ds_read_b64_tr_b16 a[174:175], v4 offset:58880
  v_rcp_f32 v223, v223
  v_mfma_f32_16x16x32_bf16 v[112:115], a[160:163], a[136:139], v[112:115]
  ds_read_b64_tr_b16 a[144:145], v5 offset:0
  v_mul_f32 v77, v77, v221
  v_mul_f32 v78, v78, v222
  v_mfma_f32_16x16x32_bf16 v[116:119], a[160:163], a[140:143], v[116:119]
  s_waitcnt lgkmcnt(5)
  ds_read_b64_tr_b16 a[146:147], v5 offset:512
  v_cvt_pk_bf16_f32 v158, v76, v77
  v_mfma_f32_16x16x32_bf16 v[120:123], a[164:167], a[136:139], v[120:123]
  buffer_load_dwordx4 v11, s[52:55], s40 offen offset:1024 lds
  v_mfma_f32_16x16x32_bf16 v[124:127], a[164:167], a[140:143], v[124:127]
  s_waitcnt lgkmcnt(4)
  v_mul_f32 v79, v79, v223
  v_cvt_pk_bf16_f32 v159, v78, v79
  v_mfma_f32_16x16x32_bf16 v[128:131], a[168:171], a[136:139], v[128:131]
  s_add_u32 m0, s42, 114688
  ds_read_b64_tr_b16 a[148:149], v6 offset:0
  v_mfma_f32_16x16x32_bf16 v[132:135], a[168:171], a[140:143], v[132:135]
  s_waitcnt lgkmcnt(3)
  ds_read_b64_tr_b16 a[150:151], v6 offset:512
  v_mfma_f32_16x16x32_bf16 v[136:139], a[172:175], a[136:139], v[136:139]
  s_waitcnt vmcnt(18)
  ds_read_b64_tr_b16 a[152:153], v7 offset:0
  v_mfma_f32_16x16x32_bf16 v[140:143], a[172:175], a[140:143], v[140:143]
  s_barrier
  v_mfma_f32_16x16x16_bf16 v[80:83], a[176:177], a[192:193], v[80:83]
  s_mov_b32 s40, 3539200
  ds_read_b64_tr_b16 a[154:155], v7 offset:512
  v_mfma_f32_16x16x16_bf16 v[112:115], a[184:185], a[192:193], v[112:115]
  ds_read_b64_tr_b16 a[156:157], v8 offset:0
  v_mfma_f32_16x16x16_bf16 v[88:91], a[178:179], a[192:193], v[88:91]
  buffer_load_dwordx4 v11, s[8:11], s40 offen offset:0 lds
  v_mfma_f32_16x16x16_bf16 v[120:123], a[186:187], a[192:193], v[120:123]
  s_mov_b32 s69, 2048
  ds_read_b64_tr_b16 a[158:159], v8 offset:512
  v_mfma_f32_16x16x16_bf16 v[96:99], a[180:181], a[192:193], v[96:99]
  ds_read_b64_tr_b16 a[160:161], v5 offset:1024
  v_mul_f32 v216, v224, v80
  v_mfma_f32_16x16x16_bf16 v[128:131], a[188:189], a[192:193], v[128:131]
  ds_read_b64_tr_b16 a[162:163], v5 offset:1536
  v_mul_f32 v217, v224, v81
  v_mfma_f32_16x16x16_bf16 v[104:107], a[182:183], a[192:193], v[104:107]
  buffer_store_dwordx4 v[152:155], v233, s[76:79], s69 offen sc1
  v_mfma_f32_16x16x16_bf16 v[136:139], a[190:191], a[192:193], v[136:139]
  ds_read_b64_tr_b16 a[164:165], v6 offset:1024
  v_mul_f32 v218, v224, v82
  v_mfma_f32_16x16x16_bf16 v[84:87], a[176:177], a[194:195], v[84:87]
  ds_read_b64_tr_b16 a[166:167], v6 offset:1536
  v_mul_f32 v219, v224, v83
  v_mfma_f32_16x16x16_bf16 v[116:119], a[184:185], a[194:195], v[116:119]
  ds_read_b64_tr_b16 a[168:169], v7 offset:1024
  v_exp_f32 v216, v216
  v_mfma_f32_16x16x16_bf16 v[92:95], a[178:179], a[194:195], v[92:95]
  buffer_load_dwordx4 v11, s[52:55], s40 offen offset:1024 lds
  v_mfma_f32_16x16x16_bf16 v[124:127], a[186:187], a[194:195], v[124:127]
  s_mov_b32 s69, 3072
  ds_read_b64_tr_b16 a[170:171], v7 offset:1536
  v_mul_f32 v112, v80, v112
  v_mfma_f32_16x16x16_bf16 v[100:103], a[180:181], a[194:195], v[100:103]
  ds_read_b64_tr_b16 a[172:173], v8 offset:1024
  v_exp_f32 v217, v217
  v_mfma_f32_16x16x16_bf16 v[132:135], a[188:189], a[194:195], v[132:135]
  s_mov_b32 s40, 3834112
  ds_read_b64_tr_b16 a[174:175], v8 offset:1536
  v_mul_f32 v113, v81, v113
  v_mfma_f32_16x16x16_bf16 v[108:111], a[182:183], a[194:195], v[108:111]
  s_add_u32 m0, s42, 122880
  buffer_store_dwordx4 v[156:159], v233, s[76:79], s69 offen sc1
  v_mfma_f32_16x16x16_bf16 v[140:143], a[190:191], a[194:195], v[140:143]
  s_waitcnt lgkmcnt(3)
  v_exp_f32 v218, v218
  v_fma_f32 v216, v216, v225, v225
  v_mfma_f32_16x16x32_bf16 v[16:19], a[144:147], a[0:3], 0
  v_fma_f32 v217, v217, v225, v225
  v_mfma_f32_16x16x32_bf16 v[20:23], a[144:147], a[4:7], 0
  ds_read_b64_tr_b16 a[144:145], v5 offset:8192
  v_exp_f32 v219, v219
  v_mfma_f32_16x16x32_bf16 v[24:27], a[148:151], a[0:3], 0
  buffer_load_dwordx4 v11, s[8:11], s40 offen offset:0 lds
  v_mfma_f32_16x16x32_bf16 v[28:31], a[148:151], a[4:7], 0
  ds_read_b64_tr_b16 a[146:147], v5 offset:8704
  v_mul_f32 v114, v82, v114
  v_mfma_f32_16x16x32_bf16 v[32:35], a[152:155], a[0:3], 0
  ds_read_b64_tr_b16 a[148:149], v6 offset:8192
  v_rcp_f32 v216, v216
  v_mfma_f32_16x16x32_bf16 v[36:39], a[152:155], a[4:7], 0
L3_pad3:
  s_cmp_lg_u32 s82, 0
  s_cbranch_scc1 L3_pad7
  ds_read_b64_tr_b16 a[150:151], v6 offset:8704
  v_fma_f32 v218, v218, v225, v225
  v_mfma_f32_16x16x32_bf16 v[40:43], a[156:159], a[0:3], 0
  ds_read_b64_tr_b16 a[152:153], v7 offset:8192
  v_rcp_f32 v217, v217
  v_mfma_f32_16x16x32_bf16 v[44:47], a[156:159], a[4:7], 0
  ds_read_b64_tr_b16 a[154:155], v7 offset:8704
  v_mul_f32 v115, v83, v115
  v_mfma_f32_16x16x32_bf16 v[48:51], a[160:163], a[0:3], 0
  ds_read_b64_tr_b16 a[156:157], v8 offset:8192
  v_fma_f32 v219, v219, v225, v225
  v_mfma_f32_16x16x32_bf16 v[52:55], a[160:163], a[4:7], 0
  ds_read_b64_tr_b16 a[158:159], v8 offset:8704
  v_rcp_f32 v218, v218
  v_mfma_f32_16x16x32_bf16 v[56:59], a[164:167], a[0:3], 0
  buffer_load_dwordx4 v11, s[52:55], s40 offen offset:1024 lds
  v_mfma_f32_16x16x32_bf16 v[60:63], a[164:167], a[4:7], 0
  s_waitcnt lgkmcnt(4)
  ds_read_b64_tr_b16 a[160:161], v5 offset:9216
  v_mul_f32 v112, v112, v216
  v_mfma_f32_16x16x32_bf16 v[64:67], a[168:171], a[0:3], 0
  ds_read_b64_tr_b16 a[162:163], v5 offset:9728
  v_mfma_f32_16x16x32_bf16 v[68:71], a[168:171], a[4:7], 0
  ds_read_b64_tr_b16 a[164:165], v6 offset:9216
  v_rcp_f32 v219, v219
  v_mfma_f32_16x16x32_bf16 v[72:75], a[172:175], a[0:3], 0
  s_add_u32 m0, s42, 49152
  ds_read_b64_tr_b16 a[166:167], v6 offset:9728
  v_mul_f32 v113, v113, v217
  v_mul_f32 v114, v114, v218
  v_mfma_f32_16x16x32_bf16 v[76:79], a[172:175], a[4:7], 0
  s_mov_b32 s40, 4129024
  ds_read_b64_tr_b16 a[168:169], v7 offset:9216
  v_cvt_pk_bf16_f32 v160, v112, v113
  v_mfma_f32_16x16x32_bf16 v[16:19], a[144:147], a[8:11], v[16:19]
  ds_read_b64_tr_b16 a[170:171], v7 offset:9728
  v_mul_f32 v115, v115, v219
  v_mfma_f32_16x16x32_bf16 v[20:23], a[144:147], a[12:15], v[20:23]
  ds_read_b64_tr_b16 a[172:173], v8 offset:9216
  v_cvt_pk_bf16_f32 v161, v114, v115
  v_mul_f32 v220, v226, v84
  v_mfma_f32_16x16x32_bf16 v[24:27], a[148:151], a[8:11], v[24:27]
  buffer_load_dwordx4 v11, s[8:11], s40 offen offset:0 lds
  v_mfma_f32_16x16x32_bf16 v[28:31], a[148:151], a[12:15], v[28:31]
  s_waitcnt lgkmcnt(4)
  ds_read_b64_tr_b16 a[174:175], v8 offset:9728
  v_mul_f32 v221, v226, v85
  v_mfma_f32_16x16x32_bf16 v[32:35], a[152:155], a[8:11], v[32:35]
  ds_read_b64_tr_b16 a[144:145], v5 offset:16384
  v_mul_f32 v222, v226, v86
  v_mfma_f32_16x16x32_bf16 v[36:39], a[152:155], a[12:15], v[36:39]
  ds_read_b64_tr_b16 a[146:147], v5 offset:16896
  v_mul_f32 v223, v226, v87
  v_mfma_f32_16x16x32_bf16 v[40:43], a[156:159], a[8:11], v[40:43]
  ds_read_b64_tr_b16 a[148:149], v6 offset:16384
  v_exp_f32 v220, v220
  v_mfma_f32_16x16x32_bf16 v[44:47], a[156:159], a[12:15], v[44:47]
  ds_read_b64_tr_b16 a[150:151], v6 offset:16896
  v_mul_f32 v116, v84, v116
  v_mfma_f32_16x16x32_bf16 v[48:51], a[160:163], a[8:11], v[48:51]
  ds_read_b64_tr_b16 a[152:153], v7 offset:16384
  v_mfma_f32_16x16x32_bf16 v[52:55], a[160:163], a[12:15], v[52:55]
  s_waitcnt lgkmcnt(5)
  ds_read_b64_tr_b16 a[154:155], v7 offset:16896
  v_exp_f32 v221, v221
  v_mfma_f32_16x16x32_bf16 v[56:59], a[164:167], a[8:11], v[56:59]
  buffer_load_dwordx4 v11, s[52:55], s40 offen offset:1024 lds
  v_mfma_f32_16x16x32_bf16 v[60:63], a[164:167], a[12:15], v[60:63]
  s_add_u32 s68, s66, 1024
  ds_read_b64_tr_b16 a[156:157], v8 offset:16384
  v_mul_f32 v117, v85, v117
  v_mfma_f32_16x16x32_bf16 v[64:67], a[168:171], a[8:11], v[64:67]
  ds_read_b64_tr_b16 a[158:159], v8 offset:16896
  v_exp_f32 v222, v222
  v_mfma_f32_16x16x32_bf16 v[68:71], a[168:171], a[12:15], v[68:71]
  s_mov_b32 s40, 4423936
  ds_read_b64_tr_b16 a[160:161], v5 offset:17408
  v_fma_f32 v220, v220, v227, v227
  v_fma_f32 v221, v221, v227, v227
  v_mfma_f32_16x16x32_bf16 v[72:75], a[172:175], a[8:11], v[72:75]
  s_add_u32 m0, s42, 57344
  buffer_load_dwordx2 a[176:177], v232, s[20:23], s68 offen offset:0 sc1
  v_mfma_f32_16x16x32_bf16 v[76:79], a[172:175], a[12:15], v[76:79]
  s_waitcnt lgkmcnt(3)
  ds_read_b64_tr_b16 a[162:163], v5 offset:17920
  v_mfma_f32_16x16x32_bf16 v[16:19], a[144:147], a[16:19], v[16:19]
  ds_read_b64_tr_b16 a[164:165], v6 offset:17408
  v_exp_f32 v223, v223
  v_mfma_f32_16x16x32_bf16 v[20:23], a[144:147], a[20:23], v[20:23]
  ds_read_b64_tr_b16 a[166:167], v6 offset:17920
  v_mul_f32 v118, v86, v118
  v_mfma_f32_16x16x32_bf16 v[24:27], a[148:151], a[16:19], v[24:27]
  buffer_load_dwordx4 v11, s[8:11], s40 offen offset:0 lds
  v_mfma_f32_16x16x32_bf16 v[28:31], a[148:151], a[20:23], v[28:31]
  ds_read_b64_tr_b16 a[168:169], v7 offset:17408
  v_rcp_f32 v220, v220
  v_mfma_f32_16x16x32_bf16 v[32:35], a[152:155], a[16:19], v[32:35]
  ds_read_b64_tr_b16 a[170:171], v7 offset:17920
  v_fma_f32 v222, v222, v227, v227
  v_mfma_f32_16x16x32_bf16 v[36:39], a[152:155], a[20:23], v[36:39]
  s_waitcnt lgkmcnt(4)
  ds_read_b64_tr_b16 a[172:173], v8 offset:17408
  v_mfma_f32_16x16x32_bf16 v[40:43], a[156:159], a[16:19], v[40:43]
  buffer_load_dwordx2 a[178:179], v232, s[20:23], s68 offen offset:128 sc1
  v_mfma_f32_16x16x32_bf16 v[44:47], a[156:159], a[20:23], v[44:47]
  ds_read_b64_tr_b16 a[174:175], v8 offset:17920
  v_rcp_f32 v221, v221
  v_mfma_f32_16x16x32_bf16 v[48:51], a[160:163], a[16:19], v[48:51]
  ds_read_b64_tr_b16 a[144:145], v5 offset:24576
  v_mul_f32 v119, v87, v119
  v_fma_f32 v223, v223, v227, v227
  v_mfma_f32_16x16x32_bf16 v[52:55], a[160:163], a[20:23], v[52:55]
  s_waitcnt lgkmcnt(4)
  ds_read_b64_tr_b16 a[146:147], v5 offset:25088
  v_mfma_f32_16x16x32_bf16 v[56:59], a[164:167], a[16:19], v[56:59]
  buffer_load_dwordx4 v11, s[52:55], s40 offen offset:1024 lds
  v_mfma_f32_16x16x32_bf16 v[60:63], a[164:167], a[20:23], v[60:63]
  s_waitcnt lgkmcnt(3)
  ds_read_b64_tr_b16 a[148:149], v6 offset:24576
  ds_read_b64_tr_b16 a[150:151], v6 offset:25088
  v_mfma_f32_16x16x32_bf16 v[64:67], a[168:171], a[16:19], v[64:67]
  s_add_u32 m0, s42, 65536
  ds_read_b64_tr_b16 a[152:153], v7 offset:24576
  ds_read_b64_tr_b16 a[154:155], v7 offset:25088
  v_mfma_f32_16x16x32_bf16 v[68:71], a[168:171], a[20:23], v[68:71]
  s_waitcnt lgkmcnt(6)
  ds_read_b64_tr_b16 a[156:157], v8 offset:24576
  ds_read_b64_tr_b16 a[158:159], v8 offset:25088
  v_mfma_f32_16x16x32_bf16 v[72:75], a[172:175], a[16:19], v[72:75]
  s_waitcnt vmcnt(24) lgkmcnt(6)
  buffer_load_dwordx2 a[180:181], v232, s[20:23], s68 offen offset:256 sc1
  v_mfma_f32_16x16x32_bf16 v[76:79], a[172:175], a[20:23], v[76:79]
  s_barrier
  v_mfma_f32_16x16x32_bf16 v[16:19], a[144:147], a[24:27], v[16:19]
  s_mov_b32 s40, 4718848
  ds_read_b64_tr_b16 a[160:161], v5 offset:25600
  v_rcp_f32 v222, v222
  v_mfma_f32_16x16x32_bf16 v[20:23], a[144:147], a[28:31], v[20:23]
  s_waitcnt lgkmcnt(5)
  ds_read_b64_tr_b16 a[162:163], v5 offset:26112
  v_mul_f32 v116, v116, v220
  v_mfma_f32_16x16x32_bf16 v[24:27], a[148:151], a[24:27], v[24:27]
  buffer_load_dwordx4 v11, s[8:11], s40 offen offset:0 lds
  v_mfma_f32_16x16x32_bf16 v[28:31], a[148:151], a[28:31], v[28:31]
  s_waitcnt lgkmcnt(2)
  ds_read_b64_tr_b16 a[164:165], v6 offset:25600
  ds_read_b64_tr_b16 a[166:167], v6 offset:26112
  v_mfma_f32_16x16x32_bf16 v[32:35], a[152:155], a[24:27], v[32:35]
  ds_read_b64_tr_b16 a[168:169], v7 offset:25600
  v_rcp_f32 v223, v223
  v_mfma_f32_16x16x32_bf16 v[36:39], a[152:155], a[28:31], v[36:39]
  ds_read_b64_tr_b16 a[170:171], v7 offset:26112
  v_mul_f32 v117, v117, v221
  v_mul_f32 v118, v118, v222
  v_mfma_f32_16x16x32_bf16 v[40:43], a[156:159], a[24:27], v[40:43]
  buffer_load_dwordx2 a[182:183], v232, s[20:23], s68 offen offset:384 sc1
  v_mfma_f32_16x16x32_bf16 v[44:47], a[156:159], a[28:31], v[44:47]
  s_waitcnt lgkmcnt(4)
  ds_read_b64_tr_b16 a[172:173], v8 offset:25600
  ds_read_b64_tr_b16 a[174:175], v8 offset:26112
  v_cvt_pk_bf16_f32 v164, v116, v117
  v_mfma_f32_16x16x32_bf16 v[48:51], a[160:163], a[24:27], v[48:51]
  ds_read_b64_tr_b16 a[144:145], v1 offset:0
  v_mul_f32 v119, v119, v223
  v_mfma_f32_16x16x32_bf16 v[52:55], a[160:163], a[28:31], v[52:55]
  s_waitcnt lgkmcnt(5)
  ds_read_b64_tr_b16 a[146:147], v1 offset:512
  v_cvt_pk_bf16_f32 v165, v118, v119
  v_mfma_f32_16x16x32_bf16 v[56:59], a[164:167], a[24:27], v[56:59]
  s_add_u32 s68, s66, 37888
  buffer_load_dwordx4 v11, s[52:55], s40 offen offset:1024 lds
  v_mfma_f32_16x16x32_bf16 v[60:63], a[164:167], a[28:31], v[60:63]
  s_waitcnt lgkmcnt(4)
  ds_read_b64_tr_b16 a[148:149], v2 offset:0
  ds_read_b64_tr_b16 a[150:151], v2 offset:512
  v_mul_f32 v216, v224, v88
  v_mfma_f32_16x16x32_bf16 v[64:67], a[168:171], a[24:27], v[64:67]
  ds_read_b64_tr_b16 a[152:153], v3 offset:0
  v_mul_f32 v217, v224, v89
  v_mfma_f32_16x16x32_bf16 v[68:71], a[168:171], a[28:31], v[68:71]
  s_waitcnt lgkmcnt(5)
  ds_read_b64_tr_b16 a[154:155], v3 offset:512
  v_mul_f32 v218, v224, v90
  v_mfma_f32_16x16x32_bf16 v[72:75], a[172:175], a[24:27], v[72:75]
  s_add_u32 m0, s42, 73728
  buffer_load_dwordx2 a[184:185], v232, s[20:23], s68 offen offset:0 sc1
  v_mfma_f32_16x16x32_bf16 v[76:79], a[172:175], a[28:31], v[76:79]
  s_waitcnt lgkmcnt(4)
  ds_read_b64_tr_b16 a[156:157], v4 offset:0
  ds_read_b64_tr_b16 a[158:159], v4 offset:512
  v_mul_f32 v219, v224, v91
  v_mfma_f32_16x16x32_bf16 v[16:19], a[144:147], a[32:35], v[16:19]
  s_mov_b32 s40, 5013760
  ds_read_b64_tr_b16 a[160:161], v1 offset:1024
  v_xor_b32 v248, 32, v240
  v_mfma_f32_16x16x32_bf16 v[20:23], a[144:147], a[36:39], v[20:23]
  s_waitcnt lgkmcnt(5)
  ds_read_b64_tr_b16 a[162:163], v1 offset:1536
  v_exp_f32 v216, v216
  v_mfma_f32_16x16x32_bf16 v[24:27], a[148:151], a[32:35], v[24:27]
  buffer_load_dwordx4 v11, s[8:11], s40 offen offset:0 lds
  v_mfma_f32_16x16x32_bf16 v[28:31], a[148:151], a[36:39], v[28:31]
  s_waitcnt lgkmcnt(4)
  ds_read_b64_tr_b16 a[164:165], v2 offset:1024
  ds_read_b64_tr_b16 a[166:167], v2 offset:1536
  v_mfma_f32_16x16x32_bf16 v[32:35], a[152:155], a[32:35], v[32:35]
  ds_read_b64_tr_b16 a[168:169], v3 offset:1024
  v_mul_f32 v120, v88, v120
  v_mfma_f32_16x16x32_bf16 v[36:39], a[152:155], a[36:39], v[36:39]
  s_waitcnt lgkmcnt(5)
  ds_read_b64_tr_b16 a[170:171], v3 offset:1536
  v_exp_f32 v217, v217
  v_mfma_f32_16x16x32_bf16 v[40:43], a[156:159], a[32:35], v[40:43]
  buffer_load_dwordx2 a[186:187], v232, s[20:23], s68 offen offset:128 sc1
  v_mfma_f32_16x16x32_bf16 v[44:47], a[156:159], a[36:39], v[44:47]
  s_waitcnt lgkmcnt(4)
  ds_read_b64_tr_b16 a[172:173], v4 offset:1024
  ds_read_b64_tr_b16 a[174:175], v4 offset:1536
  v_mfma_f32_16x16x32_bf16 v[48:51], a[160:163], a[32:35], v[48:51]
  ds_read_b64_tr_b16 a[144:145], v1 offset:8192
  v_mul_f32 v121, v89, v121
  v_mfma_f32_16x16x32_bf16 v[52:55], a[160:163], a[36:39], v[52:55]
  s_waitcnt lgkmcnt(5)
  ds_read_b64_tr_b16 a[146:147], v1 offset:8704
  v_exp_f32 v218, v218
  v_mfma_f32_16x16x32_bf16 v[56:59], a[164:167], a[32:35], v[56:59]
  buffer_load_dwordx4 v11, s[52:55], s40 offen offset:1024 lds
  v_mfma_f32_16x16x32_bf16 v[60:63], a[164:167], a[36:39], v[60:63]
  s_waitcnt lgkmcnt(4)
  ds_read_b64_tr_b16 a[148:149], v2 offset:8192
  ds_read_b64_tr_b16 a[150:151], v2 offset:8704
  v_mfma_f32_16x16x32_bf16 v[64:67], a[168:171], a[32:35], v[64:67]
  ds_read_b64_tr_b16 a[152:153], v3 offset:8192
  v_fma_f32 v216, v216, v225, v225
  v_mfma_f32_16x16x32_bf16 v[68:71], a[168:171], a[36:39], v[68:71]
  s_waitcnt lgkmcnt(5)
  ds_read_b64_tr_b16 a[154:155], v3 offset:8704
  v_fma_f32 v217, v217, v225, v225
  v_mfma_f32_16x16x32_bf16 v[72:75], a[172:175], a[32:35], v[72:75]
  s_add_u32 m0, s42, 81920
  buffer_load_dwordx2 a[188:189], v232, s[20:23], s68 offen offset:256 sc1
  v_mfma_f32_16x16x32_bf16 v[76:79], a[172:175], a[36:39], v[76:79]
  s_waitcnt lgkmcnt(4)
  ds_read_b64_tr_b16 a[156:157], v4 offset:8192
  ds_read_b64_tr_b16 a[158:159], v4 offset:8704
  v_mfma_f32_16x16x32_bf16 v[16:19], a[144:147], a[40:43], v[16:19]
  s_mov_b32 s40, 384
  ds_read_b64_tr_b16 a[160:161], v1 offset:9216
  v_exp_f32 v219, v219
  v_mfma_f32_16x16x32_bf16 v[20:23], a[144:147], a[44:47], v[20:23]
  s_waitcnt lgkmcnt(5)
  ds_read_b64_tr_b16 a[162:163], v1 offset:9728
  v_mul_f32 v122, v90, v122
  v_mfma_f32_16x16x32_bf16 v[24:27], a[148:151], a[40:43], v[24:27]
  buffer_load_dwordx4 v11, s[8:11], s40 offen offset:0 lds
  v_mfma_f32_16x16x32_bf16 v[28:31], a[148:151], a[44:47], v[28:31]
  s_waitcnt lgkmcnt(4)
  ds_read_b64_tr_b16 a[164:165], v2 offset:9216
  ds_read_b64_tr_b16 a[166:167], v2 offset:9728
  v_mfma_f32_16x16x32_bf16 v[32:35], a[152:155], a[40:43], v[32:35]
  ds_read_b64_tr_b16 a[168:169], v3 offset:9216
  v_rcp_f32 v216, v216
  v_mfma_f32_16x16x32_bf16 v[36:39], a[152:155], a[44:47], v[36:39]
  s_waitcnt lgkmcnt(5)
  ds_read_b64_tr_b16 a[170:171], v3 offset:9728
  v_fma_f32 v218, v218, v225, v225
  v_mfma_f32_16x16x32_bf16 v[40:43], a[156:159], a[40:43], v[40:43]
  buffer_load_dwordx2 a[190:191], v232, s[20:23], s68 offen offset:384 sc1
  v_mfma_f32_16x16x32_bf16 v[44:47], a[156:159], a[44:47], v[44:47]
  s_waitcnt lgkmcnt(4)
  ds_read_b64_tr_b16 a[172:173], v4 offset:9216
  ds_read_b64_tr_b16 a[174:175], v4 offset:9728
  v_mfma_f32_16x16x32_bf16 v[48:51], a[160:163], a[40:43], v[48:51]
  ds_read_b64_tr_b16 a[144:145], v1 offset:16384
  v_rcp_f32 v217, v217
  v_mfma_f32_16x16x32_bf16 v[52:55], a[160:163], a[44:47], v[52:55]
  s_waitcnt lgkmcnt(5)
  ds_read_b64_tr_b16 a[146:147], v1 offset:16896
  v_mul_f32 v123, v91, v123
  v_mfma_f32_16x16x32_bf16 v[56:59], a[164:167], a[40:43], v[56:59]
  buffer_load_dwordx4 v11, s[52:55], s40 offen offset:1024 lds
  v_mfma_f32_16x16x32_bf16 v[60:63], a[164:167], a[44:47], v[60:63]
  s_waitcnt lgkmcnt(4)
  ds_read_b64_tr_b16 a[148:149], v2 offset:16384
  ds_read_b64_tr_b16 a[150:151], v2 offset:16896
  v_fma_f32 v219, v219, v225, v225
  v_mfma_f32_16x16x32_bf16 v[64:67], a[168:171], a[40:43], v[64:67]
  s_add_u32 m0, s42, 90112
  ds_read_b64_tr_b16 a[152:153], v3 offset:16384
  v_readfirstlane_b32 s81, v248
  v_mfma_f32_16x16x32_bf16 v[68:71], a[168:171], a[44:47], v[68:71]
  s_waitcnt lgkmcnt(5)
  ds_read_b64_tr_b16 a[154:155], v3 offset:16896
  v_rcp_f32 v218, v218
  v_mfma_f32_16x16x32_bf16 v[72:75], a[172:175], a[40:43], v[72:75]
  s_waitcnt vmcnt(28) lgkmcnt(4)
  ds_read_b64_tr_b16 a[156:157], v4 offset:16384
  ds_read_b64_tr_b16 a[158:159], v4 offset:16896
  v_mul_f32 v120, v120, v216
  v_mfma_f32_16x16x32_bf16 v[76:79], a[172:175], a[44:47], v[76:79]
  s_barrier
  v_mfma_f32_16x16x32_bf16 v[16:19], a[144:147], a[48:51], v[16:19]
  s_mov_b32 s40, 295296
  ds_read_b64_tr_b16 a[160:161], v1 offset:17408
  v_mov_b32 v248, s81
  v_mfma_f32_16x16x32_bf16 v[20:23], a[144:147], a[52:55], v[20:23]
  s_waitcnt lgkmcnt(5)
  ds_read_b64_tr_b16 a[162:163], v1 offset:17920
  v_rcp_f32 v219, v219
  v_mfma_f32_16x16x32_bf16 v[24:27], a[148:151], a[48:51], v[24:27]
  buffer_load_dwordx4 v11, s[8:11], s40 offen offset:0 lds
  v_mfma_f32_16x16x32_bf16 v[28:31], a[148:151], a[52:55], v[28:31]
  s_waitcnt lgkmcnt(4)
  ds_read_b64_tr_b16 a[164:165], v2 offset:17408
  ds_read_b64_tr_b16 a[166:167], v2 offset:17920
  v_mfma_f32_16x16x32_bf16 v[32:35], a[152:155], a[48:51], v[32:35]
  ds_read_b64_tr_b16 a[168:169], v3 offset:17408
  v_mul_f32 v121, v121, v217
  v_mul_f32 v122, v122, v218
  v_mfma_f32_16x16x32_bf16 v[36:39], a[152:155], a[52:55], v[36:39]
  s_waitcnt lgkmcnt(5)
  ds_read_b64_tr_b16 a[170:171], v3 offset:17920
  v_cvt_pk_bf16_f32 v162, v120, v121
  v_mfma_f32_16x16x32_bf16 v[40:43], a[156:159], a[48:51], v[40:43]
  ds_read_b64_tr_b16 a[172:173], v4 offset:17408
  v_mul_f32 v123, v123, v219
  v_mfma_f32_16x16x32_bf16 v[44:47], a[156:159], a[52:55], v[44:47]
  s_waitcnt lgkmcnt(5)
  ds_read_b64_tr_b16 a[174:175], v4 offset:17920
  v_cvt_pk_bf16_f32 v163, v122, v123
  v_mul_f32 v220, v226, v92
  v_mfma_f32_16x16x32_bf16 v[48:51], a[160:163], a[48:51], v[48:51]
  ds_read_b64_tr_b16 a[144:145], v1 offset:24576
  v_mul_f32 v221, v226, v93
  v_mfma_f32_16x16x32_bf16 v[52:55], a[160:163], a[52:55], v[52:55]
  s_waitcnt lgkmcnt(5)
  ds_read_b64_tr_b16 a[146:147], v1 offset:25088
  v_mul_f32 v222, v226, v94
  v_mfma_f32_16x16x32_bf16 v[56:59], a[164:167], a[48:51], v[56:59]
  buffer_load_dwordx4 v11, s[52:55], s40 offen offset:1024 lds
  v_mfma_f32_16x16x32_bf16 v[60:63], a[164:167], a[52:55], v[60:63]
  s_waitcnt lgkmcnt(4)
  ds_read_b64_tr_b16 a[148:149], v2 offset:24576
  ds_read_b64_tr_b16 a[150:151], v2 offset:25088
  v_mfma_f32_16x16x32_bf16 v[64:67], a[168:171], a[48:51], v[64:67]
  s_mov_b32 s40, 590208
  ds_read_b64_tr_b16 a[152:153], v3 offset:24576
  v_mul_f32 v223, v226, v95
  v_mfma_f32_16x16x32_bf16 v[68:71], a[168:171], a[52:55], v[68:71]
  s_waitcnt lgkmcnt(5)
  ds_read_b64_tr_b16 a[154:155], v3 offset:25088
  v_exp_f32 v220, v220
  v_mfma_f32_16x16x32_bf16 v[72:75], a[172:175], a[48:51], v[72:75]
  s_add_u32 m0, s42, 0
  ds_read_b64_tr_b16 a[156:157], v4 offset:24576
  v_mul_f32 v124, v92, v124
  v_mfma_f32_16x16x32_bf16 v[76:79], a[172:175], a[52:55], v[76:79]
  s_waitcnt lgkmcnt(5)
  ds_read_b64_tr_b16 a[158:159], v4 offset:25088
  v_exp_f32 v221, v221
  v_mfma_f32_16x16x32_bf16 v[16:19], a[144:147], a[56:59], v[16:19]
  ds_read_b64_tr_b16 a[160:161], v1 offset:25600
  v_mul_f32 v125, v93, v125
  v_mfma_f32_16x16x32_bf16 v[20:23], a[144:147], a[60:63], v[20:23]
  s_waitcnt lgkmcnt(5)
  ds_read_b64_tr_b16 a[162:163], v1 offset:26112
  v_mfma_f32_16x16x32_bf16 v[24:27], a[148:151], a[56:59], v[24:27]
  buffer_load_dwordx4 v11, s[8:11], s40 offen offset:0 lds
  v_mfma_f32_16x16x32_bf16 v[28:31], a[148:151], a[60:63], v[28:31]
  s_waitcnt lgkmcnt(4)
  ds_read_b64_tr_b16 a[164:165], v2 offset:25600
  ds_read_b64_tr_b16 a[166:167], v2 offset:26112
  v_mfma_f32_16x16x32_bf16 v[32:35], a[152:155], a[56:59], v[32:35]
  ds_read_b64_tr_b16 a[168:169], v3 offset:25600
  v_exp_f32 v222, v222
  v_mfma_f32_16x16x32_bf16 v[36:39], a[152:155], a[60:63], v[36:39]
  s_waitcnt lgkmcnt(5)
  ds_read_b64_tr_b16 a[170:171], v3 offset:26112
  v_fma_f32 v220, v220, v227, v227
  v_fma_f32 v221, v221, v227, v227
  v_mfma_f32_16x16x32_bf16 v[40:43], a[156:159], a[56:59], v[40:43]
  ds_read_b64_tr_b16 a[172:173], v4 offset:25600
  v_mfma_f32_16x16x32_bf16 v[44:47], a[156:159], a[60:63], v[44:47]
  s_waitcnt lgkmcnt(5)
  ds_read_b64_tr_b16 a[174:175], v4 offset:26112
  v_exp_f32 v223, v223
  v_mfma_f32_16x16x32_bf16 v[48:51], a[160:163], a[56:59], v[48:51]
  ds_read_b64_tr_b16 a[144:145], v1 offset:32768
  v_mul_f32 v126, v94, v126
  v_mfma_f32_16x16x32_bf16 v[52:55], a[160:163], a[60:63], v[52:55]
  s_waitcnt lgkmcnt(5)
  ds_read_b64_tr_b16 a[146:147], v1 offset:33280
  v_rcp_f32 v220, v220
  v_mfma_f32_16x16x32_bf16 v[56:59], a[164:167], a[56:59], v[56:59]
  buffer_load_dwordx4 v11, s[52:55], s40 offen offset:1024 lds
  v_mfma_f32_16x16x32_bf16 v[60:63], a[164:167], a[60:63], v[60:63]
  s_waitcnt lgkmcnt(4)
  ds_read_b64_tr_b16 a[148:149], v2 offset:32768
  ds_read_b64_tr_b16 a[150:151], v2 offset:33280
  v_mfma_f32_16x16x32_bf16 v[64:67], a[168:171], a[56:59], v[64:67]
  s_mov_b32 s40, 885120
  ds_read_b64_tr_b16 a[152:153], v3 offset:32768
  v_fma_f32 v222, v222, v227, v227
  v_mfma_f32_16x16x32_bf16 v[68:71], a[168:171], a[60:63], v[68:71]
  s_waitcnt lgkmcnt(5)
  ds_read_b64_tr_b16 a[154:155], v3 offset:33280
  v_rcp_f32 v221, v221
  v_mfma_f32_16x16x32_bf16 v[72:75], a[172:175], a[56:59], v[72:75]
  s_add_u32 m0, s42, 8192
  ds_read_b64_tr_b16 a[156:157], v4 offset:32768
  v_mul_f32 v127, v95, v127
  v_mfma_f32_16x16x32_bf16 v[76:79], a[172:175], a[60:63], v[76:79]
  s_waitcnt lgkmcnt(5)
  ds_read_b64_tr_b16 a[158:159], v4 offset:33280
  v_fma_f32 v223, v223, v227, v227
  v_mfma_f32_16x16x32_bf16 v[16:19], a[144:147], a[64:67], v[16:19]
  ds_read_b64_tr_b16 a[160:161], v1 offset:33792
  v_rcp_f32 v222, v222
  v_mfma_f32_16x16x32_bf16 v[20:23], a[144:147], a[68:71], v[20:23]
  s_waitcnt lgkmcnt(5)
  ds_read_b64_tr_b16 a[162:163], v1 offset:34304
  v_mul_f32 v124, v124, v220
  v_mfma_f32_16x16x32_bf16 v[24:27], a[148:151], a[64:67], v[24:27]
  buffer_load_dwordx4 v11, s[8:11], s40 offen offset:0 lds
  v_mfma_f32_16x16x32_bf16 v[28:31], a[148:151], a[68:71], v[28:31]
  s_waitcnt lgkmcnt(4)
  ds_read_b64_tr_b16 a[164:165], v2 offset:33792
  ds_read_b64_tr_b16 a[166:167], v2 offset:34304
  v_mfma_f32_16x16x32_bf16 v[32:35], a[152:155], a[64:67], v[32:35]
  ds_read_b64_tr_b16 a[168:169], v3 offset:33792
  v_rcp_f32 v223, v223
  v_mfma_f32_16x16x32_bf16 v[36:39], a[152:155], a[68:71], v[36:39]
  s_waitcnt lgkmcnt(5)
  ds_read_b64_tr_b16 a[170:171], v3 offset:34304
  v_mul_f32 v125, v125, v221
  v_mfma_f32_16x16x32_bf16 v[40:43], a[156:159], a[64:67], v[40:43]
  ds_read_b64_tr_b16 a[172:173], v4 offset:33792
  v_mul_f32 v126, v126, v222
  v_mfma_f32_16x16x32_bf16 v[44:47], a[156:159], a[68:71], v[44:47]
  s_waitcnt lgkmcnt(5)
  ds_read_b64_tr_b16 a[174:175], v4 offset:34304
  v_cvt_pk_bf16_f32 v166, v124, v125
  v_mul_f32 v127, v127, v223
  v_mfma_f32_16x16x32_bf16 v[48:51], a[160:163], a[64:67], v[48:51]
  ds_read_b64_tr_b16 a[144:145], v1 offset:40960
  v_cvt_pk_bf16_f32 v167, v126, v127
  v_mfma_f32_16x16x32_bf16 v[52:55], a[160:163], a[68:71], v[52:55]
  s_waitcnt lgkmcnt(5)
  ds_read_b64_tr_b16 a[146:147], v1 offset:41472
  v_mul_f32 v216, v224, v96
  v_mfma_f32_16x16x32_bf16 v[56:59], a[164:167], a[64:67], v[56:59]
  buffer_load_dwordx4 v11, s[52:55], s40 offen offset:1024 lds
  v_mfma_f32_16x16x32_bf16 v[60:63], a[164:167], a[68:71], v[60:63]
  s_waitcnt lgkmcnt(4)
  ds_read_b64_tr_b16 a[148:149], v2 offset:40960
  ds_read_b64_tr_b16 a[150:151], v2 offset:41472
  v_mul_f32 v217, v224, v97
  v_mfma_f32_16x16x32_bf16 v[64:67], a[168:171], a[64:67], v[64:67]
  s_add_u32 m0, s42, 16384
  ds_read_b64_tr_b16 a[152:153], v3 offset:40960
  v_mul_f32 v218, v224, v98
  v_mfma_f32_16x16x32_bf16 v[68:71], a[168:171], a[68:71], v[68:71]
  s_waitcnt lgkmcnt(5)
  ds_read_b64_tr_b16 a[154:155], v3 offset:41472
  v_mul_f32 v219, v224, v99
  v_mfma_f32_16x16x32_bf16 v[72:75], a[172:175], a[64:67], v[72:75]
  s_waitcnt vmcnt(27) lgkmcnt(4)
  ds_read_b64_tr_b16 a[156:157], v4 offset:40960
  ds_read_b64_tr_b16 a[158:159], v4 offset:41472
  v_mfma_f32_16x16x32_bf16 v[76:79], a[172:175], a[68:71], v[76:79]
  s_barrier
  v_mfma_f32_16x16x32_bf16 v[16:19], a[144:147], a[72:75], v[16:19]
  s_mov_b32 s40, 1180032
  ds_read_b64_tr_b16 a[160:161], v1 offset:41984
  v_exp_f32 v216, v216
  v_mfma_f32_16x16x32_bf16 v[20:23], a[144:147], a[76:79], v[20:23]
  s_waitcnt lgkmcnt(5)
  ds_read_b64_tr_b16 a[162:163], v1 offset:42496
  v_mul_f32 v128, v96, v128
  v_mfma_f32_16x16x32_bf16 v[24:27], a[148:151], a[72:75], v[24:27]
  buffer_load_dwordx4 v11, s[8:11], s40 offen offset:0 lds
  v_mfma_f32_16x16x32_bf16 v[28:31], a[148:151], a[76:79], v[28:31]
  s_waitcnt lgkmcnt(4)
  ds_read_b64_tr_b16 a[164:165], v2 offset:41984
  ds_read_b64_tr_b16 a[166:167], v2 offset:42496
  v_mfma_f32_16x16x32_bf16 v[32:35], a[152:155], a[72:75], v[32:35]
  ds_read_b64_tr_b16 a[168:169], v3 offset:41984
  v_exp_f32 v217, v217
  v_mfma_f32_16x16x32_bf16 v[36:39], a[152:155], a[76:79], v[36:39]
  s_waitcnt lgkmcnt(5)
  ds_read_b64_tr_b16 a[170:171], v3 offset:42496
  v_mul_f32 v129, v97, v129
  v_mfma_f32_16x16x32_bf16 v[40:43], a[156:159], a[72:75], v[40:43]
  ds_read_b64_tr_b16 a[172:173], v4 offset:41984
  v_mfma_f32_16x16x32_bf16 v[44:47], a[156:159], a[76:79], v[44:47]
  s_waitcnt lgkmcnt(5)
  ds_read_b64_tr_b16 a[174:175], v4 offset:42496
  v_exp_f32 v218, v218
  v_mfma_f32_16x16x32_bf16 v[48:51], a[160:163], a[72:75], v[48:51]
  ds_read_b64_tr_b16 a[144:145], v5 offset:32768
  v_fma_f32 v216, v216, v225, v225
  v_fma_f32 v217, v217, v225, v225
  v_mfma_f32_16x16x32_bf16 v[52:55], a[160:163], a[76:79], v[52:55]
  s_waitcnt lgkmcnt(5)
  ds_read_b64_tr_b16 a[146:147], v5 offset:33280
  v_mfma_f32_16x16x32_bf16 v[56:59], a[164:167], a[72:75], v[56:59]
  buffer_load_dwordx4 v11, s[52:55], s40 offen offset:1024 lds
  v_mfma_f32_16x16x32_bf16 v[60:63], a[164:167], a[76:79], v[60:63]
  s_waitcnt lgkmcnt(4)
  ds_read_b64_tr_b16 a[148:149], v6 offset:32768
  ds_read_b64_tr_b16 a[150:151], v6 offset:33280
  v_mfma_f32_16x16x32_bf16 v[64:67], a[168:171], a[72:75], v[64:67]
  s_mov_b32 s40, 1474944
  ds_read_b64_tr_b16 a[152:153], v7 offset:32768
  v_exp_f32 v219, v219
  v_mfma_f32_16x16x32_bf16 v[68:71], a[168:171], a[76:79], v[68:71]
  s_waitcnt lgkmcnt(5)
  ds_read_b64_tr_b16 a[154:155], v7 offset:33280
  v_mul_f32 v130, v98, v130
  v_mfma_f32_16x16x32_bf16 v[72:75], a[172:175], a[72:75], v[72:75]
  s_add_u32 m0, s42, 24576
  ds_read_b64_tr_b16 a[156:157], v8 offset:32768
  v_rcp_f32 v216, v216
  v_mfma_f32_16x16x32_bf16 v[76:79], a[172:175], a[76:79], v[76:79]
  s_waitcnt lgkmcnt(5)
  ds_read_b64_tr_b16 a[158:159], v8 offset:33280
  v_fma_f32 v218, v218, v225, v225
  v_mfma_f32_16x16x32_bf16 v[16:19], a[144:147], a[80:83], v[16:19]
  ds_read_b64_tr_b16 a[160:161], v5 offset:33792
  v_rcp_f32 v217, v217
  v_mfma_f32_16x16x32_bf16 v[20:23], a[144:147], a[84:87], v[20:23]
  s_waitcnt lgkmcnt(5)
  ds_read_b64_tr_b16 a[162:163], v5 offset:34304
  v_mul_f32 v131, v99, v131
  v_mfma_f32_16x16x32_bf16 v[24:27], a[148:151], a[80:83], v[24:27]
  buffer_load_dwordx4 v11, s[8:11], s40 offen offset:0 lds
  v_mfma_f32_16x16x32_bf16 v[28:31], a[148:151], a[84:87], v[28:31]
  s_waitcnt lgkmcnt(4)
  ds_read_b64_tr_b16 a[164:165], v6 offset:33792
  ds_read_b64_tr_b16 a[166:167], v6 offset:34304
  v_mfma_f32_16x16x32_bf16 v[32:35], a[152:155], a[80:83], v[32:35]
  ds_read_b64_tr_b16 a[168:169], v7 offset:33792
  v_fma_f32 v219, v219, v225, v225
  v_mfma_f32_16x16x32_bf16 v[36:39], a[152:155], a[84:87], v[36:39]
  s_waitcnt lgkmcnt(5)
  ds_read_b64_tr_b16 a[170:171], v7 offset:34304
  v_rcp_f32 v218, v218
  v_mfma_f32_16x16x32_bf16 v[40:43], a[156:159], a[80:83], v[40:43]
  ds_read_b64_tr_b16 a[172:173], v8 offset:33792
  v_mul_f32 v128, v128, v216
  v_mfma_f32_16x16x32_bf16 v[44:47], a[156:159], a[84:87], v[44:47]
  s_waitcnt lgkmcnt(5)
  ds_read_b64_tr_b16 a[174:175], v8 offset:34304
  v_mfma_f32_16x16x32_bf16 v[48:51], a[160:163], a[80:83], v[48:51]
  ds_read_b64_tr_b16 a[144:145], v5 offset:40960
  v_rcp_f32 v219, v219
  v_mfma_f32_16x16x32_bf16 v[52:55], a[160:163], a[84:87], v[52:55]
  s_waitcnt lgkmcnt(5)
  ds_read_b64_tr_b16 a[146:147], v5 offset:41472
  v_mul_f32 v129, v129, v217
  v_mul_f32 v130, v130, v218
  v_mfma_f32_16x16x32_bf16 v[56:59], a[164:167], a[80:83], v[56:59]
  buffer_load_dwordx4 v11, s[52:55], s40 offen offset:1024 lds
  v_mfma_f32_16x16x32_bf16 v[60:63], a[164:167], a[84:87], v[60:63]
  s_waitcnt lgkmcnt(4)
  ds_read_b64_tr_b16 a[148:149], v6 offset:40960
  ds_read_b64_tr_b16 a[150:151], v6 offset:41472
  v_mfma_f32_16x16x32_bf16 v[64:67], a[168:171], a[80:83], v[64:67]
  s_mov_b32 s40, 1769856
  ds_read_b64_tr_b16 a[152:153], v7 offset:40960
  v_cvt_pk_bf16_f32 v168, v128, v129
  v_mul_f32 v131, v131, v219
  v_mfma_f32_16x16x32_bf16 v[68:71], a[168:171], a[84:87], v[68:71]
  s_waitcnt lgkmcnt(5)
  ds_read_b64_tr_b16 a[154:155], v7 offset:41472
  v_cvt_pk_bf16_f32 v169, v130, v131
  v_mfma_f32_16x16x32_bf16 v[72:75], a[172:175], a[80:83], v[72:75]
  s_add_u32 m0, s42, 32768
  ds_read_b64_tr_b16 a[156:157], v8 offset:40960
  v_mul_f32 v220, v226, v100
  v_mfma_f32_16x16x32_bf16 v[76:79], a[172:175], a[84:87], v[76:79]
  s_waitcnt lgkmcnt(5)
  ds_read_b64_tr_b16 a[158:159], v8 offset:41472
  v_mul_f32 v221, v226, v101
  v_mfma_f32_16x16x32_bf16 v[16:19], a[144:147], a[88:91], v[16:19]
  ds_read_b64_tr_b16 a[160:161], v5 offset:41984
  v_mul_f32 v222, v226, v102
  v_mul_f32 v223, v226, v103
  v_mfma_f32_16x16x32_bf16 v[20:23], a[144:147], a[92:95], v[20:23]
  s_waitcnt lgkmcnt(5)
  ds_read_b64_tr_b16 a[162:163], v5 offset:42496
  v_mfma_f32_16x16x32_bf16 v[24:27], a[148:151], a[88:91], v[24:27]
  s_mov_b32 s69, 4096
  buffer_load_dwordx4 v11, s[8:11], s40 offen offset:0 lds
  v_mfma_f32_16x16x32_bf16 v[28:31], a[148:151], a[92:95], v[28:31]
  s_waitcnt lgkmcnt(4)
  ds_read_b64_tr_b16 a[164:165], v6 offset:41984
  ds_read_b64_tr_b16 a[166:167], v6 offset:42496
  v_mfma_f32_16x16x32_bf16 v[32:35], a[152:155], a[88:91], v[32:35]
L3_pad4:
  s_cmp_lg_u32 s82, 0
  s_cbranch_scc1 L3_pad8
  ds_read_b64_tr_b16 a[168:169], v7 offset:41984
  v_exp_f32 v220, v220
  v_mfma_f32_16x16x32_bf16 v[36:39], a[152:155], a[92:95], v[36:39]
  s_waitcnt lgkmcnt(5)
  ds_read_b64_tr_b16 a[170:171], v7 offset:42496
  v_mul_f32 v132, v100, v132
  v_mfma_f32_16x16x32_bf16 v[40:43], a[156:159], a[88:91], v[40:43]
  buffer_store_dwordx4 v[160:163], v233, s[76:79], s69 offen sc1
  v_mfma_f32_16x16x32_bf16 v[44:47], a[156:159], a[92:95], v[44:47]
  s_waitcnt lgkmcnt(4)
  ds_read_b64_tr_b16 a[172:173], v8 offset:41984
  ds_read_b64_tr_b16 a[174:175], v8 offset:42496
  v_mfma_f32_16x16x32_bf16 v[48:51], a[160:163], a[88:91], v[48:51]
  ds_read_b64_tr_b16 a[144:145], v5 offset:49152
  v_exp_f32 v221, v221
  v_mfma_f32_16x16x32_bf16 v[52:55], a[160:163], a[92:95], v[52:55]
  s_waitcnt lgkmcnt(5)
  ds_read_b64_tr_b16 a[146:147], v5 offset:49664
  v_mul_f32 v133, v101, v133
  v_mfma_f32_16x16x32_bf16 v[56:59], a[164:167], a[88:91], v[56:59]
  s_mov_b32 s69, 5120
  buffer_load_dwordx4 v11, s[52:55], s40 offen offset:1024 lds
  v_mfma_f32_16x16x32_bf16 v[60:63], a[164:167], a[92:95], v[60:63]
  s_waitcnt lgkmcnt(4)
  ds_read_b64_tr_b16 a[148:149], v6 offset:49152
  ds_read_b64_tr_b16 a[150:151], v6 offset:49664
  v_mfma_f32_16x16x32_bf16 v[64:67], a[168:171], a[88:91], v[64:67]
  s_add_u32 m0, s42, 40960
  ds_read_b64_tr_b16 a[152:153], v7 offset:49152
  ds_read_b64_tr_b16 a[154:155], v7 offset:49664
  v_mfma_f32_16x16x32_bf16 v[68:71], a[168:171], a[92:95], v[68:71]
  s_waitcnt lgkmcnt(6)
  ds_read_b64_tr_b16 a[156:157], v8 offset:49152
  ds_read_b64_tr_b16 a[158:159], v8 offset:49664
  v_mfma_f32_16x16x32_bf16 v[72:75], a[172:175], a[88:91], v[72:75]
  s_waitcnt vmcnt(25) lgkmcnt(6)
  buffer_store_dwordx4 v[164:167], v233, s[76:79], s69 offen sc1
  v_mfma_f32_16x16x32_bf16 v[76:79], a[172:175], a[92:95], v[76:79]
  s_barrier
  v_mfma_f32_16x16x32_bf16 v[16:19], a[144:147], a[96:99], v[16:19]
  s_mov_b32 s40, 2064768
  ds_read_b64_tr_b16 a[160:161], v5 offset:50176
  v_exp_f32 v222, v222
  v_mfma_f32_16x16x32_bf16 v[20:23], a[144:147], a[100:103], v[20:23]
  s_waitcnt lgkmcnt(5)
  ds_read_b64_tr_b16 a[162:163], v5 offset:50688
  v_fma_f32 v220, v220, v227, v227
  v_fma_f32 v221, v221, v227, v227
  v_mfma_f32_16x16x32_bf16 v[24:27], a[148:151], a[96:99], v[24:27]
  buffer_load_dwordx4 v11, s[8:11], s40 offen offset:0 lds
  v_mfma_f32_16x16x32_bf16 v[28:31], a[148:151], a[100:103], v[28:31]
  s_waitcnt lgkmcnt(2)
  ds_read_b64_tr_b16 a[164:165], v6 offset:50176
  ds_read_b64_tr_b16 a[166:167], v6 offset:50688
  v_mfma_f32_16x16x32_bf16 v[32:35], a[152:155], a[96:99], v[32:35]
  ds_read_b64_tr_b16 a[168:169], v7 offset:50176
  v_exp_f32 v223, v223
  v_mfma_f32_16x16x32_bf16 v[36:39], a[152:155], a[100:103], v[36:39]
  ds_read_b64_tr_b16 a[170:171], v7 offset:50688
  v_mul_f32 v134, v102, v134
  v_mfma_f32_16x16x32_bf16 v[40:43], a[156:159], a[96:99], v[40:43]
  ds_read_b64_tr_b16 a[172:173], v8 offset:50176
  v_mfma_f32_16x16x32_bf16 v[44:47], a[156:159], a[100:103], v[44:47]
  s_waitcnt lgkmcnt(5)
  ds_read_b64_tr_b16 a[174:175], v8 offset:50688
  v_rcp_f32 v220, v220
  v_mfma_f32_16x16x32_bf16 v[48:51], a[160:163], a[96:99], v[48:51]
  ds_read_b64_tr_b16 a[144:145], v5 offset:57344
  v_fma_f32 v222, v222, v227, v227
  v_mfma_f32_16x16x32_bf16 v[52:55], a[160:163], a[100:103], v[52:55]
  s_waitcnt lgkmcnt(5)
  ds_read_b64_tr_b16 a[146:147], v5 offset:57856
  v_rcp_f32 v221, v221
  v_mfma_f32_16x16x32_bf16 v[56:59], a[164:167], a[96:99], v[56:59]
  buffer_load_dwordx4 v11, s[52:55], s40 offen offset:1024 lds
  v_mfma_f32_16x16x32_bf16 v[60:63], a[164:167], a[100:103], v[60:63]
  s_waitcnt lgkmcnt(4)
  ds_read_b64_tr_b16 a[148:149], v6 offset:57344
  ds_read_b64_tr_b16 a[150:151], v6 offset:57856
  v_mul_f32 v135, v103, v135
  v_mfma_f32_16x16x32_bf16 v[64:67], a[168:171], a[96:99], v[64:67]
  s_mov_b32 s40, 2359680
  ds_read_b64_tr_b16 a[152:153], v7 offset:57344
  v_fma_f32 v223, v223, v227, v227
  v_mfma_f32_16x16x32_bf16 v[68:71], a[168:171], a[100:103], v[68:71]
  s_waitcnt lgkmcnt(5)
  ds_read_b64_tr_b16 a[154:155], v7 offset:57856
  v_mfma_f32_16x16x32_bf16 v[72:75], a[172:175], a[96:99], v[72:75]
  s_add_u32 m0, s42, 98304
  ds_read_b64_tr_b16 a[156:157], v8 offset:57344
  v_rcp_f32 v222, v222
  v_mfma_f32_16x16x32_bf16 v[76:79], a[172:175], a[100:103], v[76:79]
  s_waitcnt lgkmcnt(5)
  ds_read_b64_tr_b16 a[158:159], v8 offset:57856
  v_mul_f32 v132, v132, v220
  v_mfma_f32_16x16x32_bf16 v[16:19], a[144:147], a[104:107], v[16:19]
  ds_read_b64_tr_b16 a[160:161], v5 offset:58368
  v_rcp_f32 v223, v223
  v_mfma_f32_16x16x32_bf16 v[20:23], a[144:147], a[108:111], v[20:23]
  s_waitcnt lgkmcnt(5)
  ds_read_b64_tr_b16 a[162:163], v5 offset:58880
  v_mul_f32 v133, v133, v221
  v_mfma_f32_16x16x32_bf16 v[24:27], a[148:151], a[104:107], v[24:27]
  buffer_load_dwordx4 v11, s[8:11], s40 offen offset:0 lds
  v_mfma_f32_16x16x32_bf16 v[28:31], a[148:151], a[108:111], v[28:31]
  s_waitcnt lgkmcnt(4)
  ds_read_b64_tr_b16 a[164:165], v6 offset:58368
  ds_read_b64_tr_b16 a[166:167], v6 offset:58880
  v_mul_f32 v134, v134, v222
  v_mfma_f32_16x16x32_bf16 v[32:35], a[152:155], a[104:107], v[32:35]
  ds_read_b64_tr_b16 a[168:169], v7 offset:58368
  v_cvt_pk_bf16_f32 v172, v132, v133
  v_mfma_f32_16x16x32_bf16 v[36:39], a[152:155], a[108:111], v[36:39]
  s_waitcnt lgkmcnt(5)
  ds_read_b64_tr_b16 a[170:171], v7 offset:58880
  v_mul_f32 v135, v135, v223
  v_mfma_f32_16x16x32_bf16 v[40:43], a[156:159], a[104:107], v[40:43]
  ds_read_b64_tr_b16 a[172:173], v8 offset:58368
  v_cvt_pk_bf16_f32 v173, v134, v135
  v_mfma_f32_16x16x32_bf16 v[44:47], a[156:159], a[108:111], v[44:47]
  s_waitcnt lgkmcnt(5)
  ds_read_b64_tr_b16 a[174:175], v8 offset:58880
  v_mul_f32 v216, v224, v104
  v_mul_f32 v217, v224, v105
  v_mfma_f32_16x16x32_bf16 v[48:51], a[160:163], a[104:107], v[48:51]
  ds_read_b64_tr_b16 a[144:145], v1 offset:49152
  v_mul_f32 v218, v224, v106
  v_mfma_f32_16x16x32_bf16 v[52:55], a[160:163], a[108:111], v[52:55]
  s_waitcnt lgkmcnt(5)
  ds_read_b64_tr_b16 a[146:147], v1 offset:49664
  v_mul_f32 v219, v224, v107
  v_mfma_f32_16x16x32_bf16 v[56:59], a[164:167], a[104:107], v[56:59]
  buffer_load_dwordx4 v11, s[52:55], s40 offen offset:1024 lds
  v_mfma_f32_16x16x32_bf16 v[60:63], a[164:167], a[108:111], v[60:63]
  s_waitcnt lgkmcnt(4)
  ds_read_b64_tr_b16 a[148:149], v2 offset:49152
  ds_read_b64_tr_b16 a[150:151], v2 offset:49664
  v_mfma_f32_16x16x32_bf16 v[64:67], a[168:171], a[104:107], v[64:67]
  s_mov_b32 s40, 2654592
  ds_read_b64_tr_b16 a[152:153], v3 offset:49152
  v_exp_f32 v216, v216
  v_mfma_f32_16x16x32_bf16 v[68:71], a[168:171], a[108:111], v[68:71]
  s_waitcnt lgkmcnt(5)
  ds_read_b64_tr_b16 a[154:155], v3 offset:49664
  v_mul_f32 v136, v104, v136
  v_mfma_f32_16x16x32_bf16 v[72:75], a[172:175], a[104:107], v[72:75]
  s_add_u32 m0, s42, 106496
  ds_read_b64_tr_b16 a[156:157], v4 offset:49152
  v_mfma_f32_16x16x32_bf16 v[76:79], a[172:175], a[108:111], v[76:79]
  s_waitcnt lgkmcnt(5)
  ds_read_b64_tr_b16 a[158:159], v4 offset:49664
  v_exp_f32 v217, v217
  v_mfma_f32_16x16x32_bf16 v[16:19], a[144:147], a[112:115], v[16:19]
  ds_read_b64_tr_b16 a[160:161], v1 offset:50176
  v_mul_f32 v137, v105, v137
  v_mfma_f32_16x16x32_bf16 v[20:23], a[144:147], a[116:119], v[20:23]
  s_waitcnt lgkmcnt(5)
  ds_read_b64_tr_b16 a[162:163], v1 offset:50688
  v_exp_f32 v218, v218
  v_mfma_f32_16x16x32_bf16 v[24:27], a[148:151], a[112:115], v[24:27]
  buffer_load_dwordx4 v11, s[8:11], s40 offen offset:0 lds
  v_mfma_f32_16x16x32_bf16 v[28:31], a[148:151], a[116:119], v[28:31]
  s_waitcnt lgkmcnt(4)
  ds_read_b64_tr_b16 a[164:165], v2 offset:50176
  ds_read_b64_tr_b16 a[166:167], v2 offset:50688
  v_fma_f32 v216, v216, v225, v225
  v_mfma_f32_16x16x32_bf16 v[32:35], a[152:155], a[112:115], v[32:35]
  ds_read_b64_tr_b16 a[168:169], v3 offset:50176
  v_fma_f32 v217, v217, v225, v225
  v_mfma_f32_16x16x32_bf16 v[36:39], a[152:155], a[116:119], v[36:39]
  s_waitcnt lgkmcnt(5)
  ds_read_b64_tr_b16 a[170:171], v3 offset:50688
  v_mfma_f32_16x16x32_bf16 v[40:43], a[156:159], a[112:115], v[40:43]
  ds_read_b64_tr_b16 a[172:173], v4 offset:50176
  v_exp_f32 v219, v219
  v_mfma_f32_16x16x32_bf16 v[44:47], a[156:159], a[116:119], v[44:47]
  s_waitcnt lgkmcnt(5)
  ds_read_b64_tr_b16 a[174:175], v4 offset:50688
  v_mul_f32 v138, v106, v138
  v_mfma_f32_16x16x32_bf16 v[48:51], a[160:163], a[112:115], v[48:51]
  ds_read_b64_tr_b16 a[144:145], v1 offset:57344
  v_rcp_f32 v216, v216
  v_mfma_f32_16x16x32_bf16 v[52:55], a[160:163], a[116:119], v[52:55]
  s_waitcnt lgkmcnt(5)
  ds_read_b64_tr_b16 a[146:147], v1 offset:57856
  v_fma_f32 v218, v218, v225, v225
  v_mfma_f32_16x16x32_bf16 v[56:59], a[164:167], a[112:115], v[56:59]
  buffer_load_dwordx4 v11, s[52:55], s40 offen offset:1024 lds
  v_mfma_f32_16x16x32_bf16 v[60:63], a[164:167], a[116:119], v[60:63]
  s_waitcnt lgkmcnt(4)
  ds_read_b64_tr_b16 a[148:149], v2 offset:57344
  ds_read_b64_tr_b16 a[150:151], v2 offset:57856
  v_mfma_f32_16x16x32_bf16 v[64:67], a[168:171], a[112:115], v[64:67]
  s_add_u32 m0, s42, 114688
  ds_read_b64_tr_b16 a[152:153], v3 offset:57344
  v_rcp_f32 v217, v217
  v_mfma_f32_16x16x32_bf16 v[68:71], a[168:171], a[116:119], v[68:71]
  s_waitcnt lgkmcnt(5)
  ds_read_b64_tr_b16 a[154:155], v3 offset:57856
  v_mul_f32 v139, v107, v139
  v_mfma_f32_16x16x32_bf16 v[72:75], a[172:175], a[112:115], v[72:75]
  s_waitcnt vmcnt(20) lgkmcnt(4)
  ds_read_b64_tr_b16 a[156:157], v4 offset:57344
  ds_read_b64_tr_b16 a[158:159], v4 offset:57856
  v_fma_f32 v219, v219, v225, v225
  v_mfma_f32_16x16x32_bf16 v[76:79], a[172:175], a[116:119], v[76:79]
  s_barrier
  v_mfma_f32_16x16x32_bf16 v[16:19], a[144:147], a[120:123], v[16:19]
  s_mov_b32 s40, 2949504
  ds_read_b64_tr_b16 a[160:161], v1 offset:58368
  v_mfma_f32_16x16x32_bf16 v[20:23], a[144:147], a[124:127], v[20:23]
  s_waitcnt lgkmcnt(5)
  ds_read_b64_tr_b16 a[162:163], v1 offset:58880
  v_rcp_f32 v218, v218
  v_mfma_f32_16x16x32_bf16 v[24:27], a[148:151], a[120:123], v[24:27]
  buffer_load_dwordx4 v11, s[8:11], s40 offen offset:0 lds
  v_mfma_f32_16x16x32_bf16 v[28:31], a[148:151], a[124:127], v[28:31]
  s_waitcnt lgkmcnt(4)
  ds_read_b64_tr_b16 a[164:165], v2 offset:58368
  ds_read_b64_tr_b16 a[166:167], v2 offset:58880
  v_mfma_f32_16x16x32_bf16 v[32:35], a[152:155], a[120:123], v[32:35]
  ds_read_b64_tr_b16 a[168:169], v3 offset:58368
  v_mul_f32 v136, v136, v216
  v_mfma_f32_16x16x32_bf16 v[36:39], a[152:155], a[124:127], v[36:39]
  s_waitcnt lgkmcnt(5)
  ds_read_b64_tr_b16 a[170:171], v3 offset:58880
  v_rcp_f32 v219, v219
  v_mfma_f32_16x16x32_bf16 v[40:43], a[156:159], a[120:123], v[40:43]
  ds_read_b64_tr_b16 a[172:173], v4 offset:58368
  v_mul_f32 v137, v137, v217
  v_mfma_f32_16x16x32_bf16 v[44:47], a[156:159], a[124:127], v[44:47]
  s_waitcnt lgkmcnt(5)
  ds_read_b64_tr_b16 a[174:175], v4 offset:58880
  v_mul_f32 v138, v138, v218
  v_cvt_pk_bf16_f32 v170, v136, v137
  v_mfma_f32_16x16x32_bf16 v[48:51], a[160:163], a[120:123], v[48:51]
  ds_read_b64_tr_b16 a[144:145], v5 offset:0
  v_mul_f32 v139, v139, v219
  v_mfma_f32_16x16x32_bf16 v[52:55], a[160:163], a[124:127], v[52:55]
  s_waitcnt lgkmcnt(5)
  ds_read_b64_tr_b16 a[146:147], v5 offset:512
  v_cvt_pk_bf16_f32 v171, v138, v139
  v_mfma_f32_16x16x32_bf16 v[56:59], a[164:167], a[120:123], v[56:59]
  buffer_load_dwordx4 v11, s[52:55], s40 offen offset:1024 lds
  v_mfma_f32_16x16x32_bf16 v[60:63], a[164:167], a[124:127], v[60:63]
  s_waitcnt lgkmcnt(4)
  ds_read_b64_tr_b16 a[148:149], v6 offset:0
  ds_read_b64_tr_b16 a[150:151], v6 offset:512
  v_mfma_f32_16x16x32_bf16 v[64:67], a[168:171], a[120:123], v[64:67]
  s_mov_b32 s40, 3244416
  ds_read_b64_tr_b16 a[152:153], v7 offset:0
  v_mul_f32 v220, v226, v108
  v_mul_f32 v221, v226, v109
  v_mfma_f32_16x16x32_bf16 v[68:71], a[168:171], a[124:127], v[68:71]
  s_waitcnt lgkmcnt(5)
  ds_read_b64_tr_b16 a[154:155], v7 offset:512
  v_mul_f32 v222, v226, v110
  v_mfma_f32_16x16x32_bf16 v[72:75], a[172:175], a[120:123], v[72:75]
  s_add_u32 m0, s42, 122880
  ds_read_b64_tr_b16 a[156:157], v8 offset:0
  v_mul_f32 v223, v226, v111
  v_mfma_f32_16x16x32_bf16 v[76:79], a[172:175], a[124:127], v[76:79]
  s_waitcnt lgkmcnt(5)
  ds_read_b64_tr_b16 a[158:159], v8 offset:512
  v_exp_f32 v220, v220
  v_mfma_f32_16x16x32_bf16 v[16:19], a[144:147], a[128:131], v[16:19]
  ds_read_b64_tr_b16 a[160:161], v5 offset:1024
  v_mul_f32 v140, v108, v140
  v_mfma_f32_16x16x32_bf16 v[20:23], a[144:147], a[132:135], v[20:23]
  s_waitcnt lgkmcnt(5)
  ds_read_b64_tr_b16 a[162:163], v5 offset:1536
  v_mfma_f32_16x16x32_bf16 v[24:27], a[148:151], a[128:131], v[24:27]
  buffer_load_dwordx4 v11, s[8:11], s40 offen offset:0 lds
  v_mfma_f32_16x16x32_bf16 v[28:31], a[148:151], a[132:135], v[28:31]
  s_waitcnt lgkmcnt(4)
  ds_read_b64_tr_b16 a[164:165], v6 offset:1024
  ds_read_b64_tr_b16 a[166:167], v6 offset:1536
  v_mfma_f32_16x16x32_bf16 v[32:35], a[152:155], a[128:131], v[32:35]
  ds_read_b64_tr_b16 a[168:169], v7 offset:1024
  v_exp_f32 v221, v221
  v_mfma_f32_16x16x32_bf16 v[36:39], a[152:155], a[132:135], v[36:39]
  s_waitcnt lgkmcnt(5)
  ds_read_b64_tr_b16 a[170:171], v7 offset:1536
  v_mul_f32 v141, v109, v141
  v_mfma_f32_16x16x32_bf16 v[40:43], a[156:159], a[128:131], v[40:43]
  ds_read_b64_tr_b16 a[172:173], v8 offset:1024
  v_exp_f32 v222, v222
  v_mfma_f32_16x16x32_bf16 v[44:47], a[156:159], a[132:135], v[44:47]
  s_waitcnt lgkmcnt(5)
  ds_read_b64_tr_b16 a[174:175], v8 offset:1536
  v_fma_f32 v220, v220, v227, v227
  v_fma_f32 v221, v221, v227, v227
  v_mfma_f32_16x16x32_bf16 v[48:51], a[160:163], a[128:131], v[48:51]
  ds_read_b64_tr_b16 a[144:145], v5 offset:8192
  v_mfma_f32_16x16x32_bf16 v[52:55], a[160:163], a[132:135], v[52:55]
  s_waitcnt lgkmcnt(5)
  ds_read_b64_tr_b16 a[146:147], v5 offset:8704
  v_exp_f32 v223, v223
  v_mfma_f32_16x16x32_bf16 v[56:59], a[164:167], a[128:131], v[56:59]
  buffer_load_dwordx4 v11, s[52:55], s40 offen offset:1024 lds
  v_mfma_f32_16x16x32_bf16 v[60:63], a[164:167], a[132:135], v[60:63]
  s_waitcnt lgkmcnt(4)
  ds_read_b64_tr_b16 a[148:149], v6 offset:8192
  ds_read_b64_tr_b16 a[150:151], v6 offset:8704
  v_mfma_f32_16x16x32_bf16 v[64:67], a[168:171], a[128:131], v[64:67]
  s_mov_b32 s40, 3539328
  ds_read_b64_tr_b16 a[152:153], v7 offset:8192
  v_mul_f32 v142, v110, v142
  v_mfma_f32_16x16x32_bf16 v[68:71], a[168:171], a[132:135], v[68:71]
  s_waitcnt lgkmcnt(5)
  ds_read_b64_tr_b16 a[154:155], v7 offset:8704
  v_rcp_f32 v220, v220
  v_mfma_f32_16x16x32_bf16 v[72:75], a[172:175], a[128:131], v[72:75]
  s_add_u32 m0, s42, 49152
  ds_read_b64_tr_b16 a[156:157], v8 offset:8192
  v_fma_f32 v222, v222, v227, v227
  v_mfma_f32_16x16x32_bf16 v[76:79], a[172:175], a[132:135], v[76:79]
  s_waitcnt lgkmcnt(5)
  ds_read_b64_tr_b16 a[158:159], v8 offset:8704
  v_rcp_f32 v221, v221
  v_mfma_f32_16x16x32_bf16 v[16:19], a[144:147], a[136:139], v[16:19]
  ds_read_b64_tr_b16 a[160:161], v5 offset:9216
  v_mul_f32 v143, v111, v143
  v_mfma_f32_16x16x32_bf16 v[20:23], a[144:147], a[140:143], v[20:23]
  s_waitcnt lgkmcnt(5)
  ds_read_b64_tr_b16 a[162:163], v5 offset:9728
  v_fma_f32 v223, v223, v227, v227
  v_mfma_f32_16x16x32_bf16 v[24:27], a[148:151], a[136:139], v[24:27]
  buffer_load_dwordx4 v11, s[8:11], s40 offen offset:0 lds
  v_mfma_f32_16x16x32_bf16 v[28:31], a[148:151], a[140:143], v[28:31]
  s_waitcnt lgkmcnt(4)
  ds_read_b64_tr_b16 a[164:165], v6 offset:9216
  ds_read_b64_tr_b16 a[166:167], v6 offset:9728
  v_mfma_f32_16x16x32_bf16 v[32:35], a[152:155], a[136:139], v[32:35]
  ds_read_b64_tr_b16 a[168:169], v7 offset:9216
  v_rcp_f32 v222, v222
  v_mfma_f32_16x16x32_bf16 v[36:39], a[152:155], a[140:143], v[36:39]
  s_waitcnt lgkmcnt(5)
  ds_read_b64_tr_b16 a[170:171], v7 offset:9728
  v_mul_f32 v140, v140, v220
  v_mfma_f32_16x16x32_bf16 v[40:43], a[156:159], a[136:139], v[40:43]
  ds_read_b64_tr_b16 a[172:173], v8 offset:9216
  v_mfma_f32_16x16x32_bf16 v[44:47], a[156:159], a[140:143], v[44:47]
  s_waitcnt lgkmcnt(5)
  ds_read_b64_tr_b16 a[174:175], v8 offset:9728
  v_rcp_f32 v223, v223
  v_mfma_f32_16x16x32_bf16 v[48:51], a[160:163], a[136:139], v[48:51]
  ds_read_b64_tr_b16 a[144:145], v5 offset:16384
  v_mul_f32 v141, v141, v221
  v_mul_f32 v142, v142, v222
  v_mfma_f32_16x16x32_bf16 v[52:55], a[160:163], a[140:143], v[52:55]
  s_waitcnt lgkmcnt(5)
  ds_read_b64_tr_b16 a[146:147], v5 offset:16896
  v_cvt_pk_bf16_f32 v174, v140, v141
  v_mfma_f32_16x16x32_bf16 v[56:59], a[164:167], a[136:139], v[56:59]
  buffer_load_dwordx4 v11, s[52:55], s40 offen offset:1024 lds
  v_mfma_f32_16x16x32_bf16 v[60:63], a[164:167], a[140:143], v[60:63]
  s_waitcnt lgkmcnt(4)
  v_mul_f32 v143, v143, v223
  v_cvt_pk_bf16_f32 v175, v142, v143
  v_mfma_f32_16x16x32_bf16 v[64:67], a[168:171], a[136:139], v[64:67]
  s_add_u32 m0, s42, 57344
  ds_read_b64_tr_b16 a[148:149], v6 offset:16384
  v_mfma_f32_16x16x32_bf16 v[68:71], a[168:171], a[140:143], v[68:71]
  s_waitcnt lgkmcnt(3)
  ds_read_b64_tr_b16 a[150:151], v6 offset:16896
  v_mfma_f32_16x16x32_bf16 v[72:75], a[172:175], a[136:139], v[72:75]
  s_waitcnt vmcnt(20)
  ds_read_b64_tr_b16 a[152:153], v7 offset:16384
  v_mfma_f32_16x16x32_bf16 v[76:79], a[172:175], a[140:143], v[76:79]
  s_barrier
  v_mfma_f32_16x16x16_bf16 v[16:19], a[176:177], a[192:193], v[16:19]
  s_mov_b32 s40, 3834240
  ds_read_b64_tr_b16 a[154:155], v7 offset:16896
  v_mfma_f32_16x16x16_bf16 v[48:51], a[184:185], a[192:193], v[48:51]
  ds_read_b64_tr_b16 a[156:157], v8 offset:16384
  v_mfma_f32_16x16x16_bf16 v[24:27], a[178:179], a[192:193], v[24:27]
  buffer_load_dwordx4 v11, s[8:11], s40 offen offset:0 lds
  v_mfma_f32_16x16x16_bf16 v[56:59], a[186:187], a[192:193], v[56:59]
  s_mov_b32 s69, 6144
  ds_read_b64_tr_b16 a[158:159], v8 offset:16896
  v_mfma_f32_16x16x16_bf16 v[32:35], a[180:181], a[192:193], v[32:35]
  ds_read_b64_tr_b16 a[160:161], v5 offset:17408
  v_mul_f32 v216, v224, v16
  v_mfma_f32_16x16x16_bf16 v[64:67], a[188:189], a[192:193], v[64:67]
  ds_read_b64_tr_b16 a[162:163], v5 offset:17920
  v_mul_f32 v217, v224, v17
  v_mfma_f32_16x16x16_bf16 v[40:43], a[182:183], a[192:193], v[40:43]
  buffer_store_dwordx4 v[168:171], v233, s[76:79], s69 offen sc1
  v_mfma_f32_16x16x16_bf16 v[72:75], a[190:191], a[192:193], v[72:75]
  ds_read_b64_tr_b16 a[164:165], v6 offset:17408
  v_mul_f32 v218, v224, v18
  v_mfma_f32_16x16x16_bf16 v[20:23], a[176:177], a[194:195], v[20:23]
  ds_read_b64_tr_b16 a[166:167], v6 offset:17920
  v_mul_f32 v219, v224, v19
  v_mfma_f32_16x16x16_bf16 v[52:55], a[184:185], a[194:195], v[52:55]
  ds_read_b64_tr_b16 a[168:169], v7 offset:17408
  v_exp_f32 v216, v216
  v_mfma_f32_16x16x16_bf16 v[28:31], a[178:179], a[194:195], v[28:31]
  buffer_load_dwordx4 v11, s[52:55], s40 offen offset:1024 lds
  v_mfma_f32_16x16x16_bf16 v[60:63], a[186:187], a[194:195], v[60:63]
  s_mov_b32 s69, 7168
  ds_read_b64_tr_b16 a[170:171], v7 offset:17920
  v_mul_f32 v48, v16, v48
  v_mfma_f32_16x16x16_bf16 v[36:39], a[180:181], a[194:195], v[36:39]
  ds_read_b64_tr_b16 a[172:173], v8 offset:17408
  v_exp_f32 v217, v217
  v_mfma_f32_16x16x16_bf16 v[68:71], a[188:189], a[194:195], v[68:71]
  s_mov_b32 s40, 4129152
  ds_read_b64_tr_b16 a[174:175], v8 offset:17920
  v_mul_f32 v49, v17, v49
  v_mfma_f32_16x16x16_bf16 v[44:47], a[182:183], a[194:195], v[44:47]
  s_add_u32 m0, s42, 65536
  buffer_store_dwordx4 v[172:175], v233, s[76:79], s69 offen sc1
  v_mfma_f32_16x16x16_bf16 v[76:79], a[190:191], a[194:195], v[76:79]
  s_waitcnt lgkmcnt(3)
  v_exp_f32 v218, v218
  v_fma_f32 v216, v216, v225, v225
  v_mfma_f32_16x16x32_bf16 v[80:83], a[144:147], a[0:3], 0
  v_fma_f32 v217, v217, v225, v225
  v_mfma_f32_16x16x32_bf16 v[84:87], a[144:147], a[4:7], 0
  ds_read_b64_tr_b16 a[144:145], v5 offset:24576
  v_exp_f32 v219, v219
  v_mfma_f32_16x16x32_bf16 v[88:91], a[148:151], a[0:3], 0
  buffer_load_dwordx4 v11, s[8:11], s40 offen offset:0 lds
  v_mfma_f32_16x16x32_bf16 v[92:95], a[148:151], a[4:7], 0
  ds_read_b64_tr_b16 a[146:147], v5 offset:25088
  v_mul_f32 v50, v18, v50
  v_mfma_f32_16x16x32_bf16 v[96:99], a[152:155], a[0:3], 0
  ds_read_b64_tr_b16 a[148:149], v6 offset:24576
  v_rcp_f32 v216, v216
  v_mfma_f32_16x16x32_bf16 v[100:103], a[152:155], a[4:7], 0
  ds_read_b64_tr_b16 a[150:151], v6 offset:25088
  v_fma_f32 v218, v218, v225, v225
  v_mfma_f32_16x16x32_bf16 v[104:107], a[156:159], a[0:3], 0
  ds_read_b64_tr_b16 a[152:153], v7 offset:24576
  v_rcp_f32 v217, v217
  v_mfma_f32_16x16x32_bf16 v[108:111], a[156:159], a[4:7], 0
  ds_read_b64_tr_b16 a[154:155], v7 offset:25088
  v_mul_f32 v51, v19, v51
  v_mfma_f32_16x16x32_bf16 v[112:115], a[160:163], a[0:3], 0
  ds_read_b64_tr_b16 a[156:157], v8 offset:24576
  v_fma_f32 v219, v219, v225, v225
  v_mfma_f32_16x16x32_bf16 v[116:119], a[160:163], a[4:7], 0
  ds_read_b64_tr_b16 a[158:159], v8 offset:25088
  v_rcp_f32 v218, v218
  v_mfma_f32_16x16x32_bf16 v[120:123], a[164:167], a[0:3], 0
  buffer_load_dwordx4 v11, s[52:55], s40 offen offset:1024 lds
  v_mfma_f32_16x16x32_bf16 v[124:127], a[164:167], a[4:7], 0
  s_waitcnt lgkmcnt(4)
  ds_read_b64_tr_b16 a[160:161], v5 offset:25600
  v_mul_f32 v48, v48, v216
  v_mfma_f32_16x16x32_bf16 v[128:131], a[168:171], a[0:3], 0
  ds_read_b64_tr_b16 a[162:163], v5 offset:26112
  v_mfma_f32_16x16x32_bf16 v[132:135], a[168:171], a[4:7], 0
  ds_read_b64_tr_b16 a[164:165], v6 offset:25600
  v_rcp_f32 v219, v219
  v_mfma_f32_16x16x32_bf16 v[136:139], a[172:175], a[0:3], 0
  s_add_u32 m0, s42, 73728
  ds_read_b64_tr_b16 a[166:167], v6 offset:26112
  v_mul_f32 v49, v49, v217
  v_mul_f32 v50, v50, v218
  v_mfma_f32_16x16x32_bf16 v[140:143], a[172:175], a[4:7], 0
  s_mov_b32 s40, 4424064
  ds_read_b64_tr_b16 a[168:169], v7 offset:25600
  v_cvt_pk_bf16_f32 v176, v48, v49
  v_mfma_f32_16x16x32_bf16 v[80:83], a[144:147], a[8:11], v[80:83]
  ds_read_b64_tr_b16 a[170:171], v7 offset:26112
  v_mul_f32 v51, v51, v219
  v_mfma_f32_16x16x32_bf16 v[84:87], a[144:147], a[12:15], v[84:87]
  ds_read_b64_tr_b16 a[172:173], v8 offset:25600
  v_cvt_pk_bf16_f32 v177, v50, v51
  v_mul_f32 v220, v226, v20
  v_mfma_f32_16x16x32_bf16 v[88:91], a[148:151], a[8:11], v[88:91]
  buffer_load_dwordx4 v11, s[8:11], s40 offen offset:0 lds
  v_mfma_f32_16x16x32_bf16 v[92:95], a[148:151], a[12:15], v[92:95]
  s_waitcnt lgkmcnt(4)
  ds_read_b64_tr_b16 a[174:175], v8 offset:26112
  v_mul_f32 v221, v226, v21
  v_mfma_f32_16x16x32_bf16 v[96:99], a[152:155], a[8:11], v[96:99]
  ds_read_b64_tr_b16 a[144:145], v1 offset:0
  v_mul_f32 v222, v226, v22
  v_mfma_f32_16x16x32_bf16 v[100:103], a[152:155], a[12:15], v[100:103]
  ds_read_b64_tr_b16 a[146:147], v1 offset:512
  v_mul_f32 v223, v226, v23
  v_mfma_f32_16x16x32_bf16 v[104:107], a[156:159], a[8:11], v[104:107]
  ds_read_b64_tr_b16 a[148:149], v2 offset:0
  v_exp_f32 v220, v220
  v_mfma_f32_16x16x32_bf16 v[108:111], a[156:159], a[12:15], v[108:111]
  ds_read_b64_tr_b16 a[150:151], v2 offset:512
  v_mul_f32 v52, v20, v52
  v_mfma_f32_16x16x32_bf16 v[112:115], a[160:163], a[8:11], v[112:115]
  ds_read_b64_tr_b16 a[152:153], v3 offset:0
  v_mfma_f32_16x16x32_bf16 v[116:119], a[160:163], a[12:15], v[116:119]
  s_waitcnt lgkmcnt(5)
  ds_read_b64_tr_b16 a[154:155], v3 offset:512
  v_exp_f32 v221, v221
  v_mfma_f32_16x16x32_bf16 v[120:123], a[164:167], a[8:11], v[120:123]
  buffer_load_dwordx4 v11, s[52:55], s40 offen offset:1024 lds
  v_mfma_f32_16x16x32_bf16 v[124:127], a[164:167], a[12:15], v[124:127]
  s_add_u32 s68, s66, 1536
  ds_read_b64_tr_b16 a[156:157], v4 offset:0
  v_mul_f32 v53, v21, v53
  v_mfma_f32_16x16x32_bf16 v[128:131], a[168:171], a[8:11], v[128:131]
  ds_read_b64_tr_b16 a[158:159], v4 offset:512
  v_exp_f32 v222, v222
  v_mfma_f32_16x16x32_bf16 v[132:135], a[168:171], a[12:15], v[132:135]
  ds_read_b64_tr_b16 a[160:161], v1 offset:1024
  v_fma_f32 v220, v220, v227, v227
  v_fma_f32 v221, v221, v227, v227
  v_mfma_f32_16x16x32_bf16 v[136:139], a[172:175], a[8:11], v[136:139]
  buffer_load_dwordx2 a[176:177], v232, s[20:23], s68 offen offset:0 sc1
  v_mfma_f32_16x16x32_bf16 v[140:143], a[172:175], a[12:15], v[140:143]
  s_waitcnt lgkmcnt(3)
  ds_read_b64_tr_b16 a[162:163], v1 offset:1536
  v_mfma_f32_16x16x32_bf16 v[80:83], a[144:147], a[16:19], v[80:83]
  ds_read_b64_tr_b16 a[164:165], v2 offset:1024
  v_exp_f32 v223, v223
  v_mfma_f32_16x16x32_bf16 v[84:87], a[144:147], a[20:23], v[84:87]
  ds_read_b64_tr_b16 a[166:167], v2 offset:1536
  v_mul_f32 v54, v22, v54
  v_mfma_f32_16x16x32_bf16 v[88:91], a[148:151], a[16:19], v[88:91]
  buffer_load_dwordx2 a[178:179], v232, s[20:23], s68 offen offset:128 sc1
  v_mfma_f32_16x16x32_bf16 v[92:95], a[148:151], a[20:23], v[92:95]
  ds_read_b64_tr_b16 a[168:169], v3 offset:1024
  v_rcp_f32 v220, v220
  v_mfma_f32_16x16x32_bf16 v[96:99], a[152:155], a[16:19], v[96:99]
  ds_read_b64_tr_b16 a[170:171], v3 offset:1536
  v_fma_f32 v222, v222, v227, v227
  v_mfma_f32_16x16x32_bf16 v[100:103], a[152:155], a[20:23], v[100:103]
  s_waitcnt lgkmcnt(4)
  ds_read_b64_tr_b16 a[172:173], v4 offset:1024
  v_mfma_f32_16x16x32_bf16 v[104:107], a[156:159], a[16:19], v[104:107]
  buffer_load_dwordx2 a[180:181], v232, s[20:23], s68 offen offset:256 sc1
  v_mfma_f32_16x16x32_bf16 v[108:111], a[156:159], a[20:23], v[108:111]
  ds_read_b64_tr_b16 a[174:175], v4 offset:1536
  v_rcp_f32 v221, v221
  v_mfma_f32_16x16x32_bf16 v[112:115], a[160:163], a[16:19], v[112:115]
  ds_read_b64_tr_b16 a[144:145], v1 offset:8192
  v_mul_f32 v55, v23, v55
  v_fma_f32 v223, v223, v227, v227
  v_mfma_f32_16x16x32_bf16 v[116:119], a[160:163], a[20:23], v[116:119]
  s_waitcnt lgkmcnt(4)
  ds_read_b64_tr_b16 a[146:147], v1 offset:8704
  v_mfma_f32_16x16x32_bf16 v[120:123], a[164:167], a[16:19], v[120:123]
  buffer_load_dwordx2 a[182:183], v232, s[20:23], s68 offen offset:384 sc1
  v_mfma_f32_16x16x32_bf16 v[124:127], a[164:167], a[20:23], v[124:127]
  s_waitcnt lgkmcnt(3)
  s_add_u32 s68, s66, 38400
  ds_read_b64_tr_b16 a[148:149], v2 offset:8192
  ds_read_b64_tr_b16 a[150:151], v2 offset:8704
  v_mfma_f32_16x16x32_bf16 v[128:131], a[168:171], a[16:19], v[128:131]
  s_add_u32 m0, s42, 81920
  ds_read_b64_tr_b16 a[152:153], v3 offset:8192
  ds_read_b64_tr_b16 a[154:155], v3 offset:8704
  v_mfma_f32_16x16x32_bf16 v[132:135], a[168:171], a[20:23], v[132:135]
  s_waitcnt lgkmcnt(6)
  ds_read_b64_tr_b16 a[156:157], v4 offset:8192
  ds_read_b64_tr_b16 a[158:159], v4 offset:8704
  v_mfma_f32_16x16x32_bf16 v[136:139], a[172:175], a[16:19], v[136:139]
  s_waitcnt vmcnt(25) lgkmcnt(6)
  buffer_load_dwordx2 a[184:185], v232, s[20:23], s68 offen offset:0 sc1
  v_mfma_f32_16x16x32_bf16 v[140:143], a[172:175], a[20:23], v[140:143]
  s_barrier
  v_mfma_f32_16x16x32_bf16 v[80:83], a[144:147], a[24:27], v[80:83]
  s_mov_b32 s40, 4718976
  ds_read_b64_tr_b16 a[160:161], v1 offset:9216
  v_rcp_f32 v222, v222
  v_mfma_f32_16x16x32_bf16 v[84:87], a[144:147], a[28:31], v[84:87]
  s_waitcnt lgkmcnt(5)
  ds_read_b64_tr_b16 a[162:163], v1 offset:9728
  v_mul_f32 v52, v52, v220
  v_mfma_f32_16x16x32_bf16 v[88:91], a[148:151], a[24:27], v[88:91]
  buffer_load_dwordx4 v11, s[8:11], s40 offen offset:0 lds
  v_mfma_f32_16x16x32_bf16 v[92:95], a[148:151], a[28:31], v[92:95]
  s_waitcnt lgkmcnt(2)
  ds_read_b64_tr_b16 a[164:165], v2 offset:9216
  ds_read_b64_tr_b16 a[166:167], v2 offset:9728
  v_mfma_f32_16x16x32_bf16 v[96:99], a[152:155], a[24:27], v[96:99]
  ds_read_b64_tr_b16 a[168:169], v3 offset:9216
  v_rcp_f32 v223, v223
  v_mfma_f32_16x16x32_bf16 v[100:103], a[152:155], a[28:31], v[100:103]
  ds_read_b64_tr_b16 a[170:171], v3 offset:9728
  v_mul_f32 v53, v53, v221
  v_mul_f32 v54, v54, v222
  v_mfma_f32_16x16x32_bf16 v[104:107], a[156:159], a[24:27], v[104:107]
  buffer_load_dwordx2 a[186:187], v232, s[20:23], s68 offen offset:128 sc1
  v_mfma_f32_16x16x32_bf16 v[108:111], a[156:159], a[28:31], v[108:111]
  s_waitcnt lgkmcnt(4)
  ds_read_b64_tr_b16 a[172:173], v4 offset:9216
  ds_read_b64_tr_b16 a[174:175], v4 offset:9728
  v_cvt_pk_bf16_f32 v180, v52, v53
  v_mfma_f32_16x16x32_bf16 v[112:115], a[160:163], a[24:27], v[112:115]
L3_pad5:
  s_cmp_lg_u32 s82, 0
  s_cbranch_scc1 L3_pad9
  ds_read_b64_tr_b16 a[144:145], v1 offset:16384
  v_mul_f32 v55, v55, v223
  v_mfma_f32_16x16x32_bf16 v[116:119], a[160:163], a[28:31], v[116:119]
  s_waitcnt lgkmcnt(5)
  ds_read_b64_tr_b16 a[146:147], v1 offset:16896
  v_cvt_pk_bf16_f32 v181, v54, v55
  v_mfma_f32_16x16x32_bf16 v[120:123], a[164:167], a[24:27], v[120:123]
  buffer_load_dwordx4 v11, s[52:55], s40 offen offset:1024 lds
  v_mfma_f32_16x16x32_bf16 v[124:127], a[164:167], a[28:31], v[124:127]
  s_waitcnt lgkmcnt(4)
  ds_read_b64_tr_b16 a[148:149], v2 offset:16384
  ds_read_b64_tr_b16 a[150:151], v2 offset:16896
  v_mul_f32 v216, v224, v24
  v_mfma_f32_16x16x32_bf16 v[128:131], a[168:171], a[24:27], v[128:131]
  ds_read_b64_tr_b16 a[152:153], v3 offset:16384
  v_mul_f32 v217, v224, v25
  v_mfma_f32_16x16x32_bf16 v[132:135], a[168:171], a[28:31], v[132:135]
  s_waitcnt lgkmcnt(5)
  ds_read_b64_tr_b16 a[154:155], v3 offset:16896
  v_mul_f32 v218, v224, v26
  v_mfma_f32_16x16x32_bf16 v[136:139], a[172:175], a[24:27], v[136:139]
  s_add_u32 m0, s42, 90112
  buffer_load_dwordx2 a[188:189], v232, s[20:23], s68 offen offset:256 sc1
  v_mfma_f32_16x16x32_bf16 v[140:143], a[172:175], a[28:31], v[140:143]
  s_waitcnt lgkmcnt(4)
  ds_read_b64_tr_b16 a[156:157], v4 offset:16384
  ds_read_b64_tr_b16 a[158:159], v4 offset:16896
  v_mfma_f32_16x16x32_bf16 v[80:83], a[144:147], a[32:35], v[80:83]
  s_mov_b32 s40, 5013888
  ds_read_b64_tr_b16 a[160:161], v1 offset:17408
  v_mul_f32 v219, v224, v27
  v_mfma_f32_16x16x32_bf16 v[84:87], a[144:147], a[36:39], v[84:87]
  s_waitcnt lgkmcnt(5)
  ds_read_b64_tr_b16 a[162:163], v1 offset:17920
  v_exp_f32 v216, v216
  v_mfma_f32_16x16x32_bf16 v[88:91], a[148:151], a[32:35], v[88:91]
  buffer_load_dwordx4 v11, s[8:11], s40 offen offset:0 lds
  v_mfma_f32_16x16x32_bf16 v[92:95], a[148:151], a[36:39], v[92:95]
  s_waitcnt lgkmcnt(4)
  ds_read_b64_tr_b16 a[164:165], v2 offset:17408
  ds_read_b64_tr_b16 a[166:167], v2 offset:17920
  v_mfma_f32_16x16x32_bf16 v[96:99], a[152:155], a[32:35], v[96:99]
  ds_read_b64_tr_b16 a[168:169], v3 offset:17408
  v_mul_f32 v56, v24, v56
  v_mfma_f32_16x16x32_bf16 v[100:103], a[152:155], a[36:39], v[100:103]
  s_waitcnt lgkmcnt(5)
  ds_read_b64_tr_b16 a[170:171], v3 offset:17920
  v_exp_f32 v217, v217
  v_mfma_f32_16x16x32_bf16 v[104:107], a[156:159], a[32:35], v[104:107]
  buffer_load_dwordx2 a[190:191], v232, s[20:23], s68 offen offset:384 sc1
  v_mfma_f32_16x16x32_bf16 v[108:111], a[156:159], a[36:39], v[108:111]
  s_waitcnt lgkmcnt(4)
  ds_read_b64_tr_b16 a[172:173], v4 offset:17408
  ds_read_b64_tr_b16 a[174:175], v4 offset:17920
  v_mfma_f32_16x16x32_bf16 v[112:115], a[160:163], a[32:35], v[112:115]
  ds_read_b64_tr_b16 a[144:145], v1 offset:24576
  v_mul_f32 v57, v25, v57
  v_mfma_f32_16x16x32_bf16 v[116:119], a[160:163], a[36:39], v[116:119]
  s_waitcnt lgkmcnt(5)
  ds_read_b64_tr_b16 a[146:147], v1 offset:25088
  v_exp_f32 v218, v218
  v_mfma_f32_16x16x32_bf16 v[120:123], a[164:167], a[32:35], v[120:123]
  buffer_load_dwordx4 v11, s[52:55], s40 offen offset:1024 lds
  v_mfma_f32_16x16x32_bf16 v[124:127], a[164:167], a[36:39], v[124:127]
  s_waitcnt lgkmcnt(4)
  ds_read_b64_tr_b16 a[148:149], v2 offset:24576
  ds_read_b64_tr_b16 a[150:151], v2 offset:25088
  v_mfma_f32_16x16x32_bf16 v[128:131], a[168:171], a[32:35], v[128:131]
  s_mov_b32 s40, 0
  ds_read_b64_tr_b16 a[152:153], v3 offset:24576
  v_fma_f32 v216, v216, v225, v225
  v_mfma_f32_16x16x32_bf16 v[132:135], a[168:171], a[36:39], v[132:135]
  s_waitcnt lgkmcnt(5)
  ds_read_b64_tr_b16 a[154:155], v3 offset:25088
  v_fma_f32 v217, v217, v225, v225
  v_mfma_f32_16x16x32_bf16 v[136:139], a[172:175], a[32:35], v[136:139]
  s_add_u32 m0, s43, 0
  ds_read_b64_tr_b16 a[156:157], v4 offset:24576
  v_exp_f32 v219, v219
  v_mfma_f32_16x16x32_bf16 v[140:143], a[172:175], a[36:39], v[140:143]
  s_waitcnt lgkmcnt(5)
  ds_read_b64_tr_b16 a[158:159], v4 offset:25088
  v_mul_f32 v58, v26, v58
  v_mfma_f32_16x16x32_bf16 v[80:83], a[144:147], a[40:43], v[80:83]
  ds_read_b64_tr_b16 a[160:161], v1 offset:25600
  v_mfma_f32_16x16x32_bf16 v[84:87], a[144:147], a[44:47], v[84:87]
  s_waitcnt lgkmcnt(5)
  ds_read_b64_tr_b16 a[162:163], v1 offset:26112
  v_rcp_f32 v216, v216
  v_mfma_f32_16x16x32_bf16 v[88:91], a[148:151], a[40:43], v[88:91]
  buffer_load_dwordx4 v12, s[96:99], s40 offen offset:0 lds
  v_mfma_f32_16x16x32_bf16 v[92:95], a[148:151], a[44:47], v[92:95]
  s_waitcnt lgkmcnt(4)
  ds_read_b64_tr_b16 a[164:165], v2 offset:25600
  ds_read_b64_tr_b16 a[166:167], v2 offset:26112
  v_fma_f32 v218, v218, v225, v225
  v_mfma_f32_16x16x32_bf16 v[96:99], a[152:155], a[40:43], v[96:99]
  s_mov_b32 s40, 294912
  ds_read_b64_tr_b16 a[168:169], v3 offset:25600
  v_mfma_f32_16x16x32_bf16 v[100:103], a[152:155], a[44:47], v[100:103]
  s_waitcnt lgkmcnt(5)
  ds_read_b64_tr_b16 a[170:171], v3 offset:26112
  v_rcp_f32 v217, v217
  v_mfma_f32_16x16x32_bf16 v[104:107], a[156:159], a[40:43], v[104:107]
  s_add_u32 m0, s43, 4096
  ds_read_b64_tr_b16 a[172:173], v4 offset:25600
  v_mul_f32 v59, v27, v59
  v_fma_f32 v219, v219, v225, v225
  v_mfma_f32_16x16x32_bf16 v[108:111], a[156:159], a[44:47], v[108:111]
  s_waitcnt lgkmcnt(5)
  ds_read_b64_tr_b16 a[174:175], v4 offset:26112
  v_mfma_f32_16x16x32_bf16 v[112:115], a[160:163], a[40:43], v[112:115]
  ds_read_b64_tr_b16 a[144:145], v1 offset:32768
  v_rcp_f32 v218, v218
  v_mfma_f32_16x16x32_bf16 v[116:119], a[160:163], a[44:47], v[116:119]
  s_waitcnt lgkmcnt(5)
  ds_read_b64_tr_b16 a[146:147], v1 offset:33280
  v_mul_f32 v56, v56, v216
  v_mfma_f32_16x16x32_bf16 v[120:123], a[164:167], a[40:43], v[120:123]
  buffer_load_dwordx4 v12, s[96:99], s40 offen offset:0 lds
  v_mfma_f32_16x16x32_bf16 v[124:127], a[164:167], a[44:47], v[124:127]
  s_waitcnt lgkmcnt(4)
  ds_read_b64_tr_b16 a[148:149], v2 offset:32768
  ds_read_b64_tr_b16 a[150:151], v2 offset:33280
  v_mfma_f32_16x16x32_bf16 v[128:131], a[168:171], a[40:43], v[128:131]
  s_add_u32 m0, s43, 8192
  ds_read_b64_tr_b16 a[152:153], v3 offset:32768
  v_rcp_f32 v219, v219
  v_mfma_f32_16x16x32_bf16 v[132:135], a[168:171], a[44:47], v[132:135]
  s_waitcnt lgkmcnt(5)
  ds_read_b64_tr_b16 a[154:155], v3 offset:33280
  v_mul_f32 v57, v57, v217
  v_mul_f32 v58, v58, v218
  v_mfma_f32_16x16x32_bf16 v[136:139], a[172:175], a[40:43], v[136:139]
  s_waitcnt vmcnt(28) lgkmcnt(4)
  ds_read_b64_tr_b16 a[156:157], v4 offset:32768
  ds_read_b64_tr_b16 a[158:159], v4 offset:33280
  v_mfma_f32_16x16x32_bf16 v[140:143], a[172:175], a[44:47], v[140:143]
  s_barrier
  v_mfma_f32_16x16x32_bf16 v[80:83], a[144:147], a[48:51], v[80:83]
  s_mov_b32 s40, 589824
  ds_read_b64_tr_b16 a[160:161], v1 offset:33792
  v_cvt_pk_bf16_f32 v178, v56, v57
  v_mfma_f32_16x16x32_bf16 v[84:87], a[144:147], a[52:55], v[84:87]
  s_waitcnt lgkmcnt(5)
  ds_read_b64_tr_b16 a[162:163], v1 offset:34304
  v_mul_f32 v59, v59, v219
  v_mfma_f32_16x16x32_bf16 v[88:91], a[148:151], a[48:51], v[88:91]
  buffer_load_dwordx4 v12, s[96:99], s40 offen offset:0 lds
  v_mfma_f32_16x16x32_bf16 v[92:95], a[148:151], a[52:55], v[92:95]
  s_waitcnt lgkmcnt(4)
  ds_read_b64_tr_b16 a[164:165], v2 offset:33792
  ds_read_b64_tr_b16 a[166:167], v2 offset:34304
  v_mfma_f32_16x16x32_bf16 v[96:99], a[152:155], a[48:51], v[96:99]
  s_mov_b32 s40, 884736
  ds_read_b64_tr_b16 a[168:169], v3 offset:33792
  v_cvt_pk_bf16_f32 v179, v58, v59
  v_mfma_f32_16x16x32_bf16 v[100:103], a[152:155], a[52:55], v[100:103]
  s_waitcnt lgkmcnt(5)
  ds_read_b64_tr_b16 a[170:171], v3 offset:34304
  v_mul_f32 v220, v226, v28
  v_mfma_f32_16x16x32_bf16 v[104:107], a[156:159], a[48:51], v[104:107]
  s_add_u32 m0, s43, 12288
  ds_read_b64_tr_b16 a[172:173], v4 offset:33792
  v_mul_f32 v221, v226, v29
  v_mfma_f32_16x16x32_bf16 v[108:111], a[156:159], a[52:55], v[108:111]
  s_waitcnt lgkmcnt(5)
  ds_read_b64_tr_b16 a[174:175], v4 offset:34304
  v_mul_f32 v222, v226, v30
  v_mfma_f32_16x16x32_bf16 v[112:115], a[160:163], a[48:51], v[112:115]
  ds_read_b64_tr_b16 a[144:145], v1 offset:40960
  v_mul_f32 v223, v226, v31
  v_mfma_f32_16x16x32_bf16 v[116:119], a[160:163], a[52:55], v[116:119]
  s_waitcnt lgkmcnt(5)
  ds_read_b64_tr_b16 a[146:147], v1 offset:41472
  v_bfe_u32 v230, v0, 4, 1
  v_mfma_f32_16x16x32_bf16 v[120:123], a[164:167], a[48:51], v[120:123]
  buffer_load_dwordx4 v12, s[96:99], s40 offen offset:0 lds
  v_mfma_f32_16x16x32_bf16 v[124:127], a[164:167], a[52:55], v[124:127]
  s_waitcnt lgkmcnt(4)
  ds_read_b64_tr_b16 a[148:149], v2 offset:40960
  ds_read_b64_tr_b16 a[150:151], v2 offset:41472
  v_mfma_f32_16x16x32_bf16 v[128:131], a[168:171], a[48:51], v[128:131]
  s_mov_b32 s40, 1179648
  ds_read_b64_tr_b16 a[152:153], v3 offset:40960
  v_mul_u32_u24 v230, 1536, v230
  v_mfma_f32_16x16x32_bf16 v[132:135], a[168:171], a[52:55], v[132:135]
  s_waitcnt lgkmcnt(5)
  ds_read_b64_tr_b16 a[154:155], v3 offset:41472
  v_exp_f32 v220, v220
  v_mfma_f32_16x16x32_bf16 v[136:139], a[172:175], a[48:51], v[136:139]
  s_add_u32 m0, s43, 16384
  ds_read_b64_tr_b16 a[156:157], v4 offset:40960
  v_mul_f32 v60, v28, v60
  v_mfma_f32_16x16x32_bf16 v[140:143], a[172:175], a[52:55], v[140:143]
  s_waitcnt lgkmcnt(5)
  ds_read_b64_tr_b16 a[158:159], v4 offset:41472
  v_exp_f32 v221, v221
  v_mfma_f32_16x16x32_bf16 v[80:83], a[144:147], a[56:59], v[80:83]
  ds_read_b64_tr_b16 a[160:161], v1 offset:41984
  v_mul_f32 v61, v29, v61
  v_mfma_f32_16x16x32_bf16 v[84:87], a[144:147], a[60:63], v[84:87]
  s_waitcnt lgkmcnt(5)
  ds_read_b64_tr_b16 a[162:163], v1 offset:42496
  v_bfe_u32 v231, v0, 4, 2
  v_mfma_f32_16x16x32_bf16 v[88:91], a[148:151], a[56:59], v[88:91]
  buffer_load_dwordx4 v12, s[96:99], s40 offen offset:0 lds
  v_mfma_f32_16x16x32_bf16 v[92:95], a[148:151], a[60:63], v[92:95]
  s_waitcnt lgkmcnt(4)
  ds_read_b64_tr_b16 a[164:165], v2 offset:41984
  ds_read_b64_tr_b16 a[166:167], v2 offset:42496
  v_mfma_f32_16x16x32_bf16 v[96:99], a[152:155], a[56:59], v[96:99]
  s_mov_b32 s40, 1474560
  ds_read_b64_tr_b16 a[168:169], v3 offset:41984
  v_lshlrev_b32 v231, 8, v231
  v_mfma_f32_16x16x32_bf16 v[100:103], a[152:155], a[60:63], v[100:103]
  s_waitcnt lgkmcnt(5)
  ds_read_b64_tr_b16 a[170:171], v3 offset:42496
  v_exp_f32 v222, v222
  v_mfma_f32_16x16x32_bf16 v[104:107], a[156:159], a[56:59], v[104:107]
  s_add_u32 m0, s43, 20480
  ds_read_b64_tr_b16 a[172:173], v4 offset:41984
  v_fma_f32 v220, v220, v227, v227
  v_fma_f32 v221, v221, v227, v227
  v_mfma_f32_16x16x32_bf16 v[108:111], a[156:159], a[60:63], v[108:111]
  s_waitcnt lgkmcnt(5)
  ds_read_b64_tr_b16 a[174:175], v4 offset:42496
  v_exp_f32 v223, v223
  v_mfma_f32_16x16x32_bf16 v[112:115], a[160:163], a[56:59], v[112:115]
  ds_read_b64_tr_b16 a[144:145], v5 offset:32768
  v_mul_f32 v62, v30, v62
  v_mfma_f32_16x16x32_bf16 v[116:119], a[160:163], a[60:63], v[116:119]
  s_waitcnt lgkmcnt(5)
  ds_read_b64_tr_b16 a[146:147], v5 offset:33280
  v_rcp_f32 v220, v220
  v_mfma_f32_16x16x32_bf16 v[120:123], a[164:167], a[56:59], v[120:123]
  buffer_load_dwordx4 v12, s[96:99], s40 offen offset:0 lds
  v_mfma_f32_16x16x32_bf16 v[124:127], a[164:167], a[60:63], v[124:127]
  s_waitcnt lgkmcnt(4)
  ds_read_b64_tr_b16 a[148:149], v6 offset:32768
  ds_read_b64_tr_b16 a[150:151], v6 offset:33280
  v_fma_f32 v222, v222, v227, v227
  v_mfma_f32_16x16x32_bf16 v[128:131], a[168:171], a[56:59], v[128:131]
  s_mov_b32 s40, 1769472
  ds_read_b64_tr_b16 a[152:153], v7 offset:32768
  v_mfma_f32_16x16x32_bf16 v[132:135], a[168:171], a[60:63], v[132:135]
  s_waitcnt lgkmcnt(5)
  ds_read_b64_tr_b16 a[154:155], v7 offset:33280
  v_rcp_f32 v221, v221
  v_mfma_f32_16x16x32_bf16 v[136:139], a[172:175], a[56:59], v[136:139]
  s_add_u32 m0, s43, 24576
  ds_read_b64_tr_b16 a[156:157], v8 offset:32768
  v_mul_f32 v63, v31, v63
  v_fma_f32 v223, v223, v227, v227
  v_mfma_f32_16x16x32_bf16 v[140:143], a[172:175], a[60:63], v[140:143]
  s_waitcnt lgkmcnt(5)
  ds_read_b64_tr_b16 a[158:159], v8 offset:33280
  v_mfma_f32_16x16x32_bf16 v[80:83], a[144:147], a[64:67], v[80:83]
  ds_read_b64_tr_b16 a[160:161], v5 offset:33792
  v_rcp_f32 v222, v222
  v_mfma_f32_16x16x32_bf16 v[84:87], a[144:147], a[68:71], v[84:87]
  s_waitcnt lgkmcnt(5)
  ds_read_b64_tr_b16 a[162:163], v5 offset:34304
  v_mul_f32 v60, v60, v220
  v_mfma_f32_16x16x32_bf16 v[88:91], a[148:151], a[64:67], v[88:91]
  buffer_load_dwordx4 v12, s[96:99], s40 offen offset:0 lds
  v_mfma_f32_16x16x32_bf16 v[92:95], a[148:151], a[68:71], v[92:95]
  s_waitcnt lgkmcnt(4)
  ds_read_b64_tr_b16 a[164:165], v6 offset:33792
  ds_read_b64_tr_b16 a[166:167], v6 offset:34304
  v_mfma_f32_16x16x32_bf16 v[96:99], a[152:155], a[64:67], v[96:99]
  s_mov_b32 s40, 2064384
  ds_read_b64_tr_b16 a[168:169], v7 offset:33792
  v_rcp_f32 v223, v223
  v_mfma_f32_16x16x32_bf16 v[100:103], a[152:155], a[68:71], v[100:103]
  s_waitcnt lgkmcnt(5)
  ds_read_b64_tr_b16 a[170:171], v7 offset:34304
  v_mul_f32 v61, v61, v221
  v_mfma_f32_16x16x32_bf16 v[104:107], a[156:159], a[64:67], v[104:107]
  s_add_u32 m0, s43, 28672
  ds_read_b64_tr_b16 a[172:173], v8 offset:33792
  v_mul_f32 v62, v62, v222
  v_cvt_pk_bf16_f32 v182, v60, v61
  v_mfma_f32_16x16x32_bf16 v[108:111], a[156:159], a[68:71], v[108:111]
  s_waitcnt lgkmcnt(5)
  ds_read_b64_tr_b16 a[174:175], v8 offset:34304
  v_mul_f32 v63, v63, v223
  v_mfma_f32_16x16x32_bf16 v[112:115], a[160:163], a[64:67], v[112:115]
  ds_read_b64_tr_b16 a[144:145], v5 offset:40960
  v_cvt_pk_bf16_f32 v183, v62, v63
  v_mfma_f32_16x16x32_bf16 v[116:119], a[160:163], a[68:71], v[116:119]
  s_waitcnt lgkmcnt(5)
  ds_read_b64_tr_b16 a[146:147], v5 offset:41472
  v_mul_f32 v216, v224, v32
  v_mul_f32 v217, v224, v33
  v_mfma_f32_16x16x32_bf16 v[120:123], a[164:167], a[64:67], v[120:123]
  buffer_load_dwordx4 v12, s[96:99], s40 offen offset:0 lds
  v_mfma_f32_16x16x32_bf16 v[124:127], a[164:167], a[68:71], v[124:127]
  s_waitcnt lgkmcnt(4)
  ds_read_b64_tr_b16 a[148:149], v6 offset:40960
  ds_read_b64_tr_b16 a[150:151], v6 offset:41472
  v_mfma_f32_16x16x32_bf16 v[128:131], a[168:171], a[64:67], v[128:131]
  s_add_u32 m0, s43, 32768
  ds_read_b64_tr_b16 a[152:153], v7 offset:40960
  v_mul_f32 v218, v224, v34
  v_mfma_f32_16x16x32_bf16 v[132:135], a[168:171], a[68:71], v[132:135]
  s_waitcnt lgkmcnt(5)
  ds_read_b64_tr_b16 a[154:155], v7 offset:41472
  v_mul_f32 v219, v224, v35
  v_mfma_f32_16x16x32_bf16 v[136:139], a[172:175], a[64:67], v[136:139]
  s_waitcnt vmcnt(28) lgkmcnt(4)
  ds_read_b64_tr_b16 a[156:157], v8 offset:40960
  ds_read_b64_tr_b16 a[158:159], v8 offset:41472
  v_mfma_f32_16x16x32_bf16 v[140:143], a[172:175], a[68:71], v[140:143]
  s_barrier
  v_mfma_f32_16x16x32_bf16 v[80:83], a[144:147], a[72:75], v[80:83]
  s_mov_b32 s40, 2359296
  ds_read_b64_tr_b16 a[160:161], v5 offset:41984
  v_exp_f32 v216, v216
  v_mfma_f32_16x16x32_bf16 v[84:87], a[144:147], a[76:79], v[84:87]
  s_waitcnt lgkmcnt(5)
  ds_read_b64_tr_b16 a[162:163], v5 offset:42496
  v_mul_f32 v64, v32, v64
  v_mfma_f32_16x16x32_bf16 v[88:91], a[148:151], a[72:75], v[88:91]
  buffer_load_dwordx4 v12, s[96:99], s40 offen offset:0 lds
  v_mfma_f32_16x16x32_bf16 v[92:95], a[148:151], a[76:79], v[92:95]
  s_waitcnt lgkmcnt(4)
  ds_read_b64_tr_b16 a[164:165], v6 offset:41984
  ds_read_b64_tr_b16 a[166:167], v6 offset:42496
  v_mfma_f32_16x16x32_bf16 v[96:99], a[152:155], a[72:75], v[96:99]
  s_mov_b32 s40, 2654208
  ds_read_b64_tr_b16 a[168:169], v7 offset:41984
  v_exp_f32 v217, v217
  v_mfma_f32_16x16x32_bf16 v[100:103], a[152:155], a[76:79], v[100:103]
  s_waitcnt lgkmcnt(5)
  ds_read_b64_tr_b16 a[170:171], v7 offset:42496
  v_mul_f32 v65, v33, v65
  v_mfma_f32_16x16x32_bf16 v[104:107], a[156:159], a[72:75], v[104:107]
  s_add_u32 m0, s43, 36864
  ds_read_b64_tr_b16 a[172:173], v8 offset:41984
  v_mfma_f32_16x16x32_bf16 v[108:111], a[156:159], a[76:79], v[108:111]
  s_waitcnt lgkmcnt(5)
  ds_read_b64_tr_b16 a[174:175], v8 offset:42496
  v_exp_f32 v218, v218
  v_mfma_f32_16x16x32_bf16 v[112:115], a[160:163], a[72:75], v[112:115]
  ds_read_b64_tr_b16 a[144:145], v5 offset:49152
  v_fma_f32 v216, v216, v225, v225
  v_fma_f32 v217, v217, v225, v225
  v_mfma_f32_16x16x32_bf16 v[116:119], a[160:163], a[76:79], v[116:119]
  s_waitcnt lgkmcnt(5)
  ds_read_b64_tr_b16 a[146:147], v5 offset:49664
  v_mfma_f32_16x16x32_bf16 v[120:123], a[164:167], a[72:75], v[120:123]
  buffer_load_dwordx4 v12, s[96:99], s40 offen offset:0 lds
  v_mfma_f32_16x16x32_bf16 v[124:127], a[164:167], a[76:79], v[124:127]
  s_waitcnt lgkmcnt(4)
  ds_read_b64_tr_b16 a[148:149], v6 offset:49152
  ds_read_b64_tr_b16 a[150:151], v6 offset:49664
  v_mfma_f32_16x16x32_bf16 v[128:131], a[168:171], a[72:75], v[128:131]
  s_mov_b32 s40, 2949120
  ds_read_b64_tr_b16 a[152:153], v7 offset:49152
  v_exp_f32 v219, v219
  v_mfma_f32_16x16x32_bf16 v[132:135], a[168:171], a[76:79], v[132:135]
  s_waitcnt lgkmcnt(5)
  ds_read_b64_tr_b16 a[154:155], v7 offset:49664
  v_mul_f32 v66, v34, v66
  v_mfma_f32_16x16x32_bf16 v[136:139], a[172:175], a[72:75], v[136:139]
  s_add_u32 m0, s43, 40960
  ds_read_b64_tr_b16 a[156:157], v8 offset:49152
  v_rcp_f32 v216, v216
  v_mfma_f32_16x16x32_bf16 v[140:143], a[172:175], a[76:79], v[140:143]
  s_waitcnt lgkmcnt(5)
  ds_read_b64_tr_b16 a[158:159], v8 offset:49664
  v_fma_f32 v218, v218, v225, v225
  v_mfma_f32_16x16x32_bf16 v[80:83], a[144:147], a[80:83], v[80:83]
  ds_read_b64_tr_b16 a[160:161], v5 offset:50176
  v_rcp_f32 v217, v217
  v_mfma_f32_16x16x32_bf16 v[84:87], a[144:147], a[84:87], v[84:87]
  s_waitcnt lgkmcnt(5)
  ds_read_b64_tr_b16 a[162:163], v5 offset:50688
  v_mul_f32 v67, v35, v67
  v_mfma_f32_16x16x32_bf16 v[88:91], a[148:151], a[80:83], v[88:91]
  buffer_load_dwordx4 v12, s[96:99], s40 offen offset:0 lds
  v_mfma_f32_16x16x32_bf16 v[92:95], a[148:151], a[84:87], v[92:95]
  s_waitcnt lgkmcnt(4)
  ds_read_b64_tr_b16 a[164:165], v6 offset:50176
  ds_read_b64_tr_b16 a[166:167], v6 offset:50688
  v_fma_f32 v219, v219, v225, v225
  v_mfma_f32_16x16x32_bf16 v[96:99], a[152:155], a[80:83], v[96:99]
  s_mov_b32 s40, 3244032
  ds_read_b64_tr_b16 a[168:169], v7 offset:50176
  v_mfma_f32_16x16x32_bf16 v[100:103], a[152:155], a[84:87], v[100:103]
  s_waitcnt lgkmcnt(5)
  ds_read_b64_tr_b16 a[170:171], v7 offset:50688
  v_rcp_f32 v218, v218
  v_mfma_f32_16x16x32_bf16 v[104:107], a[156:159], a[80:83], v[104:107]
  s_add_u32 m0, s43, 45056
  ds_read_b64_tr_b16 a[172:173], v8 offset:50176
  v_mul_f32 v64, v64, v216
  v_mfma_f32_16x16x32_bf16 v[108:111], a[156:159], a[84:87], v[108:111]
  s_waitcnt lgkmcnt(5)
  ds_read_b64_tr_b16 a[174:175], v8 offset:50688
  v_rcp_f32 v219, v219
  v_mfma_f32_16x16x32_bf16 v[112:115], a[160:163], a[80:83], v[112:115]
  ds_read_b64_tr_b16 a[144:145], v5 offset:57344
  v_mul_f32 v65, v65, v217
  v_mfma_f32_16x16x32_bf16 v[116:119], a[160:163], a[84:87], v[116:119]
  s_waitcnt lgkmcnt(5)
  ds_read_b64_tr_b16 a[146:147], v5 offset:57856
  v_mul_f32 v66, v66, v218
  v_mfma_f32_16x16x32_bf16 v[120:123], a[164:167], a[80:83], v[120:123]
  buffer_load_dwordx4 v12, s[96:99], s40 offen offset:0 lds
  v_mfma_f32_16x16x32_bf16 v[124:127], a[164:167], a[84:87], v[124:127]
  s_waitcnt lgkmcnt(4)
  ds_read_b64_tr_b16 a[148:149], v6 offset:57344
  ds_read_b64_tr_b16 a[150:151], v6 offset:57856
  v_cvt_pk_bf16_f32 v184, v64, v65
  v_mfma_f32_16x16x32_bf16 v[128:131], a[168:171], a[80:83], v[128:131]
  s_mov_b32 s40, 3538944
  ds_read_b64_tr_b16 a[152:153], v7 offset:57344
  v_mul_f32 v67, v67, v219
  v_mfma_f32_16x16x32_bf16 v[132:135], a[168:171], a[84:87], v[132:135]
  s_waitcnt lgkmcnt(5)
  ds_read_b64_tr_b16 a[154:155], v7 offset:57856
  v_cvt_pk_bf16_f32 v185, v66, v67
  v_mfma_f32_16x16x32_bf16 v[136:139], a[172:175], a[80:83], v[136:139]
  s_add_u32 m0, s43, 98304
  ds_read_b64_tr_b16 a[156:157], v8 offset:57344
  v_mul_f32 v220, v226, v36
  v_mfma_f32_16x16x32_bf16 v[140:143], a[172:175], a[84:87], v[140:143]
  s_waitcnt lgkmcnt(5)
  ds_read_b64_tr_b16 a[158:159], v8 offset:57856
  v_mul_f32 v221, v226, v37
  v_mul_f32 v222, v226, v38
  v_mfma_f32_16x16x32_bf16 v[80:83], a[144:147], a[88:91], v[80:83]
  ds_read_b64_tr_b16 a[160:161], v5 offset:58368
  v_mul_f32 v223, v226, v39
  v_mfma_f32_16x16x32_bf16 v[84:87], a[144:147], a[92:95], v[84:87]
  s_waitcnt lgkmcnt(5)
  ds_read_b64_tr_b16 a[162:163], v5 offset:58880
  v_mfma_f32_16x16x32_bf16 v[88:91], a[148:151], a[88:91], v[88:91]
  s_mov_b32 s69, 8192
  buffer_load_dwordx4 v12, s[96:99], s40 offen offset:0 lds
  v_mfma_f32_16x16x32_bf16 v[92:95], a[148:151], a[92:95], v[92:95]
  s_waitcnt lgkmcnt(4)
  ds_read_b64_tr_b16 a[164:165], v6 offset:58368
  ds_read_b64_tr_b16 a[166:167], v6 offset:58880
  v_mfma_f32_16x16x32_bf16 v[96:99], a[152:155], a[88:91], v[96:99]
  ds_read_b64_tr_b16 a[168:169], v7 offset:58368
  v_exp_f32 v220, v220
  v_mfma_f32_16x16x32_bf16 v[100:103], a[152:155], a[92:95], v[100:103]
  s_waitcnt lgkmcnt(5)
  ds_read_b64_tr_b16 a[170:171], v7 offset:58880
  v_mul_f32 v68, v36, v68
  v_mfma_f32_16x16x32_bf16 v[104:107], a[156:159], a[88:91], v[104:107]
  s_add_u32 m0, s43, 102400
  buffer_store_dwordx4 v[176:179], v233, s[76:79], s69 offen sc1
  v_mfma_f32_16x16x32_bf16 v[108:111], a[156:159], a[92:95], v[108:111]
  s_waitcnt lgkmcnt(4)
  ds_read_b64_tr_b16 a[172:173], v8 offset:58368
  ds_read_b64_tr_b16 a[174:175], v8 offset:58880
  v_mfma_f32_16x16x32_bf16 v[112:115], a[160:163], a[88:91], v[112:115]
  s_mov_b32 s40, 3833856
  ds_read_b64_tr_b16 a[144:145], v1 offset:49152
  v_exp_f32 v221, v221
  v_mfma_f32_16x16x32_bf16 v[116:119], a[160:163], a[92:95], v[116:119]
  s_waitcnt lgkmcnt(5)
  ds_read_b64_tr_b16 a[146:147], v1 offset:49664
  v_mul_f32 v69, v37, v69
  v_mfma_f32_16x16x32_bf16 v[120:123], a[164:167], a[88:91], v[120:123]
  s_mov_b32 s69, 9216
  buffer_load_dwordx4 v12, s[96:99], s40 offen offset:0 lds
  v_mfma_f32_16x16x32_bf16 v[124:127], a[164:167], a[92:95], v[124:127]
  s_waitcnt lgkmcnt(4)
  ds_read_b64_tr_b16 a[148:149], v2 offset:49152
  ds_read_b64_tr_b16 a[150:151], v2 offset:49664
  v_mfma_f32_16x16x32_bf16 v[128:131], a[168:171], a[88:91], v[128:131]
  s_add_u32 m0, s43, 106496
  ds_read_b64_tr_b16 a[152:153], v3 offset:49152
  ds_read_b64_tr_b16 a[154:155], v3 offset:49664
  v_mfma_f32_16x16x32_bf16 v[132:135], a[168:171], a[92:95], v[132:135]
  s_waitcnt lgkmcnt(6)
  ds_read_b64_tr_b16 a[156:157], v4 offset:49152
  ds_read_b64_tr_b16 a[158:159], v4 offset:49664
  v_mfma_f32_16x16x32_bf16 v[136:139], a[172:175], a[88:91], v[136:139]
  s_waitcnt vmcnt(27) lgkmcnt(6)
  buffer_store_dwordx4 v[180:183], v233, s[76:79], s69 offen sc1
  v_mfma_f32_16x16x32_bf16 v[140:143], a[172:175], a[92:95], v[140:143]
  s_barrier
  v_mfma_f32_16x16x32_bf16 v[80:83], a[144:147], a[96:99], v[80:83]
  s_mov_b32 s40, 4128768
  ds_read_b64_tr_b16 a[160:161], v1 offset:50176
  v_exp_f32 v222, v222
  v_mfma_f32_16x16x32_bf16 v[84:87], a[144:147], a[100:103], v[84:87]
  s_waitcnt lgkmcnt(5)
  ds_read_b64_tr_b16 a[162:163], v1 offset:50688
  v_fma_f32 v220, v220, v227, v227
  v_fma_f32 v221, v221, v227, v227
  v_mfma_f32_16x16x32_bf16 v[88:91], a[148:151], a[96:99], v[88:91]
  buffer_load_dwordx4 v12, s[96:99], s40 offen offset:0 lds
  v_mfma_f32_16x16x32_bf16 v[92:95], a[148:151], a[100:103], v[92:95]
  s_waitcnt lgkmcnt(2)
  ds_read_b64_tr_b16 a[164:165], v2 offset:50176
  ds_read_b64_tr_b16 a[166:167], v2 offset:50688
  v_mfma_f32_16x16x32_bf16 v[96:99], a[152:155], a[96:99], v[96:99]
  ds_read_b64_tr_b16 a[168:169], v3 offset:50176
  v_exp_f32 v223, v223
  v_mfma_f32_16x16x32_bf16 v[100:103], a[152:155], a[100:103], v[100:103]
  s_mov_b32 s40, 4423680
  ds_read_b64_tr_b16 a[170:171], v3 offset:50688
  v_mul_f32 v70, v38, v70
  v_mfma_f32_16x16x32_bf16 v[104:107], a[156:159], a[96:99], v[104:107]
  s_add_u32 m0, s43, 110592
  ds_read_b64_tr_b16 a[172:173], v4 offset:50176
  v_rcp_f32 v220, v220
  v_mfma_f32_16x16x32_bf16 v[108:111], a[156:159], a[100:103], v[108:111]
  s_waitcnt lgkmcnt(5)
  ds_read_b64_tr_b16 a[174:175], v4 offset:50688
  v_fma_f32 v222, v222, v227, v227
  v_mfma_f32_16x16x32_bf16 v[112:115], a[160:163], a[96:99], v[112:115]
  ds_read_b64_tr_b16 a[144:145], v1 offset:57344
  v_mfma_f32_16x16x32_bf16 v[116:119], a[160:163], a[100:103], v[116:119]
  s_waitcnt lgkmcnt(5)
  ds_read_b64_tr_b16 a[146:147], v1 offset:57856
  v_rcp_f32 v221, v221
  v_mfma_f32_16x16x32_bf16 v[120:123], a[164:167], a[96:99], v[120:123]
  buffer_load_dwordx4 v12, s[96:99], s40 offen offset:0 lds
  v_mfma_f32_16x16x32_bf16 v[124:127], a[164:167], a[100:103], v[124:127]
  s_waitcnt lgkmcnt(4)
  ds_read_b64_tr_b16 a[148:149], v2 offset:57344
  ds_read_b64_tr_b16 a[150:151], v2 offset:57856
  v_mul_f32 v71, v39, v71
  v_mfma_f32_16x16x32_bf16 v[128:131], a[168:171], a[96:99], v[128:131]
  s_mov_b32 s40, 4718592
  ds_read_b64_tr_b16 a[152:153], v3 offset:57344
  v_fma_f32 v223, v223, v227, v227
  v_mfma_f32_16x16x32_bf16 v[132:135], a[168:171], a[100:103], v[132:135]
  s_waitcnt lgkmcnt(5)
  ds_read_b64_tr_b16 a[154:155], v3 offset:57856
  v_mfma_f32_16x16x32_bf16 v[136:139], a[172:175], a[96:99], v[136:139]
  s_add_u32 m0, s43, 114688
  ds_read_b64_tr_b16 a[156:157], v4 offset:57344
  v_rcp_f32 v222, v222
  v_mfma_f32_16x16x32_bf16 v[140:143], a[172:175], a[100:103], v[140:143]
  s_waitcnt lgkmcnt(5)
  ds_read_b64_tr_b16 a[158:159], v4 offset:57856
  v_mul_f32 v68, v68, v220
  v_mfma_f32_16x16x32_bf16 v[80:83], a[144:147], a[104:107], v[80:83]
  ds_read_b64_tr_b16 a[160:161], v1 offset:58368
  v_rcp_f32 v223, v223
  v_mfma_f32_16x16x32_bf16 v[84:87], a[144:147], a[108:111], v[84:87]
  s_waitcnt lgkmcnt(5)
  ds_read_b64_tr_b16 a[162:163], v1 offset:58880
  v_mul_f32 v69, v69, v221
  v_mfma_f32_16x16x32_bf16 v[88:91], a[148:151], a[104:107], v[88:91]
  buffer_load_dwordx4 v12, s[96:99], s40 offen offset:0 lds
  v_mfma_f32_16x16x32_bf16 v[92:95], a[148:151], a[108:111], v[92:95]
  s_waitcnt lgkmcnt(4)
  ds_read_b64_tr_b16 a[164:165], v2 offset:58368
  ds_read_b64_tr_b16 a[166:167], v2 offset:58880
  v_mul_f32 v70, v70, v222
  v_mfma_f32_16x16x32_bf16 v[96:99], a[152:155], a[104:107], v[96:99]
  s_mov_b32 s40, 5013504
  ds_read_b64_tr_b16 a[168:169], v3 offset:58368
  v_cvt_pk_bf16_f32 v188, v68, v69
  v_mfma_f32_16x16x32_bf16 v[100:103], a[152:155], a[108:111], v[100:103]
  s_waitcnt lgkmcnt(5)
  ds_read_b64_tr_b16 a[170:171], v3 offset:58880
  v_mul_f32 v71, v71, v223
  v_mfma_f32_16x16x32_bf16 v[104:107], a[156:159], a[104:107], v[104:107]
  s_add_u32 m0, s43, 118784
  ds_read_b64_tr_b16 a[172:173], v4 offset:58368
  v_cvt_pk_bf16_f32 v189, v70, v71
  v_mul_f32 v216, v224, v40
  v_mfma_f32_16x16x32_bf16 v[108:111], a[156:159], a[108:111], v[108:111]
  s_waitcnt lgkmcnt(5)
  ds_read_b64_tr_b16 a[174:175], v4 offset:58880
  v_mul_f32 v217, v224, v41
  v_mfma_f32_16x16x32_bf16 v[112:115], a[160:163], a[104:107], v[112:115]
  ds_read_b64_tr_b16 a[144:145], v5 offset:0
  v_mul_f32 v218, v224, v42
  v_mfma_f32_16x16x32_bf16 v[116:119], a[160:163], a[108:111], v[116:119]
  s_waitcnt lgkmcnt(5)
  ds_read_b64_tr_b16 a[146:147], v5 offset:512
  v_mul_f32 v219, v224, v43
  v_mfma_f32_16x16x32_bf16 v[120:123], a[164:167], a[104:107], v[120:123]
  buffer_load_dwordx4 v12, s[96:99], s40 offen offset:0 lds
  v_mfma_f32_16x16x32_bf16 v[124:127], a[164:167], a[108:111], v[124:127]
  s_waitcnt lgkmcnt(4)
  ds_read_b64_tr_b16 a[148:149], v6 offset:0
  ds_read_b64_tr_b16 a[150:151], v6 offset:512
  v_mfma_f32_16x16x32_bf16 v[128:131], a[168:171], a[104:107], v[128:131]
  s_add_u32 s40, s62, 0
  ds_read_b64_tr_b16 a[152:153], v7 offset:0
  v_exp_f32 v216, v216
  v_mfma_f32_16x16x32_bf16 v[132:135], a[168:171], a[108:111], v[132:135]
  s_waitcnt lgkmcnt(5)
  ds_read_b64_tr_b16 a[154:155], v7 offset:512
  v_mul_f32 v72, v40, v72
  v_mfma_f32_16x16x32_bf16 v[136:139], a[172:175], a[104:107], v[136:139]
L3_pad6:
  s_cmp_lg_u32 s82, 0
  s_cbranch_scc1 L3_pad10
  s_add_u32 m0, s42, 122880
  ds_read_b64_tr_b16 a[156:157], v8 offset:0
  v_exp_f32 v217, v217
  v_mfma_f32_16x16x32_bf16 v[140:143], a[172:175], a[108:111], v[140:143]
  s_waitcnt lgkmcnt(5)
  ds_read_b64_tr_b16 a[158:159], v8 offset:512
  v_mul_f32 v73, v41, v73
  v_mfma_f32_16x16x32_bf16 v[80:83], a[144:147], a[112:115], v[80:83]
  ds_read_b64_tr_b16 a[160:161], v5 offset:1024
  v_mfma_f32_16x16x32_bf16 v[84:87], a[144:147], a[116:119], v[84:87]
  s_waitcnt lgkmcnt(5)
  ds_read_b64_tr_b16 a[162:163], v5 offset:1536
  v_exp_f32 v218, v218
  v_mfma_f32_16x16x32_bf16 v[88:91], a[148:151], a[112:115], v[88:91]
  buffer_load_dwordx4 v13, s[12:15], s40 offen offset:0 lds
  v_mfma_f32_16x16x32_bf16 v[92:95], a[148:151], a[116:119], v[92:95]
  s_waitcnt lgkmcnt(4)
  ds_read_b64_tr_b16 a[164:165], v6 offset:1024
  ds_read_b64_tr_b16 a[166:167], v6 offset:1536
  v_fma_f32 v216, v216, v225, v225
  v_mfma_f32_16x16x32_bf16 v[96:99], a[152:155], a[112:115], v[96:99]
  ds_read_b64_tr_b16 a[168:169], v7 offset:1024
  v_fma_f32 v217, v217, v225, v225
  v_mfma_f32_16x16x32_bf16 v[100:103], a[152:155], a[116:119], v[100:103]
  s_waitcnt lgkmcnt(5)
  ds_read_b64_tr_b16 a[170:171], v7 offset:1536
  v_mfma_f32_16x16x32_bf16 v[104:107], a[156:159], a[112:115], v[104:107]
  ds_read_b64_tr_b16 a[172:173], v8 offset:1024
  v_exp_f32 v219, v219
  v_mfma_f32_16x16x32_bf16 v[108:111], a[156:159], a[116:119], v[108:111]
  s_waitcnt lgkmcnt(5)
  ds_read_b64_tr_b16 a[174:175], v8 offset:1536
  v_mul_f32 v74, v42, v74
  v_mfma_f32_16x16x32_bf16 v[112:115], a[160:163], a[112:115], v[112:115]
  ds_read_b64_tr_b16 a[144:145], v5 offset:8192
  v_rcp_f32 v216, v216
  v_mfma_f32_16x16x32_bf16 v[116:119], a[160:163], a[116:119], v[116:119]
  s_waitcnt lgkmcnt(5)
  ds_read_b64_tr_b16 a[146:147], v5 offset:8704
  v_fma_f32 v218, v218, v225, v225
  v_mfma_f32_16x16x32_bf16 v[120:123], a[164:167], a[112:115], v[120:123]
  buffer_load_dwordx4 v14, s[12:15], s40 offen offset:1024 lds
  v_mfma_f32_16x16x32_bf16 v[124:127], a[164:167], a[116:119], v[124:127]
  s_waitcnt lgkmcnt(4)
  ds_read_b64_tr_b16 a[148:149], v6 offset:8192
  ds_read_b64_tr_b16 a[150:151], v6 offset:8704
  v_mfma_f32_16x16x32_bf16 v[128:131], a[168:171], a[112:115], v[128:131]
  s_add_u32 m0, s42, 49152
  ds_read_b64_tr_b16 a[152:153], v7 offset:8192
  v_rcp_f32 v217, v217
  v_mfma_f32_16x16x32_bf16 v[132:135], a[168:171], a[116:119], v[132:135]
  s_waitcnt lgkmcnt(5)
  ds_read_b64_tr_b16 a[154:155], v7 offset:8704
  v_mul_f32 v75, v43, v75
  v_mfma_f32_16x16x32_bf16 v[136:139], a[172:175], a[112:115], v[136:139]
  s_waitcnt vmcnt(20) lgkmcnt(4)
  ds_read_b64_tr_b16 a[156:157], v8 offset:8192
  ds_read_b64_tr_b16 a[158:159], v8 offset:8704
  v_fma_f32 v219, v219, v225, v225
  v_mfma_f32_16x16x32_bf16 v[140:143], a[172:175], a[116:119], v[140:143]
  s_barrier
  v_mfma_f32_16x16x32_bf16 v[80:83], a[144:147], a[120:123], v[80:83]
  s_add_u32 s40, s62, 36864
  ds_read_b64_tr_b16 a[160:161], v5 offset:9216
  v_mfma_f32_16x16x32_bf16 v[84:87], a[144:147], a[124:127], v[84:87]
  s_waitcnt lgkmcnt(5)
  ds_read_b64_tr_b16 a[162:163], v5 offset:9728
  v_rcp_f32 v218, v218
  v_mfma_f32_16x16x32_bf16 v[88:91], a[148:151], a[120:123], v[88:91]
  buffer_load_dwordx4 v13, s[12:15], s40 offen offset:0 lds
  v_mfma_f32_16x16x32_bf16 v[92:95], a[148:151], a[124:127], v[92:95]
  s_waitcnt lgkmcnt(4)
  ds_read_b64_tr_b16 a[164:165], v6 offset:9216
  ds_read_b64_tr_b16 a[166:167], v6 offset:9728
  v_mfma_f32_16x16x32_bf16 v[96:99], a[152:155], a[120:123], v[96:99]
  ds_read_b64_tr_b16 a[168:169], v7 offset:9216
  v_mul_f32 v72, v72, v216
  v_mfma_f32_16x16x32_bf16 v[100:103], a[152:155], a[124:127], v[100:103]
  s_waitcnt lgkmcnt(5)
  ds_read_b64_tr_b16 a[170:171], v7 offset:9728
  v_rcp_f32 v219, v219
  v_mfma_f32_16x16x32_bf16 v[104:107], a[156:159], a[120:123], v[104:107]
  ds_read_b64_tr_b16 a[172:173], v8 offset:9216
  v_mul_f32 v73, v73, v217
  v_mfma_f32_16x16x32_bf16 v[108:111], a[156:159], a[124:127], v[108:111]
  s_waitcnt lgkmcnt(5)
  ds_read_b64_tr_b16 a[174:175], v8 offset:9728
  v_mul_f32 v74, v74, v218
  v_cvt_pk_bf16_f32 v186, v72, v73
  v_mfma_f32_16x16x32_bf16 v[112:115], a[160:163], a[120:123], v[112:115]
  ds_read_b64_tr_b16 a[144:145], v5 offset:16384
  v_mul_f32 v75, v75, v219
  v_mfma_f32_16x16x32_bf16 v[116:119], a[160:163], a[124:127], v[116:119]
  s_waitcnt lgkmcnt(5)
  ds_read_b64_tr_b16 a[146:147], v5 offset:16896
  v_cvt_pk_bf16_f32 v187, v74, v75
  v_mfma_f32_16x16x32_bf16 v[120:123], a[164:167], a[120:123], v[120:123]
  buffer_load_dwordx4 v14, s[12:15], s40 offen offset:1024 lds
  v_mfma_f32_16x16x32_bf16 v[124:127], a[164:167], a[124:127], v[124:127]
  s_waitcnt lgkmcnt(4)
  ds_read_b64_tr_b16 a[148:149], v6 offset:16384
  ds_read_b64_tr_b16 a[150:151], v6 offset:16896
  v_mfma_f32_16x16x32_bf16 v[128:131], a[168:171], a[120:123], v[128:131]
  s_add_u32 s40, s62, 73728
  ds_read_b64_tr_b16 a[152:153], v7 offset:16384
  v_mul_f32 v220, v226, v44
  v_mul_f32 v221, v226, v45
  v_mfma_f32_16x16x32_bf16 v[132:135], a[168:171], a[124:127], v[132:135]
  s_waitcnt lgkmcnt(5)
  ds_read_b64_tr_b16 a[154:155], v7 offset:16896
  v_mul_f32 v222, v226, v46
  v_mfma_f32_16x16x32_bf16 v[136:139], a[172:175], a[120:123], v[136:139]
  s_add_u32 m0, s42, 57344
  ds_read_b64_tr_b16 a[156:157], v8 offset:16384
  v_mul_f32 v223, v226, v47
  v_mfma_f32_16x16x32_bf16 v[140:143], a[172:175], a[124:127], v[140:143]
  s_waitcnt lgkmcnt(5)
  ds_read_b64_tr_b16 a[158:159], v8 offset:16896
  v_exp_f32 v220, v220
  v_mfma_f32_16x16x32_bf16 v[80:83], a[144:147], a[128:131], v[80:83]
  ds_read_b64_tr_b16 a[160:161], v5 offset:17408
  v_mul_f32 v76, v44, v76
  v_mfma_f32_16x16x32_bf16 v[84:87], a[144:147], a[132:135], v[84:87]
  s_waitcnt lgkmcnt(5)
  ds_read_b64_tr_b16 a[162:163], v5 offset:17920
  v_mfma_f32_16x16x32_bf16 v[88:91], a[148:151], a[128:131], v[88:91]
  buffer_load_dwordx4 v13, s[12:15], s40 offen offset:0 lds
  v_mfma_f32_16x16x32_bf16 v[92:95], a[148:151], a[132:135], v[92:95]
  s_waitcnt lgkmcnt(4)
  ds_read_b64_tr_b16 a[164:165], v6 offset:17408
  ds_read_b64_tr_b16 a[166:167], v6 offset:17920
  v_mfma_f32_16x16x32_bf16 v[96:99], a[152:155], a[128:131], v[96:99]
  ds_read_b64_tr_b16 a[168:169], v7 offset:17408
  v_exp_f32 v221, v221
  v_mfma_f32_16x16x32_bf16 v[100:103], a[152:155], a[132:135], v[100:103]
  s_waitcnt lgkmcnt(5)
  ds_read_b64_tr_b16 a[170:171], v7 offset:17920
  v_mul_f32 v77, v45, v77
  v_mfma_f32_16x16x32_bf16 v[104:107], a[156:159], a[128:131], v[104:107]
  ds_read_b64_tr_b16 a[172:173], v8 offset:17408
  v_exp_f32 v222, v222
  v_mfma_f32_16x16x32_bf16 v[108:111], a[156:159], a[132:135], v[108:111]
  s_waitcnt lgkmcnt(5)
  ds_read_b64_tr_b16 a[174:175], v8 offset:17920
  v_fma_f32 v220, v220, v227, v227
  v_fma_f32 v221, v221, v227, v227
  v_mfma_f32_16x16x32_bf16 v[112:115], a[160:163], a[128:131], v[112:115]
  ds_read_b64_tr_b16 a[144:145], v5 offset:24576
  v_mfma_f32_16x16x32_bf16 v[116:119], a[160:163], a[132:135], v[116:119]
  s_waitcnt lgkmcnt(5)
  ds_read_b64_tr_b16 a[146:147], v5 offset:25088
  v_exp_f32 v223, v223
  v_mfma_f32_16x16x32_bf16 v[120:123], a[164:167], a[128:131], v[120:123]
  buffer_load_dwordx4 v14, s[12:15], s40 offen offset:1024 lds
  v_mfma_f32_16x16x32_bf16 v[124:127], a[164:167], a[132:135], v[124:127]
  s_waitcnt lgkmcnt(4)
  ds_read_b64_tr_b16 a[148:149], v6 offset:24576
  ds_read_b64_tr_b16 a[150:151], v6 offset:25088
  v_mfma_f32_16x16x32_bf16 v[128:131], a[168:171], a[128:131], v[128:131]
  s_add_u32 s40, s62, 110592
  ds_read_b64_tr_b16 a[152:153], v7 offset:24576
  v_mul_f32 v78, v46, v78
  v_mfma_f32_16x16x32_bf16 v[132:135], a[168:171], a[132:135], v[132:135]
  s_waitcnt lgkmcnt(5)
  ds_read_b64_tr_b16 a[154:155], v7 offset:25088
  v_rcp_f32 v220, v220
  v_mfma_f32_16x16x32_bf16 v[136:139], a[172:175], a[128:131], v[136:139]
  s_add_u32 m0, s42, 65536
  ds_read_b64_tr_b16 a[156:157], v8 offset:24576
  v_fma_f32 v222, v222, v227, v227
  v_mfma_f32_16x16x32_bf16 v[140:143], a[172:175], a[132:135], v[140:143]
  s_waitcnt lgkmcnt(5)
  ds_read_b64_tr_b16 a[158:159], v8 offset:25088
  v_rcp_f32 v221, v221
  v_mfma_f32_16x16x32_bf16 v[80:83], a[144:147], a[136:139], v[80:83]
  ds_read_b64_tr_b16 a[160:161], v5 offset:25600
  v_mul_f32 v79, v47, v79
  v_mfma_f32_16x16x32_bf16 v[84:87], a[144:147], a[140:143], v[84:87]
  s_waitcnt lgkmcnt(5)
  ds_read_b64_tr_b16 a[162:163], v5 offset:26112
  v_fma_f32 v223, v223, v227, v227
  v_mfma_f32_16x16x32_bf16 v[88:91], a[148:151], a[136:139], v[88:91]
  buffer_load_dwordx4 v13, s[12:15], s40 offen offset:0 lds
  v_mfma_f32_16x16x32_bf16 v[92:95], a[148:151], a[140:143], v[92:95]
  s_waitcnt lgkmcnt(4)
  ds_read_b64_tr_b16 a[164:165], v6 offset:25600
  ds_read_b64_tr_b16 a[166:167], v6 offset:26112
  v_mfma_f32_16x16x32_bf16 v[96:99], a[152:155], a[136:139], v[96:99]
  ds_read_b64_tr_b16 a[168:169], v7 offset:25600
  v_rcp_f32 v222, v222
  v_mfma_f32_16x16x32_bf16 v[100:103], a[152:155], a[140:143], v[100:103]
  s_waitcnt lgkmcnt(5)
  ds_read_b64_tr_b16 a[170:171], v7 offset:26112
  v_mul_f32 v76, v76, v220
  v_mfma_f32_16x16x32_bf16 v[104:107], a[156:159], a[136:139], v[104:107]
  ds_read_b64_tr_b16 a[172:173], v8 offset:25600
  v_mfma_f32_16x16x32_bf16 v[108:111], a[156:159], a[140:143], v[108:111]
  s_waitcnt lgkmcnt(5)
  ds_read_b64_tr_b16 a[174:175], v8 offset:26112
  v_rcp_f32 v223, v223
  v_mfma_f32_16x16x32_bf16 v[112:115], a[160:163], a[136:139], v[112:115]
  ds_read_b64_tr_b16 a[144:145], v9 offset:0
  v_mul_f32 v77, v77, v221
  v_mul_f32 v78, v78, v222
  v_mfma_f32_16x16x32_bf16 v[116:119], a[160:163], a[140:143], v[116:119]
  s_waitcnt lgkmcnt(5)
  ds_read_b64_tr_b16 a[146:147], v9 offset:256
  v_cvt_pk_bf16_f32 v190, v76, v77
  v_mfma_f32_16x16x32_bf16 v[120:123], a[164:167], a[136:139], v[120:123]
  buffer_load_dwordx4 v14, s[12:15], s40 offen offset:1024 lds
  v_mfma_f32_16x16x32_bf16 v[124:127], a[164:167], a[140:143], v[124:127]
  s_waitcnt lgkmcnt(4)
  v_mul_f32 v79, v79, v223
  v_cvt_pk_bf16_f32 v191, v78, v79
  v_mfma_f32_16x16x32_bf16 v[128:131], a[168:171], a[136:139], v[128:131]
  s_add_u32 m0, s42, 73728
  ds_read_b64_tr_b16 a[148:149], v10 offset:0
  v_mfma_f32_16x16x32_bf16 v[132:135], a[168:171], a[140:143], v[132:135]
  s_waitcnt lgkmcnt(3)
  ds_read_b64_tr_b16 a[150:151], v10 offset:256
  v_mfma_f32_16x16x32_bf16 v[136:139], a[172:175], a[136:139], v[136:139]
  s_waitcnt vmcnt(20)
  ds_read_b64_tr_b16 a[152:153], v9 offset:2048
  v_mfma_f32_16x16x32_bf16 v[140:143], a[172:175], a[140:143], v[140:143]
  s_barrier
  v_mfma_f32_16x16x16_bf16 v[80:83], a[176:177], a[192:193], v[80:83]
  s_add_u32 s40, s62, 147456
  ds_read_b64_tr_b16 a[154:155], v9 offset:2304
  v_mfma_f32_16x16x16_bf16 v[112:115], a[184:185], a[192:193], v[112:115]
  ds_read_b64_tr_b16 a[156:157], v10 offset:2048
  v_mfma_f32_16x16x16_bf16 v[88:91], a[178:179], a[192:193], v[88:91]
  buffer_load_dwordx4 v13, s[12:15], s40 offen offset:0 lds
  v_mfma_f32_16x16x16_bf16 v[120:123], a[186:187], a[192:193], v[120:123]
  s_mov_b32 s69, 10240
  ds_read_b64_tr_b16 a[158:159], v10 offset:2304
  v_mfma_f32_16x16x16_bf16 v[96:99], a[180:181], a[192:193], v[96:99]
  ds_read_b64_tr_b16 a[160:161], v9 offset:4096
  v_mul_f32 v216, v224, v80
  v_mfma_f32_16x16x16_bf16 v[128:131], a[188:189], a[192:193], v[128:131]
  ds_read_b64_tr_b16 a[162:163], v9 offset:4352
  v_mul_f32 v217, v224, v81
  v_mfma_f32_16x16x16_bf16 v[104:107], a[182:183], a[192:193], v[104:107]
  buffer_store_dwordx4 v[184:187], v233, s[76:79], s69 offen sc1
  v_mfma_f32_16x16x16_bf16 v[136:139], a[190:191], a[192:193], v[136:139]
  ds_read_b64_tr_b16 a[164:165], v10 offset:4096
  v_mul_f32 v218, v224, v82
  v_mul_f32 v219, v224, v83
  v_mfma_f32_16x16x16_bf16 v[84:87], a[176:177], a[194:195], v[84:87]
  ds_read_b64_tr_b16 a[166:167], v10 offset:4352
  v_mfma_f32_16x16x16_bf16 v[116:119], a[184:185], a[194:195], v[116:119]
  ds_read_b64_tr_b16 a[168:169], v9 offset:6144
  v_exp_f32 v216, v216
  v_mfma_f32_16x16x16_bf16 v[92:95], a[178:179], a[194:195], v[92:95]
  buffer_load_dwordx4 v14, s[12:15], s40 offen offset:1024 lds
  v_mfma_f32_16x16x16_bf16 v[124:127], a[186:187], a[194:195], v[124:127]
  s_mov_b32 s69, 11264
  ds_read_b64_tr_b16 a[170:171], v9 offset:6400
  v_mul_f32 v112, v80, v112
  v_mfma_f32_16x16x16_bf16 v[100:103], a[180:181], a[194:195], v[100:103]
  ds_read_b64_tr_b16 a[172:173], v10 offset:6144
  v_exp_f32 v217, v217
  v_mfma_f32_16x16x16_bf16 v[132:135], a[188:189], a[194:195], v[132:135]
  s_add_u32 s40, s62, 184320
  ds_read_b64_tr_b16 a[174:175], v10 offset:6400
  v_mul_f32 v113, v81, v113
  v_mfma_f32_16x16x16_bf16 v[108:111], a[182:183], a[194:195], v[108:111]
  s_add_u32 m0, s42, 81920
  buffer_store_dwordx4 v[188:191], v233, s[76:79], s69 offen sc1
  v_mfma_f32_16x16x16_bf16 v[140:143], a[190:191], a[194:195], v[140:143]
  s_waitcnt lgkmcnt(3)
  v_exp_f32 v218, v218
  v_fma_f32 v216, v216, v225, v225
  v_mfma_f32_16x16x32_bf16 v[16:19], a[144:147], a[0:3], 0
  v_fma_f32 v217, v217, v225, v225
  v_exp_f32 v219, v219
  v_mfma_f32_16x16x32_bf16 v[20:23], a[144:147], a[4:7], 0
  ds_read_b64_tr_b16 a[144:145], v9 offset:8192
  v_mul_f32 v114, v82, v114
  v_mfma_f32_16x16x32_bf16 v[24:27], a[148:151], a[0:3], 0
  buffer_load_dwordx4 v13, s[12:15], s40 offen offset:0 lds
  v_mfma_f32_16x16x32_bf16 v[28:31], a[148:151], a[4:7], 0
  ds_read_b64_tr_b16 a[146:147], v9 offset:8448
  v_rcp_f32 v216, v216
  v_mfma_f32_16x16x32_bf16 v[32:35], a[152:155], a[0:3], 0
  ds_read_b64_tr_b16 a[148:149], v10 offset:8192
  v_fma_f32 v218, v218, v225, v225
  v_mfma_f32_16x16x32_bf16 v[36:39], a[152:155], a[4:7], 0
  ds_read_b64_tr_b16 a[150:151], v10 offset:8448
  v_rcp_f32 v217, v217
  v_mfma_f32_16x16x32_bf16 v[40:43], a[156:159], a[0:3], 0
  ds_read_b64_tr_b16 a[152:153], v9 offset:10240
  v_mul_f32 v115, v83, v115
  v_fma_f32 v219, v219, v225, v225
  v_mfma_f32_16x16x32_bf16 v[44:47], a[156:159], a[4:7], 0
  ds_read_b64_tr_b16 a[154:155], v9 offset:10496
  v_rcp_f32 v218, v218
  v_mfma_f32_16x16x32_bf16 v[16:19], a[160:163], a[8:11], v[16:19]
  ds_read_b64_tr_b16 a[156:157], v10 offset:10240
  v_sub_u32 v1, v1, v230
  v_mul_f32 v112, v112, v216
  v_mfma_f32_16x16x32_bf16 v[20:23], a[160:163], a[12:15], v[20:23]
  ds_read_b64_tr_b16 a[158:159], v10 offset:10496
  v_sub_u32 v2, v2, v230
  v_mfma_f32_16x16x32_bf16 v[24:27], a[164:167], a[8:11], v[24:27]
  buffer_load_dwordx4 v14, s[12:15], s40 offen offset:1024 lds
  v_mfma_f32_16x16x32_bf16 v[28:31], a[164:167], a[12:15], v[28:31]
  s_waitcnt lgkmcnt(4)
  ds_read_b64_tr_b16 a[160:161], v9 offset:12288
  v_sub_u32 v3, v3, v230
  v_mfma_f32_16x16x32_bf16 v[32:35], a[168:171], a[8:11], v[32:35]
  ds_read_b64_tr_b16 a[162:163], v9 offset:12544
  v_sub_u32 v4, v4, v230
  v_mfma_f32_16x16x32_bf16 v[36:39], a[168:171], a[12:15], v[36:39]
  ds_read_b64_tr_b16 a[164:165], v10 offset:12288
  v_sub_u32 v5, v5, v230
  v_mfma_f32_16x16x32_bf16 v[40:43], a[172:175], a[8:11], v[40:43]
  s_add_u32 m0, s42, 90112
  ds_read_b64_tr_b16 a[166:167], v10 offset:12544
  v_sub_u32 v6, v6, v230
  v_mfma_f32_16x16x32_bf16 v[44:47], a[172:175], a[12:15], v[44:47]
  s_add_u32 s40, s62, 221184
  ds_read_b64_tr_b16 a[168:169], v9 offset:14336
  v_sub_u32 v7, v7, v230
  v_mfma_f32_16x16x32_bf16 v[16:19], a[144:147], a[16:19], v[16:19]
  ds_read_b64_tr_b16 a[170:171], v9 offset:14592
  v_sub_u32 v8, v8, v230
  v_mfma_f32_16x16x32_bf16 v[20:23], a[144:147], a[20:23], v[20:23]
  ds_read_b64_tr_b16 a[172:173], v10 offset:14336
  v_rcp_f32 v219, v219
  v_mfma_f32_16x16x32_bf16 v[24:27], a[148:151], a[16:19], v[24:27]
  buffer_load_dwordx4 v13, s[12:15], s40 offen offset:0 lds
  v_mfma_f32_16x16x32_bf16 v[28:31], a[148:151], a[20:23], v[28:31]
  s_waitcnt lgkmcnt(4)
  ds_read_b64_tr_b16 a[174:175], v10 offset:14592
  v_mul_f32 v113, v113, v217
  v_mul_f32 v114, v114, v218
  v_mfma_f32_16x16x32_bf16 v[32:35], a[152:155], a[16:19], v[32:35]
  ds_read_b64_tr_b16 a[144:145], v9 offset:16384
  v_cvt_pk_bf16_f32 v192, v112, v113
  v_mul_f32 v115, v115, v219
  v_mfma_f32_16x16x32_bf16 v[36:39], a[152:155], a[20:23], v[36:39]
  ds_read_b64_tr_b16 a[146:147], v9 offset:16640
  v_cvt_pk_bf16_f32 v193, v114, v115
  v_mul_f32 v220, v226, v84
  v_mfma_f32_16x16x32_bf16 v[40:43], a[156:159], a[16:19], v[40:43]
  ds_read_b64_tr_b16 a[148:149], v10 offset:16384
  v_mul_f32 v221, v226, v85
  v_mul_f32 v222, v226, v86
  v_mfma_f32_16x16x32_bf16 v[44:47], a[156:159], a[20:23], v[44:47]
  ds_read_b64_tr_b16 a[150:151], v10 offset:16640
  v_mul_f32 v223, v226, v87
  v_mfma_f32_16x16x32_bf16 v[16:19], a[160:163], a[24:27], v[16:19]
  ds_read_b64_tr_b16 a[152:153], v9 offset:18432
  v_exp_f32 v220, v220
  v_mfma_f32_16x16x32_bf16 v[20:23], a[160:163], a[28:31], v[20:23]
  s_waitcnt lgkmcnt(5)
  ds_read_b64_tr_b16 a[154:155], v9 offset:18688
  v_mul_f32 v116, v84, v116
  v_mfma_f32_16x16x32_bf16 v[24:27], a[164:167], a[24:27], v[24:27]
  buffer_load_dwordx4 v14, s[12:15], s40 offen offset:1024 lds
  v_mfma_f32_16x16x32_bf16 v[28:31], a[164:167], a[28:31], v[28:31]
  s_add_u32 s68, s67, 0
  ds_read_b64_tr_b16 a[156:157], v10 offset:18432
  v_exp_f32 v221, v221
  v_mfma_f32_16x16x32_bf16 v[32:35], a[168:171], a[24:27], v[32:35]
  ds_read_b64_tr_b16 a[158:159], v10 offset:18688
  v_mul_f32 v117, v85, v117
  v_mfma_f32_16x16x32_bf16 v[36:39], a[168:171], a[28:31], v[36:39]
  ds_read_b64_tr_b16 a[160:161], v9 offset:20480
  v_exp_f32 v222, v222
  v_mfma_f32_16x16x32_bf16 v[40:43], a[172:175], a[24:27], v[40:43]
  buffer_load_dwordx2 a[176:177], v232, s[20:23], s68 offen offset:0 sc1
  v_mfma_f32_16x16x32_bf16 v[44:47], a[172:175], a[28:31], v[44:47]
  s_waitcnt lgkmcnt(3)
  ds_read_b64_tr_b16 a[162:163], v9 offset:20736
  v_fma_f32 v220, v220, v227, v227
  v_fma_f32 v221, v221, v227, v227
  v_mfma_f32_16x16x32_bf16 v[16:19], a[144:147], a[32:35], v[16:19]
  ds_read_b64_tr_b16 a[164:165], v10 offset:20480
  v_mfma_f32_16x16x32_bf16 v[20:23], a[144:147], a[36:39], v[20:23]
  ds_read_b64_tr_b16 a[166:167], v10 offset:20736
  v_exp_f32 v223, v223
  v_mfma_f32_16x16x32_bf16 v[24:27], a[148:151], a[32:35], v[24:27]
  buffer_load_dwordx2 a[178:179], v232, s[20:23], s68 offen offset:128 sc1
  v_mfma_f32_16x16x32_bf16 v[28:31], a[148:151], a[36:39], v[28:31]
  s_add_u32 s68, s67, 36864
  ds_read_b64_tr_b16 a[168:169], v9 offset:22528
  v_mul_f32 v118, v86, v118
  v_mfma_f32_16x16x32_bf16 v[32:35], a[152:155], a[32:35], v[32:35]
  ds_read_b64_tr_b16 a[170:171], v9 offset:22784
  v_rcp_f32 v220, v220
  v_mfma_f32_16x16x32_bf16 v[36:39], a[152:155], a[36:39], v[36:39]
  s_waitcnt lgkmcnt(4)
  ds_read_b64_tr_b16 a[172:173], v10 offset:22528
  v_fma_f32 v222, v222, v227, v227
  v_mfma_f32_16x16x32_bf16 v[40:43], a[156:159], a[32:35], v[40:43]
  buffer_load_dwordx2 a[184:185], v232, s[20:23], s68 offen offset:0 sc1
  v_mfma_f32_16x16x32_bf16 v[44:47], a[156:159], a[36:39], v[44:47]
  ds_read_b64_tr_b16 a[174:175], v10 offset:22784
  v_rcp_f32 v221, v221
  v_mfma_f32_16x16x32_bf16 v[16:19], a[160:163], a[40:43], v[16:19]
  ds_read_b64_tr_b16 a[144:145], v9 offset:24576
  v_mul_f32 v119, v87, v119
  v_fma_f32 v223, v223, v227, v227
  v_mfma_f32_16x16x32_bf16 v[20:23], a[160:163], a[44:47], v[20:23]
  s_waitcnt lgkmcnt(4)
  ds_read_b64_tr_b16 a[146:147], v9 offset:24832
  v_mfma_f32_16x16x32_bf16 v[24:27], a[164:167], a[40:43], v[24:27]
  buffer_load_dwordx2 a[186:187], v232, s[20:23], s68 offen offset:128 sc1
  v_mfma_f32_16x16x32_bf16 v[28:31], a[164:167], a[44:47], v[28:31]
  s_waitcnt lgkmcnt(3)
  ds_read_b64_tr_b16 a[148:149], v10 offset:24576
  ds_read_b64_tr_b16 a[150:151], v10 offset:24832
  v_mfma_f32_16x16x32_bf16 v[32:35], a[168:171], a[40:43], v[32:35]
  s_add_u32 m0, s42, 0
  ds_read_b64_tr_b16 a[152:153], v9 offset:26624
  v_rcp_f32 v222, v222
  v_mfma_f32_16x16x32_bf16 v[36:39], a[168:171], a[44:47], v[36:39]
  s_waitcnt lgkmcnt(5)
  ds_read_b64_tr_b16 a[154:155], v9 offset:26880
  v_mul_f32 v116, v116, v220
  v_mfma_f32_16x16x32_bf16 v[40:43], a[172:175], a[40:43], v[40:43]
  s_waitcnt vmcnt(25) lgkmcnt(4)
  ds_read_b64_tr_b16 a[156:157], v10 offset:26624
  ds_read_b64_tr_b16 a[158:159], v10 offset:26880
  v_mfma_f32_16x16x32_bf16 v[44:47], a[172:175], a[44:47], v[44:47]
  s_barrier
  v_mfma_f32_16x16x32_bf16 v[16:19], a[144:147], a[48:51], v[16:19]
  s_add_u32 s40, s62, 258048
  ds_read_b64_tr_b16 a[160:161], v9 offset:28672
  v_rcp_f32 v223, v223
  v_mfma_f32_16x16x32_bf16 v[20:23], a[144:147], a[52:55], v[20:23]
  s_waitcnt lgkmcnt(5)
  ds_read_b64_tr_b16 a[162:163], v9 offset:28928
  v_mul_f32 v117, v117, v221
  v_mul_f32 v118, v118, v222
  v_mfma_f32_16x16x32_bf16 v[24:27], a[148:151], a[48:51], v[24:27]
  buffer_load_dwordx4 v13, s[12:15], s40 offen offset:0 lds
  v_mfma_f32_16x16x32_bf16 v[28:31], a[148:151], a[52:55], v[28:31]
  s_waitcnt lgkmcnt(4)
  ds_read_b64_tr_b16 a[164:165], v10 offset:28672
  ds_read_b64_tr_b16 a[166:167], v10 offset:28928
  v_cvt_pk_bf16_f32 v196, v116, v117
  v_mfma_f32_16x16x32_bf16 v[32:35], a[152:155], a[48:51], v[32:35]
  ds_read_b64_tr_b16 a[168:169], v9 offset:30720
  v_mul_f32 v119, v119, v223
  v_cvt_pk_bf16_f32 v197, v118, v119
  v_mfma_f32_16x16x32_bf16 v[36:39], a[152:155], a[52:55], v[36:39]
  s_waitcnt lgkmcnt(5)
  ds_read_b64_tr_b16 a[170:171], v9 offset:30976
  v_mul_f32 v216, v224, v88
  v_mul_f32 v217, v224, v89
  v_mfma_f32_16x16x32_bf16 v[40:43], a[156:159], a[48:51], v[40:43]
  s_waitcnt vmcnt(9)
  buffer_store_dwordx2 a[224:225], v240, s[32:35], 0 offen offset:0 sc1
  v_mfma_f32_16x16x32_bf16 v[44:47], a[156:159], a[52:55], v[44:47]
  s_waitcnt lgkmcnt(4)
  ds_read_b64_tr_b16 a[172:173], v10 offset:30720
  ds_read_b64_tr_b16 a[174:175], v10 offset:30976
  v_mfma_f32_16x16x32_bf16 v[16:19], a[160:163], a[56:59], v[16:19]
  ds_read_b64_tr_b16 a[144:145], v9 offset:32768
  v_mul_f32 v218, v224, v90
  v_mul_f32 v219, v224, v91
  v_mfma_f32_16x16x32_bf16 v[20:23], a[160:163], a[60:63], v[20:23]
  s_waitcnt lgkmcnt(5)
  ds_read_b64_tr_b16 a[146:147], v9 offset:33024
  v_mfma_f32_16x16x32_bf16 v[24:27], a[164:167], a[56:59], v[24:27]
  buffer_load_dwordx4 v14, s[12:15], s40 offen offset:1024 lds
  v_mfma_f32_16x16x32_bf16 v[28:31], a[164:167], a[60:63], v[28:31]
  s_waitcnt lgkmcnt(4)
  ds_read_b64_tr_b16 a[148:149], v10 offset:32768
  ds_read_b64_tr_b16 a[150:151], v10 offset:33024
  v_mfma_f32_16x16x32_bf16 v[32:35], a[168:171], a[56:59], v[32:35]
  s_add_u32 s40, s62, 256
  ds_read_b64_tr_b16 a[152:153], v9 offset:34816
  v_exp_f32 v216, v216
  v_mfma_f32_16x16x32_bf16 v[36:39], a[168:171], a[60:63], v[36:39]
  s_waitcnt lgkmcnt(5)
  ds_read_b64_tr_b16 a[154:155], v9 offset:35072
  v_mul_f32 v120, v88, v120
  v_mfma_f32_16x16x32_bf16 v[40:43], a[172:175], a[56:59], v[40:43]
  s_add_u32 m0, s42, 8192
  ds_read_b64_tr_b16 a[156:157], v10 offset:34816
  v_exp_f32 v217, v217
  v_mfma_f32_16x16x32_bf16 v[44:47], a[172:175], a[60:63], v[44:47]
  s_waitcnt lgkmcnt(5)
  ds_read_b64_tr_b16 a[158:159], v10 offset:35072
  v_mul_f32 v121, v89, v121
  v_mfma_f32_16x16x32_bf16 v[16:19], a[144:147], a[64:67], v[16:19]
  ds_read_b64_tr_b16 a[160:161], v9 offset:36864
  v_exp_f32 v218, v218
  v_mfma_f32_16x16x32_bf16 v[20:23], a[144:147], a[68:71], v[20:23]
  s_waitcnt lgkmcnt(5)
  ds_read_b64_tr_b16 a[162:163], v9 offset:37120
  v_fma_f32 v216, v216, v225, v225
  v_fma_f32 v217, v217, v225, v225
  v_mfma_f32_16x16x32_bf16 v[24:27], a[148:151], a[64:67], v[24:27]
  buffer_load_dwordx4 v13, s[12:15], s40 offen offset:0 lds
  v_mfma_f32_16x16x32_bf16 v[28:31], a[148:151], a[68:71], v[28:31]
  s_waitcnt lgkmcnt(4)
  ds_read_b64_tr_b16 a[164:165], v10 offset:36864
  ds_read_b64_tr_b16 a[166:167], v10 offset:37120
  v_mfma_f32_16x16x32_bf16 v[32:35], a[152:155], a[64:67], v[32:35]
  ds_read_b64_tr_b16 a[168:169], v9 offset:38912
  v_exp_f32 v219, v219
  v_mfma_f32_16x16x32_bf16 v[36:39], a[152:155], a[68:71], v[36:39]
  s_waitcnt lgkmcnt(5)
  ds_read_b64_tr_b16 a[170:171], v9 offset:39168
  v_mul_f32 v122, v90, v122
  v_mfma_f32_16x16x32_bf16 v[40:43], a[156:159], a[64:67], v[40:43]
  ds_read_b64_tr_b16 a[172:173], v10 offset:38912
  v_rcp_f32 v216, v216
  v_mfma_f32_16x16x32_bf16 v[44:47], a[156:159], a[68:71], v[44:47]
  s_waitcnt lgkmcnt(5)
  ds_read_b64_tr_b16 a[174:175], v10 offset:39168
  v_fma_f32 v218, v218, v225, v225
  v_mfma_f32_16x16x32_bf16 v[16:19], a[160:163], a[72:75], v[16:19]
  ds_read_b64_tr_b16 a[144:145], v9 offset:40960
  v_rcp_f32 v217, v217
  v_mfma_f32_16x16x32_bf16 v[20:23], a[160:163], a[76:79], v[20:23]
  s_waitcnt lgkmcnt(5)
  ds_read_b64_tr_b16 a[146:147], v9 offset:41216
  v_mul_f32 v123, v91, v123
  v_fma_f32 v219, v219, v225, v225
  v_mfma_f32_16x16x32_bf16 v[24:27], a[164:167], a[72:75], v[24:27]
  buffer_load_dwordx4 v14, s[12:15], s40 offen offset:1024 lds
  v_mfma_f32_16x16x32_bf16 v[28:31], a[164:167], a[76:79], v[28:31]
  s_waitcnt lgkmcnt(4)
  ds_read_b64_tr_b16 a[148:149], v10 offset:40960
  ds_read_b64_tr_b16 a[150:151], v10 offset:41216
  v_mfma_f32_16x16x32_bf16 v[32:35], a[168:171], a[72:75], v[32:35]
  s_add_u32 s40, s62, 37120
  ds_read_b64_tr_b16 a[152:153], v9 offset:43008
  v_rcp_f32 v218, v218
  v_mfma_f32_16x16x32_bf16 v[36:39], a[168:171], a[76:79], v[36:39]
  s_waitcnt lgkmcnt(5)
  ds_read_b64_tr_b16 a[154:155], v9 offset:43264
  v_mul_f32 v120, v120, v216
  v_mfma_f32_16x16x32_bf16 v[40:43], a[172:175], a[72:75], v[40:43]
  s_add_u32 m0, s42, 16384
  ds_read_b64_tr_b16 a[156:157], v10 offset:43008
  v_rcp_f32 v219, v219
  v_mfma_f32_16x16x32_bf16 v[44:47], a[172:175], a[76:79], v[44:47]
  s_waitcnt lgkmcnt(5)
  ds_read_b64_tr_b16 a[158:159], v10 offset:43264
  v_mul_f32 v121, v121, v217
  v_mfma_f32_16x16x32_bf16 v[16:19], a[144:147], a[80:83], v[16:19]
  ds_read_b64_tr_b16 a[160:161], v9 offset:45056
  v_mul_f32 v122, v122, v218
  v_cvt_pk_bf16_f32 v194, v120, v121
  v_mfma_f32_16x16x32_bf16 v[20:23], a[144:147], a[84:87], v[20:23]
  s_waitcnt lgkmcnt(5)
  ds_read_b64_tr_b16 a[162:163], v9 offset:45312
  v_mul_f32 v123, v123, v219
  v_mfma_f32_16x16x32_bf16 v[24:27], a[148:151], a[80:83], v[24:27]
  buffer_load_dwordx4 v13, s[12:15], s40 offen offset:0 lds
  v_mfma_f32_16x16x32_bf16 v[28:31], a[148:151], a[84:87], v[28:31]
  s_waitcnt lgkmcnt(4)
  ds_read_b64_tr_b16 a[164:165], v10 offset:45056
  ds_read_b64_tr_b16 a[166:167], v10 offset:45312
  v_mfma_f32_16x16x32_bf16 v[32:35], a[152:155], a[80:83], v[32:35]
  ds_read_b64_tr_b16 a[168:169], v9 offset:47104
  v_cvt_pk_bf16_f32 v195, v122, v123
  v_mul_f32 v220, v226, v92
  v_mfma_f32_16x16x32_bf16 v[36:39], a[152:155], a[84:87], v[36:39]
  s_waitcnt lgkmcnt(5)
  ds_read_b64_tr_b16 a[170:171], v9 offset:47360
  v_mul_f32 v221, v226, v93
  v_mfma_f32_16x16x32_bf16 v[40:43], a[156:159], a[80:83], v[40:43]
  ds_read_b64_tr_b16 a[172:173], v10 offset:47104
  v_mul_f32 v222, v226, v94
  v_mul_f32 v223, v226, v95
  v_mfma_f32_16x16x32_bf16 v[44:47], a[156:159], a[84:87], v[44:47]
  s_waitcnt lgkmcnt(5)
  ds_read_b64_tr_b16 a[174:175], v10 offset:47360
  v_mfma_f32_16x16x32_bf16 v[16:19], a[160:163], a[88:91], v[16:19]
  ds_read_b64_tr_b16 a[144:145], v252 offset:32768
  v_exp_f32 v220, v220
  v_mfma_f32_16x16x32_bf16 v[20:23], a[160:163], a[92:95], v[20:23]
  s_waitcnt lgkmcnt(5)
  ds_read_b64_tr_b16 a[146:147], v252 offset:33024
  v_mul_f32 v124, v92, v124
  v_mfma_f32_16x16x32_bf16 v[24:27], a[164:167], a[88:91], v[24:27]
  buffer_load_dwordx4 v14, s[12:15], s40 offen offset:1024 lds
  v_mfma_f32_16x16x32_bf16 v[28:31], a[164:167], a[92:95], v[28:31]
  s_waitcnt lgkmcnt(4)
  ds_read_b64_tr_b16 a[148:149], v253 offset:32768
  ds_read_b64_tr_b16 a[150:151], v253 offset:33024
  v_mfma_f32_16x16x32_bf16 v[32:35], a[168:171], a[88:91], v[32:35]
  s_add_u32 m0, s42, 24576
  ds_read_b64_tr_b16 a[152:153], v252 offset:34816
  v_exp_f32 v221, v221
  v_mfma_f32_16x16x32_bf16 v[36:39], a[168:171], a[92:95], v[36:39]
  s_waitcnt lgkmcnt(5)
  ds_read_b64_tr_b16 a[154:155], v252 offset:35072
  v_mul_f32 v125, v93, v125
  v_mfma_f32_16x16x32_bf16 v[40:43], a[172:175], a[88:91], v[40:43]
  s_waitcnt lgkmcnt(4)
  ds_read_b64_tr_b16 a[156:157], v253 offset:34816
  ds_read_b64_tr_b16 a[158:159], v253 offset:35072
  v_mfma_f32_16x16x32_bf16 v[44:47], a[172:175], a[92:95], v[44:47]
  s_barrier
  v_mfma_f32_16x16x32_bf16 v[16:19], a[144:147], a[96:99], v[16:19]
L3_pad7:
  s_cmp_lg_u32 s82, 0
  s_cbranch_scc1 L3_pad11
  s_add_u32 s40, s62, 73984
  ds_read_b64_tr_b16 a[160:161], v252 offset:36864
  v_exp_f32 v222, v222
  v_mfma_f32_16x16x32_bf16 v[20:23], a[144:147], a[100:103], v[20:23]
  s_waitcnt lgkmcnt(5)
  ds_read_b64_tr_b16 a[162:163], v252 offset:37120
  v_fma_f32 v220, v220, v227, v227
  v_fma_f32 v221, v221, v227, v227
  v_mfma_f32_16x16x32_bf16 v[24:27], a[148:151], a[96:99], v[24:27]
  buffer_load_dwordx4 v13, s[12:15], s40 offen offset:0 lds
  v_mfma_f32_16x16x32_bf16 v[28:31], a[148:151], a[100:103], v[28:31]
  s_waitcnt lgkmcnt(4)
  ds_read_b64_tr_b16 a[164:165], v253 offset:36864
  ds_read_b64_tr_b16 a[166:167], v253 offset:37120
  v_mfma_f32_16x16x32_bf16 v[32:35], a[152:155], a[96:99], v[32:35]
  ds_read_b64_tr_b16 a[168:169], v252 offset:38912
  v_exp_f32 v223, v223
  v_mfma_f32_16x16x32_bf16 v[36:39], a[152:155], a[100:103], v[36:39]
  s_waitcnt lgkmcnt(5)
  ds_read_b64_tr_b16 a[170:171], v252 offset:39168
  v_mul_f32 v126, v94, v126
  v_mfma_f32_16x16x32_bf16 v[40:43], a[156:159], a[96:99], v[40:43]
  ds_read_b64_tr_b16 a[172:173], v253 offset:38912
  v_rcp_f32 v220, v220
  v_mfma_f32_16x16x32_bf16 v[44:47], a[156:159], a[100:103], v[44:47]
  s_waitcnt lgkmcnt(5)
  ds_read_b64_tr_b16 a[174:175], v253 offset:39168
  v_fma_f32 v222, v222, v227, v227
  v_mfma_f32_16x16x32_bf16 v[16:19], a[160:163], a[104:107], v[16:19]
  ds_read_b64_tr_b16 a[144:145], v252 offset:40960
  v_rcp_f32 v221, v221
  v_mfma_f32_16x16x32_bf16 v[20:23], a[160:163], a[108:111], v[20:23]
  s_waitcnt lgkmcnt(5)
  ds_read_b64_tr_b16 a[146:147], v252 offset:41216
  v_mul_f32 v127, v95, v127
  v_fma_f32 v223, v223, v227, v227
  v_mfma_f32_16x16x32_bf16 v[24:27], a[164:167], a[104:107], v[24:27]
  buffer_load_dwordx4 v14, s[12:15], s40 offen offset:1024 lds
  v_mfma_f32_16x16x32_bf16 v[28:31], a[164:167], a[108:111], v[28:31]
  s_waitcnt lgkmcnt(4)
  ds_read_b64_tr_b16 a[148:149], v253 offset:40960
  ds_read_b64_tr_b16 a[150:151], v253 offset:41216
  v_mfma_f32_16x16x32_bf16 v[32:35], a[168:171], a[104:107], v[32:35]
  s_add_u32 s40, s62, 110848
  ds_read_b64_tr_b16 a[152:153], v252 offset:43008
  v_rcp_f32 v222, v222
  v_mfma_f32_16x16x32_bf16 v[36:39], a[168:171], a[108:111], v[36:39]
  s_waitcnt lgkmcnt(5)
  ds_read_b64_tr_b16 a[154:155], v252 offset:43264
  v_mul_f32 v124, v124, v220
  v_mfma_f32_16x16x32_bf16 v[40:43], a[172:175], a[104:107], v[40:43]
  s_add_u32 m0, s42, 32768
  ds_read_b64_tr_b16 a[156:157], v253 offset:43008
  v_rcp_f32 v223, v223
  v_mfma_f32_16x16x32_bf16 v[44:47], a[172:175], a[108:111], v[44:47]
  s_waitcnt lgkmcnt(5)
  ds_read_b64_tr_b16 a[158:159], v253 offset:43264
  v_mul_f32 v125, v125, v221
  v_mul_f32 v126, v126, v222
  v_mfma_f32_16x16x32_bf16 v[16:19], a[144:147], a[112:115], v[16:19]
  ds_read_b64_tr_b16 a[160:161], v252 offset:45056
  v_cvt_pk_bf16_f32 v198, v124, v125
  v_mfma_f32_16x16x32_bf16 v[20:23], a[144:147], a[116:119], v[20:23]
  s_waitcnt lgkmcnt(5)
  ds_read_b64_tr_b16 a[162:163], v252 offset:45312
  v_mul_f32 v127, v127, v223
  v_cvt_pk_bf16_f32 v199, v126, v127
  v_mfma_f32_16x16x32_bf16 v[24:27], a[148:151], a[112:115], v[24:27]
  buffer_load_dwordx4 v13, s[12:15], s40 offen offset:0 lds
  v_mfma_f32_16x16x32_bf16 v[28:31], a[148:151], a[116:119], v[28:31]
  s_waitcnt lgkmcnt(4)
  ds_read_b64_tr_b16 a[164:165], v253 offset:45056
  ds_read_b64_tr_b16 a[166:167], v253 offset:45312
  v_mfma_f32_16x16x32_bf16 v[32:35], a[152:155], a[112:115], v[32:35]
  ds_read_b64_tr_b16 a[168:169], v252 offset:47104
  v_mul_f32 v216, v224, v96
  v_mul_f32 v217, v224, v97
  v_mfma_f32_16x16x32_bf16 v[36:39], a[152:155], a[116:119], v[36:39]
  s_waitcnt lgkmcnt(5)
  ds_read_b64_tr_b16 a[170:171], v252 offset:47360
  v_mul_f32 v218, v224, v98
  v_mfma_f32_16x16x32_bf16 v[40:43], a[156:159], a[112:115], v[40:43]
  ds_read_b64_tr_b16 a[172:173], v253 offset:47104
  v_mul_f32 v219, v224, v99
  v_mfma_f32_16x16x32_bf16 v[44:47], a[156:159], a[116:119], v[44:47]
  s_waitcnt lgkmcnt(5)
  ds_read_b64_tr_b16 a[174:175], v253 offset:47360
  v_exp_f32 v216, v216
  v_mfma_f32_16x16x32_bf16 v[16:19], a[160:163], a[120:123], v[16:19]
  ds_read_b64_tr_b16 a[144:145], v252 offset:49152
  v_mul_f32 v128, v96, v128
  v_mfma_f32_16x16x32_bf16 v[20:23], a[160:163], a[124:127], v[20:23]
  s_waitcnt lgkmcnt(5)
  ds_read_b64_tr_b16 a[146:147], v252 offset:49408
  v_exp_f32 v217, v217
  v_mfma_f32_16x16x32_bf16 v[24:27], a[164:167], a[120:123], v[24:27]
  buffer_load_dwordx4 v14, s[12:15], s40 offen offset:1024 lds
  v_mfma_f32_16x16x32_bf16 v[28:31], a[164:167], a[124:127], v[28:31]
  s_waitcnt lgkmcnt(4)
  ds_read_b64_tr_b16 a[148:149], v253 offset:49152
  ds_read_b64_tr_b16 a[150:151], v253 offset:49408
  v_mul_f32 v129, v97, v129
  v_mfma_f32_16x16x32_bf16 v[32:35], a[168:171], a[120:123], v[32:35]
  s_add_u32 s40, s62, 147712
  ds_read_b64_tr_b16 a[152:153], v252 offset:51200
  v_mfma_f32_16x16x32_bf16 v[36:39], a[168:171], a[124:127], v[36:39]
  s_waitcnt lgkmcnt(5)
  ds_read_b64_tr_b16 a[154:155], v252 offset:51456
  v_exp_f32 v218, v218
  v_mfma_f32_16x16x32_bf16 v[40:43], a[172:175], a[120:123], v[40:43]
  s_add_u32 m0, s42, 40960
  ds_read_b64_tr_b16 a[156:157], v253 offset:51200
  v_fma_f32 v216, v216, v225, v225
  v_fma_f32 v217, v217, v225, v225
  v_mfma_f32_16x16x32_bf16 v[44:47], a[172:175], a[124:127], v[44:47]
  s_waitcnt lgkmcnt(5)
  ds_read_b64_tr_b16 a[158:159], v253 offset:51456
  v_mfma_f32_16x16x32_bf16 v[16:19], a[144:147], a[128:131], v[16:19]
  ds_read_b64_tr_b16 a[160:161], v252 offset:53248
  v_exp_f32 v219, v219
  v_mfma_f32_16x16x32_bf16 v[20:23], a[144:147], a[132:135], v[20:23]
  s_waitcnt lgkmcnt(5)
  ds_read_b64_tr_b16 a[162:163], v252 offset:53504
  v_mul_f32 v130, v98, v130
  v_mfma_f32_16x16x32_bf16 v[24:27], a[148:151], a[128:131], v[24:27]
  buffer_load_dwordx4 v13, s[12:15], s40 offen offset:0 lds
  v_mfma_f32_16x16x32_bf16 v[28:31], a[148:151], a[132:135], v[28:31]
  s_waitcnt lgkmcnt(4)
  ds_read_b64_tr_b16 a[164:165], v253 offset:53248
  ds_read_b64_tr_b16 a[166:167], v253 offset:53504
  v_mfma_f32_16x16x32_bf16 v[32:35], a[152:155], a[128:131], v[32:35]
  ds_read_b64_tr_b16 a[168:169], v252 offset:55296
  v_rcp_f32 v216, v216
  v_mfma_f32_16x16x32_bf16 v[36:39], a[152:155], a[132:135], v[36:39]
  s_waitcnt lgkmcnt(5)
  ds_read_b64_tr_b16 a[170:171], v252 offset:55552
  v_fma_f32 v218, v218, v225, v225
  v_mfma_f32_16x16x32_bf16 v[40:43], a[156:159], a[128:131], v[40:43]
  ds_read_b64_tr_b16 a[172:173], v253 offset:55296
  v_rcp_f32 v217, v217
  v_mfma_f32_16x16x32_bf16 v[44:47], a[156:159], a[132:135], v[44:47]
  s_waitcnt lgkmcnt(5)
  ds_read_b64_tr_b16 a[174:175], v253 offset:55552
  v_mul_f32 v131, v99, v131
  v_fma_f32 v219, v219, v225, v225
  v_mfma_f32_16x16x32_bf16 v[16:19], a[160:163], a[136:139], v[16:19]
  ds_read_b64_tr_b16 a[144:145], v5 offset:57344
  v_rcp_f32 v218, v218
  v_mfma_f32_16x16x32_bf16 v[20:23], a[160:163], a[140:143], v[20:23]
  s_waitcnt lgkmcnt(5)
  ds_read_b64_tr_b16 a[146:147], v5 offset:59392
  v_mul_f32 v128, v128, v216
  v_mfma_f32_16x16x32_bf16 v[24:27], a[164:167], a[136:139], v[24:27]
  buffer_load_dwordx4 v14, s[12:15], s40 offen offset:1024 lds
  v_mfma_f32_16x16x32_bf16 v[28:31], a[164:167], a[140:143], v[28:31]
  s_waitcnt lgkmcnt(4)
  ds_read_b64_tr_b16 a[148:149], v6 offset:57344
  v_rcp_f32 v219, v219
  v_mfma_f32_16x16x32_bf16 v[32:35], a[168:171], a[136:139], v[32:35]
  s_add_u32 m0, s42, 98304
  ds_read_b64_tr_b16 a[150:151], v6 offset:59392
  v_mul_f32 v129, v129, v217
  v_mul_f32 v130, v130, v218
  v_mfma_f32_16x16x32_bf16 v[36:39], a[168:171], a[140:143], v[36:39]
  s_waitcnt lgkmcnt(4)
  ds_read_b64_tr_b16 a[152:153], v7 offset:57344
  v_cvt_pk_bf16_f32 v200, v128, v129
  v_mfma_f32_16x16x32_bf16 v[40:43], a[172:175], a[136:139], v[40:43]
  s_waitcnt vmcnt(16)
  ds_read_b64_tr_b16 a[154:155], v7 offset:59392
  v_mul_f32 v131, v131, v219
  v_cvt_pk_bf16_f32 v201, v130, v131
  v_mfma_f32_16x16x32_bf16 v[44:47], a[172:175], a[140:143], v[44:47]
  s_barrier
  v_mfma_f32_16x16x16_bf16 v[16:19], a[176:177], a[192:193], v[16:19]
  s_waitcnt vmcnt(14)
  s_add_u32 s40, s62, 184576
  ds_read_b64_tr_b16 a[156:157], v8 offset:57344
  v_mul_f32 v220, v226, v100
  v_mfma_f32_16x16x16_bf16 v[32:35], a[184:185], a[192:193], v[32:35]
  ds_read_b64_tr_b16 a[158:159], v8 offset:59392
  v_mul_f32 v221, v226, v101
  v_mul_f32 v222, v226, v102
  v_mfma_f32_16x16x16_bf16 v[24:27], a[178:179], a[192:193], v[24:27]
  s_waitcnt vmcnt(13)
  buffer_load_dwordx4 v13, s[12:15], s40 offen offset:0 lds
  v_mfma_f32_16x16x16_bf16 v[40:43], a[186:187], a[192:193], v[40:43]
  ds_read_b64_tr_b16 a[160:161], v5 offset:58368
  v_mul_f32 v223, v226, v103
  v_mfma_f32_16x16x16_bf16 v[20:23], a[176:177], a[194:195], v[20:23]
  ds_read_b64_tr_b16 a[162:163], v5 offset:60416
  v_exp_f32 v220, v220
  v_mfma_f32_16x16x16_bf16 v[36:39], a[184:185], a[194:195], v[36:39]
  ds_read_b64_tr_b16 a[164:165], v6 offset:58368
  v_mul_f32 v132, v100, v132
  v_mfma_f32_16x16x16_bf16 v[28:31], a[178:179], a[194:195], v[28:31]
  ds_read_b64_tr_b16 a[166:167], v6 offset:60416
  v_mfma_f32_16x16x16_bf16 v[44:47], a[186:187], a[194:195], v[44:47]
  s_waitcnt lgkmcnt(4)
  ds_read_b64_tr_b16 a[168:169], v7 offset:58368
  v_exp_f32 v221, v221
  v_mfma_f32_16x16x32_bf16 a[72:75], a[144:147], v[144:147], 0
  ds_read_b64_tr_b16 a[170:171], v7 offset:60416
  v_mul_f32 v133, v101, v133
  v_mfma_f32_16x16x32_bf16 a[76:79], a[144:147], v[148:151], 0
  ds_read_b64_tr_b16 a[172:173], v8 offset:58368
  v_exp_f32 v222, v222
  v_mfma_f32_16x16x32_bf16 a[80:83], a[148:151], v[144:147], 0
  buffer_load_dwordx4 v14, s[12:15], s40 offen offset:1024 lds
  v_mfma_f32_16x16x32_bf16 a[84:87], a[148:151], v[148:151], 0
  s_mov_b32 s69, 12288
  ds_read_b64_tr_b16 a[174:175], v8 offset:60416
  v_fma_f32 v220, v220, v227, v227
  v_fma_f32 v221, v221, v227, v227
  v_mfma_f32_16x16x32_bf16 a[88:91], a[152:155], v[144:147], 0
  ds_read_b64_tr_b16 a[144:145], v1 offset:49152
  v_exp_f32 v223, v223
  v_mfma_f32_16x16x32_bf16 a[92:95], a[152:155], v[148:151], 0
  s_add_u32 s40, s62, 221440
  ds_read_b64_tr_b16 a[146:147], v1 offset:51200
  v_mul_f32 v134, v102, v134
  v_mfma_f32_16x16x32_bf16 a[96:99], a[156:159], v[144:147], 0
  s_add_u32 m0, s42, 106496
  buffer_store_dwordx4 v[192:195], v233, s[76:79], s69 offen sc1
  v_mfma_f32_16x16x32_bf16 a[100:103], a[156:159], v[148:151], 0
  s_waitcnt lgkmcnt(3)
  ds_read_b64_tr_b16 a[148:149], v2 offset:49152
  v_rcp_f32 v220, v220
  v_mfma_f32_16x16x32_bf16 a[104:107], a[160:163], v[144:147], 0
  ds_read_b64_tr_b16 a[150:151], v2 offset:51200
  v_fma_f32 v222, v222, v227, v227
  v_mfma_f32_16x16x32_bf16 a[108:111], a[160:163], v[148:151], 0
  ds_read_b64_tr_b16 a[152:153], v3 offset:49152
  v_rcp_f32 v221, v221
  v_mfma_f32_16x16x32_bf16 a[112:115], a[164:167], v[144:147], 0
  buffer_load_dwordx4 v13, s[12:15], s40 offen offset:0 lds
  v_mfma_f32_16x16x32_bf16 a[116:119], a[164:167], v[148:151], 0
  s_mov_b32 s69, 13312
  ds_read_b64_tr_b16 a[154:155], v3 offset:51200
  v_mul_f32 v135, v103, v135
  v_mfma_f32_16x16x32_bf16 a[120:123], a[168:171], v[144:147], 0
  ds_read_b64_tr_b16 a[156:157], v4 offset:49152
  v_fma_f32 v223, v223, v227, v227
  v_mfma_f32_16x16x32_bf16 a[124:127], a[168:171], v[148:151], 0
  s_waitcnt lgkmcnt(4)
  ds_read_b64_tr_b16 a[158:159], v4 offset:51200
  v_rcp_f32 v222, v222
  v_mfma_f32_16x16x32_bf16 a[128:131], a[172:175], v[144:147], 0
  buffer_store_dwordx4 v[196:199], v233, s[76:79], s69 offen sc1
  v_mfma_f32_16x16x32_bf16 a[132:135], a[172:175], v[148:151], 0
  ds_read_b64_tr_b16 a[160:161], v1 offset:50176
  v_mul_f32 v132, v132, v220
  v_mfma_f32_16x16x32_bf16 a[72:75], a[144:147], v[152:155], a[72:75]
  ds_read_b64_tr_b16 a[162:163], v1 offset:52224
  v_sub_u32 v9, v9, v231
  v_mfma_f32_16x16x32_bf16 a[76:79], a[144:147], v[156:159], a[76:79]
  s_waitcnt lgkmcnt(4)
  ds_read_b64_tr_b16 a[164:165], v2 offset:50176
  v_rcp_f32 v223, v223
  v_mfma_f32_16x16x32_bf16 a[80:83], a[148:151], v[152:155], a[80:83]
  buffer_load_dwordx4 v14, s[12:15], s40 offen offset:1024 lds
  v_mfma_f32_16x16x32_bf16 a[84:87], a[148:151], v[156:159], a[84:87]
  ds_read_b64_tr_b16 a[166:167], v2 offset:52224
  v_mul_f32 v133, v133, v221
  v_mfma_f32_16x16x32_bf16 a[88:91], a[152:155], v[152:155], a[88:91]
  s_add_u32 s40, s62, 258304
  ds_read_b64_tr_b16 a[168:169], v3 offset:50176
  v_mul_f32 v134, v134, v222
  v_mfma_f32_16x16x32_bf16 a[92:95], a[152:155], v[156:159], a[92:95]
  s_waitcnt lgkmcnt(4)
  ds_read_b64_tr_b16 a[170:171], v3 offset:52224
  v_cvt_pk_bf16_f32 v204, v132, v133
  v_mfma_f32_16x16x32_bf16 a[96:99], a[156:159], v[152:155], a[96:99]
  s_add_u32 m0, s42, 114688
  ds_read_b64_tr_b16 a[172:173], v4 offset:50176
  v_mul_f32 v135, v135, v223
  v_mfma_f32_16x16x32_bf16 a[100:103], a[156:159], v[156:159], a[100:103]
  s_waitcnt lgkmcnt(4)
  ds_read_b64_tr_b16 a[174:175], v4 offset:52224
  v_cvt_pk_bf16_f32 v205, v134, v135
  v_mfma_f32_16x16x32_bf16 a[104:107], a[160:163], v[152:155], a[104:107]
  ds_read_b64_tr_b16 a[144:145], v1 offset:57344
  v_mul_f32 v216, v224, v104
  v_mfma_f32_16x16x32_bf16 a[108:111], a[160:163], v[156:159], a[108:111]
  s_waitcnt lgkmcnt(5)
  ds_read_b64_tr_b16 a[146:147], v1 offset:59392
  v_mul_f32 v217, v224, v105
  v_mul_f32 v218, v224, v106
  v_mfma_f32_16x16x32_bf16 a[112:115], a[164:167], v[152:155], a[112:115]
  buffer_load_dwordx4 v13, s[12:15], s40 offen offset:0 lds
  v_mfma_f32_16x16x32_bf16 a[116:119], a[164:167], v[156:159], a[116:119]
  s_waitcnt lgkmcnt(4)
  ds_read_b64_tr_b16 a[148:149], v2 offset:57344
  ds_read_b64_tr_b16 a[150:151], v2 offset:59392
  v_mfma_f32_16x16x32_bf16 a[120:123], a[168:171], v[152:155], a[120:123]
  ds_read_b64_tr_b16 a[152:153], v3 offset:57344
  v_mul_f32 v219, v224, v107
  v_mfma_f32_16x16x32_bf16 a[124:127], a[168:171], v[156:159], a[124:127]
  s_waitcnt lgkmcnt(5)
  ds_read_b64_tr_b16 a[154:155], v3 offset:59392
  v_exp_f32 v216, v216
  v_mfma_f32_16x16x32_bf16 a[128:131], a[172:175], v[152:155], a[128:131]
  ds_read_b64_tr_b16 a[156:157], v4 offset:57344
  v_mul_f32 v136, v104, v136
  v_mfma_f32_16x16x32_bf16 a[132:135], a[172:175], v[156:159], a[132:135]
  s_waitcnt lgkmcnt(5)
  ds_read_b64_tr_b16 a[158:159], v4 offset:59392
  v_exp_f32 v217, v217
  v_mfma_f32_16x16x32_bf16 a[72:75], a[144:147], v[160:163], a[72:75]
  ds_read_b64_tr_b16 a[160:161], v1 offset:58368
  v_mul_f32 v137, v105, v137
  v_mfma_f32_16x16x32_bf16 a[76:79], a[144:147], v[164:167], a[76:79]
  s_waitcnt lgkmcnt(5)
  ds_read_b64_tr_b16 a[162:163], v1 offset:60416
  v_exp_f32 v218, v218
  v_mfma_f32_16x16x32_bf16 a[80:83], a[148:151], v[160:163], a[80:83]
  buffer_load_dwordx4 v14, s[12:15], s40 offen offset:1024 lds
  v_mfma_f32_16x16x32_bf16 a[84:87], a[148:151], v[164:167], a[84:87]
  s_waitcnt lgkmcnt(4)
  s_mul_i32 m0, s3, 3072
  s_add_u32 m0, m0, 131072
  ds_read_b64_tr_b16 a[164:165], v2 offset:58368
  ds_read_b64_tr_b16 a[166:167], v2 offset:60416
  v_fma_f32 v216, v216, v225, v225
  v_mfma_f32_16x16x32_bf16 a[88:91], a[152:155], v[160:163], a[88:91]
  s_mul_i32 s41, s6, 1310720
  s_add_u32 s41, s41, 0
  s_lshl_b32 s81, s3, 17
  s_add_u32 s41, s41, s81
  ds_read_b64_tr_b16 a[168:169], v3 offset:58368
  v_fma_f32 v217, v217, v225, v225
  v_mfma_f32_16x16x32_bf16 a[92:95], a[152:155], v[164:167], a[92:95]
  s_waitcnt lgkmcnt(5)
  ds_read_b64_tr_b16 a[170:171], v3 offset:60416
  v_exp_f32 v219, v219
  v_mfma_f32_16x16x32_bf16 a[96:99], a[156:159], v[160:163], a[96:99]
  buffer_load_dwordx4 v235, s[16:19], s41 offen sc1 lds
  v_mfma_f32_16x16x32_bf16 a[100:103], a[156:159], v[164:167], a[100:103]
  s_waitcnt lgkmcnt(4)
  s_mul_i32 m0, s3, 3072
  s_add_u32 m0, m0, 132096
  ds_read_b64_tr_b16 a[172:173], v4 offset:58368
  ds_read_b64_tr_b16 a[174:175], v4 offset:60416
  v_mfma_f32_16x16x32_bf16 a[104:107], a[160:163], v[160:163], a[104:107]
  s_mul_i32 s41, s6, 1310720
  s_add_u32 s41, s41, 524288
  s_lshl_b32 s81, s3, 17
  s_add_u32 s41, s41, s81
  ds_read_b64_tr_b16 a[144:145], v5 offset:0
  v_mul_f32 v138, v106, v138
  v_mfma_f32_16x16x32_bf16 a[108:111], a[160:163], v[164:167], a[108:111]
  s_waitcnt lgkmcnt(5)
  ds_read_b64_tr_b16 a[146:147], v5 offset:2048
  v_rcp_f32 v216, v216
  v_mfma_f32_16x16x32_bf16 a[112:115], a[164:167], v[160:163], a[112:115]
  buffer_load_dwordx4 v235, s[16:19], s41 offen sc1 lds
  v_mfma_f32_16x16x32_bf16 a[116:119], a[164:167], v[164:167], a[116:119]
  s_waitcnt lgkmcnt(4)
  s_mul_i32 m0, s3, 3072
  s_add_u32 m0, m0, 133120
  ds_read_b64_tr_b16 a[148:149], v6 offset:0
  ds_read_b64_tr_b16 a[150:151], v6 offset:2048
  v_fma_f32 v218, v218, v225, v225
  v_mfma_f32_16x16x32_bf16 a[120:123], a[168:171], v[160:163], a[120:123]
  s_mul_i32 s41, s6, 131072
  s_add_u32 s41, s41, 1048576
  ds_read_b64_tr_b16 a[152:153], v7 offset:0
  ds_read_b64_tr_b16 a[154:155], v7 offset:2048
  v_mfma_f32_16x16x32_bf16 a[124:127], a[168:171], v[164:167], a[124:127]
  s_waitcnt lgkmcnt(6)
  ds_read_b64_tr_b16 a[156:157], v8 offset:0
  ds_read_b64_tr_b16 a[158:159], v8 offset:2048
  v_mfma_f32_16x16x32_bf16 a[128:131], a[172:175], v[160:163], a[128:131]
  s_waitcnt lgkmcnt(6)
  buffer_load_dwordx4 v235, s[16:19], s41 offen sc1 lds
  v_mfma_f32_16x16x32_bf16 a[132:135], a[172:175], v[164:167], a[132:135]
  s_barrier
  v_mfma_f32_16x16x32_bf16 a[72:75], a[144:147], v[168:171], a[72:75]
  s_add_u32 m0, s42, 122880
  s_add_u32 s40, s64, 0
  ds_read_b64_tr_b16 a[160:161], v5 offset:1024
  v_rcp_f32 v217, v217
  v_mfma_f32_16x16x32_bf16 a[76:79], a[144:147], v[172:175], a[76:79]
  s_waitcnt lgkmcnt(5)
  ds_read_b64_tr_b16 a[162:163], v5 offset:3072
  v_mul_f32 v139, v107, v139
  v_mfma_f32_16x16x32_bf16 a[80:83], a[148:151], v[168:171], a[80:83]
  buffer_load_dwordx4 v13, s[12:15], s40 offen offset:0 lds
  v_mfma_f32_16x16x32_bf16 a[84:87], a[148:151], v[172:175], a[84:87]
  s_waitcnt lgkmcnt(2)
  ds_read_b64_tr_b16 a[164:165], v6 offset:1024
  ds_read_b64_tr_b16 a[166:167], v6 offset:3072
  v_fma_f32 v219, v219, v225, v225
  v_mfma_f32_16x16x32_bf16 a[88:91], a[152:155], v[168:171], a[88:91]
  ds_read_b64_tr_b16 a[168:169], v7 offset:1024
  v_sub_u32 v10, v10, v231
  v_mfma_f32_16x16x32_bf16 a[92:95], a[152:155], v[172:175], a[92:95]
  ds_read_b64_tr_b16 a[170:171], v7 offset:3072
  v_rcp_f32 v218, v218
  v_mfma_f32_16x16x32_bf16 a[96:99], a[156:159], v[168:171], a[96:99]
  ds_read_b64_tr_b16 a[172:173], v8 offset:1024
  v_mul_f32 v136, v136, v216
  v_mfma_f32_16x16x32_bf16 a[100:103], a[156:159], v[172:175], a[100:103]
  s_waitcnt lgkmcnt(5)
  ds_read_b64_tr_b16 a[174:175], v8 offset:3072
  v_rcp_f32 v219, v219
  v_mfma_f32_16x16x32_bf16 a[104:107], a[160:163], v[168:171], a[104:107]
  ds_read_b64_tr_b16 a[144:145], v5 offset:8192
  v_mul_f32 v137, v137, v217
  v_mul_f32 v138, v138, v218
  v_mfma_f32_16x16x32_bf16 a[108:111], a[160:163], v[172:175], a[108:111]
  s_waitcnt lgkmcnt(5)
  ds_read_b64_tr_b16 a[146:147], v5 offset:10240
  v_cvt_pk_bf16_f32 v202, v136, v137
  v_mul_f32 v139, v139, v219
  v_mfma_f32_16x16x32_bf16 a[112:115], a[164:167], v[168:171], a[112:115]
  buffer_load_dwordx4 v14, s[12:15], s40 offen offset:1024 lds
  v_mfma_f32_16x16x32_bf16 a[116:119], a[164:167], v[172:175], a[116:119]
  s_waitcnt lgkmcnt(4)
  ds_read_b64_tr_b16 a[148:149], v6 offset:8192
  ds_read_b64_tr_b16 a[150:151], v6 offset:10240
  v_mfma_f32_16x16x32_bf16 a[120:123], a[168:171], v[168:171], a[120:123]
  s_add_u32 s40, s64, 256
  ds_read_b64_tr_b16 a[152:153], v7 offset:8192
  v_cvt_pk_bf16_f32 v203, v138, v139
  v_mul_f32 v220, v226, v108
  v_mfma_f32_16x16x32_bf16 a[124:127], a[168:171], v[172:175], a[124:127]
  s_waitcnt lgkmcnt(5)
  ds_read_b64_tr_b16 a[154:155], v7 offset:10240
  v_mul_f32 v221, v226, v109
  v_mfma_f32_16x16x32_bf16 a[128:131], a[172:175], v[168:171], a[128:131]
  s_add_u32 m0, s42, 49152
  ds_read_b64_tr_b16 a[156:157], v8 offset:8192
  v_mul_f32 v222, v226, v110
  v_mul_f32 v223, v226, v111
  v_mfma_f32_16x16x32_bf16 a[132:135], a[172:175], v[172:175], a[132:135]
  s_waitcnt lgkmcnt(5)
  ds_read_b64_tr_b16 a[158:159], v8 offset:10240
  v_sub_u32 v252, v252, v231
  v_mfma_f32_16x16x32_bf16 a[72:75], a[144:147], v[176:179], a[72:75]
  ds_read_b64_tr_b16 a[160:161], v5 offset:9216
  v_exp_f32 v220, v220
  v_mfma_f32_16x16x32_bf16 a[76:79], a[144:147], v[180:183], a[76:79]
  s_waitcnt lgkmcnt(5)
  ds_read_b64_tr_b16 a[162:163], v5 offset:11264
  v_mul_f32 v140, v108, v140
  v_mfma_f32_16x16x32_bf16 a[80:83], a[148:151], v[176:179], a[80:83]
  buffer_load_dwordx4 v13, s[12:15], s40 offen offset:0 lds
  v_mfma_f32_16x16x32_bf16 a[84:87], a[148:151], v[180:183], a[84:87]
  s_waitcnt lgkmcnt(4)
  ds_read_b64_tr_b16 a[164:165], v6 offset:9216
  ds_read_b64_tr_b16 a[166:167], v6 offset:11264
  v_mfma_f32_16x16x32_bf16 a[88:91], a[152:155], v[176:179], a[88:91]
  ds_read_b64_tr_b16 a[168:169], v7 offset:9216
  v_exp_f32 v221, v221
  v_mfma_f32_16x16x32_bf16 a[92:95], a[152:155], v[180:183], a[92:95]
  s_waitcnt lgkmcnt(5)
  ds_read_b64_tr_b16 a[170:171], v7 offset:11264
  v_mul_f32 v141, v109, v141
  v_mfma_f32_16x16x32_bf16 a[96:99], a[156:159], v[176:179], a[96:99]
  ds_read_b64_tr_b16 a[172:173], v8 offset:9216
  v_exp_f32 v222, v222
  v_mfma_f32_16x16x32_bf16 a[100:103], a[156:159], v[180:183], a[100:103]
  s_waitcnt lgkmcnt(5)
  ds_read_b64_tr_b16 a[174:175], v8 offset:11264
  v_fma_f32 v220, v220, v227, v227
  v_fma_f32 v221, v221, v227, v227
  v_mfma_f32_16x16x32_bf16 a[104:107], a[160:163], v[176:179], a[104:107]
  ds_read_b64_tr_b16 a[144:145], v5 offset:16384
  v_exp_f32 v223, v223
  v_mfma_f32_16x16x32_bf16 a[108:111], a[160:163], v[180:183], a[108:111]
  s_waitcnt lgkmcnt(5)
  ds_read_b64_tr_b16 a[146:147], v5 offset:18432
  v_mul_f32 v142, v110, v142
  v_mfma_f32_16x16x32_bf16 a[112:115], a[164:167], v[176:179], a[112:115]
  buffer_load_dwordx4 v14, s[12:15], s40 offen offset:1024 lds
  v_mfma_f32_16x16x32_bf16 a[116:119], a[164:167], v[180:183], a[116:119]
  s_waitcnt lgkmcnt(4)
  ds_read_b64_tr_b16 a[148:149], v6 offset:16384
  ds_read_b64_tr_b16 a[150:151], v6 offset:18432
  v_mfma_f32_16x16x32_bf16 a[120:123], a[168:171], v[176:179], a[120:123]
  s_add_u32 s40, s63, 0
  ds_read_b64_tr_b16 a[152:153], v7 offset:16384
  v_rcp_f32 v220, v220
  v_mfma_f32_16x16x32_bf16 a[124:127], a[168:171], v[180:183], a[124:127]
  s_waitcnt lgkmcnt(5)
  ds_read_b64_tr_b16 a[154:155], v7 offset:18432
  v_fma_f32 v222, v222, v227, v227
  v_mfma_f32_16x16x32_bf16 a[128:131], a[172:175], v[176:179], a[128:131]
  s_add_u32 m0, s42, 57344
  ds_read_b64_tr_b16 a[156:157], v8 offset:16384
  v_rcp_f32 v221, v221
  v_mfma_f32_16x16x32_bf16 a[132:135], a[172:175], v[180:183], a[132:135]
  s_waitcnt lgkmcnt(5)
  ds_read_b64_tr_b16 a[158:159], v8 offset:18432
  v_mul_f32 v143, v111, v143
  v_fma_f32 v223, v223, v227, v227
  v_mfma_f32_16x16x32_bf16 a[72:75], a[144:147], v[184:187], a[72:75]
  ds_read_b64_tr_b16 a[160:161], v5 offset:17408
  v_sub_u32 v253, v253, v231
  v_mfma_f32_16x16x32_bf16 a[76:79], a[144:147], v[188:191], a[76:79]
  s_waitcnt lgkmcnt(5)
  ds_read_b64_tr_b16 a[162:163], v5 offset:19456
  v_rcp_f32 v222, v222
  v_mfma_f32_16x16x32_bf16 a[80:83], a[148:151], v[184:187], a[80:83]
  buffer_load_dwordx4 v13, s[12:15], s40 offen offset:0 lds
  v_mfma_f32_16x16x32_bf16 a[84:87], a[148:151], v[188:191], a[84:87]
  s_waitcnt lgkmcnt(4)
  ds_read_b64_tr_b16 a[164:165], v6 offset:17408
  ds_read_b64_tr_b16 a[166:167], v6 offset:19456
  v_mul_f32 v140, v140, v220
  v_mfma_f32_16x16x32_bf16 a[88:91], a[152:155], v[184:187], a[88:91]
  ds_read_b64_tr_b16 a[168:169], v7 offset:17408
  v_rcp_f32 v223, v223
  v_mfma_f32_16x16x32_bf16 a[92:95], a[152:155], v[188:191], a[92:95]
  s_waitcnt lgkmcnt(5)
  ds_read_b64_tr_b16 a[170:171], v7 offset:19456
  v_mul_f32 v141, v141, v221
  v_mfma_f32_16x16x32_bf16 a[96:99], a[156:159], v[184:187], a[96:99]
  buffer_load_dwordx2 v[242:243], v248, s[32:35], 0 offen offset:0 sc1
  v_mfma_f32_16x16x32_bf16 a[100:103], a[156:159], v[188:191], a[100:103]
  s_waitcnt lgkmcnt(4)
  ds_read_b64_tr_b16 a[172:173], v8 offset:17408
  ds_read_b64_tr_b16 a[174:175], v8 offset:19456
  v_mul_f32 v142, v142, v222
  v_mfma_f32_16x16x32_bf16 a[104:107], a[160:163], v[184:187], a[104:107]
  ds_read_b64_tr_b16 a[144:145], v5 offset:24576
  v_cvt_pk_bf16_f32 v206, v140, v141
  v_mfma_f32_16x16x32_bf16 a[108:111], a[160:163], v[188:191], a[108:111]
  s_waitcnt lgkmcnt(5)
  ds_read_b64_tr_b16 a[146:147], v5 offset:26624
  v_mul_f32 v143, v143, v223
  v_cvt_pk_bf16_f32 v207, v142, v143
  v_mfma_f32_16x16x32_bf16 a[112:115], a[164:167], v[184:187], a[112:115]
  buffer_load_dwordx4 v14, s[12:15], s40 offen offset:1024 lds
  v_mfma_f32_16x16x32_bf16 a[116:119], a[164:167], v[188:191], a[116:119]
  s_waitcnt lgkmcnt(4)
  ds_read_b64_tr_b16 a[148:149], v6 offset:24576
  ds_read_b64_tr_b16 a[150:151], v6 offset:26624
  v_mul_f32 v216, v224, v16
  v_mfma_f32_16x16x32_bf16 a[120:123], a[168:171], v[184:187], a[120:123]
  s_add_u32 m0, s42, 65536
  ds_read_b64_tr_b16 a[152:153], v7 offset:24576
  v_mul_f32 v217, v224, v17
  v_mul_f32 v218, v224, v18
  v_mfma_f32_16x16x32_bf16 a[124:127], a[168:171], v[188:191], a[124:127]
  s_waitcnt lgkmcnt(5)
  ds_read_b64_tr_b16 a[154:155], v7 offset:26624
  v_mul_f32 v219, v224, v19
  v_mfma_f32_16x16x32_bf16 a[128:131], a[172:175], v[184:187], a[128:131]
  s_waitcnt vmcnt(24) lgkmcnt(4)
  ds_read_b64_tr_b16 a[156:157], v8 offset:24576
  ds_read_b64_tr_b16 a[158:159], v8 offset:26624
  v_mfma_f32_16x16x32_bf16 a[132:135], a[172:175], v[188:191], a[132:135]
  s_barrier
  v_mfma_f32_16x16x32_bf16 a[72:75], a[144:147], v[192:195], a[72:75]
  s_add_u32 s40, s63, 36864
  ds_read_b64_tr_b16 a[160:161], v5 offset:25600
  v_exp_f32 v216, v216
  v_mfma_f32_16x16x32_bf16 a[76:79], a[144:147], v[196:199], a[76:79]
  s_waitcnt lgkmcnt(5)
  ds_read_b64_tr_b16 a[162:163], v5 offset:27648
  v_mul_f32 v32, v16, v32
  v_mfma_f32_16x16x32_bf16 a[80:83], a[148:151], v[192:195], a[80:83]
  s_mov_b32 s69, 14336
  buffer_load_dwordx4 v13, s[12:15], s40 offen offset:0 lds
  v_mfma_f32_16x16x32_bf16 a[84:87], a[148:151], v[196:199], a[84:87]
  s_waitcnt lgkmcnt(4)
  ds_read_b64_tr_b16 a[164:165], v6 offset:25600
  ds_read_b64_tr_b16 a[166:167], v6 offset:27648
  v_mfma_f32_16x16x32_bf16 a[88:91], a[152:155], v[192:195], a[88:91]
  ds_read_b64_tr_b16 a[168:169], v7 offset:25600
  v_exp_f32 v217, v217
  v_mfma_f32_16x16x32_bf16 a[92:95], a[152:155], v[196:199], a[92:95]
  s_waitcnt lgkmcnt(5)
  ds_read_b64_tr_b16 a[170:171], v7 offset:27648
  v_mul_f32 v33, v17, v33
  v_mfma_f32_16x16x32_bf16 a[96:99], a[156:159], v[192:195], a[96:99]
  buffer_store_dwordx4 v[200:203], v233, s[76:79], s69 offen sc1
  v_mfma_f32_16x16x32_bf16 a[100:103], a[156:159], v[196:199], a[100:103]
  s_waitcnt lgkmcnt(4)
  ds_read_b64_tr_b16 a[172:173], v8 offset:25600
  ds_read_b64_tr_b16 a[174:175], v8 offset:27648
  v_mfma_f32_16x16x32_bf16 a[104:107], a[160:163], v[192:195], a[104:107]
  ds_read_b64_tr_b16 a[144:145], v1 offset:0
  v_exp_f32 v218, v218
  v_mfma_f32_16x16x32_bf16 a[108:111], a[160:163], v[196:199], a[108:111]
  s_waitcnt lgkmcnt(5)
  ds_read_b64_tr_b16 a[146:147], v1 offset:2048
  v_fma_f32 v216, v216, v225, v225
  v_fma_f32 v217, v217, v225, v225
  v_mfma_f32_16x16x32_bf16 a[112:115], a[164:167], v[192:195], a[112:115]
  s_mov_b32 s69, 15360
  buffer_load_dwordx4 v14, s[12:15], s40 offen offset:1024 lds
  v_mfma_f32_16x16x32_bf16 a[116:119], a[164:167], v[196:199], a[116:119]
  s_waitcnt lgkmcnt(4)
  ds_read_b64_tr_b16 a[148:149], v2 offset:0
  ds_read_b64_tr_b16 a[150:151], v2 offset:2048
  v_exp_f32 v219, v219
  v_mfma_f32_16x16x32_bf16 a[120:123], a[168:171], v[192:195], a[120:123]
  ds_read_b64_tr_b16 a[152:153], v3 offset:0
  v_mul_f32 v34, v18, v34
  v_mfma_f32_16x16x32_bf16 a[124:127], a[168:171], v[196:199], a[124:127]
  s_waitcnt lgkmcnt(5)
  ds_read_b64_tr_b16 a[154:155], v3 offset:2048
  v_rcp_f32 v216, v216
  v_mfma_f32_16x16x32_bf16 a[128:131], a[172:175], v[192:195], a[128:131]
L3_pad8:
  s_cmp_lg_u32 s82, 0
  s_cbranch_scc1 L3_main
  s_add_u32 m0, s42, 73728
  buffer_store_dwordx4 v[204:207], v233, s[76:79], s69 offen sc1
  v_mfma_f32_16x16x32_bf16 a[132:135], a[172:175], v[196:199], a[132:135]
  s_waitcnt lgkmcnt(4)
  ds_read_b64_tr_b16 a[156:157], v4 offset:0
  ds_read_b64_tr_b16 a[158:159], v4 offset:2048
  v_fma_f32 v218, v218, v225, v225
  v_mfma_f32_16x16x32_bf16 a[72:75], a[144:147], v[200:203], a[72:75]
  s_add_u32 s40, s63, 73728
  ds_read_b64_tr_b16 a[160:161], v1 offset:1024
  v_rcp_f32 v217, v217
  v_mfma_f32_16x16x32_bf16 a[76:79], a[144:147], v[204:207], a[76:79]
  s_waitcnt lgkmcnt(5)
  ds_read_b64_tr_b16 a[162:163], v1 offset:3072
  v_mul_f32 v35, v19, v35
  v_fma_f32 v219, v219, v225, v225
  v_mfma_f32_16x16x32_bf16 a[80:83], a[148:151], v[200:203], a[80:83]
  buffer_load_dwordx4 v13, s[12:15], s40 offen offset:0 lds
  v_mfma_f32_16x16x32_bf16 a[84:87], a[148:151], v[204:207], a[84:87]
  s_waitcnt lgkmcnt(4)
  ds_read_b64_tr_b16 a[164:165], v2 offset:1024
  ds_read_b64_tr_b16 a[166:167], v2 offset:3072
  v_rcp_f32 v218, v218
  v_mfma_f32_16x16x32_bf16 a[88:91], a[152:155], v[200:203], a[88:91]
  ds_read_b64_tr_b16 a[168:169], v3 offset:1024
  v_mul_f32 v32, v32, v216
  v_mfma_f32_16x16x32_bf16 a[92:95], a[152:155], v[204:207], a[92:95]
  s_waitcnt lgkmcnt(5)
  ds_read_b64_tr_b16 a[170:171], v3 offset:3072
  v_rcp_f32 v219, v219
  v_mfma_f32_16x16x32_bf16 a[96:99], a[156:159], v[200:203], a[96:99]
  ds_read_b64_tr_b16 a[172:173], v4 offset:1024
  v_mul_f32 v33, v33, v217
  v_mul_f32 v34, v34, v218
  v_mfma_f32_16x16x32_bf16 a[100:103], a[156:159], v[204:207], a[100:103]
  s_waitcnt lgkmcnt(5)
  ds_read_b64_tr_b16 a[174:175], v4 offset:3072
  v_cvt_pk_bf16_f32 v208, v32, v33
  v_mul_f32 v35, v35, v219
  v_mfma_f32_16x16x32_bf16 a[104:107], a[160:163], v[200:203], a[104:107]
  ds_read_b64_tr_b16 a[144:145], v1 offset:8192
  v_cvt_pk_bf16_f32 v209, v34, v35
  v_mul_f32 v220, v226, v20
  v_mfma_f32_16x16x32_bf16 a[108:111], a[160:163], v[204:207], a[108:111]
  s_waitcnt lgkmcnt(5)
  ds_read_b64_tr_b16 a[146:147], v1 offset:10240
  v_mul_f32 v221, v226, v21
  v_mul_f32 v222, v226, v22
  v_mfma_f32_16x16x32_bf16 a[112:115], a[164:167], v[200:203], a[112:115]
  buffer_load_dwordx4 v14, s[12:15], s40 offen offset:1024 lds
  v_mfma_f32_16x16x32_bf16 a[116:119], a[164:167], v[204:207], a[116:119]
  s_waitcnt lgkmcnt(4)
  ds_read_b64_tr_b16 a[148:149], v2 offset:8192
  ds_read_b64_tr_b16 a[150:151], v2 offset:10240
  v_mul_f32 v223, v226, v23
  v_mfma_f32_16x16x32_bf16 a[120:123], a[168:171], v[200:203], a[120:123]
  s_add_u32 s40, s63, 110592
  ds_read_b64_tr_b16 a[152:153], v3 offset:8192
  v_exp_f32 v220, v220
  v_mfma_f32_16x16x32_bf16 a[124:127], a[168:171], v[204:207], a[124:127]
  s_waitcnt lgkmcnt(5)
  ds_read_b64_tr_b16 a[154:155], v3 offset:10240
  v_mul_f32 v36, v20, v36
  v_mfma_f32_16x16x32_bf16 a[128:131], a[172:175], v[200:203], a[128:131]
  s_add_u32 m0, s42, 81920
  ds_read_b64_tr_b16 a[156:157], v4 offset:8192
  v_exp_f32 v221, v221
  v_mul_f32 v37, v21, v37
  v_mfma_f32_16x16x32_bf16 a[132:135], a[172:175], v[204:207], a[132:135]
  s_waitcnt lgkmcnt(5)
  ds_read_b64_tr_b16 a[158:159], v4 offset:10240
  v_exp_f32 v222, v222
  v_mfma_f32_16x16x32_bf16 v[80:83], a[144:147], v[144:147], 0
  s_waitcnt vmcnt(7)
  v_accvgpr_read_b32 v244, a224
  v_accvgpr_read_b32 v245, a225
  v_cmp_ne_u64 s[74:75], v[242:243], v[244:245]
  s_nop 3
  s_cmp_lg_u64 s[74:75], 0
  s_cbranch_scc1 L3_hx0
L3_hxok0:
  ds_read_b64_tr_b16 a[160:161], v1 offset:9216
  v_fma_f32 v220, v220, v227, v227
  v_fma_f32 v221, v221, v227, v227
  v_mfma_f32_16x16x32_bf16 v[84:87], a[144:147], v[148:151], 0
  s_waitcnt lgkmcnt(5)
  ds_read_b64_tr_b16 a[162:163], v1 offset:11264
  v_exp_f32 v223, v223
  v_mfma_f32_16x16x32_bf16 v[88:91], a[148:151], v[144:147], 0
  s_mov_b32 s69, 0
  buffer_load_dwordx4 v13, s[12:15], s40 offen offset:0 lds
  v_mfma_f32_16x16x32_bf16 v[92:95], a[148:151], v[148:151], 0
  s_waitcnt lgkmcnt(4)
  ds_read_b64_tr_b16 a[164:165], v2 offset:9216
  ds_read_b64_tr_b16 a[166:167], v2 offset:11264
  v_mul_f32 v38, v22, v38
  v_mfma_f32_16x16x32_bf16 v[96:99], a[152:155], v[144:147], 0
  ds_read_b64_tr_b16 a[168:169], v3 offset:9216
  v_rcp_f32 v220, v220
  v_fma_f32 v222, v222, v227, v227
  v_mfma_f32_16x16x32_bf16 v[100:103], a[152:155], v[148:151], 0
  s_waitcnt lgkmcnt(5)
  ds_read_b64_tr_b16 a[170:171], v3 offset:11264
  v_rcp_f32 v221, v221
  v_mfma_f32_16x16x32_bf16 v[104:107], a[156:159], v[144:147], 0
  buffer_load_dwordx4 a[0:3], v233, s[84:87], s69 offen sc1
  v_mfma_f32_16x16x32_bf16 v[108:111], a[156:159], v[148:151], 0
  s_waitcnt lgkmcnt(4)
  ds_read_b64_tr_b16 a[172:173], v4 offset:9216
  ds_read_b64_tr_b16 a[174:175], v4 offset:11264
  v_mul_f32 v39, v23, v39
  v_fma_f32 v223, v223, v227, v227
  v_mfma_f32_16x16x32_bf16 v[112:115], a[160:163], v[144:147], 0
  ds_read_b64_tr_b16 a[144:145], v1 offset:16384
  v_rcp_f32 v222, v222
  v_mfma_f32_16x16x32_bf16 v[116:119], a[160:163], v[148:151], 0
  s_waitcnt lgkmcnt(5)
  ds_read_b64_tr_b16 a[146:147], v1 offset:18432
  v_mul_f32 v36, v36, v220
  v_mfma_f32_16x16x32_bf16 v[120:123], a[164:167], v[144:147], 0
  s_mov_b32 s69, 1024
  buffer_load_dwordx4 v14, s[12:15], s40 offen offset:1024 lds
  v_mfma_f32_16x16x32_bf16 v[124:127], a[164:167], v[148:151], 0
  s_waitcnt lgkmcnt(4)
  ds_read_b64_tr_b16 a[148:149], v2 offset:16384
  ds_read_b64_tr_b16 a[150:151], v2 offset:18432
  v_rcp_f32 v223, v223
  v_mfma_f32_16x16x32_bf16 v[128:131], a[168:171], v[144:147], 0
  s_add_u32 m0, s42, 90112
  ds_read_b64_tr_b16 a[152:153], v3 offset:16384
  ds_read_b64_tr_b16 a[154:155], v3 offset:18432
  v_mul_f32 v37, v37, v221
  v_mul_f32 v38, v38, v222
  v_mfma_f32_16x16x32_bf16 v[132:135], a[168:171], v[148:151], 0
  s_waitcnt lgkmcnt(6)
  ds_read_b64_tr_b16 a[156:157], v4 offset:16384
  ds_read_b64_tr_b16 a[158:159], v4 offset:18432
  v_cvt_pk_bf16_f32 v212, v36, v37
  v_mul_f32 v39, v39, v223
  v_mfma_f32_16x16x32_bf16 v[136:139], a[172:175], v[144:147], 0
  s_waitcnt lgkmcnt(6)
  buffer_load_dwordx4 a[4:7], v233, s[84:87], s69 offen sc1
  v_mfma_f32_16x16x32_bf16 v[140:143], a[172:175], v[148:151], 0
  s_barrier
  v_mfma_f32_16x16x32_bf16 v[80:83], a[144:147], v[152:155], v[80:83]
  s_add_u32 s40, s63, 147456
  ds_read_b64_tr_b16 a[160:161], v1 offset:17408
  v_cvt_pk_bf16_f32 v213, v38, v39
  v_mul_f32 v216, v224, v24
  v_mul_f32 v217, v224, v25
  v_mfma_f32_16x16x32_bf16 v[84:87], a[144:147], v[156:159], v[84:87]
  s_waitcnt lgkmcnt(5)
  ds_read_b64_tr_b16 a[162:163], v1 offset:19456
  v_mul_f32 v218, v224, v26
  v_mul_f32 v219, v224, v27
  v_mfma_f32_16x16x32_bf16 v[88:91], a[148:151], v[152:155], v[88:91]
  s_mov_b32 s69, 2048
  buffer_load_dwordx4 v13, s[12:15], s40 offen offset:0 lds
  v_mfma_f32_16x16x32_bf16 v[92:95], a[148:151], v[156:159], v[92:95]
  s_waitcnt lgkmcnt(2)
  ds_read_b64_tr_b16 a[164:165], v2 offset:17408
  ds_read_b64_tr_b16 a[166:167], v2 offset:19456
  v_exp_f32 v216, v216
  v_mfma_f32_16x16x32_bf16 v[96:99], a[152:155], v[152:155], v[96:99]
  ds_read_b64_tr_b16 a[168:169], v3 offset:17408
  v_mul_f32 v40, v24, v40
  v_mfma_f32_16x16x32_bf16 v[100:103], a[152:155], v[156:159], v[100:103]
  ds_read_b64_tr_b16 a[170:171], v3 offset:19456
  v_exp_f32 v217, v217
  v_mfma_f32_16x16x32_bf16 v[104:107], a[156:159], v[152:155], v[104:107]
  buffer_load_dwordx4 a[8:11], v233, s[84:87], s69 offen sc1
  v_mfma_f32_16x16x32_bf16 v[108:111], a[156:159], v[156:159], v[108:111]
  s_waitcnt lgkmcnt(4)
  ds_read_b64_tr_b16 a[172:173], v4 offset:17408
  ds_read_b64_tr_b16 a[174:175], v4 offset:19456
  v_mul_f32 v41, v25, v41
  v_mfma_f32_16x16x32_bf16 v[112:115], a[160:163], v[152:155], v[112:115]
  ds_read_b64_tr_b16 a[144:145], v1 offset:24576
  v_exp_f32 v218, v218
  v_mfma_f32_16x16x32_bf16 v[116:119], a[160:163], v[156:159], v[116:119]
  s_waitcnt lgkmcnt(5)
  ds_read_b64_tr_b16 a[146:147], v1 offset:26624
  v_fma_f32 v216, v216, v225, v225
  v_fma_f32 v217, v217, v225, v225
  v_mfma_f32_16x16x32_bf16 v[120:123], a[164:167], v[152:155], v[120:123]
  s_mov_b32 s69, 3072
  buffer_load_dwordx4 v14, s[12:15], s40 offen offset:1024 lds
  v_mfma_f32_16x16x32_bf16 v[124:127], a[164:167], v[156:159], v[124:127]
  s_waitcnt lgkmcnt(4)
  ds_read_b64_tr_b16 a[148:149], v2 offset:24576
  ds_read_b64_tr_b16 a[150:151], v2 offset:26624
  v_exp_f32 v219, v219
  v_mfma_f32_16x16x32_bf16 v[128:131], a[168:171], v[152:155], v[128:131]
  ds_read_b64_tr_b16 a[152:153], v3 offset:24576
  v_mul_f32 v42, v26, v42
  v_mfma_f32_16x16x32_bf16 v[132:135], a[168:171], v[156:159], v[132:135]
  s_waitcnt lgkmcnt(5)
  ds_read_b64_tr_b16 a[154:155], v3 offset:26624
  v_rcp_f32 v216, v216
  v_mfma_f32_16x16x32_bf16 v[136:139], a[172:175], v[152:155], v[136:139]
  s_add_u32 m0, s42, 0
  buffer_load_dwordx4 a[12:15], v233, s[84:87], s69 offen sc1
  v_mfma_f32_16x16x32_bf16 v[140:143], a[172:175], v[156:159], v[140:143]
  s_waitcnt lgkmcnt(4)
  ds_read_b64_tr_b16 a[156:157], v4 offset:24576
  ds_read_b64_tr_b16 a[158:159], v4 offset:26624
  v_fma_f32 v218, v218, v225, v225
  v_mfma_f32_16x16x32_bf16 v[80:83], a[144:147], v[160:163], v[80:83]
  s_add_u32 s40, s63, 184320
  ds_read_b64_tr_b16 a[160:161], v1 offset:25600
  v_rcp_f32 v217, v217
  v_mfma_f32_16x16x32_bf16 v[84:87], a[144:147], v[164:167], v[84:87]
  s_waitcnt lgkmcnt(5)
  ds_read_b64_tr_b16 a[162:163], v1 offset:27648
  v_mul_f32 v43, v27, v43
  v_fma_f32 v219, v219, v225, v225
  v_mfma_f32_16x16x32_bf16 v[88:91], a[148:151], v[160:163], v[88:91]
  s_mov_b32 s69, 4096
  buffer_load_dwordx4 v13, s[12:15], s40 offen offset:0 lds
  v_mfma_f32_16x16x32_bf16 v[92:95], a[148:151], v[164:167], v[92:95]
  s_waitcnt lgkmcnt(4)
  ds_read_b64_tr_b16 a[164:165], v2 offset:25600
  ds_read_b64_tr_b16 a[166:167], v2 offset:27648
  v_rcp_f32 v218, v218
  v_mfma_f32_16x16x32_bf16 v[96:99], a[152:155], v[160:163], v[96:99]
  ds_read_b64_tr_b16 a[168:169], v3 offset:25600
  v_mul_f32 v40, v40, v216
  v_mfma_f32_16x16x32_bf16 v[100:103], a[152:155], v[164:167], v[100:103]
  s_waitcnt lgkmcnt(5)
  ds_read_b64_tr_b16 a[170:171], v3 offset:27648
  v_rcp_f32 v219, v219
  v_mfma_f32_16x16x32_bf16 v[104:107], a[156:159], v[160:163], v[104:107]
  buffer_load_dwordx4 a[16:19], v233, s[84:87], s69 offen sc1
  v_mfma_f32_16x16x32_bf16 v[108:111], a[156:159], v[164:167], v[108:111]
  s_waitcnt lgkmcnt(4)
  ds_read_b64_tr_b16 a[172:173], v4 offset:25600
  ds_read_b64_tr_b16 a[174:175], v4 offset:27648
  v_mul_f32 v41, v41, v217
  v_mul_f32 v42, v42, v218
  v_mfma_f32_16x16x32_bf16 v[112:115], a[160:163], v[160:163], v[112:115]
  ds_read_b64_tr_b16 a[144:145], v1 offset:32768
  v_cvt_pk_bf16_f32 v210, v40, v41
  v_mul_f32 v43, v43, v219
  v_mfma_f32_16x16x32_bf16 v[116:119], a[160:163], v[164:167], v[116:119]
  s_waitcnt lgkmcnt(5)
  ds_read_b64_tr_b16 a[146:147], v1 offset:34816
  v_cvt_pk_bf16_f32 v211, v42, v43
  v_mul_f32 v220, v226, v28
  v_mfma_f32_16x16x32_bf16 v[120:123], a[164:167], v[160:163], v[120:123]
  s_mov_b32 s69, 5120
  buffer_load_dwordx4 v14, s[12:15], s40 offen offset:1024 lds
  v_mfma_f32_16x16x32_bf16 v[124:127], a[164:167], v[164:167], v[124:127]
  s_waitcnt lgkmcnt(4)
  ds_read_b64_tr_b16 a[148:149], v2 offset:32768
  ds_read_b64_tr_b16 a[150:151], v2 offset:34816
  v_mul_f32 v221, v226, v29
  v_mul_f32 v222, v226, v30
  v_mfma_f32_16x16x32_bf16 v[128:131], a[168:171], v[160:163], v[128:131]
  ds_read_b64_tr_b16 a[152:153], v3 offset:32768
  v_mul_f32 v223, v226, v31
  v_mfma_f32_16x16x32_bf16 v[132:135], a[168:171], v[164:167], v[132:135]
  s_waitcnt lgkmcnt(5)
  ds_read_b64_tr_b16 a[154:155], v3 offset:34816
  v_exp_f32 v220, v220
  v_mfma_f32_16x16x32_bf16 v[136:139], a[172:175], v[160:163], v[136:139]
  s_add_u32 m0, s42, 8192
  buffer_load_dwordx4 a[20:23], v233, s[84:87], s69 offen sc1
  v_mfma_f32_16x16x32_bf16 v[140:143], a[172:175], v[164:167], v[140:143]
  s_waitcnt lgkmcnt(4)
  ds_read_b64_tr_b16 a[156:157], v4 offset:32768
  ds_read_b64_tr_b16 a[158:159], v4 offset:34816
  v_mul_f32 v44, v28, v44
  v_mfma_f32_16x16x32_bf16 v[80:83], a[144:147], v[168:171], v[80:83]
  s_add_u32 s40, s63, 256
  ds_read_b64_tr_b16 a[160:161], v1 offset:33792
  v_exp_f32 v221, v221
  v_mfma_f32_16x16x32_bf16 v[84:87], a[144:147], v[172:175], v[84:87]
  s_waitcnt lgkmcnt(5)
  ds_read_b64_tr_b16 a[162:163], v1 offset:35840
  v_mul_f32 v45, v29, v45
  v_mfma_f32_16x16x32_bf16 v[88:91], a[148:151], v[168:171], v[88:91]
  s_mov_b32 s69, 6144
  buffer_load_dwordx4 v13, s[12:15], s40 offen offset:0 lds
  v_mfma_f32_16x16x32_bf16 v[92:95], a[148:151], v[172:175], v[92:95]
  s_waitcnt lgkmcnt(4)
  ds_read_b64_tr_b16 a[164:165], v2 offset:33792
  ds_read_b64_tr_b16 a[166:167], v2 offset:35840
  v_exp_f32 v222, v222
  v_mfma_f32_16x16x32_bf16 v[96:99], a[152:155], v[168:171], v[96:99]
  ds_read_b64_tr_b16 a[168:169], v3 offset:33792
  v_fma_f32 v220, v220, v227, v227
  v_fma_f32 v221, v221, v227, v227
  v_mfma_f32_16x16x32_bf16 v[100:103], a[152:155], v[172:175], v[100:103]
  s_waitcnt lgkmcnt(5)
  ds_read_b64_tr_b16 a[170:171], v3 offset:35840
  v_exp_f32 v223, v223
  v_mfma_f32_16x16x32_bf16 v[104:107], a[156:159], v[168:171], v[104:107]
  buffer_load_dwordx4 a[24:27], v233, s[84:87], s69 offen sc1
  v_mfma_f32_16x16x32_bf16 v[108:111], a[156:159], v[172:175], v[108:111]
  s_waitcnt lgkmcnt(4)
  ds_read_b64_tr_b16 a[172:173], v4 offset:33792
  ds_read_b64_tr_b16 a[174:175], v4 offset:35840
  v_mul_f32 v46, v30, v46
  v_mfma_f32_16x16x32_bf16 v[112:115], a[160:163], v[168:171], v[112:115]
  ds_read_b64_tr_b16 a[144:145], v1 offset:40960
  v_rcp_f32 v220, v220
  v_fma_f32 v222, v222, v227, v227
  v_mfma_f32_16x16x32_bf16 v[116:119], a[160:163], v[172:175], v[116:119]
  s_waitcnt lgkmcnt(5)
  ds_read_b64_tr_b16 a[146:147], v1 offset:43008
  v_rcp_f32 v221, v221
  v_mfma_f32_16x16x32_bf16 v[120:123], a[164:167], v[168:171], v[120:123]
  s_mov_b32 s69, 7168
  buffer_load_dwordx4 v14, s[12:15], s40 offen offset:1024 lds
  v_mul_f32 v47, v31, v47
  v_fma_f32 v223, v223, v227, v227
  v_rcp_f32 v222, v222
  v_mfma_f32_16x16x32_bf16 v[124:127], a[164:167], v[172:175], v[124:127]
  s_waitcnt lgkmcnt(4)
  ds_read_b64_tr_b16 a[148:149], v2 offset:40960
  ds_read_b64_tr_b16 a[150:151], v2 offset:43008
  v_mul_f32 v44, v44, v220
  v_rcp_f32 v223, v223
  v_mul_f32 v45, v45, v221
  v_mfma_f32_16x16x32_bf16 v[128:131], a[168:171], v[168:171], v[128:131]
  s_add_u32 m0, s42, 16384
  ds_read_b64_tr_b16 a[152:153], v3 offset:40960
  ds_read_b64_tr_b16 a[154:155], v3 offset:43008
  v_mul_f32 v46, v46, v222
  v_cvt_pk_bf16_f32 v214, v44, v45
  v_mul_f32 v47, v47, v223
  v_cvt_pk_bf16_f32 v215, v46, v47
  v_mfma_f32_16x16x32_bf16 v[132:135], a[168:171], v[172:175], v[132:135]
  s_waitcnt lgkmcnt(6)
  ds_read_b64_tr_b16 a[156:157], v4 offset:40960
  ds_read_b64_tr_b16 a[158:159], v4 offset:43008
  v_mfma_f32_16x16x32_bf16 v[136:139], a[172:175], v[168:171], v[136:139]
  s_waitcnt lgkmcnt(6)
  buffer_load_dwordx4 a[28:31], v233, s[84:87], s69 offen sc1
  v_mfma_f32_16x16x32_bf16 v[140:143], a[172:175], v[172:175], v[140:143]
  s_barrier
  v_mfma_f32_16x16x32_bf16 v[80:83], a[144:147], v[176:179], v[80:83]
  s_add_u32 s40, s63, 37120
  ds_read_b64_tr_b16 a[160:161], v1 offset:41984
  v_mfma_f32_16x16x32_bf16 v[84:87], a[144:147], v[180:183], v[84:87]
  s_waitcnt lgkmcnt(5)
  ds_read_b64_tr_b16 a[162:163], v1 offset:44032
  v_mfma_f32_16x16x32_bf16 v[88:91], a[148:151], v[176:179], v[88:91]
  s_mov_b32 s69, 8192
  buffer_load_dwordx4 v13, s[12:15], s40 offen offset:0 lds
  v_mfma_f32_16x16x32_bf16 v[92:95], a[148:151], v[180:183], v[92:95]
  s_waitcnt lgkmcnt(2)
  ds_read_b64_tr_b16 a[164:165], v2 offset:41984
  ds_read_b64_tr_b16 a[166:167], v2 offset:44032
  v_mfma_f32_16x16x32_bf16 v[96:99], a[152:155], v[176:179], v[96:99]
  ds_read_b64_tr_b16 a[168:169], v3 offset:41984
  v_mfma_f32_16x16x32_bf16 v[100:103], a[152:155], v[180:183], v[100:103]
  ds_read_b64_tr_b16 a[170:171], v3 offset:44032
  v_mfma_f32_16x16x32_bf16 v[104:107], a[156:159], v[176:179], v[104:107]
  buffer_load_dwordx4 a[32:35], v233, s[84:87], s69 offen sc1
  v_mfma_f32_16x16x32_bf16 v[108:111], a[156:159], v[180:183], v[108:111]
  s_waitcnt lgkmcnt(4)
  ds_read_b64_tr_b16 a[172:173], v4 offset:41984
  ds_read_b64_tr_b16 a[174:175], v4 offset:44032
  v_mfma_f32_16x16x32_bf16 v[112:115], a[160:163], v[176:179], v[112:115]
  ds_read_b64_tr_b16 a[144:145], v5 offset:32768
  v_mfma_f32_16x16x32_bf16 v[116:119], a[160:163], v[180:183], v[116:119]
  s_waitcnt lgkmcnt(5)
  ds_read_b64_tr_b16 a[146:147], v5 offset:34816
  v_mfma_f32_16x16x32_bf16 v[120:123], a[164:167], v[176:179], v[120:123]
  s_mov_b32 s69, 9216
  buffer_load_dwordx4 v14, s[12:15], s40 offen offset:1024 lds
  v_mfma_f32_16x16x32_bf16 v[124:127], a[164:167], v[180:183], v[124:127]
  s_waitcnt lgkmcnt(4)
  ds_read_b64_tr_b16 a[148:149], v6 offset:32768
  ds_read_b64_tr_b16 a[150:151], v6 offset:34816
  v_mfma_f32_16x16x32_bf16 v[128:131], a[168:171], v[176:179], v[128:131]
  ds_read_b64_tr_b16 a[152:153], v7 offset:32768
  v_mfma_f32_16x16x32_bf16 v[132:135], a[168:171], v[180:183], v[132:135]
  s_waitcnt lgkmcnt(5)
  ds_read_b64_tr_b16 a[154:155], v7 offset:34816
  v_mfma_f32_16x16x32_bf16 v[136:139], a[172:175], v[176:179], v[136:139]
  s_add_u32 m0, s42, 24576
  buffer_load_dwordx4 a[36:39], v233, s[84:87], s69 offen sc1
  v_mfma_f32_16x16x32_bf16 v[140:143], a[172:175], v[180:183], v[140:143]
  s_waitcnt lgkmcnt(4)
  ds_read_b64_tr_b16 a[156:157], v8 offset:32768
  ds_read_b64_tr_b16 a[158:159], v8 offset:34816
  v_mfma_f32_16x16x32_bf16 v[80:83], a[144:147], v[184:187], v[80:83]
  s_add_u32 s40, s63, 73984
  ds_read_b64_tr_b16 a[160:161], v5 offset:33792
  v_mfma_f32_16x16x32_bf16 v[84:87], a[144:147], v[188:191], v[84:87]
  s_waitcnt lgkmcnt(5)
  ds_read_b64_tr_b16 a[162:163], v5 offset:35840
  v_mfma_f32_16x16x32_bf16 v[88:91], a[148:151], v[184:187], v[88:91]
  s_mov_b32 s69, 10240
  buffer_load_dwordx4 v13, s[12:15], s40 offen offset:0 lds
  v_mfma_f32_16x16x32_bf16 v[92:95], a[148:151], v[188:191], v[92:95]
  s_waitcnt lgkmcnt(4)
  ds_read_b64_tr_b16 a[164:165], v6 offset:33792
  ds_read_b64_tr_b16 a[166:167], v6 offset:35840
  v_mfma_f32_16x16x32_bf16 v[96:99], a[152:155], v[184:187], v[96:99]
  ds_read_b64_tr_b16 a[168:169], v7 offset:33792
  v_mfma_f32_16x16x32_bf16 v[100:103], a[152:155], v[188:191], v[100:103]
  s_waitcnt lgkmcnt(5)
  ds_read_b64_tr_b16 a[170:171], v7 offset:35840
  v_mfma_f32_16x16x32_bf16 v[104:107], a[156:159], v[184:187], v[104:107]
  buffer_load_dwordx4 a[40:43], v233, s[84:87], s69 offen sc1
  v_mfma_f32_16x16x32_bf16 v[108:111], a[156:159], v[188:191], v[108:111]
  s_waitcnt lgkmcnt(4)
  ds_read_b64_tr_b16 a[172:173], v8 offset:33792
  ds_read_b64_tr_b16 a[174:175], v8 offset:35840
  v_mfma_f32_16x16x32_bf16 v[112:115], a[160:163], v[184:187], v[112:115]
  ds_read_b64_tr_b16 a[144:145], v5 offset:40960
  v_mfma_f32_16x16x32_bf16 v[116:119], a[160:163], v[188:191], v[116:119]
  s_waitcnt lgkmcnt(5)
  ds_read_b64_tr_b16 a[146:147], v5 offset:43008
  v_mfma_f32_16x16x32_bf16 v[120:123], a[164:167], v[184:187], v[120:123]
  s_mov_b32 s69, 11264
  buffer_load_dwordx4 v14, s[12:15], s40 offen offset:1024 lds
  v_mfma_f32_16x16x32_bf16 v[124:127], a[164:167], v[188:191], v[124:127]
  s_waitcnt lgkmcnt(4)
  ds_read_b64_tr_b16 a[148:149], v6 offset:40960
  ds_read_b64_tr_b16 a[150:151], v6 offset:43008
  v_mfma_f32_16x16x32_bf16 v[128:131], a[168:171], v[184:187], v[128:131]
  ds_read_b64_tr_b16 a[152:153], v7 offset:40960
  v_mfma_f32_16x16x32_bf16 v[132:135], a[168:171], v[188:191], v[132:135]
  s_waitcnt lgkmcnt(5)
  ds_read_b64_tr_b16 a[154:155], v7 offset:43008
  v_mfma_f32_16x16x32_bf16 v[136:139], a[172:175], v[184:187], v[136:139]
  s_add_u32 m0, s42, 32768
  buffer_load_dwordx4 a[44:47], v233, s[84:87], s69 offen sc1
  v_mfma_f32_16x16x32_bf16 v[140:143], a[172:175], v[188:191], v[140:143]
  s_waitcnt lgkmcnt(4)
  ds_read_b64_tr_b16 a[156:157], v8 offset:40960
  ds_read_b64_tr_b16 a[158:159], v8 offset:43008
  v_mfma_f32_16x16x32_bf16 v[80:83], a[144:147], v[192:195], v[80:83]
  s_add_u32 s40, s63, 221184
  ds_read_b64_tr_b16 a[160:161], v5 offset:41984
  v_mfma_f32_16x16x32_bf16 v[84:87], a[144:147], v[196:199], v[84:87]
  s_waitcnt lgkmcnt(5)
  ds_read_b64_tr_b16 a[162:163], v5 offset:44032
  v_mfma_f32_16x16x32_bf16 v[88:91], a[148:151], v[192:195], v[88:91]
  s_mov_b32 s69, 16384
  buffer_load_dwordx4 v13, s[12:15], s40 offen offset:0 lds
  v_mfma_f32_16x16x32_bf16 v[92:95], a[148:151], v[196:199], v[92:95]
  s_waitcnt lgkmcnt(4)
  ds_read_b64_tr_b16 a[164:165], v6 offset:41984
  ds_read_b64_tr_b16 a[166:167], v6 offset:44032
  v_mfma_f32_16x16x32_bf16 v[96:99], a[152:155], v[192:195], v[96:99]
  ds_read_b64_tr_b16 a[168:169], v7 offset:41984
  v_mfma_f32_16x16x32_bf16 v[100:103], a[152:155], v[196:199], v[100:103]
  s_waitcnt lgkmcnt(5)
  ds_read_b64_tr_b16 a[170:171], v7 offset:44032
  v_mfma_f32_16x16x32_bf16 v[104:107], a[156:159], v[192:195], v[104:107]
  buffer_store_dwordx4 v[208:211], v233, s[76:79], s69 offen sc1
  v_mfma_f32_16x16x32_bf16 v[108:111], a[156:159], v[196:199], v[108:111]
  s_waitcnt lgkmcnt(4)
  ds_read_b64_tr_b16 a[172:173], v8 offset:41984
  ds_read_b64_tr_b16 a[174:175], v8 offset:44032
  v_mfma_f32_16x16x32_bf16 v[112:115], a[160:163], v[192:195], v[112:115]
  ds_read_b64_tr_b16 a[144:145], v5 offset:49152
  v_mfma_f32_16x16x32_bf16 v[116:119], a[160:163], v[196:199], v[116:119]
  s_waitcnt lgkmcnt(5)
  ds_read_b64_tr_b16 a[146:147], v5 offset:51200
  v_mfma_f32_16x16x32_bf16 v[120:123], a[164:167], v[192:195], v[120:123]
  s_mov_b32 s69, 17408
  buffer_load_dwordx4 v14, s[12:15], s40 offen offset:1024 lds
  v_mfma_f32_16x16x32_bf16 v[124:127], a[164:167], v[196:199], v[124:127]
  s_waitcnt lgkmcnt(4)
  ds_read_b64_tr_b16 a[148:149], v6 offset:49152
  ds_read_b64_tr_b16 a[150:151], v6 offset:51200
  v_mfma_f32_16x16x32_bf16 v[128:131], a[168:171], v[192:195], v[128:131]
  s_add_u32 m0, s42, 40960
  ds_read_b64_tr_b16 a[152:153], v7 offset:49152
  ds_read_b64_tr_b16 a[154:155], v7 offset:51200
  v_mfma_f32_16x16x32_bf16 v[132:135], a[168:171], v[196:199], v[132:135]
  s_waitcnt lgkmcnt(6)
  ds_read_b64_tr_b16 a[156:157], v8 offset:49152
  ds_read_b64_tr_b16 a[158:159], v8 offset:51200
  v_mfma_f32_16x16x32_bf16 v[136:139], a[172:175], v[192:195], v[136:139]
  s_waitcnt vmcnt(33) lgkmcnt(6)
  buffer_store_dwordx4 v[212:215], v233, s[76:79], s69 offen sc1
  v_mfma_f32_16x16x32_bf16 v[140:143], a[172:175], v[196:199], v[140:143]
  s_barrier
  v_mfma_f32_16x16x32_bf16 v[80:83], a[144:147], v[200:203], v[80:83]
  s_add_u32 s40, s63, 258048
  ds_read_b64_tr_b16 a[160:161], v5 offset:50176
  v_mfma_f32_16x16x32_bf16 v[84:87], a[144:147], v[204:207], v[84:87]
  s_waitcnt lgkmcnt(5)
  ds_read_b64_tr_b16 a[162:163], v5 offset:52224
  v_mfma_f32_16x16x32_bf16 v[88:91], a[148:151], v[200:203], v[88:91]
  buffer_load_dwordx4 v13, s[12:15], s40 offen offset:0 lds
  v_mfma_f32_16x16x32_bf16 v[92:95], a[148:151], v[204:207], v[92:95]
  s_waitcnt lgkmcnt(2)
  ds_read_b64_tr_b16 a[164:165], v6 offset:50176
  ds_read_b64_tr_b16 a[166:167], v6 offset:52224
  v_mfma_f32_16x16x32_bf16 v[96:99], a[152:155], v[200:203], v[96:99]
  ds_read_b64_tr_b16 a[168:169], v7 offset:50176
  v_mfma_f32_16x16x32_bf16 v[100:103], a[152:155], v[204:207], v[100:103]
  ds_read_b64_tr_b16 a[170:171], v7 offset:52224
  v_mfma_f32_16x16x32_bf16 v[104:107], a[156:159], v[200:203], v[104:107]
  ds_read_b64_tr_b16 a[172:173], v8 offset:50176
  v_mfma_f32_16x16x32_bf16 v[108:111], a[156:159], v[204:207], v[108:111]
  s_waitcnt lgkmcnt(5)
  ds_read_b64_tr_b16 a[174:175], v8 offset:52224
  v_mfma_f32_16x16x32_bf16 v[112:115], a[160:163], v[200:203], v[112:115]
  ds_read_b64_tr_b16 a[144:145], v5 offset:57344
  v_mfma_f32_16x16x32_bf16 v[116:119], a[160:163], v[204:207], v[116:119]
  s_waitcnt lgkmcnt(5)
  ds_read_b64_tr_b16 a[146:147], v5 offset:59392
  v_mfma_f32_16x16x32_bf16 v[120:123], a[164:167], v[200:203], v[120:123]
  buffer_load_dwordx4 v14, s[12:15], s40 offen offset:1024 lds
  v_mfma_f32_16x16x32_bf16 v[124:127], a[164:167], v[204:207], v[124:127]
  s_waitcnt lgkmcnt(4)
  ds_read_b64_tr_b16 a[148:149], v6 offset:57344
  ds_read_b64_tr_b16 a[150:151], v6 offset:59392
  v_mfma_f32_16x16x32_bf16 v[128:131], a[168:171], v[200:203], v[128:131]
  s_add_u32 s40, s65, 0
  ds_read_b64_tr_b16 a[152:153], v7 offset:57344
  v_mfma_f32_16x16x32_bf16 v[132:135], a[168:171], v[204:207], v[132:135]
  s_waitcnt lgkmcnt(5)
  ds_read_b64_tr_b16 a[154:155], v7 offset:59392
  v_mfma_f32_16x16x32_bf16 v[136:139], a[172:175], v[200:203], v[136:139]
  s_add_u32 m0, s42, 98304
  ds_read_b64_tr_b16 a[156:157], v8 offset:57344
  v_mfma_f32_16x16x32_bf16 v[140:143], a[172:175], v[204:207], v[140:143]
  s_waitcnt lgkmcnt(5)
  ds_read_b64_tr_b16 a[158:159], v8 offset:59392
  v_mfma_f32_16x16x32_bf16 a[72:75], a[144:147], v[208:211], a[72:75]
  ds_read_b64_tr_b16 a[160:161], v5 offset:58368
  v_mfma_f32_16x16x32_bf16 a[76:79], a[144:147], v[212:215], a[76:79]
  s_waitcnt lgkmcnt(5)
  ds_read_b64_tr_b16 a[162:163], v5 offset:60416
  v_mfma_f32_16x16x32_bf16 a[80:83], a[148:151], v[208:211], a[80:83]
  buffer_load_dwordx4 v13, s[12:15], s40 offen offset:0 lds
  v_mfma_f32_16x16x32_bf16 a[84:87], a[148:151], v[212:215], a[84:87]
  s_waitcnt lgkmcnt(4)
  ds_read_b64_tr_b16 a[164:165], v6 offset:58368
  ds_read_b64_tr_b16 a[166:167], v6 offset:60416
  v_mfma_f32_16x16x32_bf16 a[88:91], a[152:155], v[208:211], a[88:91]
  ds_read_b64_tr_b16 a[168:169], v7 offset:58368
  v_mfma_f32_16x16x32_bf16 a[92:95], a[152:155], v[212:215], a[92:95]
  s_waitcnt lgkmcnt(5)
  ds_read_b64_tr_b16 a[170:171], v7 offset:60416
  v_mfma_f32_16x16x32_bf16 a[96:99], a[156:159], v[208:211], a[96:99]
  ds_read_b64_tr_b16 a[172:173], v8 offset:58368
  v_mfma_f32_16x16x32_bf16 a[100:103], a[156:159], v[212:215], a[100:103]
  s_waitcnt lgkmcnt(5)
  ds_read_b64_tr_b16 a[174:175], v8 offset:60416
  v_mfma_f32_16x16x32_bf16 a[104:107], a[160:163], v[208:211], a[104:107]
  ds_read_b64_tr_b16 a[144:145], v1 offset:49152
  v_mfma_f32_16x16x32_bf16 a[108:111], a[160:163], v[212:215], a[108:111]
  s_waitcnt lgkmcnt(5)
  ds_read_b64_tr_b16 a[146:147], v1 offset:51200
  v_mfma_f32_16x16x32_bf16 a[112:115], a[164:167], v[208:211], a[112:115]
  buffer_load_dwordx4 v14, s[12:15], s40 offen offset:1024 lds
  v_mfma_f32_16x16x32_bf16 a[116:119], a[164:167], v[212:215], a[116:119]
  s_waitcnt lgkmcnt(4)
  ds_read_b64_tr_b16 a[148:149], v2 offset:49152
  ds_read_b64_tr_b16 a[150:151], v2 offset:51200
  v_mfma_f32_16x16x32_bf16 a[120:123], a[168:171], v[208:211], a[120:123]
  s_add_u32 s40, s63, 110848
  ds_read_b64_tr_b16 a[152:153], v3 offset:49152
  v_mfma_f32_16x16x32_bf16 a[124:127], a[168:171], v[212:215], a[124:127]
  s_waitcnt lgkmcnt(5)
  ds_read_b64_tr_b16 a[154:155], v3 offset:51200
  v_mfma_f32_16x16x32_bf16 a[128:131], a[172:175], v[208:211], a[128:131]
  s_add_u32 m0, s42, 106496
  ds_read_b64_tr_b16 a[156:157], v4 offset:49152
  v_mfma_f32_16x16x32_bf16 a[132:135], a[172:175], v[212:215], a[132:135]
  s_waitcnt lgkmcnt(5)
  ds_read_b64_tr_b16 a[158:159], v4 offset:51200
  v_mfma_f32_16x16x32_bf16 v[80:83], a[144:147], v[208:211], v[80:83]
  ds_read_b64_tr_b16 a[160:161], v1 offset:50176
  v_mfma_f32_16x16x32_bf16 v[84:87], a[144:147], v[212:215], v[84:87]
  s_waitcnt lgkmcnt(5)
  ds_read_b64_tr_b16 a[162:163], v1 offset:52224
  v_mfma_f32_16x16x32_bf16 v[88:91], a[148:151], v[208:211], v[88:91]
  buffer_load_dwordx4 v13, s[12:15], s40 offen offset:0 lds
  v_mfma_f32_16x16x32_bf16 v[92:95], a[148:151], v[212:215], v[92:95]
  s_waitcnt lgkmcnt(4)
  ds_read_b64_tr_b16 a[164:165], v2 offset:50176
  ds_read_b64_tr_b16 a[166:167], v2 offset:52224
  v_mfma_f32_16x16x32_bf16 v[96:99], a[152:155], v[208:211], v[96:99]
  ds_read_b64_tr_b16 a[168:169], v3 offset:50176
  v_mfma_f32_16x16x32_bf16 v[100:103], a[152:155], v[212:215], v[100:103]
  s_waitcnt lgkmcnt(5)
  ds_read_b64_tr_b16 a[170:171], v3 offset:52224
  v_mfma_f32_16x16x32_bf16 v[104:107], a[156:159], v[208:211], v[104:107]
L3_pad9:
  s_cmp_lg_u32 s82, 0
  s_cbranch_scc1 L3_main
  ds_read_b64_tr_b16 a[172:173], v4 offset:50176
  v_mfma_f32_16x16x32_bf16 v[108:111], a[156:159], v[212:215], v[108:111]
  s_waitcnt lgkmcnt(5)
  ds_read_b64_tr_b16 a[174:175], v4 offset:52224
  v_mfma_f32_16x16x32_bf16 v[112:115], a[160:163], v[208:211], v[112:115]
  ds_read_b64_tr_b16 a[144:145], v1 offset:57344
  v_mfma_f32_16x16x32_bf16 v[116:119], a[160:163], v[212:215], v[116:119]
  s_waitcnt lgkmcnt(5)
  ds_read_b64_tr_b16 a[146:147], v1 offset:59392
  v_mfma_f32_16x16x32_bf16 v[120:123], a[164:167], v[208:211], v[120:123]
  buffer_load_dwordx4 v14, s[12:15], s40 offen offset:1024 lds
  v_mfma_f32_16x16x32_bf16 v[124:127], a[164:167], v[212:215], v[124:127]
  s_waitcnt lgkmcnt(4)
  ds_read_b64_tr_b16 a[148:149], v2 offset:57344
  ds_read_b64_tr_b16 a[150:151], v2 offset:59392
  v_mfma_f32_16x16x32_bf16 v[128:131], a[168:171], v[208:211], v[128:131]
  s_add_u32 m0, s42, 114688
  ds_read_b64_tr_b16 a[152:153], v3 offset:57344
  v_mfma_f32_16x16x32_bf16 v[132:135], a[168:171], v[212:215], v[132:135]
  s_waitcnt lgkmcnt(5)
  ds_read_b64_tr_b16 a[154:155], v3 offset:59392
  v_mfma_f32_16x16x32_bf16 v[136:139], a[172:175], v[208:211], v[136:139]
  s_waitcnt vmcnt(31) lgkmcnt(4)
  ds_read_b64_tr_b16 a[156:157], v4 offset:57344
  ds_read_b64_tr_b16 a[158:159], v4 offset:59392
  v_mfma_f32_16x16x32_bf16 v[140:143], a[172:175], v[212:215], v[140:143]
  s_barrier
  v_mfma_f32_16x16x32_bf16 a[72:75], a[144:147], a[0:3], a[72:75]
  s_waitcnt vmcnt(30)
  s_add_u32 s40, s63, 147712
  ds_read_b64_tr_b16 a[160:161], v1 offset:58368
  v_mfma_f32_16x16x32_bf16 a[76:79], a[144:147], a[4:7], a[76:79]
  s_waitcnt lgkmcnt(5)
  ds_read_b64_tr_b16 a[162:163], v1 offset:60416
  v_mfma_f32_16x16x32_bf16 a[80:83], a[148:151], a[0:3], a[80:83]
  buffer_load_dwordx4 v13, s[12:15], s40 offen offset:0 lds
  v_mfma_f32_16x16x32_bf16 a[84:87], a[148:151], a[4:7], a[84:87]
  s_waitcnt lgkmcnt(4)
  ds_read_b64_tr_b16 a[164:165], v2 offset:58368
  ds_read_b64_tr_b16 a[166:167], v2 offset:60416
  v_mfma_f32_16x16x32_bf16 a[88:91], a[152:155], a[0:3], a[88:91]
  ds_read_b64_tr_b16 a[168:169], v3 offset:58368
  v_mfma_f32_16x16x32_bf16 a[92:95], a[152:155], a[4:7], a[92:95]
  s_waitcnt lgkmcnt(5)
  ds_read_b64_tr_b16 a[170:171], v3 offset:60416
  v_mfma_f32_16x16x32_bf16 a[96:99], a[156:159], a[0:3], a[96:99]
  s_waitcnt vmcnt(7)
  buffer_store_dwordx2 a[224:225], v240, s[32:35], 0 offen offset:768 sc1
  v_mfma_f32_16x16x32_bf16 a[100:103], a[156:159], a[4:7], a[100:103]
  s_waitcnt lgkmcnt(4)
  ds_read_b64_tr_b16 a[172:173], v4 offset:58368
  ds_read_b64_tr_b16 a[174:175], v4 offset:60416
  v_mfma_f32_16x16x32_bf16 a[104:107], a[160:163], a[0:3], a[104:107]
  ds_read_b64_tr_b16 a[144:145], v5 offset:0
  v_mfma_f32_16x16x32_bf16 a[108:111], a[160:163], a[4:7], a[108:111]
  s_waitcnt lgkmcnt(5)
  ds_read_b64_tr_b16 a[146:147], v5 offset:2048
  v_mfma_f32_16x16x32_bf16 a[112:115], a[164:167], a[0:3], a[112:115]
  buffer_load_dwordx4 v14, s[12:15], s40 offen offset:1024 lds
  v_mfma_f32_16x16x32_bf16 a[116:119], a[164:167], a[4:7], a[116:119]
  s_waitcnt lgkmcnt(4)
  ds_read_b64_tr_b16 a[148:149], v6 offset:0
  ds_read_b64_tr_b16 a[150:151], v6 offset:2048
  v_mfma_f32_16x16x32_bf16 a[120:123], a[168:171], a[0:3], a[120:123]
  s_add_u32 s40, s63, 184576
  ds_read_b64_tr_b16 a[152:153], v7 offset:0
  v_mfma_f32_16x16x32_bf16 a[124:127], a[168:171], a[4:7], a[124:127]
  s_waitcnt lgkmcnt(5)
  ds_read_b64_tr_b16 a[154:155], v7 offset:2048
  v_mfma_f32_16x16x32_bf16 a[128:131], a[172:175], a[0:3], a[128:131]
  s_add_u32 m0, s42, 122880
  ds_read_b64_tr_b16 a[156:157], v8 offset:0
  v_mfma_f32_16x16x32_bf16 a[132:135], a[172:175], a[4:7], a[132:135]
  s_waitcnt lgkmcnt(5)
  ds_read_b64_tr_b16 a[158:159], v8 offset:2048
  v_mfma_f32_16x16x32_bf16 a[72:75], a[144:147], a[8:11], a[72:75]
  ds_read_b64_tr_b16 a[160:161], v5 offset:1024
  v_mfma_f32_16x16x32_bf16 a[76:79], a[144:147], a[12:15], a[76:79]
  s_waitcnt lgkmcnt(5)
  ds_read_b64_tr_b16 a[162:163], v5 offset:3072
  v_mfma_f32_16x16x32_bf16 a[80:83], a[148:151], a[8:11], a[80:83]
  buffer_load_dwordx4 v13, s[12:15], s40 offen offset:0 lds
  v_mfma_f32_16x16x32_bf16 a[84:87], a[148:151], a[12:15], a[84:87]
  s_waitcnt lgkmcnt(4)
  ds_read_b64_tr_b16 a[164:165], v6 offset:1024
  ds_read_b64_tr_b16 a[166:167], v6 offset:3072
  v_mfma_f32_16x16x32_bf16 a[88:91], a[152:155], a[8:11], a[88:91]
  ds_read_b64_tr_b16 a[168:169], v7 offset:1024
  v_mfma_f32_16x16x32_bf16 a[92:95], a[152:155], a[12:15], a[92:95]
  s_waitcnt lgkmcnt(5)
  ds_read_b64_tr_b16 a[170:171], v7 offset:3072
  v_mfma_f32_16x16x32_bf16 a[96:99], a[156:159], a[8:11], a[96:99]
  ds_read_b64_tr_b16 a[172:173], v8 offset:1024
  v_mfma_f32_16x16x32_bf16 a[100:103], a[156:159], a[12:15], a[100:103]
  s_waitcnt lgkmcnt(5)
  ds_read_b64_tr_b16 a[174:175], v8 offset:3072
  v_mfma_f32_16x16x32_bf16 a[104:107], a[160:163], a[8:11], a[104:107]
  ds_read_b64_tr_b16 a[144:145], v5 offset:8192
  v_mfma_f32_16x16x32_bf16 a[108:111], a[160:163], a[12:15], a[108:111]
  s_waitcnt lgkmcnt(5)
  ds_read_b64_tr_b16 a[146:147], v5 offset:10240
  v_mfma_f32_16x16x32_bf16 a[112:115], a[164:167], a[8:11], a[112:115]
  buffer_load_dwordx4 v14, s[12:15], s40 offen offset:1024 lds
  v_mfma_f32_16x16x32_bf16 a[116:119], a[164:167], a[12:15], a[116:119]
  s_waitcnt lgkmcnt(4)
  ds_read_b64_tr_b16 a[148:149], v6 offset:8192
  ds_read_b64_tr_b16 a[150:151], v6 offset:10240
  v_mfma_f32_16x16x32_bf16 a[120:123], a[168:171], a[8:11], a[120:123]
  s_add_u32 s40, s63, 221440
  ds_read_b64_tr_b16 a[152:153], v7 offset:8192
  v_mfma_f32_16x16x32_bf16 a[124:127], a[168:171], a[12:15], a[124:127]
  s_waitcnt lgkmcnt(5)
  ds_read_b64_tr_b16 a[154:155], v7 offset:10240
  v_mfma_f32_16x16x32_bf16 a[128:131], a[172:175], a[8:11], a[128:131]
  s_add_u32 m0, s42, 49152
  ds_read_b64_tr_b16 a[156:157], v8 offset:8192
  v_mfma_f32_16x16x32_bf16 a[132:135], a[172:175], a[12:15], a[132:135]
  s_waitcnt lgkmcnt(5)
  ds_read_b64_tr_b16 a[158:159], v8 offset:10240
  v_mfma_f32_16x16x32_bf16 a[72:75], a[144:147], a[16:19], a[72:75]
  ds_read_b64_tr_b16 a[160:161], v5 offset:9216
  v_mfma_f32_16x16x32_bf16 a[76:79], a[144:147], a[20:23], a[76:79]
  s_waitcnt lgkmcnt(5)
  ds_read_b64_tr_b16 a[162:163], v5 offset:11264
  v_mfma_f32_16x16x32_bf16 a[80:83], a[148:151], a[16:19], a[80:83]
  buffer_load_dwordx4 v13, s[12:15], s40 offen offset:0 lds
  v_mfma_f32_16x16x32_bf16 a[84:87], a[148:151], a[20:23], a[84:87]
  s_waitcnt lgkmcnt(4)
  ds_read_b64_tr_b16 a[164:165], v6 offset:9216
  ds_read_b64_tr_b16 a[166:167], v6 offset:11264
  v_mfma_f32_16x16x32_bf16 a[88:91], a[152:155], a[16:19], a[88:91]
  ds_read_b64_tr_b16 a[168:169], v7 offset:9216
  v_mfma_f32_16x16x32_bf16 a[92:95], a[152:155], a[20:23], a[92:95]
  s_waitcnt lgkmcnt(5)
  ds_read_b64_tr_b16 a[170:171], v7 offset:11264
  v_mfma_f32_16x16x32_bf16 a[96:99], a[156:159], a[16:19], a[96:99]
  ds_read_b64_tr_b16 a[172:173], v8 offset:9216
  v_mfma_f32_16x16x32_bf16 a[100:103], a[156:159], a[20:23], a[100:103]
  s_waitcnt lgkmcnt(5)
  ds_read_b64_tr_b16 a[174:175], v8 offset:11264
  v_mfma_f32_16x16x32_bf16 a[104:107], a[160:163], a[16:19], a[104:107]
  ds_read_b64_tr_b16 a[144:145], v5 offset:16384
  v_mfma_f32_16x16x32_bf16 a[108:111], a[160:163], a[20:23], a[108:111]
  s_waitcnt lgkmcnt(5)
  ds_read_b64_tr_b16 a[146:147], v5 offset:18432
  v_mfma_f32_16x16x32_bf16 a[112:115], a[164:167], a[16:19], a[112:115]
  buffer_load_dwordx4 v14, s[12:15], s40 offen offset:1024 lds
  v_mfma_f32_16x16x32_bf16 a[116:119], a[164:167], a[20:23], a[116:119]
  s_waitcnt lgkmcnt(4)
  ds_read_b64_tr_b16 a[148:149], v6 offset:16384
  ds_read_b64_tr_b16 a[150:151], v6 offset:18432
  v_mfma_f32_16x16x32_bf16 a[120:123], a[168:171], a[16:19], a[120:123]
  s_add_u32 m0, s42, 57344
  ds_read_b64_tr_b16 a[152:153], v7 offset:16384
  v_mfma_f32_16x16x32_bf16 a[124:127], a[168:171], a[20:23], a[124:127]
  s_waitcnt lgkmcnt(5)
  ds_read_b64_tr_b16 a[154:155], v7 offset:18432
  v_mfma_f32_16x16x32_bf16 a[128:131], a[172:175], a[16:19], a[128:131]
  s_waitcnt lgkmcnt(4)
  ds_read_b64_tr_b16 a[156:157], v8 offset:16384
  ds_read_b64_tr_b16 a[158:159], v8 offset:18432
  v_mfma_f32_16x16x32_bf16 a[132:135], a[172:175], a[20:23], a[132:135]
  s_barrier
  v_mfma_f32_16x16x32_bf16 a[72:75], a[144:147], a[24:27], a[72:75]
  s_add_u32 s40, s63, 258304
  ds_read_b64_tr_b16 a[160:161], v5 offset:17408
  v_mfma_f32_16x16x32_bf16 a[76:79], a[144:147], a[28:31], a[76:79]
  s_waitcnt lgkmcnt(5)
  ds_read_b64_tr_b16 a[162:163], v5 offset:19456
  v_mfma_f32_16x16x32_bf16 a[80:83], a[148:151], a[24:27], a[80:83]
  buffer_load_dwordx4 v13, s[12:15], s40 offen offset:0 lds
  v_mfma_f32_16x16x32_bf16 a[84:87], a[148:151], a[28:31], a[84:87]
  s_waitcnt lgkmcnt(4)
  ds_read_b64_tr_b16 a[164:165], v6 offset:17408
  ds_read_b64_tr_b16 a[166:167], v6 offset:19456
  v_mfma_f32_16x16x32_bf16 a[88:91], a[152:155], a[24:27], a[88:91]
  ds_read_b64_tr_b16 a[168:169], v7 offset:17408
  v_mfma_f32_16x16x32_bf16 a[92:95], a[152:155], a[28:31], a[92:95]
  s_waitcnt lgkmcnt(5)
  ds_read_b64_tr_b16 a[170:171], v7 offset:19456
  v_mfma_f32_16x16x32_bf16 a[96:99], a[156:159], a[24:27], a[96:99]
  buffer_load_dwordx2 v[242:243], v248, s[32:35], 0 offen offset:768 sc1
  v_mfma_f32_16x16x32_bf16 a[100:103], a[156:159], a[28:31], a[100:103]
  s_waitcnt lgkmcnt(4)
  ds_read_b64_tr_b16 a[172:173], v8 offset:17408
  ds_read_b64_tr_b16 a[174:175], v8 offset:19456
  v_mfma_f32_16x16x32_bf16 a[104:107], a[160:163], a[24:27], a[104:107]
  ds_read_b64_tr_b16 a[144:145], v5 offset:24576
  v_mfma_f32_16x16x32_bf16 a[108:111], a[160:163], a[28:31], a[108:111]
  s_waitcnt lgkmcnt(5)
  ds_read_b64_tr_b16 a[146:147], v5 offset:26624
  v_mfma_f32_16x16x32_bf16 a[112:115], a[164:167], a[24:27], a[112:115]
  buffer_load_dwordx4 v14, s[12:15], s40 offen offset:1024 lds
  v_mfma_f32_16x16x32_bf16 a[116:119], a[164:167], a[28:31], a[116:119]
  s_waitcnt lgkmcnt(4)
  ds_read_b64_tr_b16 a[148:149], v6 offset:24576
  ds_read_b64_tr_b16 a[150:151], v6 offset:26624
  v_mfma_f32_16x16x32_bf16 a[120:123], a[168:171], a[24:27], a[120:123]
  s_add_u32 s40, s65, 256
  ds_read_b64_tr_b16 a[152:153], v7 offset:24576
  v_mfma_f32_16x16x32_bf16 a[124:127], a[168:171], a[28:31], a[124:127]
  s_waitcnt lgkmcnt(5)
  ds_read_b64_tr_b16 a[154:155], v7 offset:26624
  v_mfma_f32_16x16x32_bf16 a[128:131], a[172:175], a[24:27], a[128:131]
  s_add_u32 m0, s42, 65536
  ds_read_b64_tr_b16 a[156:157], v8 offset:24576
  v_mfma_f32_16x16x32_bf16 a[132:135], a[172:175], a[28:31], a[132:135]
  s_waitcnt lgkmcnt(5)
  ds_read_b64_tr_b16 a[158:159], v8 offset:26624
  v_mfma_f32_16x16x32_bf16 a[72:75], a[144:147], a[32:35], a[72:75]
  ds_read_b64_tr_b16 a[228:229], v236 offset:0
  v_mfma_f32_16x16x32_bf16 a[76:79], a[144:147], a[36:39], a[76:79]
  s_waitcnt lgkmcnt(5)
  ds_read_b64_tr_b16 a[160:161], v5 offset:25600
  ds_read_b64_tr_b16 a[162:163], v5 offset:27648
  v_mfma_f32_16x16x32_bf16 a[80:83], a[148:151], a[32:35], a[80:83]
  buffer_load_dwordx4 v13, s[12:15], s40 offen offset:0 lds
  v_mfma_f32_16x16x32_bf16 a[84:87], a[148:151], a[36:39], a[84:87]
  s_waitcnt lgkmcnt(5)
  ds_read_b64_tr_b16 a[164:165], v6 offset:25600
  ds_read_b64_tr_b16 a[166:167], v6 offset:27648
  v_mfma_f32_16x16x32_bf16 a[88:91], a[152:155], a[32:35], a[88:91]
  ds_read_b64_tr_b16 a[168:169], v7 offset:25600
  v_mfma_f32_16x16x32_bf16 a[92:95], a[152:155], a[36:39], a[92:95]
  s_waitcnt lgkmcnt(6)
  ds_read_b64_tr_b16 a[170:171], v7 offset:27648
  v_mfma_f32_16x16x32_bf16 a[96:99], a[156:159], a[32:35], a[96:99]
  ds_read_b64_tr_b16 a[172:173], v8 offset:25600
  v_mfma_f32_16x16x32_bf16 a[100:103], a[156:159], a[36:39], a[100:103]
  s_waitcnt lgkmcnt(5)
  ds_read_b64_tr_b16 a[174:175], v8 offset:27648
  v_mfma_f32_16x16x32_bf16 a[104:107], a[160:163], a[32:35], a[104:107]
  ds_read_b64_tr_b16 a[144:145], v1 offset:0
  v_mfma_f32_16x16x32_bf16 a[108:111], a[160:163], a[36:39], a[108:111]
  s_waitcnt lgkmcnt(5)
  ds_read_b64_tr_b16 a[146:147], v1 offset:2048
  v_mfma_f32_16x16x32_bf16 a[112:115], a[164:167], a[32:35], a[112:115]
  buffer_load_dwordx4 v14, s[12:15], s40 offen offset:1024 lds
  v_mfma_f32_16x16x32_bf16 a[116:119], a[164:167], a[36:39], a[116:119]
  s_waitcnt lgkmcnt(4)
  ds_read_b64_tr_b16 a[148:149], v2 offset:0
  ds_read_b64_tr_b16 a[150:151], v2 offset:2048
  v_mfma_f32_16x16x32_bf16 a[120:123], a[168:171], a[32:35], a[120:123]
  s_add_u32 s40, s62, 0
  ds_read_b64_tr_b16 a[152:153], v3 offset:0
  v_mfma_f32_16x16x32_bf16 a[124:127], a[168:171], a[36:39], a[124:127]
  s_waitcnt lgkmcnt(5)
  ds_read_b64_tr_b16 a[154:155], v3 offset:2048
  v_mfma_f32_16x16x32_bf16 a[128:131], a[172:175], a[32:35], a[128:131]
  s_add_u32 m0, s43, 73728
  ds_read_b64_tr_b16 a[156:157], v4 offset:0
  v_mfma_f32_16x16x32_bf16 a[132:135], a[172:175], a[36:39], a[132:135]
  s_waitcnt lgkmcnt(5)
  ds_read_b64_tr_b16 a[158:159], v4 offset:2048
  v_mfma_f32_16x16x32_bf16 a[72:75], a[144:147], a[40:43], a[72:75]
  ds_read_b64_tr_b16 a[230:231], v236 offset:128
  v_mfma_f32_16x16x32_bf16 a[76:79], a[144:147], a[44:47], a[76:79]
  s_waitcnt lgkmcnt(5)
  ds_read_b64_tr_b16 a[160:161], v1 offset:1024
  ds_read_b64_tr_b16 a[162:163], v1 offset:3072
  v_mfma_f32_16x16x32_bf16 a[80:83], a[148:151], a[40:43], a[80:83]
  buffer_load_dwordx4 v238, s[12:15], s40 offen offset:0 lds
  v_mfma_f32_16x16x32_bf16 a[84:87], a[148:151], a[44:47], a[84:87]
  s_waitcnt lgkmcnt(5)
  ds_read_b64_tr_b16 a[164:165], v2 offset:1024
  ds_read_b64_tr_b16 a[166:167], v2 offset:3072
  v_mfma_f32_16x16x32_bf16 a[88:91], a[152:155], a[40:43], a[88:91]
  s_add_u32 s40, s62, 73728
  ds_read_b64_tr_b16 a[168:169], v3 offset:1024
  v_mfma_f32_16x16x32_bf16 a[92:95], a[152:155], a[44:47], a[92:95]
  s_waitcnt lgkmcnt(6)
  ds_read_b64_tr_b16 a[170:171], v3 offset:3072
  v_mfma_f32_16x16x32_bf16 a[96:99], a[156:159], a[40:43], a[96:99]
  s_add_u32 m0, s43, 77824
  ds_read_b64_tr_b16 a[172:173], v4 offset:1024
  v_mfma_f32_16x16x32_bf16 a[100:103], a[156:159], a[44:47], a[100:103]
  s_waitcnt lgkmcnt(5)
  ds_read_b64_tr_b16 a[174:175], v4 offset:3072
  v_mfma_f32_16x16x32_bf16 a[104:107], a[160:163], a[40:43], a[104:107]
  ds_read_b64_tr_b16 a[144:145], v1 offset:8192
  v_mfma_f32_16x16x32_bf16 a[108:111], a[160:163], a[44:47], a[108:111]
  s_waitcnt lgkmcnt(5)
  ds_read_b64_tr_b16 a[146:147], v1 offset:10240
  v_mfma_f32_16x16x32_bf16 a[112:115], a[164:167], a[40:43], a[112:115]
  buffer_load_dwordx4 v238, s[12:15], s40 offen offset:0 lds
  v_mfma_f32_16x16x32_bf16 a[116:119], a[164:167], a[44:47], a[116:119]
  s_waitcnt lgkmcnt(4)
  ds_read_b64_tr_b16 a[148:149], v2 offset:8192
  ds_read_b64_tr_b16 a[150:151], v2 offset:10240
  v_mfma_f32_16x16x32_bf16 a[120:123], a[168:171], a[40:43], a[120:123]
  s_add_u32 m0, s43, 81920
  ds_read_b64_tr_b16 a[152:153], v3 offset:8192
  v_mfma_f32_16x16x32_bf16 a[124:127], a[168:171], a[44:47], a[124:127]
  s_waitcnt lgkmcnt(5)
  ds_read_b64_tr_b16 a[154:155], v3 offset:10240
  v_mfma_f32_16x16x32_bf16 a[128:131], a[172:175], a[40:43], a[128:131]
  s_waitcnt lgkmcnt(4)
  ds_read_b64_tr_b16 a[156:157], v4 offset:8192
  ds_read_b64_tr_b16 a[158:159], v4 offset:10240
  v_mfma_f32_16x16x32_bf16 a[132:135], a[172:175], a[44:47], a[132:135]
  s_barrier
  v_mfma_f32_16x16x32_bf16 v[80:83], a[144:147], a[0:3], v[80:83]
  s_waitcnt vmcnt(5)
  v_accvgpr_read_b32 v244, a224
  v_accvgpr_read_b32 v245, a225
  v_cmp_ne_u64 s[74:75], v[242:243], v[244:245]
  s_nop 3
  s_cmp_lg_u64 s[74:75], 0
  s_cbranch_scc1 L3_hx1
L3_hxok1:
  s_add_u32 s40, s62, 147456
  ds_read_b64_tr_b16 a[232:233], v236 offset:1024
  v_mfma_f32_16x16x32_bf16 v[84:87], a[144:147], a[4:7], v[84:87]
  s_waitcnt lgkmcnt(5)
  ds_read_b64_tr_b16 a[160:161], v1 offset:9216
  ds_read_b64_tr_b16 a[162:163], v1 offset:11264
  v_mfma_f32_16x16x32_bf16 v[88:91], a[148:151], a[0:3], v[88:91]
  s_mov_b32 s69, 12288
  buffer_load_dwordx4 v238, s[12:15], s40 offen offset:0 lds
  v_mfma_f32_16x16x32_bf16 v[92:95], a[148:151], a[4:7], v[92:95]
  s_waitcnt lgkmcnt(5)
  ds_read_b64_tr_b16 a[164:165], v2 offset:9216
  ds_read_b64_tr_b16 a[166:167], v2 offset:11264
  v_mfma_f32_16x16x32_bf16 v[96:99], a[152:155], a[0:3], v[96:99]
  ds_read_b64_tr_b16 a[168:169], v3 offset:9216
  v_mfma_f32_16x16x32_bf16 v[100:103], a[152:155], a[4:7], v[100:103]
  s_waitcnt lgkmcnt(6)
  ds_read_b64_tr_b16 a[170:171], v3 offset:11264
  v_mfma_f32_16x16x32_bf16 v[104:107], a[156:159], a[0:3], v[104:107]
  s_add_u32 m0, s43, 86016
  buffer_load_dwordx4 a[48:51], v233, s[84:87], s69 offen sc1
  v_mfma_f32_16x16x32_bf16 v[108:111], a[156:159], a[4:7], v[108:111]
  s_waitcnt lgkmcnt(4)
  ds_read_b64_tr_b16 a[172:173], v4 offset:9216
  ds_read_b64_tr_b16 a[174:175], v4 offset:11264
  v_mfma_f32_16x16x32_bf16 v[112:115], a[160:163], a[0:3], v[112:115]
  s_add_u32 s40, s62, 221184
  ds_read_b64_tr_b16 a[144:145], v1 offset:16384
  v_mfma_f32_16x16x32_bf16 v[116:119], a[160:163], a[4:7], v[116:119]
  s_waitcnt lgkmcnt(5)
  ds_read_b64_tr_b16 a[146:147], v1 offset:18432
  v_mfma_f32_16x16x32_bf16 v[120:123], a[164:167], a[0:3], v[120:123]
  s_mov_b32 s69, 13312
  buffer_load_dwordx4 v238, s[12:15], s40 offen offset:0 lds
  v_mfma_f32_16x16x32_bf16 v[124:127], a[164:167], a[4:7], v[124:127]
  s_waitcnt lgkmcnt(4)
  ds_read_b64_tr_b16 a[148:149], v2 offset:16384
  ds_read_b64_tr_b16 a[150:151], v2 offset:18432
  v_mfma_f32_16x16x32_bf16 v[128:131], a[168:171], a[0:3], v[128:131]
  ds_read_b64_tr_b16 a[152:153], v3 offset:16384
  v_mfma_f32_16x16x32_bf16 v[132:135], a[168:171], a[4:7], v[132:135]
  s_waitcnt lgkmcnt(5)
  ds_read_b64_tr_b16 a[154:155], v3 offset:18432
  v_mfma_f32_16x16x32_bf16 v[136:139], a[172:175], a[0:3], v[136:139]
  s_add_u32 m0, s43, 90112
  buffer_load_dwordx4 a[52:55], v233, s[84:87], s69 offen sc1
  v_mfma_f32_16x16x32_bf16 v[140:143], a[172:175], a[4:7], v[140:143]
  s_waitcnt lgkmcnt(4)
  ds_read_b64_tr_b16 a[156:157], v4 offset:16384
  ds_read_b64_tr_b16 a[158:159], v4 offset:18432
  v_mfma_f32_16x16x32_bf16 v[80:83], a[144:147], a[8:11], v[80:83]
  s_add_u32 s40, s63, 0
  ds_read_b64_tr_b16 a[234:235], v236 offset:1152
  v_mfma_f32_16x16x32_bf16 v[84:87], a[144:147], a[12:15], v[84:87]
  s_waitcnt lgkmcnt(5)
  ds_read_b64_tr_b16 a[160:161], v1 offset:17408
  ds_read_b64_tr_b16 a[162:163], v1 offset:19456
  v_mfma_f32_16x16x32_bf16 v[88:91], a[148:151], a[8:11], v[88:91]
  s_mov_b32 s69, 14336
  buffer_load_dwordx4 v238, s[12:15], s40 offen offset:0 lds
  v_mfma_f32_16x16x32_bf16 v[92:95], a[148:151], a[12:15], v[92:95]
  s_waitcnt lgkmcnt(5)
  ds_read_b64_tr_b16 a[164:165], v2 offset:17408
  ds_read_b64_tr_b16 a[166:167], v2 offset:19456
  v_mfma_f32_16x16x32_bf16 v[96:99], a[152:155], a[8:11], v[96:99]
  ds_read_b64_tr_b16 a[168:169], v3 offset:17408
  v_mfma_f32_16x16x32_bf16 v[100:103], a[152:155], a[12:15], v[100:103]
  s_waitcnt lgkmcnt(6)
  ds_read_b64_tr_b16 a[170:171], v3 offset:19456
  v_mfma_f32_16x16x32_bf16 v[104:107], a[156:159], a[8:11], v[104:107]
  s_add_u32 m0, s43, 94208
  buffer_load_dwordx4 a[56:59], v233, s[84:87], s69 offen sc1
  v_mfma_f32_16x16x32_bf16 v[108:111], a[156:159], a[12:15], v[108:111]
  s_waitcnt lgkmcnt(4)
  ds_read_b64_tr_b16 a[172:173], v4 offset:17408
  ds_read_b64_tr_b16 a[174:175], v4 offset:19456
  v_mfma_f32_16x16x32_bf16 v[112:115], a[160:163], a[8:11], v[112:115]
  s_add_u32 s40, s63, 73728
  ds_read_b64_tr_b16 a[144:145], v1 offset:24576
  v_mfma_f32_16x16x32_bf16 v[116:119], a[160:163], a[12:15], v[116:119]
  s_waitcnt lgkmcnt(5)
  ds_read_b64_tr_b16 a[146:147], v1 offset:26624
  v_mfma_f32_16x16x32_bf16 v[120:123], a[164:167], a[8:11], v[120:123]
  s_mov_b32 s69, 15360
  buffer_load_dwordx4 v238, s[12:15], s40 offen offset:0 lds
  v_mfma_f32_16x16x32_bf16 v[124:127], a[164:167], a[12:15], v[124:127]
  s_waitcnt lgkmcnt(4)
  ds_read_b64_tr_b16 a[148:149], v2 offset:24576
  ds_read_b64_tr_b16 a[150:151], v2 offset:26624
  v_mfma_f32_16x16x32_bf16 v[128:131], a[168:171], a[8:11], v[128:131]
  ds_read_b64_tr_b16 a[152:153], v3 offset:24576
  v_mfma_f32_16x16x32_bf16 v[132:135], a[168:171], a[12:15], v[132:135]
  s_waitcnt lgkmcnt(5)
  ds_read_b64_tr_b16 a[154:155], v3 offset:26624
  v_mfma_f32_16x16x32_bf16 v[136:139], a[172:175], a[8:11], v[136:139]
  s_add_u32 m0, s43, 0
  buffer_load_dwordx4 a[60:63], v233, s[84:87], s69 offen sc1
  v_mfma_f32_16x16x32_bf16 v[140:143], a[172:175], a[12:15], v[140:143]
  s_waitcnt lgkmcnt(4)
  ds_read_b64_tr_b16 a[156:157], v4 offset:24576
  ds_read_b64_tr_b16 a[158:159], v4 offset:26624
  v_mfma_f32_16x16x32_bf16 v[80:83], a[144:147], a[16:19], v[80:83]
  s_add_u32 s40, s63, 147456
  ds_read_b64_tr_b16 a[236:237], v236 offset:2048
  v_mfma_f32_16x16x32_bf16 v[84:87], a[144:147], a[20:23], v[84:87]
  s_waitcnt lgkmcnt(5)
  ds_read_b64_tr_b16 a[160:161], v1 offset:25600
  ds_read_b64_tr_b16 a[162:163], v1 offset:27648
  v_mfma_f32_16x16x32_bf16 v[88:91], a[148:151], a[16:19], v[88:91]
  s_mov_b32 s69, 16384
  buffer_load_dwordx4 v238, s[12:15], s40 offen offset:0 lds
  v_mfma_f32_16x16x32_bf16 v[92:95], a[148:151], a[20:23], v[92:95]
  s_waitcnt lgkmcnt(5)
  ds_read_b64_tr_b16 a[164:165], v2 offset:25600
  ds_read_b64_tr_b16 a[166:167], v2 offset:27648
  v_mfma_f32_16x16x32_bf16 v[96:99], a[152:155], a[16:19], v[96:99]
  ds_read_b64_tr_b16 a[168:169], v3 offset:25600
  v_mfma_f32_16x16x32_bf16 v[100:103], a[152:155], a[20:23], v[100:103]
  s_waitcnt lgkmcnt(6)
  ds_read_b64_tr_b16 a[170:171], v3 offset:27648
  v_mfma_f32_16x16x32_bf16 v[104:107], a[156:159], a[16:19], v[104:107]
  s_add_u32 m0, s43, 4096
  buffer_load_dwordx4 a[64:67], v233, s[84:87], s69 offen sc1
  v_mfma_f32_16x16x32_bf16 v[108:111], a[156:159], a[20:23], v[108:111]
  s_waitcnt lgkmcnt(4)
  ds_read_b64_tr_b16 a[172:173], v4 offset:25600
  ds_read_b64_tr_b16 a[174:175], v4 offset:27648
  v_mfma_f32_16x16x32_bf16 v[112:115], a[160:163], a[16:19], v[112:115]
  s_add_u32 s40, s63, 221184
  ds_read_b64_tr_b16 a[144:145], v1 offset:32768
  v_mfma_f32_16x16x32_bf16 v[116:119], a[160:163], a[20:23], v[116:119]
  s_waitcnt lgkmcnt(5)
  ds_read_b64_tr_b16 a[146:147], v1 offset:34816
  v_mfma_f32_16x16x32_bf16 v[120:123], a[164:167], a[16:19], v[120:123]
  s_mov_b32 s69, 17408
  buffer_load_dwordx4 v238, s[12:15], s40 offen offset:0 lds
  v_mfma_f32_16x16x32_bf16 v[124:127], a[164:167], a[20:23], v[124:127]
  s_waitcnt lgkmcnt(4)
  ds_read_b64_tr_b16 a[148:149], v2 offset:32768
  ds_read_b64_tr_b16 a[150:151], v2 offset:34816
  v_mfma_f32_16x16x32_bf16 v[128:131], a[168:171], a[16:19], v[128:131]
  s_add_u32 m0, s43, 8192
  ds_read_b64_tr_b16 a[152:153], v3 offset:32768
  ds_read_b64_tr_b16 a[154:155], v3 offset:34816
  v_mfma_f32_16x16x32_bf16 v[132:135], a[168:171], a[20:23], v[132:135]
  s_waitcnt lgkmcnt(6)
  ds_read_b64_tr_b16 a[156:157], v4 offset:32768
  ds_read_b64_tr_b16 a[158:159], v4 offset:34816
  v_mfma_f32_16x16x32_bf16 v[136:139], a[172:175], a[16:19], v[136:139]
  s_waitcnt vmcnt(9) lgkmcnt(6)
  buffer_load_dwordx4 a[68:71], v233, s[84:87], s69 offen sc1
  v_mfma_f32_16x16x32_bf16 v[140:143], a[172:175], a[20:23], v[140:143]
  s_barrier
  v_mfma_f32_16x16x32_bf16 a[72:75], a[144:147], a[48:51], a[72:75]
  s_waitcnt vmcnt(8)
  s_mov_b32 s40, 0
  ds_read_b64_tr_b16 a[238:239], v236 offset:2176
  v_mfma_f32_16x16x32_bf16 a[76:79], a[144:147], a[52:55], a[76:79]
  s_waitcnt lgkmcnt(5)
  ds_read_b64_tr_b16 a[160:161], v1 offset:33792
  ds_read_b64_tr_b16 a[162:163], v1 offset:35840
  v_mfma_f32_16x16x32_bf16 a[80:83], a[148:151], a[48:51], a[80:83]
  buffer_load_dwordx4 v239, s[12:15], s40 offen offset:0 lds
  v_mfma_f32_16x16x32_bf16 a[84:87], a[148:151], a[52:55], a[84:87]
  s_waitcnt lgkmcnt(3)
  ds_read_b64_tr_b16 a[164:165], v2 offset:33792
  ds_read_b64_tr_b16 a[166:167], v2 offset:35840
  v_mfma_f32_16x16x32_bf16 a[88:91], a[152:155], a[48:51], a[88:91]
  ds_read_b64_tr_b16 a[168:169], v3 offset:33792
  v_mfma_f32_16x16x32_bf16 a[92:95], a[152:155], a[52:55], a[92:95]
  ds_read_b64_tr_b16 a[170:171], v3 offset:35840
  v_mfma_f32_16x16x32_bf16 a[96:99], a[156:159], a[48:51], a[96:99]
  ds_read_b64_tr_b16 a[172:173], v4 offset:33792
  v_mfma_f32_16x16x32_bf16 a[100:103], a[156:159], a[52:55], a[100:103]
  s_waitcnt lgkmcnt(5)
  ds_read_b64_tr_b16 a[174:175], v4 offset:35840
  v_mfma_f32_16x16x32_bf16 a[104:107], a[160:163], a[48:51], a[104:107]
  ds_read_b64_tr_b16 a[144:145], v1 offset:40960
  v_mfma_f32_16x16x32_bf16 a[108:111], a[160:163], a[52:55], a[108:111]
  s_waitcnt lgkmcnt(5)
  ds_read_b64_tr_b16 a[146:147], v1 offset:43008
  v_mfma_f32_16x16x32_bf16 a[112:115], a[164:167], a[48:51], a[112:115]
  ds_read_b64_tr_b16 a[148:149], v2 offset:40960
  v_mfma_f32_16x16x32_bf16 a[116:119], a[164:167], a[52:55], a[116:119]
  s_waitcnt lgkmcnt(5)
  ds_read_b64_tr_b16 a[150:151], v2 offset:43008
  v_mfma_f32_16x16x32_bf16 a[120:123], a[168:171], a[48:51], a[120:123]
  ds_read_b64_tr_b16 a[152:153], v3 offset:40960
  v_mfma_f32_16x16x32_bf16 a[124:127], a[168:171], a[52:55], a[124:127]
  s_waitcnt lgkmcnt(5)
  ds_read_b64_tr_b16 a[154:155], v3 offset:43008
  v_mfma_f32_16x16x32_bf16 a[128:131], a[172:175], a[48:51], a[128:131]
  ds_read_b64_tr_b16 a[156:157], v4 offset:40960
  v_mfma_f32_16x16x32_bf16 a[132:135], a[172:175], a[52:55], a[132:135]
  s_waitcnt vmcnt(7) lgkmcnt(5)
  ds_read_b64_tr_b16 a[158:159], v4 offset:43008
  v_mfma_f32_16x16x32_bf16 a[72:75], a[144:147], a[56:59], a[72:75]
  s_waitcnt vmcnt(5)
  ds_read_b64_tr_b16 a[160:161], v1 offset:41984
  v_mfma_f32_16x16x32_bf16 a[76:79], a[144:147], a[60:63], a[76:79]
  s_waitcnt lgkmcnt(5)
  ds_read_b64_tr_b16 a[162:163], v1 offset:44032
  v_mfma_f32_16x16x32_bf16 a[80:83], a[148:151], a[56:59], a[80:83]
  ds_read_b64_tr_b16 a[164:165], v2 offset:41984
  v_mfma_f32_16x16x32_bf16 a[84:87], a[148:151], a[60:63], a[84:87]
  s_waitcnt lgkmcnt(5)
  ds_read_b64_tr_b16 a[166:167], v2 offset:44032
  v_mfma_f32_16x16x32_bf16 a[88:91], a[152:155], a[56:59], a[88:91]
  ds_read_b64_tr_b16 a[168:169], v3 offset:41984
  v_mfma_f32_16x16x32_bf16 a[92:95], a[152:155], a[60:63], a[92:95]
  s_waitcnt lgkmcnt(5)
  ds_read_b64_tr_b16 a[170:171], v3 offset:44032
  v_mfma_f32_16x16x32_bf16 a[96:99], a[156:159], a[56:59], a[96:99]
  ds_read_b64_tr_b16 a[172:173], v4 offset:41984
  v_mfma_f32_16x16x32_bf16 a[100:103], a[156:159], a[60:63], a[100:103]
  s_waitcnt lgkmcnt(5)
  ds_read_b64_tr_b16 a[174:175], v4 offset:44032
  v_mfma_f32_16x16x32_bf16 a[104:107], a[160:163], a[56:59], a[104:107]
  ds_read_b64_tr_b16 a[144:145], v5 offset:32768
  v_mfma_f32_16x16x32_bf16 a[108:111], a[160:163], a[60:63], a[108:111]
  s_waitcnt lgkmcnt(5)
  ds_read_b64_tr_b16 a[146:147], v5 offset:34816
  v_mfma_f32_16x16x32_bf16 a[112:115], a[164:167], a[56:59], a[112:115]
  ds_read_b64_tr_b16 a[148:149], v6 offset:32768
  v_mfma_f32_16x16x32_bf16 a[116:119], a[164:167], a[60:63], a[116:119]
  s_waitcnt lgkmcnt(5)
  ds_read_b64_tr_b16 a[150:151], v6 offset:34816
  v_mfma_f32_16x16x32_bf16 a[120:123], a[168:171], a[56:59], a[120:123]
  ds_read_b64_tr_b16 a[152:153], v7 offset:32768
  v_mfma_f32_16x16x32_bf16 a[124:127], a[168:171], a[60:63], a[124:127]
  s_waitcnt lgkmcnt(5)
  ds_read_b64_tr_b16 a[154:155], v7 offset:34816
  v_mfma_f32_16x16x32_bf16 a[128:131], a[172:175], a[56:59], a[128:131]
  ds_read_b64_tr_b16 a[156:157], v8 offset:32768
  v_mfma_f32_16x16x32_bf16 a[132:135], a[172:175], a[60:63], a[132:135]
  s_waitcnt vmcnt(3) lgkmcnt(5)
  ds_read_b64_tr_b16 a[158:159], v8 offset:34816
  v_mfma_f32_16x16x32_bf16 a[72:75], a[144:147], a[64:67], a[72:75]
  s_waitcnt vmcnt(1)
  ds_read_b64_tr_b16 a[160:161], v5 offset:33792
  v_mfma_f32_16x16x32_bf16 a[76:79], a[144:147], a[68:71], a[76:79]
  s_waitcnt lgkmcnt(5)
  ds_read_b64_tr_b16 a[162:163], v5 offset:35840
  v_mfma_f32_16x16x32_bf16 a[80:83], a[148:151], a[64:67], a[80:83]
  ds_read_b64_tr_b16 a[164:165], v6 offset:33792
  v_mfma_f32_16x16x32_bf16 a[84:87], a[148:151], a[68:71], a[84:87]
  s_waitcnt lgkmcnt(5)
  ds_read_b64_tr_b16 a[166:167], v6 offset:35840
  v_mfma_f32_16x16x32_bf16 a[88:91], a[152:155], a[64:67], a[88:91]
  ds_read_b64_tr_b16 a[168:169], v7 offset:33792
  v_mfma_f32_16x16x32_bf16 a[92:95], a[152:155], a[68:71], a[92:95]
  s_waitcnt lgkmcnt(5)
  ds_read_b64_tr_b16 a[170:171], v7 offset:35840
  v_mfma_f32_16x16x32_bf16 a[96:99], a[156:159], a[64:67], a[96:99]
  ds_read_b64_tr_b16 a[172:173], v8 offset:33792
  v_mfma_f32_16x16x32_bf16 a[100:103], a[156:159], a[68:71], a[100:103]
  s_waitcnt lgkmcnt(5)
  ds_read_b64_tr_b16 a[174:175], v8 offset:35840
  v_mfma_f32_16x16x32_bf16 a[104:107], a[160:163], a[64:67], a[104:107]
L3_pad10:
  s_cmp_lg_u32 s82, 0
  s_cbranch_scc1 L3_main
  ds_read_b64_tr_b16 a[144:145], v5 offset:40960
  v_mfma_f32_16x16x32_bf16 a[108:111], a[160:163], a[68:71], a[108:111]
  s_waitcnt lgkmcnt(5)
  ds_read_b64_tr_b16 a[146:147], v5 offset:43008
  v_mfma_f32_16x16x32_bf16 a[112:115], a[164:167], a[64:67], a[112:115]
  ds_read_b64_tr_b16 a[148:149], v6 offset:40960
  v_mfma_f32_16x16x32_bf16 a[116:119], a[164:167], a[68:71], a[116:119]
  s_waitcnt lgkmcnt(5)
  ds_read_b64_tr_b16 a[150:151], v6 offset:43008
  v_mfma_f32_16x16x32_bf16 a[120:123], a[168:171], a[64:67], a[120:123]
  ds_read_b64_tr_b16 a[152:153], v7 offset:40960
  v_mfma_f32_16x16x32_bf16 a[124:127], a[168:171], a[68:71], a[124:127]
  s_waitcnt lgkmcnt(5)
  ds_read_b64_tr_b16 a[154:155], v7 offset:43008
  v_mfma_f32_16x16x32_bf16 a[128:131], a[172:175], a[64:67], a[128:131]
  s_waitcnt lgkmcnt(4)
  ds_read_b64_tr_b16 a[156:157], v8 offset:40960
  ds_read_b64_tr_b16 a[158:159], v8 offset:43008
  v_mfma_f32_16x16x32_bf16 a[132:135], a[172:175], a[68:71], a[132:135]
  s_barrier
  v_mfma_f32_16x16x32_bf16 v[80:83], a[144:147], a[24:27], v[80:83]
  ds_read_b64_tr_b16 a[160:161], v5 offset:41984
  v_mfma_f32_16x16x32_bf16 v[84:87], a[144:147], a[28:31], v[84:87]
  s_waitcnt lgkmcnt(5)
  ds_read_b64_tr_b16 a[162:163], v5 offset:44032
  v_mfma_f32_16x16x32_bf16 v[88:91], a[148:151], a[24:27], v[88:91]
  ds_read_b64_tr_b16 a[164:165], v6 offset:41984
  v_mfma_f32_16x16x32_bf16 v[92:95], a[148:151], a[28:31], v[92:95]
  s_waitcnt lgkmcnt(5)
  ds_read_b64_tr_b16 a[166:167], v6 offset:44032
  v_mfma_f32_16x16x32_bf16 v[96:99], a[152:155], a[24:27], v[96:99]
  ds_read_b64_tr_b16 a[168:169], v7 offset:41984
  v_accvgpr_read_b32 v16, a72
  v_mfma_f32_16x16x32_bf16 v[100:103], a[152:155], a[28:31], v[100:103]
  s_waitcnt lgkmcnt(5)
  ds_read_b64_tr_b16 a[170:171], v7 offset:44032
  v_accvgpr_read_b32 v17, a73
  v_mfma_f32_16x16x32_bf16 v[104:107], a[156:159], a[24:27], v[104:107]
  ds_read_b64_tr_b16 a[172:173], v8 offset:41984
  v_accvgpr_read_b32 v18, a74
  v_mfma_f32_16x16x32_bf16 v[108:111], a[156:159], a[28:31], v[108:111]
  s_waitcnt lgkmcnt(5)
  ds_read_b64_tr_b16 a[174:175], v8 offset:44032
  v_accvgpr_read_b32 v19, a75
  v_mfma_f32_16x16x32_bf16 v[112:115], a[160:163], a[24:27], v[112:115]
  ds_read_b64_tr_b16 a[144:145], v5 offset:49152
  v_cvt_pk_bf16_f32 v242, v16, v17
  v_mfma_f32_16x16x32_bf16 v[116:119], a[160:163], a[28:31], v[116:119]
  s_waitcnt lgkmcnt(5)
  ds_read_b64_tr_b16 a[146:147], v5 offset:51200
  v_cvt_pk_bf16_f32 v243, v18, v19
  v_mfma_f32_16x16x32_bf16 v[120:123], a[164:167], a[24:27], v[120:123]
  ds_read_b64_tr_b16 a[148:149], v6 offset:49152
  v_accvgpr_read_b32 v20, a80
  v_mfma_f32_16x16x32_bf16 v[124:127], a[164:167], a[28:31], v[124:127]
  s_waitcnt lgkmcnt(5)
  ds_read_b64_tr_b16 a[150:151], v6 offset:51200
  v_accvgpr_read_b32 v21, a81
  v_mfma_f32_16x16x32_bf16 v[128:131], a[168:171], a[24:27], v[128:131]
  ds_read_b64_tr_b16 a[152:153], v7 offset:49152
  v_accvgpr_read_b32 v22, a82
  v_mfma_f32_16x16x32_bf16 v[132:135], a[168:171], a[28:31], v[132:135]
  s_waitcnt lgkmcnt(5)
  ds_read_b64_tr_b16 a[154:155], v7 offset:51200
  v_accvgpr_read_b32 v23, a83
  v_mfma_f32_16x16x32_bf16 v[136:139], a[172:175], a[24:27], v[136:139]
  ds_read_b64_tr_b16 a[156:157], v8 offset:49152
  v_cvt_pk_bf16_f32 v244, v20, v21
  v_mfma_f32_16x16x32_bf16 v[140:143], a[172:175], a[28:31], v[140:143]
  s_waitcnt lgkmcnt(5)
  ds_read_b64_tr_b16 a[158:159], v8 offset:51200
  v_cvt_pk_bf16_f32 v245, v22, v23
  v_mfma_f32_16x16x32_bf16 v[80:83], a[144:147], a[32:35], v[80:83]
  ds_read_b64_tr_b16 a[160:161], v5 offset:50176
  v_mfma_f32_16x16x32_bf16 v[84:87], a[144:147], a[36:39], v[84:87]
  s_waitcnt lgkmcnt(5)
  ds_read_b64_tr_b16 a[162:163], v5 offset:52224
  v_mfma_f32_16x16x32_bf16 v[88:91], a[148:151], a[32:35], v[88:91]
  ds_read_b64_tr_b16 a[164:165], v6 offset:50176
  v_permlane16_swap_b32 v242, v244
  v_mfma_f32_16x16x32_bf16 v[92:95], a[148:151], a[36:39], v[92:95]
  s_waitcnt lgkmcnt(5)
  ds_read_b64_tr_b16 a[166:167], v6 offset:52224
  v_permlane16_swap_b32 v243, v245
  v_mfma_f32_16x16x32_bf16 v[96:99], a[152:155], a[32:35], v[96:99]
  ds_read_b64_tr_b16 a[168:169], v7 offset:50176
  v_accvgpr_read_b32 v24, a88
  v_mfma_f32_16x16x32_bf16 v[100:103], a[152:155], a[36:39], v[100:103]
  s_waitcnt lgkmcnt(5)
  ds_read_b64_tr_b16 a[170:171], v7 offset:52224
  v_accvgpr_read_b32 v25, a89
  v_mfma_f32_16x16x32_bf16 v[104:107], a[156:159], a[32:35], v[104:107]
  s_mov_b32 s45, 0
  ds_read_b64_tr_b16 a[172:173], v8 offset:50176
  v_accvgpr_read_b32 v26, a90
  v_mfma_f32_16x16x32_bf16 v[108:111], a[156:159], a[36:39], v[108:111]
  s_waitcnt lgkmcnt(5)
  ds_read_b64_tr_b16 a[174:175], v8 offset:52224
  v_accvgpr_read_b32 v27, a91
  v_mfma_f32_16x16x32_bf16 v[112:115], a[160:163], a[32:35], v[112:115]
  ds_read_b64_tr_b16 a[144:145], v5 offset:57344
  v_cvt_pk_bf16_f32 v216, v24, v25
  v_mfma_f32_16x16x32_bf16 v[116:119], a[160:163], a[36:39], v[116:119]
  s_waitcnt lgkmcnt(5)
  ds_read_b64_tr_b16 a[146:147], v5 offset:59392
  v_cvt_pk_bf16_f32 v217, v26, v27
  v_mfma_f32_16x16x32_bf16 v[120:123], a[164:167], a[32:35], v[120:123]
  buffer_store_dwordx4 v[242:245], v234, s[24:27], s45 offen sc1
  v_mfma_f32_16x16x32_bf16 v[124:127], a[164:167], a[36:39], v[124:127]
  s_waitcnt lgkmcnt(4)
  ds_read_b64_tr_b16 a[148:149], v6 offset:57344
  ds_read_b64_tr_b16 a[150:151], v6 offset:59392
  v_mfma_f32_16x16x32_bf16 v[128:131], a[168:171], a[32:35], v[128:131]
  ds_read_b64_tr_b16 a[152:153], v7 offset:57344
  v_accvgpr_read_b32 v28, a96
  v_mfma_f32_16x16x32_bf16 v[132:135], a[168:171], a[36:39], v[132:135]
  s_waitcnt lgkmcnt(5)
  ds_read_b64_tr_b16 a[154:155], v7 offset:59392
  v_accvgpr_read_b32 v29, a97
  v_mfma_f32_16x16x32_bf16 v[136:139], a[172:175], a[32:35], v[136:139]
  ds_read_b64_tr_b16 a[156:157], v8 offset:57344
  v_accvgpr_read_b32 v30, a98
  v_accvgpr_read_b32 v31, a99
  v_mfma_f32_16x16x32_bf16 v[140:143], a[172:175], a[36:39], v[140:143]
  s_waitcnt lgkmcnt(5)
  ds_read_b64_tr_b16 a[158:159], v8 offset:59392
  v_cvt_pk_bf16_f32 v218, v28, v29
  v_cvt_pk_bf16_f32 v219, v30, v31
  v_mfma_f32_16x16x32_bf16 v[80:83], a[144:147], a[40:43], v[80:83]
  ds_read_b64_tr_b16 a[160:161], v5 offset:58368
  v_permlane16_swap_b32 v216, v218
  v_mfma_f32_16x16x32_bf16 v[84:87], a[144:147], a[44:47], v[84:87]
  s_waitcnt lgkmcnt(5)
  ds_read_b64_tr_b16 a[162:163], v5 offset:60416
  v_permlane16_swap_b32 v217, v219
  v_mfma_f32_16x16x32_bf16 v[88:91], a[148:151], a[40:43], v[88:91]
  s_mov_b32 s45, 1024
  ds_read_b64_tr_b16 a[164:165], v6 offset:58368
  v_accvgpr_read_b32 v16, a104
  v_mfma_f32_16x16x32_bf16 v[92:95], a[148:151], a[44:47], v[92:95]
  s_waitcnt lgkmcnt(5)
  ds_read_b64_tr_b16 a[166:167], v6 offset:60416
  v_accvgpr_read_b32 v17, a105
  v_mfma_f32_16x16x32_bf16 v[96:99], a[152:155], a[40:43], v[96:99]
  ds_read_b64_tr_b16 a[168:169], v7 offset:58368
  v_accvgpr_read_b32 v18, a106
  v_mfma_f32_16x16x32_bf16 v[100:103], a[152:155], a[44:47], v[100:103]
  s_waitcnt lgkmcnt(5)
  ds_read_b64_tr_b16 a[170:171], v7 offset:60416
  v_accvgpr_read_b32 v19, a107
  v_mfma_f32_16x16x32_bf16 v[104:107], a[156:159], a[40:43], v[104:107]
  buffer_store_dwordx4 v[216:219], v234, s[24:27], s45 offen sc1
  v_mfma_f32_16x16x32_bf16 v[108:111], a[156:159], a[44:47], v[108:111]
  s_waitcnt lgkmcnt(4)
  ds_read_b64_tr_b16 a[172:173], v8 offset:58368
  ds_read_b64_tr_b16 a[174:175], v8 offset:60416
  v_cvt_pk_bf16_f32 v246, v16, v17
  v_mfma_f32_16x16x32_bf16 v[112:115], a[160:163], a[40:43], v[112:115]
  ds_read_b64_tr_b16 a[144:145], v1 offset:49152
  v_cvt_pk_bf16_f32 v247, v18, v19
  v_accvgpr_read_b32 v20, a112
  v_mfma_f32_16x16x32_bf16 v[116:119], a[160:163], a[44:47], v[116:119]
  s_waitcnt lgkmcnt(5)
  ds_read_b64_tr_b16 a[146:147], v1 offset:51200
  v_accvgpr_read_b32 v21, a113
  v_accvgpr_read_b32 v22, a114
  v_mfma_f32_16x16x32_bf16 v[120:123], a[164:167], a[40:43], v[120:123]
  s_mov_b32 s45, 2048
  ds_read_b64_tr_b16 a[148:149], v2 offset:49152
  v_accvgpr_read_b32 v23, a115
  v_cvt_pk_bf16_f32 v248, v20, v21
  v_mfma_f32_16x16x32_bf16 v[124:127], a[164:167], a[44:47], v[124:127]
  s_waitcnt lgkmcnt(5)
  ds_read_b64_tr_b16 a[150:151], v2 offset:51200
  v_cvt_pk_bf16_f32 v249, v22, v23
  v_mfma_f32_16x16x32_bf16 v[128:131], a[168:171], a[40:43], v[128:131]
  ds_read_b64_tr_b16 a[152:153], v3 offset:49152
  ds_read_b64_tr_b16 a[154:155], v3 offset:51200
  v_permlane16_swap_b32 v246, v248
  v_permlane16_swap_b32 v247, v249
  v_mfma_f32_16x16x32_bf16 v[132:135], a[168:171], a[44:47], v[132:135]
  s_waitcnt lgkmcnt(6)
  ds_read_b64_tr_b16 a[156:157], v4 offset:49152
  ds_read_b64_tr_b16 a[158:159], v4 offset:51200
  v_mfma_f32_16x16x32_bf16 v[136:139], a[172:175], a[40:43], v[136:139]
  s_waitcnt lgkmcnt(6)
  buffer_store_dwordx4 v[246:249], v234, s[24:27], s45 offen sc1
  v_mfma_f32_16x16x32_bf16 v[140:143], a[172:175], a[44:47], v[140:143]
  s_barrier
  v_mfma_f32_16x16x32_bf16 v[80:83], a[144:147], a[48:51], v[80:83]
  ds_read_b64_tr_b16 a[160:161], v1 offset:50176
  v_accvgpr_read_b32 v24, a120
  v_accvgpr_read_b32 v25, a121
  v_mfma_f32_16x16x32_bf16 v[84:87], a[144:147], a[52:55], v[84:87]
  s_waitcnt lgkmcnt(5)
  ds_read_b64_tr_b16 a[162:163], v1 offset:52224
  v_accvgpr_read_b32 v26, a122
  v_accvgpr_read_b32 v27, a123
  v_mfma_f32_16x16x32_bf16 v[88:91], a[148:151], a[48:51], v[88:91]
  s_mov_b32 s45, 3072
  ds_read_b64_tr_b16 a[164:165], v2 offset:50176
  v_cvt_pk_bf16_f32 v220, v24, v25
  v_cvt_pk_bf16_f32 v221, v26, v27
  v_mfma_f32_16x16x32_bf16 v[92:95], a[148:151], a[52:55], v[92:95]
  s_waitcnt lgkmcnt(3)
  ds_read_b64_tr_b16 a[166:167], v2 offset:52224
  v_accvgpr_read_b32 v28, a128
  v_accvgpr_read_b32 v29, a129
  v_mfma_f32_16x16x32_bf16 v[96:99], a[152:155], a[48:51], v[96:99]
  v_accvgpr_read_b32 v30, a130
  v_accvgpr_read_b32 v31, a131
  v_cvt_pk_bf16_f32 v222, v28, v29
  v_cvt_pk_bf16_f32 v223, v30, v31
  v_mfma_f32_16x16x32_bf16 v[100:103], a[152:155], a[52:55], v[100:103]
  ds_read_b64_tr_b16 a[168:169], v3 offset:50176
  ds_read_b64_tr_b16 a[170:171], v3 offset:52224
  v_permlane16_swap_b32 v220, v222
  v_permlane16_swap_b32 v221, v223
  v_mfma_f32_16x16x32_bf16 v[104:107], a[156:159], a[48:51], v[104:107]
  buffer_store_dwordx4 v[220:223], v234, s[24:27], s45 offen sc1
  v_mfma_f32_16x16x32_bf16 v[108:111], a[156:159], a[52:55], v[108:111]
  s_waitcnt lgkmcnt(4)
  ds_read_b64_tr_b16 a[172:173], v4 offset:50176
  ds_read_b64_tr_b16 a[174:175], v4 offset:52224
  v_mfma_f32_16x16x32_bf16 v[112:115], a[160:163], a[48:51], v[112:115]
  ds_read_b64_tr_b16 a[144:145], v1 offset:57344
  v_accvgpr_read_b32 v16, a76
  v_mfma_f32_16x16x32_bf16 v[116:119], a[160:163], a[52:55], v[116:119]
  s_waitcnt lgkmcnt(5)
  ds_read_b64_tr_b16 a[146:147], v1 offset:59392
  v_accvgpr_read_b32 v17, a77
  v_mfma_f32_16x16x32_bf16 v[120:123], a[164:167], a[48:51], v[120:123]
  ds_read_b64_tr_b16 a[148:149], v2 offset:57344
  v_accvgpr_read_b32 v18, a78
  v_accvgpr_read_b32 v19, a79
  v_mfma_f32_16x16x32_bf16 v[124:127], a[164:167], a[52:55], v[124:127]
  s_waitcnt lgkmcnt(5)
  ds_read_b64_tr_b16 a[150:151], v2 offset:59392
  v_cvt_pk_bf16_f32 v242, v16, v17
  v_cvt_pk_bf16_f32 v243, v18, v19
  v_mfma_f32_16x16x32_bf16 v[128:131], a[168:171], a[48:51], v[128:131]
  ds_read_b64_tr_b16 a[152:153], v3 offset:57344
  v_accvgpr_read_b32 v20, a84
  v_accvgpr_read_b32 v21, a85
  v_mfma_f32_16x16x32_bf16 v[132:135], a[168:171], a[52:55], v[132:135]
  s_waitcnt lgkmcnt(5)
  ds_read_b64_tr_b16 a[154:155], v3 offset:59392
  v_accvgpr_read_b32 v22, a86
  v_accvgpr_read_b32 v23, a87
  v_mfma_f32_16x16x32_bf16 v[136:139], a[172:175], a[48:51], v[136:139]
  s_mov_b32 s45, 9216
  ds_read_b64_tr_b16 a[156:157], v4 offset:57344
  v_cvt_pk_bf16_f32 v244, v20, v21
  v_cvt_pk_bf16_f32 v245, v22, v23
  v_mfma_f32_16x16x32_bf16 v[140:143], a[172:175], a[52:55], v[140:143]
  s_waitcnt lgkmcnt(5)
  ds_read_b64_tr_b16 a[158:159], v4 offset:59392
  v_permlane16_swap_b32 v242, v244
  v_mfma_f32_16x16x32_bf16 v[80:83], a[144:147], a[56:59], v[80:83]
  v_permlane16_swap_b32 v243, v245
  v_mfma_f32_16x16x32_bf16 v[84:87], a[144:147], a[60:63], v[84:87]
  s_waitcnt lgkmcnt(4)
  ds_read_b64_tr_b16 a[160:161], v1 offset:58368
  ds_read_b64_tr_b16 a[162:163], v1 offset:60416
  v_mfma_f32_16x16x32_bf16 v[88:91], a[148:151], a[56:59], v[88:91]
  buffer_store_dwordx4 v[242:245], v234, s[24:27], s45 offen sc1
  v_mfma_f32_16x16x32_bf16 v[92:95], a[148:151], a[60:63], v[92:95]
  s_waitcnt lgkmcnt(4)
  ds_read_b64_tr_b16 a[164:165], v2 offset:58368
  ds_read_b64_tr_b16 a[166:167], v2 offset:60416
  v_accvgpr_read_b32 v24, a92
  v_mfma_f32_16x16x32_bf16 v[96:99], a[152:155], a[56:59], v[96:99]
  ds_read_b64_tr_b16 a[168:169], v3 offset:58368
  v_accvgpr_read_b32 v25, a93
  v_accvgpr_read_b32 v26, a94
  v_mfma_f32_16x16x32_bf16 v[100:103], a[152:155], a[60:63], v[100:103]
  s_waitcnt lgkmcnt(5)
  ds_read_b64_tr_b16 a[170:171], v3 offset:60416
  v_accvgpr_read_b32 v27, a95
  v_cvt_pk_bf16_f32 v216, v24, v25
  v_mfma_f32_16x16x32_bf16 v[104:107], a[156:159], a[56:59], v[104:107]
  s_mov_b32 s45, 10240
  ds_read_b64_tr_b16 a[172:173], v4 offset:58368
  v_cvt_pk_bf16_f32 v217, v26, v27
  v_accvgpr_read_b32 v28, a100
  v_mfma_f32_16x16x32_bf16 v[108:111], a[156:159], a[60:63], v[108:111]
  s_waitcnt lgkmcnt(5)
  ds_read_b64_tr_b16 a[174:175], v4 offset:60416
  v_accvgpr_read_b32 v29, a101
  v_accvgpr_read_b32 v30, a102
  v_mfma_f32_16x16x32_bf16 v[112:115], a[160:163], a[56:59], v[112:115]
  v_accvgpr_read_b32 v31, a103
  v_cvt_pk_bf16_f32 v218, v28, v29
  v_cvt_pk_bf16_f32 v219, v30, v31
  v_mfma_f32_16x16x32_bf16 v[116:119], a[160:163], a[60:63], v[116:119]
  s_waitcnt lgkmcnt(4)
  ds_read_b64_tr_b16 a[144:145], v5 offset:0
  ds_read_b64_tr_b16 a[146:147], v5 offset:2048
  v_permlane16_swap_b32 v216, v218
  v_permlane16_swap_b32 v217, v219
  v_mfma_f32_16x16x32_bf16 v[120:123], a[164:167], a[56:59], v[120:123]
  buffer_store_dwordx4 v[216:219], v234, s[24:27], s45 offen sc1
  v_mfma_f32_16x16x32_bf16 v[124:127], a[164:167], a[60:63], v[124:127]
  s_waitcnt lgkmcnt(4)
  ds_read_b64_tr_b16 a[148:149], v6 offset:0
  ds_read_b64_tr_b16 a[150:151], v6 offset:2048
  v_mfma_f32_16x16x32_bf16 v[128:131], a[168:171], a[56:59], v[128:131]
  ds_read_b64_tr_b16 a[152:153], v7 offset:0
  v_accvgpr_read_b32 v16, a108
  v_mfma_f32_16x16x32_bf16 v[132:135], a[168:171], a[60:63], v[132:135]
  s_waitcnt lgkmcnt(5)
  ds_read_b64_tr_b16 a[154:155], v7 offset:2048
  v_accvgpr_read_b32 v17, a109
  v_mfma_f32_16x16x32_bf16 v[136:139], a[172:175], a[56:59], v[136:139]
  ds_read_b64_tr_b16 a[156:157], v8 offset:0
  v_accvgpr_read_b32 v18, a110
  v_accvgpr_read_b32 v19, a111
  v_mfma_f32_16x16x32_bf16 v[140:143], a[172:175], a[60:63], v[140:143]
  s_waitcnt lgkmcnt(5)
  ds_read_b64_tr_b16 a[158:159], v8 offset:2048
  v_cvt_pk_bf16_f32 v246, v16, v17
  v_cvt_pk_bf16_f32 v247, v18, v19
  v_mfma_f32_16x16x32_bf16 v[80:83], a[144:147], a[64:67], v[80:83]
  ds_read_b64_tr_b16 a[160:161], v5 offset:1024
  v_accvgpr_read_b32 v20, a116
  v_accvgpr_read_b32 v21, a117
  v_mfma_f32_16x16x32_bf16 v[84:87], a[144:147], a[68:71], v[84:87]
  s_waitcnt lgkmcnt(5)
  ds_read_b64_tr_b16 a[162:163], v5 offset:3072
  v_accvgpr_read_b32 v22, a118
  v_accvgpr_read_b32 v23, a119
  v_mfma_f32_16x16x32_bf16 v[88:91], a[148:151], a[64:67], v[88:91]
  s_mov_b32 s45, 11264
  ds_read_b64_tr_b16 a[164:165], v6 offset:1024
  v_cvt_pk_bf16_f32 v248, v20, v21
  v_cvt_pk_bf16_f32 v249, v22, v23
  v_mfma_f32_16x16x32_bf16 v[92:95], a[148:151], a[68:71], v[92:95]
  s_waitcnt lgkmcnt(5)
  ds_read_b64_tr_b16 a[166:167], v6 offset:3072
  v_permlane16_swap_b32 v246, v248
  v_mfma_f32_16x16x32_bf16 v[96:99], a[152:155], a[64:67], v[96:99]
  v_permlane16_swap_b32 v247, v249
  v_mfma_f32_16x16x32_bf16 v[100:103], a[152:155], a[68:71], v[100:103]
  s_waitcnt lgkmcnt(4)
  ds_read_b64_tr_b16 a[168:169], v7 offset:1024
  ds_read_b64_tr_b16 a[170:171], v7 offset:3072
  v_mfma_f32_16x16x32_bf16 v[104:107], a[156:159], a[64:67], v[104:107]
  buffer_store_dwordx4 v[246:249], v234, s[24:27], s45 offen sc1
  v_mfma_f32_16x16x32_bf16 v[108:111], a[156:159], a[68:71], v[108:111]
  s_waitcnt lgkmcnt(4)
  ds_read_b64_tr_b16 a[172:173], v8 offset:1024
  ds_read_b64_tr_b16 a[174:175], v8 offset:3072
  v_accvgpr_read_b32 v24, a124
  v_mfma_f32_16x16x32_bf16 v[112:115], a[160:163], a[64:67], v[112:115]
  ds_read_b64_tr_b16 a[144:145], v252 offset:8192
  v_accvgpr_read_b32 v25, a125
  v_accvgpr_read_b32 v26, a126
  v_mfma_f32_16x16x32_bf16 v[116:119], a[160:163], a[68:71], v[116:119]
  s_waitcnt lgkmcnt(5)
  ds_read_b64_tr_b16 a[146:147], v252 offset:9216
  v_accvgpr_read_b32 v27, a127
  v_cvt_pk_bf16_f32 v220, v24, v25
  v_mfma_f32_16x16x32_bf16 v[120:123], a[164:167], a[64:67], v[120:123]
  s_mov_b32 s45, 12288
  ds_read_b64_tr_b16 a[148:149], v253 offset:8192
  v_cvt_pk_bf16_f32 v221, v26, v27
  v_accvgpr_read_b32 v28, a132
  v_mfma_f32_16x16x32_bf16 v[124:127], a[164:167], a[68:71], v[124:127]
  s_waitcnt lgkmcnt(5)
  ds_read_b64_tr_b16 a[150:151], v253 offset:9216
  v_accvgpr_read_b32 v29, a133
  v_accvgpr_read_b32 v30, a134
  v_mfma_f32_16x16x32_bf16 v[128:131], a[168:171], a[64:67], v[128:131]
  ds_read_b64_tr_b16 a[152:153], v252 offset:10240
  ds_read_b64_tr_b16 a[154:155], v252 offset:11264
  v_accvgpr_read_b32 v31, a135
  v_cvt_pk_bf16_f32 v222, v28, v29
  v_cvt_pk_bf16_f32 v223, v30, v31
  v_mfma_f32_16x16x32_bf16 v[132:135], a[168:171], a[68:71], v[132:135]
  s_waitcnt lgkmcnt(6)
  ds_read_b64_tr_b16 a[156:157], v253 offset:10240
  ds_read_b64_tr_b16 a[158:159], v253 offset:11264
  v_permlane16_swap_b32 v220, v222
  v_permlane16_swap_b32 v221, v223
  v_mfma_f32_16x16x32_bf16 v[136:139], a[172:175], a[64:67], v[136:139]
  s_waitcnt lgkmcnt(6)
  buffer_store_dwordx4 v[220:223], v234, s[24:27], s45 offen sc1
  v_mfma_f32_16x16x32_bf16 v[140:143], a[172:175], a[68:71], v[140:143]
  s_barrier
  v_mfma_f32_16x16x32_bf16 v[48:51], a[144:147], v[144:147], 0
  ds_read_b64_tr_b16 a[160:161], v252 offset:12288
  v_mfma_f32_16x16x32_bf16 v[52:55], a[144:147], v[148:151], 0
  s_waitcnt lgkmcnt(5)
  ds_read_b64_tr_b16 a[162:163], v252 offset:13312
  v_mfma_f32_16x16x32_bf16 v[56:59], a[148:151], v[144:147], 0
  ds_read_b64_tr_b16 a[164:165], v253 offset:12288
  v_mfma_f32_16x16x32_bf16 v[60:63], a[148:151], v[148:151], 0
  s_waitcnt lgkmcnt(3)
  ds_read_b64_tr_b16 a[166:167], v253 offset:13312
  v_mfma_f32_16x16x32_bf16 v[48:51], a[152:155], v[152:155], v[48:51]
  ds_read_b64_tr_b16 a[168:169], v252 offset:14336
  v_cvt_pk_bf16_f32 v242, v80, v81
  v_mfma_f32_16x16x32_bf16 v[52:55], a[152:155], v[156:159], v[52:55]
  ds_read_b64_tr_b16 a[170:171], v252 offset:15360
  v_cvt_pk_bf16_f32 v243, v82, v83
  v_mfma_f32_16x16x32_bf16 v[56:59], a[156:159], v[152:155], v[56:59]
  ds_read_b64_tr_b16 a[172:173], v253 offset:14336
  v_cvt_pk_bf16_f32 v244, v88, v89
  v_mfma_f32_16x16x32_bf16 v[60:63], a[156:159], v[156:159], v[60:63]
  s_waitcnt lgkmcnt(5)
  ds_read_b64_tr_b16 a[174:175], v253 offset:15360
  v_cvt_pk_bf16_f32 v245, v90, v91
  v_mfma_f32_16x16x32_bf16 v[48:51], a[160:163], v[160:163], v[48:51]
  ds_read_b64_tr_b16 a[144:145], v252 offset:16384
  v_mfma_f32_16x16x32_bf16 v[52:55], a[160:163], v[164:167], v[52:55]
  s_waitcnt lgkmcnt(5)
  ds_read_b64_tr_b16 a[146:147], v252 offset:17408
  v_mfma_f32_16x16x32_bf16 v[56:59], a[164:167], v[160:163], v[56:59]
  ds_read_b64_tr_b16 a[148:149], v253 offset:16384
  v_permlane16_swap_b32 v242, v244
  v_mfma_f32_16x16x32_bf16 v[60:63], a[164:167], v[164:167], v[60:63]
  s_waitcnt lgkmcnt(5)
  ds_read_b64_tr_b16 a[150:151], v253 offset:17408
  v_permlane16_swap_b32 v243, v245
  v_mfma_f32_16x16x32_bf16 v[48:51], a[168:171], v[168:171], v[48:51]
  ds_read_b64_tr_b16 a[152:153], v252 offset:18432
  v_cvt_pk_bf16_f32 v216, v96, v97
  v_mfma_f32_16x16x32_bf16 v[52:55], a[168:171], v[172:175], v[52:55]
  s_waitcnt lgkmcnt(5)
  ds_read_b64_tr_b16 a[154:155], v252 offset:19456
  v_cvt_pk_bf16_f32 v217, v98, v99
  v_mfma_f32_16x16x32_bf16 v[56:59], a[172:175], v[168:171], v[56:59]
  s_mov_b32 s45, 4096
  ds_read_b64_tr_b16 a[156:157], v253 offset:18432
  v_cvt_pk_bf16_f32 v218, v104, v105
  v_cvt_pk_bf16_f32 v219, v106, v107
  v_mfma_f32_16x16x32_bf16 v[60:63], a[172:175], v[172:175], v[60:63]
  s_waitcnt lgkmcnt(5)
  ds_read_b64_tr_b16 a[158:159], v253 offset:19456
  v_permlane16_swap_b32 v216, v218
  v_mfma_f32_16x16x32_bf16 v[48:51], a[144:147], v[176:179], v[48:51]
  ds_read_b64_tr_b16 a[160:161], v252 offset:20480
  v_permlane16_swap_b32 v217, v219
  v_mfma_f32_16x16x32_bf16 v[52:55], a[144:147], v[180:183], v[52:55]
  s_waitcnt lgkmcnt(5)
  ds_read_b64_tr_b16 a[162:163], v252 offset:21504
  v_cvt_pk_bf16_f32 v246, v112, v113
  v_mfma_f32_16x16x32_bf16 v[56:59], a[148:151], v[176:179], v[56:59]
  buffer_store_dwordx4 v[242:245], v234, s[24:27], s45 offen sc1
  v_mfma_f32_16x16x32_bf16 v[60:63], a[148:151], v[180:183], v[60:63]
  s_waitcnt lgkmcnt(4)
  s_mov_b32 s45, 5120
  ds_read_b64_tr_b16 a[164:165], v253 offset:20480
  ds_read_b64_tr_b16 a[166:167], v253 offset:21504
  v_mfma_f32_16x16x32_bf16 v[48:51], a[152:155], v[184:187], v[48:51]
  ds_read_b64_tr_b16 a[168:169], v252 offset:22528
  v_cvt_pk_bf16_f32 v247, v114, v115
  v_mfma_f32_16x16x32_bf16 v[52:55], a[152:155], v[188:191], v[52:55]
  s_waitcnt lgkmcnt(5)
  ds_read_b64_tr_b16 a[170:171], v252 offset:23552
  v_cvt_pk_bf16_f32 v248, v120, v121
  v_mfma_f32_16x16x32_bf16 v[56:59], a[156:159], v[184:187], v[56:59]
  buffer_store_dwordx4 v[216:219], v234, s[24:27], s45 offen sc1
  v_mfma_f32_16x16x32_bf16 v[60:63], a[156:159], v[188:191], v[60:63]
  s_waitcnt lgkmcnt(4)
  ds_read_b64_tr_b16 a[172:173], v253 offset:22528
  ds_read_b64_tr_b16 a[174:175], v253 offset:23552
  v_cvt_pk_bf16_f32 v249, v122, v123
  v_mfma_f32_16x16x32_bf16 v[48:51], a[160:163], v[192:195], v[48:51]
  ds_read_b64_tr_b16 a[144:145], v252 offset:24576
  v_permlane16_swap_b32 v246, v248
  v_mfma_f32_16x16x32_bf16 v[52:55], a[160:163], v[196:199], v[52:55]
  s_waitcnt lgkmcnt(5)
  ds_read_b64_tr_b16 a[146:147], v252 offset:25600
  v_permlane16_swap_b32 v247, v249
  v_mfma_f32_16x16x32_bf16 v[56:59], a[164:167], v[192:195], v[56:59]
  s_mov_b32 s45, 6144
  ds_read_b64_tr_b16 a[148:149], v253 offset:24576
  v_cvt_pk_bf16_f32 v220, v128, v129
  v_mfma_f32_16x16x32_bf16 v[60:63], a[164:167], v[196:199], v[60:63]
  s_waitcnt lgkmcnt(5)
  ds_read_b64_tr_b16 a[150:151], v253 offset:25600
  v_cvt_pk_bf16_f32 v221, v130, v131
  v_mfma_f32_16x16x32_bf16 v[48:51], a[168:171], v[200:203], v[48:51]
  ds_read_b64_tr_b16 a[152:153], v252 offset:26624
  v_cvt_pk_bf16_f32 v222, v136, v137
  v_mfma_f32_16x16x32_bf16 v[52:55], a[168:171], v[204:207], v[52:55]
  s_waitcnt lgkmcnt(5)
  ds_read_b64_tr_b16 a[154:155], v252 offset:27648
  v_cvt_pk_bf16_f32 v223, v138, v139
  v_mfma_f32_16x16x32_bf16 v[56:59], a[172:175], v[200:203], v[56:59]
  buffer_store_dwordx4 v[246:249], v234, s[24:27], s45 offen sc1
  v_mfma_f32_16x16x32_bf16 v[60:63], a[172:175], v[204:207], v[60:63]
  s_waitcnt lgkmcnt(4)
  ds_read_b64_tr_b16 a[156:157], v253 offset:26624
  ds_read_b64_tr_b16 a[158:159], v253 offset:27648
  v_mfma_f32_16x16x32_bf16 v[48:51], a[144:147], a[0:3], v[48:51]
  ds_read_b64_tr_b16 a[160:161], v252 offset:28672
  v_permlane16_swap_b32 v220, v222
  v_mfma_f32_16x16x32_bf16 v[52:55], a[144:147], a[4:7], v[52:55]
  s_waitcnt lgkmcnt(5)
  ds_read_b64_tr_b16 a[162:163], v252 offset:29696
  v_permlane16_swap_b32 v221, v223
  v_mfma_f32_16x16x32_bf16 v[56:59], a[148:151], a[0:3], v[56:59]
  s_mov_b32 s45, 7168
  ds_read_b64_tr_b16 a[164:165], v253 offset:28672
  v_cvt_pk_bf16_f32 v242, v84, v85
  v_mfma_f32_16x16x32_bf16 v[60:63], a[148:151], a[4:7], v[60:63]
  s_waitcnt lgkmcnt(5)
  ds_read_b64_tr_b16 a[166:167], v253 offset:29696
  v_cvt_pk_bf16_f32 v243, v86, v87
  v_mfma_f32_16x16x32_bf16 v[48:51], a[152:155], a[8:11], v[48:51]
  ds_read_b64_tr_b16 a[168:169], v252 offset:30720
  v_cvt_pk_bf16_f32 v244, v92, v93
  v_mfma_f32_16x16x32_bf16 v[52:55], a[152:155], a[12:15], v[52:55]
  s_waitcnt lgkmcnt(5)
  ds_read_b64_tr_b16 a[170:171], v252 offset:31744
  v_cvt_pk_bf16_f32 v245, v94, v95
  v_mfma_f32_16x16x32_bf16 v[56:59], a[156:159], a[8:11], v[56:59]
  buffer_store_dwordx4 v[220:223], v234, s[24:27], s45 offen sc1
  v_mfma_f32_16x16x32_bf16 v[60:63], a[156:159], a[12:15], v[60:63]
  s_waitcnt lgkmcnt(4)
  ds_read_b64_tr_b16 a[172:173], v253 offset:30720
  ds_read_b64_tr_b16 a[174:175], v253 offset:31744
  v_mfma_f32_16x16x32_bf16 v[48:51], a[160:163], a[16:19], v[48:51]
  ds_read_b64_tr_b16 a[144:145], v9 offset:0
  v_permlane16_swap_b32 v242, v244
  v_mfma_f32_16x16x32_bf16 v[52:55], a[160:163], a[20:23], v[52:55]
  s_waitcnt lgkmcnt(5)
  ds_read_b64_tr_b16 a[146:147], v9 offset:1024
  v_permlane16_swap_b32 v243, v245
  v_mfma_f32_16x16x32_bf16 v[56:59], a[164:167], a[16:19], v[56:59]
  s_mov_b32 s45, 13312
  ds_read_b64_tr_b16 a[148:149], v10 offset:0
  v_cvt_pk_bf16_f32 v216, v100, v101
  v_mfma_f32_16x16x32_bf16 v[60:63], a[164:167], a[20:23], v[60:63]
  s_waitcnt lgkmcnt(5)
  ds_read_b64_tr_b16 a[150:151], v10 offset:1024
  v_cvt_pk_bf16_f32 v217, v102, v103
  v_mfma_f32_16x16x32_bf16 v[48:51], a[168:171], a[24:27], v[48:51]
  ds_read_b64_tr_b16 a[152:153], v9 offset:2048
  ds_read_b64_tr_b16 a[154:155], v9 offset:3072
  v_mfma_f32_16x16x32_bf16 v[52:55], a[168:171], a[28:31], v[52:55]
  s_waitcnt lgkmcnt(6)
  ds_read_b64_tr_b16 a[156:157], v10 offset:2048
  ds_read_b64_tr_b16 a[158:159], v10 offset:3072
  v_mfma_f32_16x16x32_bf16 v[56:59], a[172:175], a[24:27], v[56:59]
  s_waitcnt vmcnt(4) lgkmcnt(6)
  buffer_store_dwordx4 v[242:245], v234, s[24:27], s45 offen sc1
  v_mfma_f32_16x16x32_bf16 v[60:63], a[172:175], a[28:31], v[60:63]
  s_barrier
  v_mfma_f32_16x16x32_bf16 v[48:51], a[144:147], a[32:35], v[48:51]
  ds_read_b64_tr_b16 a[160:161], v9 offset:4096
  v_cvt_pk_bf16_f32 v218, v108, v109
  v_cvt_pk_bf16_f32 v219, v110, v111
  v_mfma_f32_16x16x32_bf16 v[52:55], a[144:147], a[36:39], v[52:55]
  s_waitcnt lgkmcnt(5)
  ds_read_b64_tr_b16 a[162:163], v9 offset:5120
  v_permlane16_swap_b32 v216, v218
  v_mfma_f32_16x16x32_bf16 v[56:59], a[148:151], a[32:35], v[56:59]
  s_mov_b32 s45, 14336
  buffer_store_dwordx2 a[224:225], v237, s[32:35], 0 offen sc1
  v_mfma_f32_16x16x32_bf16 v[60:63], a[148:151], a[36:39], v[60:63]
  s_waitcnt lgkmcnt(2)
  ds_read_b64_tr_b16 a[164:165], v10 offset:4096
  ds_read_b64_tr_b16 a[166:167], v10 offset:5120
  v_mfma_f32_16x16x32_bf16 v[48:51], a[152:155], a[40:43], v[48:51]
L3_pad11:
  s_cmp_lg_u32 s82, 0
  s_cbranch_scc1 L3_main
  v_permlane16_swap_b32 v217, v219
  v_cvt_pk_bf16_f32 v246, v116, v117
  v_mfma_f32_16x16x32_bf16 v[52:55], a[152:155], a[44:47], v[52:55]
  ds_read_b64_tr_b16 a[168:169], v9 offset:6144
  ds_read_b64_tr_b16 a[170:171], v9 offset:7168
  v_cvt_pk_bf16_f32 v247, v118, v119
  v_mfma_f32_16x16x32_bf16 v[56:59], a[156:159], a[40:43], v[56:59]
  buffer_store_dwordx4 v[216:219], v234, s[24:27], s45 offen sc1
  v_mfma_f32_16x16x32_bf16 v[60:63], a[156:159], a[44:47], v[60:63]
  s_waitcnt lgkmcnt(4)
  s_mov_b32 s45, 15360
  ds_read_b64_tr_b16 a[172:173], v10 offset:6144
  ds_read_b64_tr_b16 a[174:175], v10 offset:7168
  v_cvt_pk_bf16_f32 v248, v124, v125
  v_mfma_f32_16x16x32_bf16 v[48:51], a[160:163], a[48:51], v[48:51]
  v_cvt_pk_bf16_f32 v249, v126, v127
  v_mfma_f32_16x16x32_bf16 v[52:55], a[160:163], a[52:55], v[52:55]
  s_waitcnt lgkmcnt(4)
  ds_read_b64_tr_b16 a[144:145], v9 offset:8192
  ds_read_b64_tr_b16 a[146:147], v9 offset:9216
  v_permlane16_swap_b32 v246, v248
  v_permlane16_swap_b32 v247, v249
  v_mfma_f32_16x16x32_bf16 v[56:59], a[164:167], a[48:51], v[56:59]
  buffer_store_dwordx4 v[246:249], v234, s[24:27], s45 offen sc1
  v_mfma_f32_16x16x32_bf16 v[60:63], a[164:167], a[52:55], v[60:63]
  s_waitcnt lgkmcnt(4)
  ds_read_b64_tr_b16 a[148:149], v10 offset:8192
  ds_read_b64_tr_b16 a[150:151], v10 offset:9216
  v_cvt_pk_bf16_f32 v220, v132, v133
  v_mfma_f32_16x16x32_bf16 v[48:51], a[168:171], a[56:59], v[48:51]
  ds_read_b64_tr_b16 a[152:153], v9 offset:10240
  v_cvt_pk_bf16_f32 v221, v134, v135
  v_cvt_pk_bf16_f32 v222, v140, v141
  v_mfma_f32_16x16x32_bf16 v[52:55], a[168:171], a[60:63], v[52:55]
  s_waitcnt lgkmcnt(5)
  ds_read_b64_tr_b16 a[154:155], v9 offset:11264
  v_cvt_pk_bf16_f32 v223, v142, v143
  v_mfma_f32_16x16x32_bf16 v[56:59], a[172:175], a[56:59], v[56:59]
  s_mov_b32 s45, 16384
  ds_read_b64_tr_b16 a[156:157], v10 offset:10240
  v_permlane16_swap_b32 v220, v222
  v_mfma_f32_16x16x32_bf16 v[60:63], a[172:175], a[60:63], v[60:63]
  s_waitcnt lgkmcnt(5)
  ds_read_b64_tr_b16 a[158:159], v10 offset:11264
  v_permlane16_swap_b32 v221, v223
  v_mfma_f32_16x16x32_bf16 v[48:51], a[144:147], v[208:211], v[48:51]
  v_mfma_f32_16x16x32_bf16 v[52:55], a[144:147], v[212:215], v[52:55]
  s_waitcnt lgkmcnt(4)
  v_mfma_f32_16x16x32_bf16 v[56:59], a[148:151], v[208:211], v[56:59]
  buffer_store_dwordx4 v[220:223], v234, s[24:27], s45 offen sc1
  v_mfma_f32_16x16x32_bf16 v[60:63], a[148:151], v[212:215], v[60:63]
  s_waitcnt lgkmcnt(2)
  v_mfma_f32_16x16x32_bf16 v[48:51], a[152:155], a[64:67], v[48:51]
  v_mfma_f32_16x16x32_bf16 v[52:55], a[152:155], a[68:71], v[52:55]
  s_waitcnt lgkmcnt(0)
  v_mfma_f32_16x16x32_bf16 v[56:59], a[156:159], a[64:67], v[56:59]
  s_mov_b32 s45, 8192
  v_mfma_f32_16x16x32_bf16 v[60:63], a[156:159], a[68:71], v[60:63]
  s_nop 2
  v_cvt_pk_bf16_f32 v16, v48, v49
  v_cvt_pk_bf16_f32 v17, v50, v51
  s_nop 0
  v_cvt_pk_bf16_f32 v18, v56, v57
  v_cvt_pk_bf16_f32 v19, v58, v59
  s_nop 0
  v_permlane16_swap_b32 v16, v18
  v_permlane16_swap_b32 v17, v19
  buffer_store_dwordx4 v[16:19], v234, s[24:27], s45 offen sc1
  v_cvt_pk_bf16_f32 v20, v52, v53
  v_cvt_pk_bf16_f32 v21, v54, v55
  v_cvt_pk_bf16_f32 v22, v60, v61
  v_cvt_pk_bf16_f32 v23, v62, v63
  s_nop 0
  v_permlane16_swap_b32 v20, v22
  v_permlane16_swap_b32 v21, v23
  s_mov_b32 s45, 17408
  buffer_store_dwordx4 v[20:23], v234, s[24:27], s45 offen sc1
  s_lshl_b32 s46, 1, s4
  s_xor_b32 s46, s46, 0xff
  v_and_b32 v17, 7, v0
  v_and_b32 v25, 8, v0
  v_lshl_add_u32 v17, s6, 3, v17
  v_lshl_add_u32 v17, v25, 1, v17
  v_lshlrev_b32 v17, 3, v17
  v_accvgpr_read_b32 v22, a224
  v_accvgpr_read_b32 v23, a225
  v_lshlrev_b32 v24, 4, v0
  s_mul_i32 s49, s6, 640
  s_lshl_b32 s50, s3, 6
  s_add_u32 s49, s49, s50
  s_lshl_b32 s50, s6, 6
  s_add_u32 s50, s50, 512
  s_cmp_lg_u32 s3, 3
  s_cbranch_scc1 L3_w0
  buffer_load_dwordx2 v[20:21], v17, s[32:35], 0 offen offset:2816 sc1
  s_waitcnt vmcnt(0)
  v_cmp_ne_u64 s[74:75], v[20:21], v[22:23]
  s_nop 3
L3_poll0:
  s_and_b32 s48, s74, s46
  s_cbranch_scc0 L3_seen0
  s_add_u32 s44, s44, 1
  s_cmp_ge_u32 s44, 0x40000
  s_cbranch_scc1 L3_seen0
  buffer_load_dwordx2 v[20:21], v17, s[32:35], 0 offen offset:2816 sc1
  s_waitcnt vmcnt(0)
  v_cmp_ne_u64 s[74:75], v[20:21], v[22:23]
  s_nop 3
  s_branch L3_poll0
L3_seen0:
L3_w0:
  s_waitcnt vmcnt(0)
  s_barrier
  buffer_store_dwordx2 v[22:23], v237, s[32:35], 0 offen offset:128 sc1
  s_mov_b32 s40, 0
  buffer_load_dwordx4 a[0:3], v24, s[28:31], s40 offen sc1
  s_mov_b32 s40, 73728
  buffer_load_dwordx4 a[4:7], v24, s[28:31], s40 offen sc1
  s_mov_b32 s40, 147456
  buffer_load_dwordx4 a[8:11], v24, s[28:31], s40 offen sc1
  s_mov_b32 s40, 221184
  buffer_load_dwordx4 a[12:15], v24, s[28:31], s40 offen sc1
  s_mov_b32 s40, 294912
  buffer_load_dwordx4 a[16:19], v24, s[28:31], s40 offen sc1
  s_mov_b32 s40, 368640
  buffer_load_dwordx4 a[20:23], v24, s[28:31], s40 offen sc1
  s_mov_b32 s40, 442368
  buffer_load_dwordx4 a[24:27], v24, s[28:31], s40 offen sc1
  s_mov_b32 s40, 516096
  buffer_load_dwordx4 a[28:31], v24, s[28:31], s40 offen sc1
  s_cmp_lg_u32 s3, 3
  s_cbranch_scc1 L3_w1
  s_lshl_b32 s46, s46, 8
  s_mov_b32 s74, -1
L3_poll1:
  s_and_b32 s48, s74, s46
  s_cbranch_scc0 L3_seen1
  s_add_u32 s44, s44, 1
  s_cmp_ge_u32 s44, 0x40000
  s_cbranch_scc1 L3_seen1
  buffer_load_dwordx2 v[20:21], v17, s[32:35], 0 offen offset:2816 sc1
  s_waitcnt vmcnt(0)
  v_cmp_ne_u64 s[74:75], v[20:21], v[22:23]
  s_nop 3
  s_branch L3_poll1
L3_seen1:
  s_or_b32 s48, s4, s6
  s_cbranch_scc1 L3_w1
  buffer_store_dword v22, v237, s[32:35], 0 offen offset:768 sc1
L3_w1:
  s_barrier
  s_mov_b32 s40, 4096
  buffer_load_dwordx4 a[32:35], v24, s[28:31], s40 offen sc1
  s_mov_b32 s40, 77824
  buffer_load_dwordx4 a[36:39], v24, s[28:31], s40 offen sc1
  s_mov_b32 s40, 151552
  buffer_load_dwordx4 a[40:43], v24, s[28:31], s40 offen sc1
  s_mov_b32 s40, 225280
  buffer_load_dwordx4 a[44:47], v24, s[28:31], s40 offen sc1
  s_mov_b32 s40, 299008
  buffer_load_dwordx4 a[48:51], v24, s[28:31], s40 offen sc1
  s_mov_b32 s40, 372736
  buffer_load_dwordx4 a[52:55], v24, s[28:31], s40 offen sc1
  s_mov_b32 s40, 446464
  buffer_load_dwordx4 a[56:59], v24, s[28:31], s40 offen sc1
  s_mov_b32 s40, 520192
  buffer_load_dwordx4 a[60:63], v24, s[28:31], s40 offen sc1
  s_cmp_lg_u32 s3, 0
  s_cbranch_scc0 L3_zero
  v_mfma_f32_16x16x32_bf16 v[32:35], a[216:219], a[228:231], 0
  v_mfma_f32_16x16x32_bf16 v[36:39], a[220:223], a[228:231], 0
  s_waitcnt vmcnt(15)
  v_mfma_f32_16x16x32_bf16 v[32:35], a[216:219], a[0:3], v[32:35]
  v_mfma_f32_16x16x32_bf16 v[36:39], a[220:223], a[0:3], v[36:39]
  s_waitcnt vmcnt(14)
  v_mfma_f32_16x16x32_bf16 v[32:35], a[216:219], a[4:7], v[32:35]
  v_mfma_f32_16x16x32_bf16 v[36:39], a[220:223], a[4:7], v[36:39]
  s_waitcnt vmcnt(13)
  v_mfma_f32_16x16x32_bf16 v[32:35], a[216:219], a[8:11], v[32:35]
  v_mfma_f32_16x16x32_bf16 v[36:39], a[220:223], a[8:11], v[36:39]
  s_waitcnt vmcnt(12)
  v_mfma_f32_16x16x32_bf16 v[32:35], a[216:219], a[12:15], v[32:35]
  v_mfma_f32_16x16x32_bf16 v[36:39], a[220:223], a[12:15], v[36:39]
  s_waitcnt vmcnt(11)
  v_mfma_f32_16x16x32_bf16 v[32:35], a[216:219], a[16:19], v[32:35]
  v_mfma_f32_16x16x32_bf16 v[36:39], a[220:223], a[16:19], v[36:39]
  s_waitcnt vmcnt(10)
  v_mfma_f32_16x16x32_bf16 v[32:35], a[216:219], a[20:23], v[32:35]
  v_mfma_f32_16x16x32_bf16 v[36:39], a[220:223], a[20:23], v[36:39]
  s_waitcnt vmcnt(9)
  v_mfma_f32_16x16x32_bf16 v[32:35], a[216:219], a[24:27], v[32:35]
  v_mfma_f32_16x16x32_bf16 v[36:39], a[220:223], a[24:27], v[36:39]
  s_waitcnt vmcnt(8)
  v_mfma_f32_16x16x32_bf16 v[32:35], a[216:219], a[28:31], v[32:35]
  v_mfma_f32_16x16x32_bf16 v[36:39], a[220:223], a[28:31], v[36:39]
  s_nop 6
  v_cvt_pk_bf16_f32 v56, v32, v33
  v_cvt_pk_bf16_f32 v57, v34, v35
  v_cvt_pk_bf16_f32 v58, v36, v37
  v_cvt_pk_bf16_f32 v59, v38, v39
  buffer_store_dwordx4 v[56:59], v15, s[36:39], s49 offen offset:0 sc1
  v_mfma_f32_16x16x32_bf16 v[40:43], a[216:219], a[232:235], 0
  v_mfma_f32_16x16x32_bf16 v[44:47], a[220:223], a[232:235], 0
  s_waitcnt vmcnt(8)
  v_mfma_f32_16x16x32_bf16 v[40:43], a[216:219], a[32:35], v[40:43]
  v_mfma_f32_16x16x32_bf16 v[44:47], a[220:223], a[32:35], v[44:47]
  s_waitcnt vmcnt(7)
  v_mfma_f32_16x16x32_bf16 v[40:43], a[216:219], a[36:39], v[40:43]
  v_mfma_f32_16x16x32_bf16 v[44:47], a[220:223], a[36:39], v[44:47]
  s_waitcnt vmcnt(6)
  v_mfma_f32_16x16x32_bf16 v[40:43], a[216:219], a[40:43], v[40:43]
  v_mfma_f32_16x16x32_bf16 v[44:47], a[220:223], a[40:43], v[44:47]
  s_waitcnt vmcnt(5)
  v_mfma_f32_16x16x32_bf16 v[40:43], a[216:219], a[44:47], v[40:43]
  v_mfma_f32_16x16x32_bf16 v[44:47], a[220:223], a[44:47], v[44:47]
  s_waitcnt vmcnt(4)
  v_mfma_f32_16x16x32_bf16 v[40:43], a[216:219], a[48:51], v[40:43]
  v_mfma_f32_16x16x32_bf16 v[44:47], a[220:223], a[48:51], v[44:47]
  s_waitcnt vmcnt(3)
  v_mfma_f32_16x16x32_bf16 v[40:43], a[216:219], a[52:55], v[40:43]
  v_mfma_f32_16x16x32_bf16 v[44:47], a[220:223], a[52:55], v[44:47]
  s_waitcnt vmcnt(2)
  v_mfma_f32_16x16x32_bf16 v[40:43], a[216:219], a[56:59], v[40:43]
  v_mfma_f32_16x16x32_bf16 v[44:47], a[220:223], a[56:59], v[44:47]
  s_waitcnt vmcnt(1)
  v_mfma_f32_16x16x32_bf16 v[40:43], a[216:219], a[60:63], v[40:43]
  v_mfma_f32_16x16x32_bf16 v[44:47], a[220:223], a[60:63], v[44:47]
  s_nop 6
  v_cvt_pk_bf16_f32 v60, v40, v41
  v_cvt_pk_bf16_f32 v61, v42, v43
  v_cvt_pk_bf16_f32 v62, v44, v45
  v_cvt_pk_bf16_f32 v63, v46, v47
  buffer_store_dwordx4 v[60:63], v15, s[36:39], s49 offen offset:256 sc1
  s_branch L3_fin
L3_zero:
  s_mov_b32 s40, 8192
  buffer_load_dwordx4 a[64:67], v233, s[28:31], s40 offen sc1
  s_mov_b32 s40, 81920
  buffer_load_dwordx4 a[68:71], v233, s[28:31], s40 offen sc1
  s_mov_b32 s40, 155648
  buffer_load_dwordx4 a[72:75], v233, s[28:31], s40 offen sc1
  s_mov_b32 s40, 229376
  buffer_load_dwordx4 a[76:79], v233, s[28:31], s40 offen sc1
  s_mov_b32 s40, 303104
  buffer_load_dwordx4 a[80:83], v233, s[28:31], s40 offen sc1
  s_mov_b32 s40, 376832
  buffer_load_dwordx4 a[84:87], v233, s[28:31], s40 offen sc1
  s_mov_b32 s40, 450560
  buffer_load_dwordx4 a[88:91], v233, s[28:31], s40 offen sc1
  s_mov_b32 s40, 524288
  buffer_load_dwordx4 a[92:95], v233, s[28:31], s40 offen sc1
  v_mfma_f32_16x16x32_bf16 v[32:35], a[216:219], a[228:231], 0
  v_mfma_f32_16x16x32_bf16 v[36:39], a[220:223], a[228:231], 0
  s_waitcnt vmcnt(23)
  v_mfma_f32_16x16x32_bf16 v[32:35], a[216:219], a[0:3], v[32:35]
  v_mfma_f32_16x16x32_bf16 v[36:39], a[220:223], a[0:3], v[36:39]
  s_waitcnt vmcnt(22)
  v_mfma_f32_16x16x32_bf16 v[32:35], a[216:219], a[4:7], v[32:35]
  v_mfma_f32_16x16x32_bf16 v[36:39], a[220:223], a[4:7], v[36:39]
  s_waitcnt vmcnt(21)
  v_mfma_f32_16x16x32_bf16 v[32:35], a[216:219], a[8:11], v[32:35]
  v_mfma_f32_16x16x32_bf16 v[36:39], a[220:223], a[8:11], v[36:39]
  s_waitcnt vmcnt(20)
  v_mfma_f32_16x16x32_bf16 v[32:35], a[216:219], a[12:15], v[32:35]
  v_mfma_f32_16x16x32_bf16 v[36:39], a[220:223], a[12:15], v[36:39]
  s_waitcnt vmcnt(19)
  v_mfma_f32_16x16x32_bf16 v[32:35], a[216:219], a[16:19], v[32:35]
  v_mfma_f32_16x16x32_bf16 v[36:39], a[220:223], a[16:19], v[36:39]
  s_waitcnt vmcnt(18)
  v_mfma_f32_16x16x32_bf16 v[32:35], a[216:219], a[20:23], v[32:35]
  v_mfma_f32_16x16x32_bf16 v[36:39], a[220:223], a[20:23], v[36:39]
  s_waitcnt vmcnt(17)
  v_mfma_f32_16x16x32_bf16 v[32:35], a[216:219], a[24:27], v[32:35]
  v_mfma_f32_16x16x32_bf16 v[36:39], a[220:223], a[24:27], v[36:39]
  s_waitcnt vmcnt(16)
  v_mfma_f32_16x16x32_bf16 v[32:35], a[216:219], a[28:31], v[32:35]
  v_mfma_f32_16x16x32_bf16 v[36:39], a[220:223], a[28:31], v[36:39]
  s_nop 6
  v_cvt_pk_bf16_f32 v56, v32, v33
  v_cvt_pk_bf16_f32 v57, v34, v35
  v_cvt_pk_bf16_f32 v58, v36, v37
  v_cvt_pk_bf16_f32 v59, v38, v39
  buffer_store_dwordx4 v[56:59], v15, s[36:39], s49 offen offset:0 sc1
  v_mfma_f32_16x16x32_bf16 v[40:43], a[216:219], a[232:235], 0
  v_mfma_f32_16x16x32_bf16 v[44:47], a[220:223], a[232:235], 0
  s_waitcnt vmcnt(16)
  v_mfma_f32_16x16x32_bf16 v[40:43], a[216:219], a[32:35], v[40:43]
  v_mfma_f32_16x16x32_bf16 v[44:47], a[220:223], a[32:35], v[44:47]
  s_waitcnt vmcnt(15)
  v_mfma_f32_16x16x32_bf16 v[40:43], a[216:219], a[36:39], v[40:43]
  v_mfma_f32_16x16x32_bf16 v[44:47], a[220:223], a[36:39], v[44:47]
  s_waitcnt vmcnt(14)
  v_mfma_f32_16x16x32_bf16 v[40:43], a[216:219], a[40:43], v[40:43]
  v_mfma_f32_16x16x32_bf16 v[44:47], a[220:223], a[40:43], v[44:47]
  s_waitcnt vmcnt(13)
  v_mfma_f32_16x16x32_bf16 v[40:43], a[216:219], a[44:47], v[40:43]
  v_mfma_f32_16x16x32_bf16 v[44:47], a[220:223], a[44:47], v[44:47]
  s_waitcnt vmcnt(12)
  v_mfma_f32_16x16x32_bf16 v[40:43], a[216:219], a[48:51], v[40:43]
  v_mfma_f32_16x16x32_bf16 v[44:47], a[220:223], a[48:51], v[44:47]
  s_waitcnt vmcnt(11)
  v_mfma_f32_16x16x32_bf16 v[40:43], a[216:219], a[52:55], v[40:43]
  v_mfma_f32_16x16x32_bf16 v[44:47], a[220:223], a[52:55], v[44:47]
  s_waitcnt vmcnt(10)
  v_mfma_f32_16x16x32_bf16 v[40:43], a[216:219], a[56:59], v[40:43]
  v_mfma_f32_16x16x32_bf16 v[44:47], a[220:223], a[56:59], v[44:47]
  s_waitcnt vmcnt(9)
  v_mfma_f32_16x16x32_bf16 v[40:43], a[216:219], a[60:63], v[40:43]
  v_mfma_f32_16x16x32_bf16 v[44:47], a[220:223], a[60:63], v[44:47]
  s_nop 6
  v_cvt_pk_bf16_f32 v60, v40, v41
  v_cvt_pk_bf16_f32 v61, v42, v43
  v_cvt_pk_bf16_f32 v62, v44, v45
  v_cvt_pk_bf16_f32 v63, v46, v47
  buffer_store_dwordx4 v[60:63], v15, s[36:39], s49 offen offset:256 sc1
  s_waitcnt vmcnt(2)
  v_mfma_f32_16x16x32_bf16 v[48:51], a[216:219], a[236:239], 0
  v_mfma_f32_16x16x32_bf16 v[52:55], a[220:223], a[236:239], 0
  v_mfma_f32_16x16x32_bf16 v[48:51], a[216:219], a[64:67], v[48:51]
  v_mfma_f32_16x16x32_bf16 v[52:55], a[220:223], a[64:67], v[52:55]
  v_mfma_f32_16x16x32_bf16 v[48:51], a[216:219], a[68:71], v[48:51]
  v_mfma_f32_16x16x32_bf16 v[52:55], a[220:223], a[68:71], v[52:55]
  v_mfma_f32_16x16x32_bf16 v[48:51], a[216:219], a[72:75], v[48:51]
  v_mfma_f32_16x16x32_bf16 v[52:55], a[220:223], a[72:75], v[52:55]
  v_mfma_f32_16x16x32_bf16 v[48:51], a[216:219], a[76:79], v[48:51]
  v_mfma_f32_16x16x32_bf16 v[52:55], a[220:223], a[76:79], v[52:55]
  v_mfma_f32_16x16x32_bf16 v[48:51], a[216:219], a[80:83], v[48:51]
  v_mfma_f32_16x16x32_bf16 v[52:55], a[220:223], a[80:83], v[52:55]
  v_mfma_f32_16x16x32_bf16 v[48:51], a[216:219], a[84:87], v[48:51]
  v_mfma_f32_16x16x32_bf16 v[52:55], a[220:223], a[84:87], v[52:55]
  v_mfma_f32_16x16x32_bf16 v[48:51], a[216:219], a[88:91], v[48:51]
  v_mfma_f32_16x16x32_bf16 v[52:55], a[220:223], a[88:91], v[52:55]
  v_mfma_f32_16x16x32_bf16 v[48:51], a[216:219], a[92:95], v[48:51]
  v_mfma_f32_16x16x32_bf16 v[52:55], a[220:223], a[92:95], v[52:55]
  s_nop 6
  v_cvt_pk_bf16_f32 v64, v48, v49
  v_cvt_pk_bf16_f32 v65, v50, v51
  v_cvt_pk_bf16_f32 v66, v52, v53
  v_cvt_pk_bf16_f32 v67, v54, v55
  buffer_store_dwordx4 v[64:67], v15, s[36:39], s50 offen offset:0 sc1
L3_fin:
L3_end:
s_endpgm
L3_codeend:
.section .rodata,"a"
.p2align 6
.amdhsa_kernel sequential_preLN__ssm_conv_h3__glu_gated_swiglu__prompt_kernel
  .amdhsa_next_free_vgpr 512
  .amdhsa_next_free_sgpr 102
  .amdhsa_accum_offset 256
  .amdhsa_group_segment_fixed_size 0
  .amdhsa_kernarg_size 104
  .amdhsa_user_sgpr_count 2
  .amdhsa_user_sgpr_kernarg_segment_ptr 1
  .amdhsa_system_sgpr_workgroup_id_x 1
.end_amdhsa_kernel
.text
```
